```python
import torch

def _softmax(x, axis=-1):
    return torch.softmax(x, dim=axis)
def _gelu(x):
    return torch.nn.functional.gelu(x, approximate="tanh")
def _silu(x):
    return torch.nn.functional.silu(x)
def _sigmoid(x):
    return torch.sigmoid(x)
def _layernorm(x, axis=-1, eps=1e-5):
    m = x.mean(dim=axis, keepdim=True)
    v = x.var(dim=axis, keepdim=True, unbiased=False)
    return (x - m) / torch.sqrt(v + eps)
def _scatter_add(tgt, idx, src, axis=0):
    return tgt.clone().index_add_(axis, idx, src)
def _segment_sum(src, seg, n):
    out = torch.zeros((n,) + src.shape[1:], dtype=src.dtype)
    return out.index_add_(0, seg, src)
def _pad(x, pw):
    flat = tuple(v for pair in reversed(pw) for v in pair)
    return torch.nn.functional.pad(x, flat)

kernel_name = 'sequential_preLN__mha_block__glu_gated_reglu__prompt'

def setup_inputs():

    _w = (lambda a: (lambda t: t.to(torch.bfloat16) if t.is_floating_point() else t)(torch.as_tensor(a)))
    def _A_setup():
        B, S, D, H = 1, 2048, 1024, 32
        return {
            "x": _w((lambda *s: torch.randn(*s, dtype=torch.bfloat16) * 0.05)(B, S, D)),
            "wqkv": _w((lambda *s: torch.randn(*s, dtype=torch.bfloat16) * 0.05)(D, 3 * D)),
            "wo": _w((lambda *s: torch.randn(*s, dtype=torch.bfloat16) * 0.05)(D, D)),
        }
    _A_in = _A_setup()

    def _B_setup():
        B, S, D, F = 1, 2048, 1024, 3584
        return {
            "x": _w((lambda *s: torch.randn(*s, dtype=torch.bfloat16) * 0.05)(B, S, D)),
            "W_gate": _w((lambda *s: torch.randn(*s, dtype=torch.bfloat16) * 0.8)(D, F) * (2.0 / D) ** 0.5),
            "W_up": _w((lambda *s: torch.randn(*s, dtype=torch.bfloat16) * 0.8)(D, F) * (2.0 / D) ** 0.5),
            "W_down": _w((lambda *s: torch.randn(*s, dtype=torch.bfloat16) * 0.8)(F, D) * (1.0 / F) ** 0.5),
        }
    _B_in = _B_setup()

    return {
        "A_x": _A_in["x"],
        "A_wqkv": _A_in["wqkv"],
        "A_wo": _A_in["wo"],
        "B_x": _B_in["x"],
        "B_W_gate": _B_in["W_gate"],
        "B_W_up": _B_in["W_up"],
        "B_W_down": _B_in["W_down"],
    }

def reference(A_x, A_wqkv, A_wo, B_x, B_W_gate, B_W_up, B_W_down):
    def _A_ref(x, wqkv, wo):
        B, S, D = x.shape
        H = 32
        Dh = D // H
        qkv = (lambda x, *d: x.permute(*d))((x @ wqkv).reshape(B, S, 3, H, Dh), 2, 0, 3, 1, 4)
        q, k, v = qkv[0], qkv[1], qkv[2]
        scores = torch.einsum("bhqd,bhkd->bhqk", q, k) * (Dh ** -0.5)
        p = _softmax(scores, axis=-1)
        o = torch.einsum("bhqk,bhkd->bhqd", p, v)
        return (lambda x, *d: x.permute(*d))(o, 0, 2, 1, 3).reshape(B, S, D) @ wo

    def _B_ref(x, W_gate, W_up, W_down):
        gate = torch.einsum("bsd,df->bsf", x, W_gate)
        up = torch.einsum("bsd,df->bsf", x, W_up)
        gate = gate * (lambda x, dt: x.to(dt))(gate > 0, gate.dtype)
        h = gate * up
        return torch.einsum("bsf,fd->bsd", h, W_down)

    x = A_x
    h = x + _A_ref(_layernorm(x, axis=-1), A_wqkv, A_wo)
    h2 = h + _B_ref(_layernorm(h, axis=-1), B_W_gate, B_W_up, B_W_down)
    return h2
```

```asm
; @launch grid=(256,1,1) block=(256,1,1) lds=163840
.amdgcn_target "amdgcn-amd-amdhsa--gfx950"
.text
.globl sequential_preLN__mha_block__glu_gated_reglu__prompt_kernel
.p2align 8
.type sequential_preLN__mha_block__glu_gated_reglu__prompt_kernel,@function
sequential_preLN__mha_block__glu_gated_reglu__prompt_kernel:
  s_cmp_ge_u32 s2, 256
  s_cbranch_scc1 L_end
  s_getpc_b64 s[58:59]
L_base:
  s_load_dwordx16 s[64:79], s[0:1], 0
  s_load_dwordx4 s[80:83], s[0:1], 64
  v_lshrrev_b32 v1, 6, v0
  v_and_b32 v5, 31, v0
  v_readfirstlane_b32 s5, v1
  v_and_b32 v1, 63, v0
  v_lshlrev_b32 v2, 4, v1
  v_and_b32 v3, 15, v1
  v_lshrrev_b32 v4, 4, v1
  v_lshrrev_b32 v6, 5, v1
  s_and_b32 s3, s2, 7
  s_lshr_b32 s4, s2, 3
L_P1:
  s_and_b32 s32, s3, 1
  s_lshl_b32 s32, s32, 3
  s_and_b32 s29, s4, 7
  s_add_u32 s32, s32, s29
  s_lshr_b32 s33, s3, 1
  s_lshl_b32 s33, s33, 2
  s_lshr_b32 s29, s4, 3
  s_add_u32 s33, s33, s29
  s_and_b32 s34, s5, 1
  s_lshr_b32 s35, s5, 1
  v_lshrrev_b32 v22, 3, v1
  s_lshl_b32 s29, s32, 7
  s_lshl_b32 s28, s5, 5
  s_add_u32 s29, s29, s28
  v_add_u32 v23, s29, v22
  v_lshlrev_b32 v23, 11, v23
  v_and_b32 v24, 7, v1
  v_xor_b32 v24, v24, v4
  v_xor_b32 v25, 4, v24
  v_lshl_add_u32 v8, v24, 4, v23
  v_lshl_add_u32 v25, v25, 4, v23
  v_add_u32 v9, 15360, v25
  v_add_u32 v10, 30720, v8
  v_add_u32 v11, 46080, v25
  v_mul_u32_u24 v22, 6144, v22
  v_and_b32 v23, 1, v4
  v_lshlrev_b32 v23, 1, v23
  v_and_b32 v24, 7, v1
  v_xor_b32 v23, v23, v24
  s_mul_i32 s31, s5, 3
  s_and_b32 s30, s33, 12
  s_add_u32 s28, s31, 0
  s_lshr_b32 s29, s28, 2
  s_mul_i32 s27, s29, 0
  s_add_u32 s27, s27, s33
  s_and_b32 s27, s27, 3
  s_or_b32 s27, s27, s30
  s_lshl_b32 s29, s29, 4
  s_add_u32 s29, s29, s27
  s_lshl_b32 s29, s29, 7
  s_and_b32 s28, s28, 3
  s_and_b32 s27, s28, 1
  s_lshl_b32 s27, s27, 2
  s_mul_i32 s28, s28, 49152
  s_add_u32 s28, s28, s29
  s_sub_u32 s28, s28, 0
  v_xor_b32 v24, s27, v23
  v_lshl_add_u32 v24, v24, 4, v22
  v_add_u32 v12, s28, v24
  s_add_u32 s28, s31, 1
  s_lshr_b32 s29, s28, 2
  s_mul_i32 s27, s29, 0
  s_add_u32 s27, s27, s33
  s_and_b32 s27, s27, 3
  s_or_b32 s27, s27, s30
  s_lshl_b32 s29, s29, 4
  s_add_u32 s29, s29, s27
  s_lshl_b32 s29, s29, 7
  s_and_b32 s28, s28, 3
  s_and_b32 s27, s28, 1
  s_lshl_b32 s27, s27, 2
  s_mul_i32 s28, s28, 49152
  s_add_u32 s28, s28, s29
  s_sub_u32 s28, s28, 1024
  v_xor_b32 v24, s27, v23
  v_lshl_add_u32 v24, v24, 4, v22
  v_add_u32 v13, s28, v24
  s_add_u32 s28, s31, 2
  s_lshr_b32 s29, s28, 2
  s_mul_i32 s27, s29, 0
  s_add_u32 s27, s27, s33
  s_and_b32 s27, s27, 3
  s_or_b32 s27, s27, s30
  s_lshl_b32 s29, s29, 4
  s_add_u32 s29, s29, s27
  s_lshl_b32 s29, s29, 7
  s_and_b32 s28, s28, 3
  s_and_b32 s27, s28, 1
  s_lshl_b32 s27, s27, 2
  s_mul_i32 s28, s28, 49152
  s_add_u32 s28, s28, s29
  s_sub_u32 s28, s28, 2048
  v_xor_b32 v24, s27, v23
  v_lshl_add_u32 v24, v24, 4, v22
  v_add_u32 v14, s28, v24
  s_add_u32 s27, s33, 0
  s_and_b32 s27, s27, 3
  s_or_b32 s60, s27, s30
  s_add_u32 s27, s33, 0
  s_and_b32 s27, s27, 3
  s_or_b32 s61, s27, s30
  s_add_u32 s27, s33, 0
  s_and_b32 s27, s27, 3
  s_or_b32 s62, s27, s30
  s_waitcnt lgkmcnt(0)
  s_mov_b32 s12, s64
  s_mov_b32 s13, s65
  s_mov_b32 s14, 4194304
  s_mov_b32 s15, 0x20000
  s_mov_b32 s16, s66
  s_mov_b32 s17, s67
  s_mov_b32 s18, 6291456
  s_mov_b32 s19, 0x20000
  s_mov_b32 s36, 0
  s_mov_b32 s37, 0
  s_lshl_b32 s40, s5, 12
  s_mul_i32 s41, s5, 3072
  s_add_u32 s41, s41, 65536
  s_lshl_b32 s42, s32, 7
  s_lshl_b32 s28, s33, 3
  s_add_u32 s42, s42, s28
  s_lshl_b32 s28, s5, 1
  s_add_u32 s42, s42, s28
  v_lshlrev_b32 v22, 11, v6
  v_lshl_add_u32 v22, v5, 4, v22
  s_lshl_b32 s28, s42, 11
  buffer_load_dwordx4 v[124:127], v22, s[12:15], s28 offen offset:0
  buffer_load_dwordx4 v[128:131], v22, s[12:15], s28 offen offset:512
  buffer_load_dwordx4 v[132:135], v22, s[12:15], s28 offen offset:1024
  buffer_load_dwordx4 v[136:139], v22, s[12:15], s28 offen offset:1536
  s_add_u32 m0, s40, 0
  s_mov_b32 s36, 0
  buffer_load_dwordx4 v8, s[12:15], s36 offen offset:0 lds
  buffer_load_dwordx4 v9, s[12:15], s36 offen offset:1024 lds
  buffer_load_dwordx4 v10, s[12:15], s36 offen offset:2048 lds
  buffer_load_dwordx4 v11, s[12:15], s36 offen offset:3072 lds
  s_add_u32 m0, s41, 0
  s_mov_b32 s37, 0
  buffer_load_dwordx4 v12, s[16:19], s37 offen offset:0 lds
  buffer_load_dwordx4 v13, s[16:19], s37 offen offset:1024 lds
  buffer_load_dwordx4 v14, s[16:19], s37 offen offset:2048 lds
  s_add_u32 m0, s41, 12288
  s_mov_b32 s37, 196608
  buffer_load_dwordx4 v12, s[16:19], s37 offen offset:0 lds
  buffer_load_dwordx4 v13, s[16:19], s37 offen offset:1024 lds
  buffer_load_dwordx4 v14, s[16:19], s37 offen offset:2048 lds
  v_min_u32 v22, 17, v1
  v_mul_u32_u24 v23, 43, v22
  v_lshrrev_b32 v23, 7, v23
  v_mul_u32_u24 v24, 3, v23
  v_sub_u32 v22, v22, v24
  s_mul_i32 s28, s2, 12
  s_mul_i32 s29, s5, 3
  s_add_u32 s28, s28, s29
  v_add_u32 v22, s28, v22
  s_mov_b32 s28, 89478486
  v_mul_hi_u32 v24, v22, s28
  v_lshl_add_u32 v23, v23, 6, v24
  v_mul_u32_u24 v24, 48, v24
  v_sub_u32 v22, v22, v24
  v_mul_u32_u24 v23, 6144, v23
  v_lshl_add_u32 v22, v22, 7, v23
  s_mov_b32 s28, 393216
  buffer_load_dword v181, v22, s[16:19], s28 offen
  s_add_u32 s56, s58, L_P1-L_base
  s_addc_u32 s57, s59, 0
  v_and_b32 v182, 7, v0
  v_lshl_add_u32 v182, v182, 5, s4
  v_lshlrev_b32 v182, 7, v182
  v_min_u32 v182, L_P2-L_P1-4, v182
  global_load_dword v182, v182, s[56:57]
  s_add_u32 m0, s40, 16384
  s_mov_b32 s36, 128
  buffer_load_dwordx4 v8, s[12:15], s36 offen offset:0 lds
  buffer_load_dwordx4 v9, s[12:15], s36 offen offset:1024 lds
  buffer_load_dwordx4 v10, s[12:15], s36 offen offset:2048 lds
  buffer_load_dwordx4 v11, s[12:15], s36 offen offset:3072 lds
  s_add_u32 m0, s41, 24576
  s_mov_b32 s37, 393216
  buffer_load_dwordx4 v12, s[16:19], s37 offen offset:0 lds
  buffer_load_dwordx4 v13, s[16:19], s37 offen offset:1024 lds
  buffer_load_dwordx4 v14, s[16:19], s37 offen offset:2048 lds
  s_add_u32 m0, s41, 36864
  s_mov_b32 s37, 589824
  buffer_load_dwordx4 v12, s[16:19], s37 offen offset:0 lds
  buffer_load_dwordx4 v13, s[16:19], s37 offen offset:1024 lds
  buffer_load_dwordx4 v14, s[16:19], s37 offen offset:2048 lds
  s_mov_b32 s8, s82
  s_mov_b32 s9, s83
  s_mov_b32 s10, 50331648
  s_mov_b32 s11, 0x20000
  s_mov_b32 s20, s80
  s_mov_b32 s21, s81
  s_mov_b32 s22, 256
  s_mov_b32 s23, 0x20000
  v_lshrrev_b32 v22, 1, v3
  v_xor_b32 v22, v22, v4
  s_lshl_b32 s28, s34, 13
  v_lshlrev_b32 v23, 7, v3
  v_add_u32 v23, s28, v23
  v_lshl_add_u32 v16, v22, 4, v23
  v_xor_b32 v17, 64, v16
  v_lshrrev_b32 v22, 2, v1
  v_and_b32 v22, 3, v22
  v_lshl_add_u32 v23, v4, 3, v22
  v_lshlrev_b32 v23, 7, v23
  v_lshrrev_b32 v22, 1, v22
  v_and_b32 v24, 1, v4
  v_lshl_add_u32 v22, v24, 1, v22
  s_lshl_b32 s28, s35, 1
  v_xor_b32 v22, s28, v22
  v_lshl_add_u32 v23, v22, 5, v23
  v_and_b32 v22, 3, v1
  v_lshl_add_u32 v23, v22, 3, v23
  v_add_u32 v18, 65536, v23
  v_xor_b32 v19, 32, v18
  v_add_u32 v20, 49152, v18
  v_add_u32 v21, 49152, v19
  v_lshrrev_b32 v22, 3, v5
  v_and_b32 v23, 7, v5
  v_and_b32 v24, 1, v23
  v_lshlrev_b32 v24, 4, v24
  v_mov_b32 v25, 0x3f80
  v_lshlrev_b32 v25, v24, v25
  v_cmp_eq_u32 vcc, v22, v6
  v_lshrrev_b32 v23, 1, v23
  s_nop 0
  v_cndmask_b32 v25, 0, v25, vcc
  v_cmp_eq_u32 vcc, 0, v23
  s_nop 1
  v_cndmask_b32 v24, 0, v25, vcc
  v_accvgpr_write_b32 a112, v24
  v_cmp_eq_u32 vcc, 1, v23
  s_nop 1
  v_cndmask_b32 v24, 0, v25, vcc
  v_accvgpr_write_b32 a113, v24
  v_cmp_eq_u32 vcc, 2, v23
  s_nop 1
  v_cndmask_b32 v24, 0, v25, vcc
  v_accvgpr_write_b32 a114, v24
  v_cmp_eq_u32 vcc, 3, v23
  s_nop 1
  v_cndmask_b32 v24, 0, v25, vcc
  v_accvgpr_write_b32 a115, v24
  s_waitcnt vmcnt(22)
  v_mov_b32 v156, 0
  v_mov_b32 v157, 0
  v_mov_b32 v158, 0x3f803f80
  v_dot2c_f32_bf16 v156, v124, v158
  v_dot2c_f32_bf16 v157, v124, v124
  v_dot2c_f32_bf16 v156, v125, v158
  v_dot2c_f32_bf16 v157, v125, v125
  v_dot2c_f32_bf16 v156, v126, v158
  v_dot2c_f32_bf16 v157, v126, v126
  v_dot2c_f32_bf16 v156, v127, v158
  v_dot2c_f32_bf16 v157, v127, v127
  v_dot2c_f32_bf16 v156, v128, v158
  v_dot2c_f32_bf16 v157, v128, v128
  v_dot2c_f32_bf16 v156, v129, v158
  v_dot2c_f32_bf16 v157, v129, v129
  v_dot2c_f32_bf16 v156, v130, v158
  v_dot2c_f32_bf16 v157, v130, v130
  v_dot2c_f32_bf16 v156, v131, v158
  v_dot2c_f32_bf16 v157, v131, v131
  v_dot2c_f32_bf16 v156, v132, v158
  v_dot2c_f32_bf16 v157, v132, v132
  v_dot2c_f32_bf16 v156, v133, v158
  v_dot2c_f32_bf16 v157, v133, v133
  v_dot2c_f32_bf16 v156, v134, v158
  v_dot2c_f32_bf16 v157, v134, v134
  v_dot2c_f32_bf16 v156, v135, v158
  v_dot2c_f32_bf16 v157, v135, v135
  v_dot2c_f32_bf16 v156, v136, v158
  v_dot2c_f32_bf16 v157, v136, v136
  v_dot2c_f32_bf16 v156, v137, v158
  v_dot2c_f32_bf16 v157, v137, v137
  v_dot2c_f32_bf16 v156, v138, v158
  v_dot2c_f32_bf16 v157, v138, v138
  v_dot2c_f32_bf16 v156, v139, v158
  v_dot2c_f32_bf16 v157, v139, v139
  s_nop 2
  s_nop 0
  v_add_f32_dpp v156, v156, v156 quad_perm:[1,0,3,2] row_mask:0xf bank_mask:0xf
  v_add_f32_dpp v157, v157, v157 quad_perm:[1,0,3,2] row_mask:0xf bank_mask:0xf
  s_nop 0
  v_add_f32_dpp v156, v156, v156 quad_perm:[2,3,0,1] row_mask:0xf bank_mask:0xf
  v_add_f32_dpp v157, v157, v157 quad_perm:[2,3,0,1] row_mask:0xf bank_mask:0xf
  s_nop 0
  v_add_f32_dpp v156, v156, v156 row_half_mirror row_mask:0xf bank_mask:0xf
  v_add_f32_dpp v157, v157, v157 row_half_mirror row_mask:0xf bank_mask:0xf
  s_nop 0
  v_add_f32_dpp v156, v156, v156 row_mirror row_mask:0xf bank_mask:0xf
  v_add_f32_dpp v157, v157, v157 row_mirror row_mask:0xf bank_mask:0xf
  v_mov_b32 v158, v156
  v_mov_b32 v159, v157
  s_nop 0
  v_permlane16_swap_b32 v156, v158
  v_permlane16_swap_b32 v157, v159
  v_add_f32 v156, v156, v158
  v_add_f32 v157, v157, v159
  v_mul_f32 v156, 0xba800000, v156
  v_mul_f32 v157, 0x3a800000, v157
  v_fma_f32 v157, -v156, v156, v157
  v_max_f32 v157, 0, v157
  v_add_f32 v157, 0x3727c5ac, v157
  v_rsq_f32 v157, v157
  v_lshlrev_b32 v160, 2, v6
  s_lshl_b32 s48, s42, 2
  s_add_u32 s48, s48, 38862848
  buffer_store_dword v157, v160, s[8:11], s48 offen sc1
  s_add_u32 s48, s48, 8192
  buffer_store_dword v156, v160, s[8:11], s48 offen sc1
  s_waitcnt vmcnt(14)
  s_barrier
  ds_read_b128 a[0:3], v16 offset:0
  ds_read_b128 a[4:7], v16 offset:2048
  ds_read_b128 a[8:11], v16 offset:4096
  ds_read_b128 a[12:15], v16 offset:6144
  ds_read_b64_tr_b16 a[32:33], v18 offset:0
  ds_read_b64_tr_b16 a[34:35], v18 offset:512
  ds_read_b64_tr_b16 a[36:37], v19 offset:0
  ds_read_b64_tr_b16 a[38:39], v19 offset:512
  ds_read_b64_tr_b16 a[40:41], v18 offset:4096
  ds_read_b64_tr_b16 a[42:43], v18 offset:4608
  ds_read_b64_tr_b16 a[44:45], v19 offset:4096
  ds_read_b64_tr_b16 a[46:47], v19 offset:4608
  ds_read_b64_tr_b16 a[48:49], v18 offset:8192
  ds_read_b64_tr_b16 a[50:51], v18 offset:8704
  ds_read_b64_tr_b16 a[52:53], v19 offset:8192
  ds_read_b64_tr_b16 a[54:55], v19 offset:8704
  s_waitcnt lgkmcnt(0)
  v_mfma_f32_16x16x32_bf16 v[28:31], a[32:35], a[0:3], 0
  s_add_u32 m0, s40, 32768
  ds_read_b128 a[16:19], v17 offset:0
  ds_read_b128 a[20:23], v17 offset:2048
  v_mfma_f32_16x16x32_bf16 v[52:55], a[32:35], a[4:7], 0
  s_mov_b32 s36, 256
  buffer_load_dwordx4 v8, s[12:15], s36 offen offset:0 lds
  ds_read_b128 a[24:27], v17 offset:4096
  v_mfma_f32_16x16x32_bf16 v[76:79], a[32:35], a[8:11], 0
  ds_read_b128 a[28:31], v17 offset:6144
  ds_read_b64_tr_b16 a[56:57], v18 offset:12288
  v_mfma_f32_16x16x32_bf16 v[100:103], a[32:35], a[12:15], 0
  buffer_load_dwordx4 v9, s[12:15], s36 offen offset:1024 lds
  ds_read_b64_tr_b16 a[58:59], v18 offset:12800
  v_mfma_f32_16x16x32_bf16 v[104:107], a[36:39], a[12:15], 0
  ds_read_b64_tr_b16 a[60:61], v19 offset:12288
  ds_read_b64_tr_b16 a[62:63], v19 offset:12800
  v_mfma_f32_16x16x32_bf16 v[80:83], a[36:39], a[8:11], 0
  buffer_load_dwordx4 v10, s[12:15], s36 offen offset:2048 lds
  ds_read_b64_tr_b16 a[64:65], v18 offset:16384
  v_mfma_f32_16x16x32_bf16 v[56:59], a[36:39], a[4:7], 0
  ds_read_b64_tr_b16 a[66:67], v18 offset:16896
  ds_read_b64_tr_b16 a[68:69], v19 offset:16384
  v_mfma_f32_16x16x32_bf16 v[32:35], a[36:39], a[0:3], 0
  ds_read_b64_tr_b16 a[70:71], v19 offset:16896
  ds_read_b64_tr_b16 a[72:73], v18 offset:20480
  v_mfma_f32_16x16x32_bf16 v[36:39], a[40:43], a[0:3], 0
  buffer_load_dwordx4 v11, s[12:15], s36 offen offset:3072 lds
  s_add_u32 m0, s41, 49152
  ds_read_b64_tr_b16 a[74:75], v18 offset:20992
  v_mfma_f32_16x16x32_bf16 v[60:63], a[40:43], a[4:7], 0
  s_mov_b32 s37, 786432
  ds_read_b64_tr_b16 a[76:77], v19 offset:20480
  ds_read_b64_tr_b16 a[78:79], v19 offset:20992
  v_mfma_f32_16x16x32_bf16 v[84:87], a[40:43], a[8:11], 0
  buffer_load_dwordx4 v12, s[16:19], s37 offen offset:0 lds
  buffer_load_dwordx4 v13, s[16:19], s37 offen offset:1024 lds
  v_mfma_f32_16x16x32_bf16 v[108:111], a[40:43], a[12:15], 0
  buffer_load_dwordx4 v14, s[16:19], s37 offen offset:2048 lds
  s_add_u32 m0, s41, 61440
  v_mfma_f32_16x16x32_bf16 v[112:115], a[44:47], a[12:15], 0
  s_mov_b32 s37, 983040
  buffer_load_dwordx4 v12, s[16:19], s37 offen offset:0 lds
  buffer_load_dwordx4 v13, s[16:19], s37 offen offset:1024 lds
  v_mfma_f32_16x16x32_bf16 v[88:91], a[44:47], a[8:11], 0
  buffer_load_dwordx4 v14, s[16:19], s37 offen offset:2048 lds
  v_mfma_f32_16x16x32_bf16 v[64:67], a[44:47], a[4:7], 0
  v_mfma_f32_16x16x32_bf16 v[40:43], a[44:47], a[0:3], 0
  v_mfma_f32_16x16x32_bf16 v[44:47], a[0:3], a[48:51], 0
  v_mfma_f32_16x16x32_bf16 v[68:71], a[4:7], a[48:51], 0
  v_mfma_f32_16x16x32_bf16 v[92:95], a[8:11], a[48:51], 0
  v_mfma_f32_16x16x32_bf16 v[116:119], a[12:15], a[48:51], 0
  v_mfma_f32_16x16x32_bf16 v[120:123], a[12:15], a[52:55], 0
  v_mfma_f32_16x16x32_bf16 v[96:99], a[8:11], a[52:55], 0
  v_mfma_f32_16x16x32_bf16 v[72:75], a[4:7], a[52:55], 0
  v_mfma_f32_16x16x32_bf16 v[48:51], a[0:3], a[52:55], 0
  s_waitcnt vmcnt(12) lgkmcnt(0)
  s_barrier
  v_mfma_f32_16x16x32_bf16 v[28:31], a[56:59], a[16:19], v[28:31]
  s_add_u32 m0, s41, 73728
  s_mov_b32 s37, 1179648
  buffer_load_dwordx4 v12, s[16:19], s37 offen offset:0 lds
  ds_read_b128 a[0:3], v16 offset:16384
  v_mfma_f32_16x16x32_bf16 v[52:55], a[56:59], a[20:23], v[52:55]
  ds_read_b128 a[4:7], v16 offset:18432
  ds_read_b128 a[8:11], v16 offset:20480
  v_mfma_f32_16x16x32_bf16 v[76:79], a[56:59], a[24:27], v[76:79]
  ds_read_b128 a[12:15], v16 offset:22528
  ds_read_b64_tr_b16 a[32:33], v18 offset:24576
  v_mfma_f32_16x16x32_bf16 v[100:103], a[56:59], a[28:31], v[100:103]
  buffer_load_dwordx4 v13, s[16:19], s37 offen offset:1024 lds
  ds_read_b64_tr_b16 a[34:35], v18 offset:25088
  v_mfma_f32_16x16x32_bf16 v[104:107], a[60:63], a[28:31], v[104:107]
  ds_read_b64_tr_b16 a[36:37], v19 offset:24576
  ds_read_b64_tr_b16 a[38:39], v19 offset:25088
  v_mfma_f32_16x16x32_bf16 v[80:83], a[60:63], a[24:27], v[80:83]
  buffer_load_dwordx4 v14, s[16:19], s37 offen offset:2048 lds
  s_add_u32 m0, s41, 0
  s_mov_b32 s37, 1376256
  ds_read_b64_tr_b16 a[40:41], v18 offset:28672
  v_mfma_f32_16x16x32_bf16 v[56:59], a[60:63], a[20:23], v[56:59]
  ds_read_b64_tr_b16 a[42:43], v18 offset:29184
  ds_read_b64_tr_b16 a[44:45], v19 offset:28672
  v_mfma_f32_16x16x32_bf16 v[32:35], a[60:63], a[16:19], v[32:35]
  buffer_load_dwordx4 v12, s[16:19], s37 offen offset:0 lds
  ds_read_b64_tr_b16 a[46:47], v19 offset:29184
  v_mfma_f32_16x16x32_bf16 v[36:39], a[64:67], a[16:19], v[36:39]
  ds_read_b64_tr_b16 a[48:49], v18 offset:32768
  ds_read_b64_tr_b16 a[50:51], v18 offset:33280
  v_mfma_f32_16x16x32_bf16 v[60:63], a[64:67], a[20:23], v[60:63]
  buffer_load_dwordx4 v13, s[16:19], s37 offen offset:1024 lds
  ds_read_b64_tr_b16 a[52:53], v19 offset:32768
  v_mfma_f32_16x16x32_bf16 v[84:87], a[64:67], a[24:27], v[84:87]
  ds_read_b64_tr_b16 a[54:55], v19 offset:33280
  buffer_load_dwordx4 v14, s[16:19], s37 offen offset:2048 lds
  s_add_u32 m0, s40, 49152
  s_mov_b32 s36, 384
  v_mfma_f32_16x16x32_bf16 v[108:111], a[64:67], a[28:31], v[108:111]
  buffer_load_dwordx4 v8, s[12:15], s36 offen offset:0 lds
  buffer_load_dwordx4 v9, s[12:15], s36 offen offset:1024 lds
  v_mfma_f32_16x16x32_bf16 v[112:115], a[68:71], a[28:31], v[112:115]
  buffer_load_dwordx4 v10, s[12:15], s36 offen offset:2048 lds
  buffer_load_dwordx4 v11, s[12:15], s36 offen offset:3072 lds
  v_min_u32 v22, 26, v1
  v_mul_u32_u24 v23, 43, v22
  v_mfma_f32_16x16x32_bf16 v[88:91], a[68:71], a[24:27], v[88:91]
  v_lshrrev_b32 v23, 7, v23
  v_mul_u32_u24 v24, 3, v23
  v_mfma_f32_16x16x32_bf16 v[64:67], a[68:71], a[20:23], v[64:67]
  v_sub_u32 v22, v22, v24
  s_mul_i32 s28, s2, 12
  v_mfma_f32_16x16x32_bf16 v[40:43], a[68:71], a[16:19], v[40:43]
  s_mul_i32 s29, s5, 3
  s_add_u32 s28, s28, s29
  v_mfma_f32_16x16x32_bf16 v[44:47], a[16:19], a[72:75], v[44:47]
  v_add_u32 v22, s28, v22
  s_mov_b32 s28, 89478486
  v_mfma_f32_16x16x32_bf16 v[68:71], a[20:23], a[72:75], v[68:71]
  v_mul_hi_u32 v24, v22, s28
  v_lshl_add_u32 v23, v23, 6, v24
  v_mfma_f32_16x16x32_bf16 v[92:95], a[24:27], a[72:75], v[92:95]
  v_mul_u32_u24 v24, 48, v24
  v_sub_u32 v22, v22, v24
  v_mfma_f32_16x16x32_bf16 v[116:119], a[28:31], a[72:75], v[116:119]
  v_mul_u32_u24 v23, 6144, v23
  v_lshl_add_u32 v22, v22, 7, v23
  v_mfma_f32_16x16x32_bf16 v[120:123], a[28:31], a[76:79], v[120:123]
  s_mov_b32 s28, 2752512
  buffer_load_dword v177, v22, s[16:19], s28 offen
  v_mfma_f32_16x16x32_bf16 v[96:99], a[24:27], a[76:79], v[96:99]
  v_mfma_f32_16x16x32_bf16 v[72:75], a[20:23], a[76:79], v[72:75]
  v_mfma_f32_16x16x32_bf16 v[48:51], a[16:19], a[76:79], v[48:51]
  s_waitcnt lgkmcnt(0)
  v_mfma_f32_16x16x32_bf16 v[28:31], a[32:35], a[0:3], v[28:31]
  s_add_u32 m0, s41, 12288
  ds_read_b128 a[16:19], v17 offset:16384
  v_mfma_f32_16x16x32_bf16 v[52:55], a[32:35], a[4:7], v[52:55]
  s_mov_b32 s37, 1572864
  buffer_load_dwordx4 v12, s[16:19], s37 offen offset:0 lds
  v_mfma_f32_16x16x32_bf16 v[76:79], a[32:35], a[8:11], v[76:79]
  ds_read_b128 a[20:23], v17 offset:18432
  v_mfma_f32_16x16x32_bf16 v[100:103], a[32:35], a[12:15], v[100:103]
  ds_read_b128 a[24:27], v17 offset:20480
  v_mfma_f32_16x16x32_bf16 v[104:107], a[36:39], a[12:15], v[104:107]
  buffer_load_dwordx4 v13, s[16:19], s37 offen offset:1024 lds
  v_mfma_f32_16x16x32_bf16 v[80:83], a[36:39], a[8:11], v[80:83]
  ds_read_b128 a[28:31], v17 offset:22528
  v_mfma_f32_16x16x32_bf16 v[56:59], a[36:39], a[4:7], v[56:59]
  ds_read_b64_tr_b16 a[56:57], v18 offset:36864
  v_mfma_f32_16x16x32_bf16 v[32:35], a[36:39], a[0:3], v[32:35]
  buffer_load_dwordx4 v14, s[16:19], s37 offen offset:2048 lds
  s_add_u32 m0, s40, 0
  v_mfma_f32_16x16x32_bf16 v[36:39], a[40:43], a[0:3], v[36:39]
  s_mov_b32 s36, 512
  ds_read_b64_tr_b16 a[58:59], v18 offset:37376
  v_mfma_f32_16x16x32_bf16 v[60:63], a[40:43], a[4:7], v[60:63]
  ds_read_b64_tr_b16 a[60:61], v19 offset:36864
  v_mfma_f32_16x16x32_bf16 v[84:87], a[40:43], a[8:11], v[84:87]
  ds_read_b64_tr_b16 a[62:63], v19 offset:37376
  v_mfma_f32_16x16x32_bf16 v[108:111], a[40:43], a[12:15], v[108:111]
  buffer_load_dwordx4 v8, s[12:15], s36 offen offset:0 lds
  v_mfma_f32_16x16x32_bf16 v[112:115], a[44:47], a[12:15], v[112:115]
  ds_read_b64_tr_b16 a[64:65], v18 offset:40960
  v_mfma_f32_16x16x32_bf16 v[88:91], a[44:47], a[8:11], v[88:91]
  ds_read_b64_tr_b16 a[66:67], v18 offset:41472
  v_mfma_f32_16x16x32_bf16 v[64:67], a[44:47], a[4:7], v[64:67]
  ds_read_b64_tr_b16 a[68:69], v19 offset:40960
  v_mfma_f32_16x16x32_bf16 v[40:43], a[44:47], a[0:3], v[40:43]
  ds_read_b64_tr_b16 a[70:71], v19 offset:41472
  v_mfma_f32_16x16x32_bf16 v[44:47], a[0:3], a[48:51], v[44:47]
  ds_read_b64_tr_b16 a[72:73], v18 offset:45056
  v_mfma_f32_16x16x32_bf16 v[68:71], a[4:7], a[48:51], v[68:71]
  ds_read_b64_tr_b16 a[74:75], v18 offset:45568
  v_mfma_f32_16x16x32_bf16 v[92:95], a[8:11], a[48:51], v[92:95]
  ds_read_b64_tr_b16 a[76:77], v19 offset:45056
  v_mfma_f32_16x16x32_bf16 v[116:119], a[12:15], a[48:51], v[116:119]
  ds_read_b64_tr_b16 a[78:79], v19 offset:45568
  v_mfma_f32_16x16x32_bf16 v[120:123], a[12:15], a[52:55], v[120:123]
  buffer_load_dwordx4 v9, s[12:15], s36 offen offset:1024 lds
  v_mfma_f32_16x16x32_bf16 v[96:99], a[8:11], a[52:55], v[96:99]
  buffer_load_dwordx4 v10, s[12:15], s36 offen offset:2048 lds
  v_mfma_f32_16x16x32_bf16 v[72:75], a[4:7], a[52:55], v[72:75]
  buffer_load_dwordx4 v11, s[12:15], s36 offen offset:3072 lds
  v_mfma_f32_16x16x32_bf16 v[48:51], a[0:3], a[52:55], v[48:51]
  s_waitcnt vmcnt(18) lgkmcnt(0)
  s_barrier
  v_mfma_f32_16x16x32_bf16 v[28:31], a[56:59], a[16:19], v[28:31]
  s_add_u32 m0, s41, 24576
  ds_read_b128 a[0:3], v16 offset:32768
  v_mfma_f32_16x16x32_bf16 v[52:55], a[56:59], a[20:23], v[52:55]
  s_mov_b32 s37, 1769472
  buffer_load_dwordx4 v12, s[16:19], s37 offen offset:0 lds
  v_mfma_f32_16x16x32_bf16 v[76:79], a[56:59], a[24:27], v[76:79]
  ds_read_b128 a[4:7], v16 offset:34816
  v_mfma_f32_16x16x32_bf16 v[100:103], a[56:59], a[28:31], v[100:103]
  ds_read_b128 a[8:11], v16 offset:36864
  v_mfma_f32_16x16x32_bf16 v[104:107], a[60:63], a[28:31], v[104:107]
  ds_read_b128 a[12:15], v16 offset:38912
  v_mfma_f32_16x16x32_bf16 v[80:83], a[60:63], a[24:27], v[80:83]
  buffer_load_dwordx4 v13, s[16:19], s37 offen offset:1024 lds
  v_mfma_f32_16x16x32_bf16 v[56:59], a[60:63], a[20:23], v[56:59]
  ds_read_b64_tr_b16 a[32:33], v20 offset:0
  v_mfma_f32_16x16x32_bf16 v[32:35], a[60:63], a[16:19], v[32:35]
  ds_read_b64_tr_b16 a[34:35], v20 offset:512
  v_mfma_f32_16x16x32_bf16 v[36:39], a[64:67], a[16:19], v[36:39]
  ds_read_b64_tr_b16 a[36:37], v21 offset:0
  v_mfma_f32_16x16x32_bf16 v[60:63], a[64:67], a[20:23], v[60:63]
  ds_read_b64_tr_b16 a[38:39], v21 offset:512
  v_mfma_f32_16x16x32_bf16 v[84:87], a[64:67], a[24:27], v[84:87]
  buffer_load_dwordx4 v14, s[16:19], s37 offen offset:2048 lds
  s_add_u32 m0, s40, 16384
  v_mfma_f32_16x16x32_bf16 v[108:111], a[64:67], a[28:31], v[108:111]
  s_mov_b32 s36, 640
  ds_read_b64_tr_b16 a[40:41], v20 offset:4096
  v_mfma_f32_16x16x32_bf16 v[112:115], a[68:71], a[28:31], v[112:115]
  ds_read_b64_tr_b16 a[42:43], v20 offset:4608
  v_mfma_f32_16x16x32_bf16 v[88:91], a[68:71], a[24:27], v[88:91]
  ds_read_b64_tr_b16 a[44:45], v21 offset:4096
  v_mfma_f32_16x16x32_bf16 v[64:67], a[68:71], a[20:23], v[64:67]
  ds_read_b64_tr_b16 a[46:47], v21 offset:4608
  v_mfma_f32_16x16x32_bf16 v[40:43], a[68:71], a[16:19], v[40:43]
  buffer_load_dwordx4 v8, s[12:15], s36 offen offset:0 lds
  v_mfma_f32_16x16x32_bf16 v[44:47], a[16:19], a[72:75], v[44:47]
  ds_read_b64_tr_b16 a[48:49], v20 offset:8192
  v_mfma_f32_16x16x32_bf16 v[68:71], a[20:23], a[72:75], v[68:71]
  ds_read_b64_tr_b16 a[50:51], v20 offset:8704
  v_mfma_f32_16x16x32_bf16 v[92:95], a[24:27], a[72:75], v[92:95]
  ds_read_b64_tr_b16 a[52:53], v21 offset:8192
  v_mfma_f32_16x16x32_bf16 v[116:119], a[28:31], a[72:75], v[116:119]
  ds_read_b64_tr_b16 a[54:55], v21 offset:8704
  v_mfma_f32_16x16x32_bf16 v[120:123], a[28:31], a[76:79], v[120:123]
  buffer_load_dwordx4 v9, s[12:15], s36 offen offset:1024 lds
  v_mfma_f32_16x16x32_bf16 v[96:99], a[24:27], a[76:79], v[96:99]
  v_mfma_f32_16x16x32_bf16 v[72:75], a[20:23], a[76:79], v[72:75]
  v_mfma_f32_16x16x32_bf16 v[48:51], a[16:19], a[76:79], v[48:51]
  s_waitcnt lgkmcnt(0)
  v_mfma_f32_16x16x32_bf16 v[28:31], a[32:35], a[0:3], v[28:31]
  s_add_u32 m0, s41, 36864
  ds_read_b128 a[16:19], v17 offset:32768
  v_mfma_f32_16x16x32_bf16 v[52:55], a[32:35], a[4:7], v[52:55]
  s_mov_b32 s37, 1966080
  buffer_load_dwordx4 v12, s[16:19], s37 offen offset:0 lds
  v_mfma_f32_16x16x32_bf16 v[76:79], a[32:35], a[8:11], v[76:79]
  ds_read_b128 a[20:23], v17 offset:34816
  v_mfma_f32_16x16x32_bf16 v[100:103], a[32:35], a[12:15], v[100:103]
  ds_read_b128 a[24:27], v17 offset:36864
  v_mfma_f32_16x16x32_bf16 v[104:107], a[36:39], a[12:15], v[104:107]
  ds_read_b128 a[28:31], v17 offset:38912
  v_mfma_f32_16x16x32_bf16 v[80:83], a[36:39], a[8:11], v[80:83]
  buffer_load_dwordx4 v13, s[16:19], s37 offen offset:1024 lds
  v_mfma_f32_16x16x32_bf16 v[56:59], a[36:39], a[4:7], v[56:59]
  ds_read_b64_tr_b16 a[56:57], v20 offset:12288
  v_mfma_f32_16x16x32_bf16 v[32:35], a[36:39], a[0:3], v[32:35]
  ds_read_b64_tr_b16 a[58:59], v20 offset:12800
  v_mfma_f32_16x16x32_bf16 v[36:39], a[40:43], a[0:3], v[36:39]
  ds_read_b64_tr_b16 a[60:61], v21 offset:12288
  v_mfma_f32_16x16x32_bf16 v[60:63], a[40:43], a[4:7], v[60:63]
  ds_read_b64_tr_b16 a[62:63], v21 offset:12800
  v_mfma_f32_16x16x32_bf16 v[84:87], a[40:43], a[8:11], v[84:87]
  buffer_load_dwordx4 v14, s[16:19], s37 offen offset:2048 lds
  s_add_u32 m0, s40, 16384
  v_mfma_f32_16x16x32_bf16 v[108:111], a[40:43], a[12:15], v[108:111]
  s_mov_b32 s36, 640
  ds_read_b64_tr_b16 a[64:65], v20 offset:16384
  v_mfma_f32_16x16x32_bf16 v[112:115], a[44:47], a[12:15], v[112:115]
  ds_read_b64_tr_b16 a[66:67], v20 offset:16896
  v_mfma_f32_16x16x32_bf16 v[88:91], a[44:47], a[8:11], v[88:91]
  ds_read_b64_tr_b16 a[68:69], v21 offset:16384
  v_mfma_f32_16x16x32_bf16 v[64:67], a[44:47], a[4:7], v[64:67]
  ds_read_b64_tr_b16 a[70:71], v21 offset:16896
  v_mfma_f32_16x16x32_bf16 v[40:43], a[44:47], a[0:3], v[40:43]
  buffer_load_dwordx4 v10, s[12:15], s36 offen offset:2048 lds
  v_mfma_f32_16x16x32_bf16 v[44:47], a[0:3], a[48:51], v[44:47]
  ds_read_b64_tr_b16 a[72:73], v20 offset:20480
  v_mfma_f32_16x16x32_bf16 v[68:71], a[4:7], a[48:51], v[68:71]
  ds_read_b64_tr_b16 a[74:75], v20 offset:20992
  v_mfma_f32_16x16x32_bf16 v[92:95], a[8:11], a[48:51], v[92:95]
  ds_read_b64_tr_b16 a[76:77], v21 offset:20480
  v_mfma_f32_16x16x32_bf16 v[116:119], a[12:15], a[48:51], v[116:119]
  ds_read_b64_tr_b16 a[78:79], v21 offset:20992
  v_mfma_f32_16x16x32_bf16 v[120:123], a[12:15], a[52:55], v[120:123]
  buffer_load_dwordx4 v11, s[12:15], s36 offen offset:3072 lds
  v_mfma_f32_16x16x32_bf16 v[96:99], a[8:11], a[52:55], v[96:99]
  v_mfma_f32_16x16x32_bf16 v[72:75], a[4:7], a[52:55], v[72:75]
  v_mfma_f32_16x16x32_bf16 v[48:51], a[0:3], a[52:55], v[48:51]
  s_waitcnt vmcnt(18) lgkmcnt(0)
  s_barrier
  v_mfma_f32_16x16x32_bf16 v[28:31], a[56:59], a[16:19], v[28:31]
  s_add_u32 m0, s41, 49152
  s_mov_b32 s37, 2162688
  buffer_load_dwordx4 v12, s[16:19], s37 offen offset:0 lds
  ds_read_b128 a[0:3], v16 offset:49152
  v_mfma_f32_16x16x32_bf16 v[52:55], a[56:59], a[20:23], v[52:55]
  ds_read_b128 a[4:7], v16 offset:51200
  ds_read_b128 a[8:11], v16 offset:53248
  v_mfma_f32_16x16x32_bf16 v[76:79], a[56:59], a[24:27], v[76:79]
  ds_read_b128 a[12:15], v16 offset:55296
  ds_read_b64_tr_b16 a[32:33], v20 offset:24576
  v_mfma_f32_16x16x32_bf16 v[100:103], a[56:59], a[28:31], v[100:103]
  buffer_load_dwordx4 v13, s[16:19], s37 offen offset:1024 lds
  ds_read_b64_tr_b16 a[34:35], v20 offset:25088
  v_mfma_f32_16x16x32_bf16 v[104:107], a[60:63], a[28:31], v[104:107]
  ds_read_b64_tr_b16 a[36:37], v21 offset:24576
  ds_read_b64_tr_b16 a[38:39], v21 offset:25088
  v_mfma_f32_16x16x32_bf16 v[80:83], a[60:63], a[24:27], v[80:83]
  ds_read_b64_tr_b16 a[40:41], v20 offset:28672
  ds_read_b64_tr_b16 a[42:43], v20 offset:29184
  v_mfma_f32_16x16x32_bf16 v[56:59], a[60:63], a[20:23], v[56:59]
  buffer_load_dwordx4 v14, s[16:19], s37 offen offset:2048 lds
  s_add_u32 m0, s40, 32768
  s_mov_b32 s36, 768
  ds_read_b64_tr_b16 a[44:45], v21 offset:28672
  v_mfma_f32_16x16x32_bf16 v[32:35], a[60:63], a[16:19], v[32:35]
  ds_read_b64_tr_b16 a[46:47], v21 offset:29184
  ds_read_b64_tr_b16 a[48:49], v20 offset:32768
  v_mfma_f32_16x16x32_bf16 v[36:39], a[64:67], a[16:19], v[36:39]
  buffer_load_dwordx4 v8, s[12:15], s36 offen offset:0 lds
  ds_read_b64_tr_b16 a[50:51], v20 offset:33280
  v_mfma_f32_16x16x32_bf16 v[60:63], a[64:67], a[20:23], v[60:63]
  ds_read_b64_tr_b16 a[52:53], v21 offset:32768
  ds_read_b64_tr_b16 a[54:55], v21 offset:33280
  v_mfma_f32_16x16x32_bf16 v[84:87], a[64:67], a[24:27], v[84:87]
  buffer_load_dwordx4 v9, s[12:15], s36 offen offset:1024 lds
  v_lshrrev_b32 v22, 2, v5
  v_mul_u32_u24 v22, 6144, v22
  v_mfma_f32_16x16x32_bf16 v[108:111], a[64:67], a[28:31], v[108:111]
  v_and_b32 v23, 3, v1
  v_lshl_add_u32 v22, v23, 5, v22
  v_mfma_f32_16x16x32_bf16 v[112:115], a[68:71], a[28:31], v[112:115]
  v_lshl_add_u32 v22, v6, 4, v22
  s_and_b32 s28, s32, 3
  v_mfma_f32_16x16x32_bf16 v[88:91], a[68:71], a[24:27], v[88:91]
  s_lshl_b32 s28, s28, 2
  s_add_u32 s28, s28, s5
  v_mfma_f32_16x16x32_bf16 v[64:67], a[68:71], a[20:23], v[64:67]
  s_mul_i32 s28, s28, 393216
  s_lshr_b32 s43, s32, 2
  v_mfma_f32_16x16x32_bf16 v[40:43], a[68:71], a[16:19], v[40:43]
  s_mul_i32 s63, s43, 0
  s_add_u32 s63, s63, s33
  v_mfma_f32_16x16x32_bf16 v[44:47], a[16:19], a[72:75], v[44:47]
  s_lshl_b32 s48, s5, 12
  s_add_u32 s48, s48, 39845888
  v_mfma_f32_16x16x32_bf16 v[68:71], a[20:23], a[72:75], v[68:71]
  s_cmp_eq_u32 s2, 0
  s_cselect_b32 s48, s48, 2146435072
  v_mfma_f32_16x16x32_bf16 v[92:95], a[24:27], a[72:75], v[92:95]
  v_mov_b32 v164, 0
  v_mov_b32 v168, -1
  v_mfma_f32_16x16x32_bf16 v[116:119], a[28:31], a[72:75], v[116:119]
  v_mov_b32 v165, 0
  v_mov_b32 v169, -1
  v_mfma_f32_16x16x32_bf16 v[120:123], a[28:31], a[76:79], v[120:123]
  v_mov_b32 v166, 0
  v_mov_b32 v170, -1
  v_mfma_f32_16x16x32_bf16 v[96:99], a[24:27], a[76:79], v[96:99]
  v_mov_b32 v167, 0
  v_mov_b32 v171, -1
  buffer_store_dwordx4 v[164:167], v2, s[8:11], s48 offen offset:0 sc1
  buffer_store_dwordx4 v[164:167], v2, s[8:11], s48 offen offset:1024 sc1
  v_mfma_f32_16x16x32_bf16 v[72:75], a[20:23], a[76:79], v[72:75]
  buffer_store_dwordx4 v[164:167], v2, s[8:11], s48 offen offset:2048 sc1
  buffer_store_dwordx4 v[164:167], v2, s[8:11], s48 offen offset:3072 sc1
  v_mfma_f32_16x16x32_bf16 v[48:51], a[16:19], a[76:79], v[48:51]
  s_waitcnt lgkmcnt(0)
  v_mfma_f32_16x16x32_bf16 v[28:31], a[32:35], a[0:3], v[28:31]
  s_add_u32 m0, s41, 61440
  ds_read_b128 a[16:19], v17 offset:49152
  ds_read_b128 a[20:23], v17 offset:51200
  v_mfma_f32_16x16x32_bf16 v[52:55], a[32:35], a[4:7], v[52:55]
  s_mov_b32 s37, 2359296
  buffer_load_dwordx4 v12, s[16:19], s37 offen offset:0 lds
  ds_read_b128 a[24:27], v17 offset:53248
  v_mfma_f32_16x16x32_bf16 v[76:79], a[32:35], a[8:11], v[76:79]
  ds_read_b128 a[28:31], v17 offset:55296
  ds_read_b64_tr_b16 a[56:57], v18 offset:0
  v_mfma_f32_16x16x32_bf16 v[100:103], a[32:35], a[12:15], v[100:103]
  buffer_load_dwordx4 v13, s[16:19], s37 offen offset:1024 lds
  ds_read_b64_tr_b16 a[58:59], v18 offset:512
  v_mfma_f32_16x16x32_bf16 v[104:107], a[36:39], a[12:15], v[104:107]
  ds_read_b64_tr_b16 a[60:61], v19 offset:0
  ds_read_b64_tr_b16 a[62:63], v19 offset:512
  v_mfma_f32_16x16x32_bf16 v[80:83], a[36:39], a[8:11], v[80:83]
  ds_read_b64_tr_b16 a[64:65], v18 offset:4096
  ds_read_b64_tr_b16 a[66:67], v18 offset:4608
  v_mfma_f32_16x16x32_bf16 v[56:59], a[36:39], a[4:7], v[56:59]
  buffer_load_dwordx4 v14, s[16:19], s37 offen offset:2048 lds
  s_add_u32 m0, s40, 32768
  ds_read_b64_tr_b16 a[68:69], v19 offset:4096
  v_mfma_f32_16x16x32_bf16 v[32:35], a[36:39], a[0:3], v[32:35]
  s_mov_b32 s36, 768
  ds_read_b64_tr_b16 a[70:71], v19 offset:4608
  ds_read_b64_tr_b16 a[72:73], v18 offset:8192
  v_mfma_f32_16x16x32_bf16 v[36:39], a[40:43], a[0:3], v[36:39]
  ds_read_b64_tr_b16 a[74:75], v18 offset:8704
  ds_read_b64_tr_b16 a[76:77], v19 offset:8192
  v_mfma_f32_16x16x32_bf16 v[60:63], a[40:43], a[4:7], v[60:63]
  buffer_load_dwordx4 v10, s[12:15], s36 offen offset:2048 lds
  ds_read_b64_tr_b16 a[78:79], v19 offset:8704
  v_mfma_f32_16x16x32_bf16 v[84:87], a[40:43], a[8:11], v[84:87]
  buffer_load_dwordx4 v11, s[12:15], s36 offen offset:3072 lds
  s_and_b32 s63, s63, 3
  v_mfma_f32_16x16x32_bf16 v[108:111], a[40:43], a[12:15], v[108:111]
  s_or_b32 s63, s63, s30
  v_mfma_f32_16x16x32_bf16 v[112:115], a[44:47], a[12:15], v[112:115]
  s_lshl_b32 s29, s43, 11
  v_mfma_f32_16x16x32_bf16 v[88:91], a[44:47], a[8:11], v[88:91]
  s_add_u32 s28, s28, s29
  v_mfma_f32_16x16x32_bf16 v[64:67], a[44:47], a[4:7], v[64:67]
  s_lshl_b32 s29, s63, 7
  v_mfma_f32_16x16x32_bf16 v[40:43], a[44:47], a[0:3], v[40:43]
  s_add_u32 s28, s28, s29
  v_mfma_f32_16x16x32_bf16 v[44:47], a[0:3], a[48:51], v[44:47]
  s_cmp_eq_u32 s43, 3
  s_cselect_b32 s28, 2146435072, s28
  buffer_load_dwordx4 a[80:83], v22, s[16:19], s28 offen
  v_mfma_f32_16x16x32_bf16 v[68:71], a[4:7], a[48:51], v[68:71]
  s_add_u32 s28, s28, 49152
  buffer_load_dwordx4 a[84:87], v22, s[16:19], s28 offen
  v_mfma_f32_16x16x32_bf16 v[92:95], a[8:11], a[48:51], v[92:95]
  s_add_u32 s28, s28, 49152
  buffer_load_dwordx4 a[88:91], v22, s[16:19], s28 offen
  v_mfma_f32_16x16x32_bf16 v[116:119], a[12:15], a[48:51], v[116:119]
  v_mfma_f32_16x16x32_bf16 v[120:123], a[12:15], a[52:55], v[120:123]
  v_mfma_f32_16x16x32_bf16 v[96:99], a[8:11], a[52:55], v[96:99]
  v_mfma_f32_16x16x32_bf16 v[72:75], a[4:7], a[52:55], v[72:75]
  v_mfma_f32_16x16x32_bf16 v[48:51], a[0:3], a[52:55], v[48:51]
  s_waitcnt vmcnt(24) lgkmcnt(0)
  s_barrier
  v_mfma_f32_16x16x32_bf16 v[28:31], a[56:59], a[16:19], v[28:31]
  s_add_u32 m0, s41, 73728
  ds_read_b128 a[0:3], v16 offset:0
  ds_read_b128 a[4:7], v16 offset:2048
  v_mfma_f32_16x16x32_bf16 v[52:55], a[56:59], a[20:23], v[52:55]
  s_mov_b32 s37, 2555904
  buffer_load_dwordx4 v12, s[16:19], s37 offen offset:0 lds
  ds_read_b128 a[8:11], v16 offset:4096
  v_mfma_f32_16x16x32_bf16 v[76:79], a[56:59], a[24:27], v[76:79]
  ds_read_b128 a[12:15], v16 offset:6144
  ds_read_b64_tr_b16 a[32:33], v18 offset:12288
  v_mfma_f32_16x16x32_bf16 v[100:103], a[56:59], a[28:31], v[100:103]
  buffer_load_dwordx4 v13, s[16:19], s37 offen offset:1024 lds
  ds_read_b64_tr_b16 a[34:35], v18 offset:12800
  v_mfma_f32_16x16x32_bf16 v[104:107], a[60:63], a[28:31], v[104:107]
  ds_read_b64_tr_b16 a[36:37], v19 offset:12288
  ds_read_b64_tr_b16 a[38:39], v19 offset:12800
  v_mfma_f32_16x16x32_bf16 v[80:83], a[60:63], a[24:27], v[80:83]
  buffer_load_dwordx4 v14, s[16:19], s37 offen offset:2048 lds
  s_add_u32 m0, s40, 49152
  ds_read_b64_tr_b16 a[40:41], v18 offset:16384
  v_mfma_f32_16x16x32_bf16 v[56:59], a[60:63], a[20:23], v[56:59]
  s_mov_b32 s36, 896
  ds_read_b64_tr_b16 a[42:43], v18 offset:16896
  ds_read_b64_tr_b16 a[44:45], v19 offset:16384
  v_mfma_f32_16x16x32_bf16 v[32:35], a[60:63], a[16:19], v[32:35]
  ds_read_b64_tr_b16 a[46:47], v19 offset:16896
  ds_read_b64_tr_b16 a[48:49], v18 offset:20480
  v_mfma_f32_16x16x32_bf16 v[36:39], a[64:67], a[16:19], v[36:39]
  buffer_load_dwordx4 v8, s[12:15], s36 offen offset:0 lds
  ds_read_b64_tr_b16 a[50:51], v18 offset:20992
  v_mfma_f32_16x16x32_bf16 v[60:63], a[64:67], a[20:23], v[60:63]
  ds_read_b64_tr_b16 a[52:53], v19 offset:20480
  ds_read_b64_tr_b16 a[54:55], v19 offset:20992
  v_mfma_f32_16x16x32_bf16 v[84:87], a[64:67], a[24:27], v[84:87]
  buffer_load_dwordx4 v9, s[12:15], s36 offen offset:1024 lds
  s_add_u32 s28, s28, 49152
  buffer_load_dwordx4 a[92:95], v22, s[16:19], s28 offen
  v_mfma_f32_16x16x32_bf16 v[108:111], a[64:67], a[28:31], v[108:111]
  s_add_u32 s28, s28, 49152
  buffer_load_dwordx4 a[96:99], v22, s[16:19], s28 offen
  v_mfma_f32_16x16x32_bf16 v[112:115], a[68:71], a[28:31], v[112:115]
  s_add_u32 s28, s28, 49152
  buffer_load_dwordx4 a[100:103], v22, s[16:19], s28 offen
  v_mfma_f32_16x16x32_bf16 v[88:91], a[68:71], a[24:27], v[88:91]
  s_add_u32 s28, s28, 49152
  buffer_load_dwordx4 a[104:107], v22, s[16:19], s28 offen
  v_mfma_f32_16x16x32_bf16 v[64:67], a[68:71], a[20:23], v[64:67]
  s_add_u32 s28, s28, 49152
  buffer_load_dwordx4 a[108:111], v22, s[16:19], s28 offen
  v_mfma_f32_16x16x32_bf16 v[40:43], a[68:71], a[16:19], v[40:43]
  s_add_u32 s28, s28, 49152
  v_mfma_f32_16x16x32_bf16 v[44:47], a[16:19], a[72:75], v[44:47]
  v_mfma_f32_16x16x32_bf16 v[68:71], a[20:23], a[72:75], v[68:71]
  v_mfma_f32_16x16x32_bf16 v[92:95], a[24:27], a[72:75], v[92:95]
  v_mfma_f32_16x16x32_bf16 v[116:119], a[28:31], a[72:75], v[116:119]
  v_mfma_f32_16x16x32_bf16 v[120:123], a[28:31], a[76:79], v[120:123]
  v_mfma_f32_16x16x32_bf16 v[96:99], a[24:27], a[76:79], v[96:99]
  v_mfma_f32_16x16x32_bf16 v[72:75], a[20:23], a[76:79], v[72:75]
  v_mfma_f32_16x16x32_bf16 v[48:51], a[16:19], a[76:79], v[48:51]
  s_waitcnt lgkmcnt(0)
  v_mfma_f32_16x16x32_bf16 v[28:31], a[32:35], a[0:3], v[28:31]
  s_add_u32 m0, s41, 0
  ds_read_b128 a[16:19], v17 offset:0
  v_mfma_f32_16x16x32_bf16 v[52:55], a[32:35], a[4:7], v[52:55]
  s_mov_b32 s37, 2752512
  buffer_load_dwordx4 v12, s[16:19], s37 offen offset:0 lds
  v_mfma_f32_16x16x32_bf16 v[76:79], a[32:35], a[8:11], v[76:79]
  ds_read_b128 a[20:23], v17 offset:2048
  v_mfma_f32_16x16x32_bf16 v[100:103], a[32:35], a[12:15], v[100:103]
  ds_read_b128 a[24:27], v17 offset:4096
  v_mfma_f32_16x16x32_bf16 v[104:107], a[36:39], a[12:15], v[104:107]
  ds_read_b128 a[28:31], v17 offset:6144
  v_mfma_f32_16x16x32_bf16 v[80:83], a[36:39], a[8:11], v[80:83]
  buffer_load_dwordx4 v13, s[16:19], s37 offen offset:1024 lds
  v_mfma_f32_16x16x32_bf16 v[56:59], a[36:39], a[4:7], v[56:59]
  ds_read_b64_tr_b16 a[56:57], v18 offset:24576
  v_mfma_f32_16x16x32_bf16 v[32:35], a[36:39], a[0:3], v[32:35]
  ds_read_b64_tr_b16 a[58:59], v18 offset:25088
  v_mfma_f32_16x16x32_bf16 v[36:39], a[40:43], a[0:3], v[36:39]
  ds_read_b64_tr_b16 a[60:61], v19 offset:24576
  v_mfma_f32_16x16x32_bf16 v[60:63], a[40:43], a[4:7], v[60:63]
  ds_read_b64_tr_b16 a[62:63], v19 offset:25088
  v_mfma_f32_16x16x32_bf16 v[84:87], a[40:43], a[8:11], v[84:87]
  buffer_load_dwordx4 v14, s[16:19], s37 offen offset:2048 lds
  s_add_u32 m0, s40, 49152
  v_mfma_f32_16x16x32_bf16 v[108:111], a[40:43], a[12:15], v[108:111]
  s_mov_b32 s36, 896
  ds_read_b64_tr_b16 a[64:65], v18 offset:28672
  v_mfma_f32_16x16x32_bf16 v[112:115], a[44:47], a[12:15], v[112:115]
  ds_read_b64_tr_b16 a[66:67], v18 offset:29184
  v_mfma_f32_16x16x32_bf16 v[88:91], a[44:47], a[8:11], v[88:91]
  ds_read_b64_tr_b16 a[68:69], v19 offset:28672
  v_mfma_f32_16x16x32_bf16 v[64:67], a[44:47], a[4:7], v[64:67]
  ds_read_b64_tr_b16 a[70:71], v19 offset:29184
  v_mfma_f32_16x16x32_bf16 v[40:43], a[44:47], a[0:3], v[40:43]
  buffer_load_dwordx4 v10, s[12:15], s36 offen offset:2048 lds
  v_mfma_f32_16x16x32_bf16 v[44:47], a[0:3], a[48:51], v[44:47]
  ds_read_b64_tr_b16 a[72:73], v18 offset:32768
  v_mfma_f32_16x16x32_bf16 v[68:71], a[4:7], a[48:51], v[68:71]
  ds_read_b64_tr_b16 a[74:75], v18 offset:33280
  v_mfma_f32_16x16x32_bf16 v[92:95], a[8:11], a[48:51], v[92:95]
  ds_read_b64_tr_b16 a[76:77], v19 offset:32768
  v_mfma_f32_16x16x32_bf16 v[116:119], a[12:15], a[48:51], v[116:119]
  ds_read_b64_tr_b16 a[78:79], v19 offset:33280
  v_mfma_f32_16x16x32_bf16 v[120:123], a[12:15], a[52:55], v[120:123]
  buffer_load_dwordx4 v11, s[12:15], s36 offen offset:3072 lds
  v_mfma_f32_16x16x32_bf16 v[96:99], a[8:11], a[52:55], v[96:99]
  v_mfma_f32_16x16x32_bf16 v[72:75], a[4:7], a[52:55], v[72:75]
  v_mfma_f32_16x16x32_bf16 v[48:51], a[0:3], a[52:55], v[48:51]
  s_waitcnt vmcnt(23) lgkmcnt(0)
  s_barrier
  v_mfma_f32_16x16x32_bf16 v[28:31], a[56:59], a[16:19], v[28:31]
  s_add_u32 m0, s41, 12288
  ds_read_b128 a[0:3], v16 offset:16384
  v_mfma_f32_16x16x32_bf16 v[52:55], a[56:59], a[20:23], v[52:55]
  s_mov_b32 s37, 2949120
  buffer_load_dwordx4 v12, s[16:19], s37 offen offset:0 lds
  v_mfma_f32_16x16x32_bf16 v[76:79], a[56:59], a[24:27], v[76:79]
  ds_read_b128 a[4:7], v16 offset:18432
  v_mfma_f32_16x16x32_bf16 v[100:103], a[56:59], a[28:31], v[100:103]
  ds_read_b128 a[8:11], v16 offset:20480
  v_mfma_f32_16x16x32_bf16 v[104:107], a[60:63], a[28:31], v[104:107]
  buffer_load_dwordx4 v13, s[16:19], s37 offen offset:1024 lds
  v_mfma_f32_16x16x32_bf16 v[80:83], a[60:63], a[24:27], v[80:83]
  ds_read_b128 a[12:15], v16 offset:22528
  v_mfma_f32_16x16x32_bf16 v[56:59], a[60:63], a[20:23], v[56:59]
  ds_read_b64_tr_b16 a[32:33], v18 offset:36864
  v_mfma_f32_16x16x32_bf16 v[32:35], a[60:63], a[16:19], v[32:35]
  ds_read_b64_tr_b16 a[34:35], v18 offset:37376
  v_mfma_f32_16x16x32_bf16 v[36:39], a[64:67], a[16:19], v[36:39]
  buffer_load_dwordx4 v14, s[16:19], s37 offen offset:2048 lds
  s_add_u32 m0, s40, 0
  v_mfma_f32_16x16x32_bf16 v[60:63], a[64:67], a[20:23], v[60:63]
  s_mov_b32 s36, 1024
  ds_read_b64_tr_b16 a[36:37], v19 offset:36864
  v_mfma_f32_16x16x32_bf16 v[84:87], a[64:67], a[24:27], v[84:87]
  ds_read_b64_tr_b16 a[38:39], v19 offset:37376
  v_mfma_f32_16x16x32_bf16 v[108:111], a[64:67], a[28:31], v[108:111]
  ds_read_b64_tr_b16 a[40:41], v18 offset:40960
  v_mfma_f32_16x16x32_bf16 v[112:115], a[68:71], a[28:31], v[112:115]
  buffer_load_dwordx4 v8, s[12:15], s36 offen offset:0 lds
  v_mfma_f32_16x16x32_bf16 v[88:91], a[68:71], a[24:27], v[88:91]
  ds_read_b64_tr_b16 a[42:43], v18 offset:41472
  v_mfma_f32_16x16x32_bf16 v[64:67], a[68:71], a[20:23], v[64:67]
  ds_read_b64_tr_b16 a[44:45], v19 offset:40960
  v_mfma_f32_16x16x32_bf16 v[40:43], a[68:71], a[16:19], v[40:43]
  ds_read_b64_tr_b16 a[46:47], v19 offset:41472
  v_mfma_f32_16x16x32_bf16 v[44:47], a[16:19], a[72:75], v[44:47]
  ds_read_b64_tr_b16 a[48:49], v18 offset:45056
  v_mfma_f32_16x16x32_bf16 v[68:71], a[20:23], a[72:75], v[68:71]
  ds_read_b64_tr_b16 a[50:51], v18 offset:45568
  v_mfma_f32_16x16x32_bf16 v[92:95], a[24:27], a[72:75], v[92:95]
  ds_read_b64_tr_b16 a[52:53], v19 offset:45056
  v_mfma_f32_16x16x32_bf16 v[116:119], a[28:31], a[72:75], v[116:119]
  ds_read_b64_tr_b16 a[54:55], v19 offset:45568
  v_mfma_f32_16x16x32_bf16 v[120:123], a[28:31], a[76:79], v[120:123]
  buffer_load_dwordx4 v9, s[12:15], s36 offen offset:1024 lds
  v_mov_b32 v24, 1
  v_mfma_f32_16x16x32_bf16 v[96:99], a[24:27], a[76:79], v[96:99]
  v_mov_b32 v25, 0
  v_mfma_f32_16x16x32_bf16 v[72:75], a[20:23], a[76:79], v[72:75]
  s_or_b32 s48, s2, s5
  v_mfma_f32_16x16x32_bf16 v[48:51], a[16:19], a[76:79], v[48:51]
  s_cmp_eq_u32 s48, 0
  s_cselect_b32 s48, 0, 2146435072
  buffer_store_dword v24, v25, s[20:23], s48 offen sc1
  s_waitcnt lgkmcnt(0)
  v_mfma_f32_16x16x32_bf16 v[28:31], a[32:35], a[0:3], v[28:31]
  s_add_u32 m0, s41, 24576
  ds_read_b128 a[16:19], v17 offset:16384
  ds_read_b128 a[20:23], v17 offset:18432
  ds_read_b128 a[24:27], v17 offset:20480
  v_mfma_f32_16x16x32_bf16 v[52:55], a[32:35], a[4:7], v[52:55]
  s_mov_b32 s37, 3145728
  buffer_load_dwordx4 v12, s[16:19], s37 offen offset:0 lds
  ds_read_b128 a[28:31], v17 offset:22528
  ds_read_b64_tr_b16 a[56:57], v20 offset:0
  v_mfma_f32_16x16x32_bf16 v[76:79], a[32:35], a[8:11], v[76:79]
  ds_read_b64_tr_b16 a[58:59], v20 offset:512
  ds_read_b64_tr_b16 a[60:61], v21 offset:0
  ds_read_b64_tr_b16 a[62:63], v21 offset:512
  v_mfma_f32_16x16x32_bf16 v[100:103], a[32:35], a[12:15], v[100:103]
  ds_read_b64_tr_b16 a[64:65], v20 offset:4096
  ds_read_b64_tr_b16 a[66:67], v20 offset:4608
  ds_read_b64_tr_b16 a[68:69], v21 offset:4096
  v_mfma_f32_16x16x32_bf16 v[104:107], a[36:39], a[12:15], v[104:107]
  ds_read_b64_tr_b16 a[70:71], v21 offset:4608
  ds_read_b64_tr_b16 a[72:73], v20 offset:8192
  ds_read_b64_tr_b16 a[74:75], v20 offset:8704
  v_mfma_f32_16x16x32_bf16 v[80:83], a[36:39], a[8:11], v[80:83]
  buffer_load_dwordx4 v13, s[16:19], s37 offen offset:1024 lds
  ds_read_b64_tr_b16 a[76:77], v21 offset:8192
  ds_read_b64_tr_b16 a[78:79], v21 offset:8704
  v_mfma_f32_16x16x32_bf16 v[56:59], a[36:39], a[4:7], v[56:59]
  buffer_load_dwordx4 v14, s[16:19], s37 offen offset:2048 lds
  s_add_u32 m0, s40, 0
  v_mfma_f32_16x16x32_bf16 v[32:35], a[36:39], a[0:3], v[32:35]
  s_mov_b32 s36, 1024
  buffer_load_dwordx4 v10, s[12:15], s36 offen offset:2048 lds
  buffer_load_dwordx4 v11, s[12:15], s36 offen offset:3072 lds
  v_mfma_f32_16x16x32_bf16 v[36:39], a[40:43], a[0:3], v[36:39]
  s_waitcnt vmcnt(16)
  v_mfma_f32_16x16x32_bf16 v[60:63], a[40:43], a[4:7], v[60:63]
  v_mfma_f32_32x32x16_bf16 v[140:155], a[80:83], a[112:115], 0
  v_mfma_f32_16x16x32_bf16 v[84:87], a[40:43], a[8:11], v[84:87]
  v_mfma_f32_32x32x16_bf16 v[140:155], a[84:87], a[112:115], v[140:155]
  v_mfma_f32_16x16x32_bf16 v[108:111], a[40:43], a[12:15], v[108:111]
  v_mfma_f32_32x32x16_bf16 v[140:155], a[88:91], a[112:115], v[140:155]
  v_mfma_f32_16x16x32_bf16 v[112:115], a[44:47], a[12:15], v[112:115]
  v_mfma_f32_32x32x16_bf16 v[140:155], a[92:95], a[112:115], v[140:155]
  v_mfma_f32_16x16x32_bf16 v[88:91], a[44:47], a[8:11], v[88:91]
  v_mfma_f32_32x32x16_bf16 v[140:155], a[96:99], a[112:115], v[140:155]
  v_mfma_f32_16x16x32_bf16 v[64:67], a[44:47], a[4:7], v[64:67]
  v_mfma_f32_32x32x16_bf16 v[140:155], a[100:103], a[112:115], v[140:155]
  v_mfma_f32_16x16x32_bf16 v[40:43], a[44:47], a[0:3], v[40:43]
  v_mfma_f32_32x32x16_bf16 v[140:155], a[104:107], a[112:115], v[140:155]
  v_mfma_f32_16x16x32_bf16 v[44:47], a[0:3], a[48:51], v[44:47]
  v_mfma_f32_32x32x16_bf16 v[140:155], a[108:111], a[112:115], v[140:155]
  v_mfma_f32_16x16x32_bf16 v[68:71], a[4:7], a[48:51], v[68:71]
  s_nop 0
  v_mfma_f32_16x16x32_bf16 v[92:95], a[8:11], a[48:51], v[92:95]
  s_nop 0
  v_mfma_f32_16x16x32_bf16 v[116:119], a[12:15], a[48:51], v[116:119]
  s_nop 0
  v_mfma_f32_16x16x32_bf16 v[120:123], a[12:15], a[52:55], v[120:123]
  s_nop 0
  v_mfma_f32_16x16x32_bf16 v[96:99], a[8:11], a[52:55], v[96:99]
  s_nop 0
  v_mfma_f32_16x16x32_bf16 v[72:75], a[4:7], a[52:55], v[72:75]
  s_nop 0
  v_mfma_f32_16x16x32_bf16 v[48:51], a[0:3], a[52:55], v[48:51]
  s_waitcnt vmcnt(23) lgkmcnt(0)
  s_barrier
  v_mfma_f32_16x16x32_bf16 v[28:31], a[56:59], a[16:19], v[28:31]
  s_add_u32 m0, s41, 36864
  ds_read_b128 a[0:3], v16 offset:32768
  ds_read_b128 a[4:7], v16 offset:34816
  ds_read_b128 a[8:11], v16 offset:36864
  v_mfma_f32_16x16x32_bf16 v[52:55], a[56:59], a[20:23], v[52:55]
  s_mov_b32 s37, 3342336
  buffer_load_dwordx4 v12, s[16:19], s37 offen offset:0 lds
  ds_read_b128 a[12:15], v16 offset:38912
  ds_read_b64_tr_b16 a[32:33], v20 offset:12288
  v_mfma_f32_16x16x32_bf16 v[76:79], a[56:59], a[24:27], v[76:79]
  ds_read_b64_tr_b16 a[34:35], v20 offset:12800
  ds_read_b64_tr_b16 a[36:37], v21 offset:12288
  ds_read_b64_tr_b16 a[38:39], v21 offset:12800
  v_mfma_f32_16x16x32_bf16 v[100:103], a[56:59], a[28:31], v[100:103]
  ds_read_b64_tr_b16 a[40:41], v20 offset:16384
  ds_read_b64_tr_b16 a[42:43], v20 offset:16896
  ds_read_b64_tr_b16 a[44:45], v21 offset:16384
  v_mfma_f32_16x16x32_bf16 v[104:107], a[60:63], a[28:31], v[104:107]
  ds_read_b64_tr_b16 a[46:47], v21 offset:16896
  ds_read_b64_tr_b16 a[48:49], v20 offset:20480
  ds_read_b64_tr_b16 a[50:51], v20 offset:20992
  v_mfma_f32_16x16x32_bf16 v[80:83], a[60:63], a[24:27], v[80:83]
  buffer_load_dwordx4 v13, s[16:19], s37 offen offset:1024 lds
  ds_read_b64_tr_b16 a[52:53], v21 offset:20480
  ds_read_b64_tr_b16 a[54:55], v21 offset:20992
  v_mfma_f32_16x16x32_bf16 v[56:59], a[60:63], a[20:23], v[56:59]
  buffer_load_dwordx4 v14, s[16:19], s37 offen offset:2048 lds
  s_add_u32 m0, s40, 16384
  v_mfma_f32_16x16x32_bf16 v[32:35], a[60:63], a[16:19], v[32:35]
  s_mov_b32 s36, 1152
  buffer_load_dwordx4 v8, s[12:15], s36 offen offset:0 lds
  buffer_load_dwordx4 v9, s[12:15], s36 offen offset:1024 lds
  v_mfma_f32_16x16x32_bf16 v[36:39], a[64:67], a[16:19], v[36:39]
  v_add_f32 v140, v140, v144
  v_mfma_f32_16x16x32_bf16 v[60:63], a[64:67], a[20:23], v[60:63]
  v_add_f32 v148, v148, v152
  v_mfma_f32_16x16x32_bf16 v[84:87], a[64:67], a[24:27], v[84:87]
  v_add_f32 v141, v141, v145
  v_mfma_f32_16x16x32_bf16 v[108:111], a[64:67], a[28:31], v[108:111]
  v_add_f32 v149, v149, v153
  v_mfma_f32_16x16x32_bf16 v[112:115], a[68:71], a[28:31], v[112:115]
  v_add_f32 v142, v142, v146
  v_mfma_f32_16x16x32_bf16 v[88:91], a[68:71], a[24:27], v[88:91]
  v_add_f32 v150, v150, v154
  v_mfma_f32_16x16x32_bf16 v[64:67], a[68:71], a[20:23], v[64:67]
  v_add_f32 v143, v143, v147
  v_mfma_f32_16x16x32_bf16 v[40:43], a[68:71], a[16:19], v[40:43]
  v_add_f32 v151, v151, v155
  v_mfma_f32_16x16x32_bf16 v[44:47], a[16:19], a[72:75], v[44:47]
  v_add_f32 v140, v140, v148
  v_mfma_f32_16x16x32_bf16 v[68:71], a[20:23], a[72:75], v[68:71]
  v_add_f32 v141, v141, v149
  v_mfma_f32_16x16x32_bf16 v[92:95], a[24:27], a[72:75], v[92:95]
  v_add_f32 v142, v142, v150
  v_mfma_f32_16x16x32_bf16 v[116:119], a[28:31], a[72:75], v[116:119]
  v_add_f32 v143, v143, v151
  v_mfma_f32_16x16x32_bf16 v[120:123], a[28:31], a[76:79], v[120:123]
  v_mov_b32 v144, v140
  v_mfma_f32_16x16x32_bf16 v[96:99], a[24:27], a[76:79], v[96:99]
  v_mov_b32 v145, v141
  v_mfma_f32_16x16x32_bf16 v[72:75], a[20:23], a[76:79], v[72:75]
  v_mov_b32 v146, v142
  v_mfma_f32_16x16x32_bf16 v[48:51], a[16:19], a[76:79], v[48:51]
  s_waitcnt lgkmcnt(0)
  v_mfma_f32_16x16x32_bf16 v[28:31], a[32:35], a[0:3], v[28:31]
  s_add_u32 m0, s41, 49152
  ds_read_b128 a[16:19], v17 offset:32768
  ds_read_b128 a[20:23], v17 offset:34816
  ds_read_b128 a[24:27], v17 offset:36864
  v_mfma_f32_16x16x32_bf16 v[52:55], a[32:35], a[4:7], v[52:55]
  s_mov_b32 s37, 3538944
  buffer_load_dwordx4 v12, s[16:19], s37 offen offset:0 lds
  ds_read_b128 a[28:31], v17 offset:38912
  ds_read_b64_tr_b16 a[56:57], v20 offset:24576
  v_mfma_f32_16x16x32_bf16 v[76:79], a[32:35], a[8:11], v[76:79]
  ds_read_b64_tr_b16 a[58:59], v20 offset:25088
  ds_read_b64_tr_b16 a[60:61], v21 offset:24576
  ds_read_b64_tr_b16 a[62:63], v21 offset:25088
  v_mfma_f32_16x16x32_bf16 v[100:103], a[32:35], a[12:15], v[100:103]
  ds_read_b64_tr_b16 a[64:65], v20 offset:28672
  ds_read_b64_tr_b16 a[66:67], v20 offset:29184
  ds_read_b64_tr_b16 a[68:69], v21 offset:28672
  v_mfma_f32_16x16x32_bf16 v[104:107], a[36:39], a[12:15], v[104:107]
  buffer_load_dwordx4 v13, s[16:19], s37 offen offset:1024 lds
  ds_read_b64_tr_b16 a[70:71], v21 offset:29184
  ds_read_b64_tr_b16 a[72:73], v20 offset:32768
  v_mfma_f32_16x16x32_bf16 v[80:83], a[36:39], a[8:11], v[80:83]
  ds_read_b64_tr_b16 a[74:75], v20 offset:33280
  ds_read_b64_tr_b16 a[76:77], v21 offset:32768
  ds_read_b64_tr_b16 a[78:79], v21 offset:33280
  v_mfma_f32_16x16x32_bf16 v[56:59], a[36:39], a[4:7], v[56:59]
  buffer_load_dwordx4 v14, s[16:19], s37 offen offset:2048 lds
  s_add_u32 m0, s40, 16384
  v_mfma_f32_16x16x32_bf16 v[32:35], a[36:39], a[0:3], v[32:35]
  s_mov_b32 s36, 1152
  buffer_load_dwordx4 v10, s[12:15], s36 offen offset:2048 lds
  buffer_load_dwordx4 v11, s[12:15], s36 offen offset:3072 lds
  v_mfma_f32_16x16x32_bf16 v[36:39], a[40:43], a[0:3], v[36:39]
  v_mov_b32 v25, 0
  v_mfma_f32_16x16x32_bf16 v[60:63], a[40:43], a[4:7], v[60:63]
  v_mov_b32 v182, 1
  s_cmp_lg_u32 s5, 0
  s_cbranch_scc1 L_p1_nd
  buffer_load_dword v182, v25, s[20:23], 0 offen sc1
L_p1_nd:
  v_mfma_f32_16x16x32_bf16 v[84:87], a[40:43], a[8:11], v[84:87]
  v_mov_b32 v147, v143
  v_mfma_f32_16x16x32_bf16 v[108:111], a[40:43], a[12:15], v[108:111]
  s_lshl_b32 s28, s5, 8
  v_mfma_f32_16x16x32_bf16 v[112:115], a[44:47], a[12:15], v[112:115]
  s_add_u32 s28, s28, 151552
  v_mfma_f32_16x16x32_bf16 v[88:91], a[44:47], a[8:11], v[88:91]
  v_lshl_add_u32 v22, v3, 4, s28
  v_mfma_f32_16x16x32_bf16 v[64:67], a[44:47], a[4:7], v[64:67]
  v_permlane32_swap_b32 v140, v144
  v_mfma_f32_16x16x32_bf16 v[40:43], a[44:47], a[0:3], v[40:43]
  v_permlane32_swap_b32 v141, v145
  v_mfma_f32_16x16x32_bf16 v[44:47], a[0:3], a[48:51], v[44:47]
  v_permlane32_swap_b32 v142, v146
  v_mfma_f32_16x16x32_bf16 v[68:71], a[4:7], a[48:51], v[68:71]
  v_permlane32_swap_b32 v143, v147
  v_mfma_f32_16x16x32_bf16 v[92:95], a[8:11], a[48:51], v[92:95]
  v_and_b32 v23, 16, v1
  v_mfma_f32_16x16x32_bf16 v[116:119], a[12:15], a[48:51], v[116:119]
  v_lshl_add_u32 v22, v23, 6, v22
  v_mfma_f32_16x16x32_bf16 v[120:123], a[12:15], a[52:55], v[120:123]
  v_add_f32 v140, v140, v144
  v_mfma_f32_16x16x32_bf16 v[96:99], a[8:11], a[52:55], v[96:99]
  v_add_f32 v141, v141, v145
  v_mfma_f32_16x16x32_bf16 v[72:75], a[4:7], a[52:55], v[72:75]
  v_add_f32 v142, v142, v146
  v_mfma_f32_16x16x32_bf16 v[48:51], a[0:3], a[52:55], v[48:51]
  v_add_f32 v143, v143, v147
  ds_write_b128 v22, v[140:143]
  s_waitcnt vmcnt(18) lgkmcnt(0)
  s_barrier
  v_mfma_f32_16x16x32_bf16 v[28:31], a[56:59], a[16:19], v[28:31]
  s_add_u32 m0, s41, 61440
  s_mov_b32 s37, 3735552
  buffer_load_dwordx4 v12, s[16:19], s37 offen offset:0 lds
  ds_read_b128 a[0:3], v16 offset:49152
  v_mfma_f32_16x16x32_bf16 v[52:55], a[56:59], a[20:23], v[52:55]
  ds_read_b128 a[4:7], v16 offset:51200
  ds_read_b128 a[8:11], v16 offset:53248
  v_mfma_f32_16x16x32_bf16 v[76:79], a[56:59], a[24:27], v[76:79]
  ds_read_b128 a[12:15], v16 offset:55296
  ds_read_b64_tr_b16 a[32:33], v18 offset:0
  v_mfma_f32_16x16x32_bf16 v[100:103], a[56:59], a[28:31], v[100:103]
  buffer_load_dwordx4 v13, s[16:19], s37 offen offset:1024 lds
  ds_read_b64_tr_b16 a[34:35], v18 offset:512
  v_mfma_f32_16x16x32_bf16 v[104:107], a[60:63], a[28:31], v[104:107]
  ds_read_b64_tr_b16 a[36:37], v19 offset:0
  ds_read_b64_tr_b16 a[38:39], v19 offset:512
  v_mfma_f32_16x16x32_bf16 v[80:83], a[60:63], a[24:27], v[80:83]
  buffer_load_dwordx4 v14, s[16:19], s37 offen offset:2048 lds
  s_add_u32 m0, s40, 32768
  s_mov_b32 s36, 1280
  ds_read_b64_tr_b16 a[40:41], v18 offset:4096
  v_mfma_f32_16x16x32_bf16 v[56:59], a[60:63], a[20:23], v[56:59]
  ds_read_b64_tr_b16 a[42:43], v18 offset:4608
  ds_read_b64_tr_b16 a[44:45], v19 offset:4096
  v_mfma_f32_16x16x32_bf16 v[32:35], a[60:63], a[16:19], v[32:35]
  ds_read_b64_tr_b16 a[46:47], v19 offset:4608
  ds_read_b64_tr_b16 a[48:49], v18 offset:8192
  v_mfma_f32_16x16x32_bf16 v[36:39], a[64:67], a[16:19], v[36:39]
  buffer_load_dwordx4 v8, s[12:15], s36 offen offset:0 lds
  ds_read_b64_tr_b16 a[50:51], v18 offset:8704
  v_mfma_f32_16x16x32_bf16 v[60:63], a[64:67], a[20:23], v[60:63]
  ds_read_b64_tr_b16 a[52:53], v19 offset:8192
  ds_read_b64_tr_b16 a[54:55], v19 offset:8704
  v_mfma_f32_16x16x32_bf16 v[84:87], a[64:67], a[24:27], v[84:87]
  buffer_load_dwordx4 v9, s[12:15], s36 offen offset:1024 lds
  v_lshlrev_b32 v22, 4, v3
  v_lshl_add_u32 v22, v4, 2, v22
  v_mfma_f32_16x16x32_bf16 v[108:111], a[64:67], a[28:31], v[108:111]
  v_add_u32 v22, 151552, v22
  ds_read_b32 v160, v22 offset:0
  ds_read_b32 v161, v22 offset:256
  v_mfma_f32_16x16x32_bf16 v[112:115], a[68:71], a[28:31], v[112:115]
  ds_read_b32 v162, v22 offset:512
  ds_read_b32 v163, v22 offset:768
  s_and_b32 s28, s32, 3
  s_mul_i32 s28, s28, 12288
  v_mfma_f32_16x16x32_bf16 v[88:91], a[68:71], a[24:27], v[88:91]
  s_lshl_b32 s29, s43, 12
  s_add_u32 s28, s28, s29
  v_mfma_f32_16x16x32_bf16 v[64:67], a[68:71], a[20:23], v[64:67]
  s_lshl_b32 s29, s63, 8
  s_add_u32 s28, s28, s29
  v_mfma_f32_16x16x32_bf16 v[40:43], a[68:71], a[16:19], v[40:43]
  s_add_u32 s28, s28, 38879232
  s_lshl_b32 s29, s5, 2
  v_mfma_f32_16x16x32_bf16 v[44:47], a[16:19], a[72:75], v[44:47]
  s_or_b32 s29, s29, s43
  s_cmp_lt_u32 s29, 3
  s_cselect_b32 s28, s28, 2146435072
  v_mfma_f32_16x16x32_bf16 v[68:71], a[20:23], a[72:75], v[68:71]
  v_lshlrev_b32 v22, 2, v1
  s_waitcnt lgkmcnt(0)
  v_mfma_f32_16x16x32_bf16 v[92:95], a[24:27], a[72:75], v[92:95]
  v_add_f32 v160, v160, v161
  v_add_f32 v162, v162, v163
  v_mfma_f32_16x16x32_bf16 v[116:119], a[28:31], a[72:75], v[116:119]
  v_add_f32 v160, v160, v162
  buffer_store_dword v160, v22, s[8:11], s28 offen sc1
  v_mfma_f32_16x16x32_bf16 v[120:123], a[28:31], a[76:79], v[120:123]
  v_mfma_f32_16x16x32_bf16 v[96:99], a[24:27], a[76:79], v[96:99]
  v_mfma_f32_16x16x32_bf16 v[72:75], a[20:23], a[76:79], v[72:75]
  v_mfma_f32_16x16x32_bf16 v[48:51], a[16:19], a[76:79], v[48:51]
  s_waitcnt lgkmcnt(0)
  v_mfma_f32_16x16x32_bf16 v[28:31], a[32:35], a[0:3], v[28:31]
  s_add_u32 m0, s41, 73728
  ds_read_b128 a[16:19], v17 offset:49152
  v_mfma_f32_16x16x32_bf16 v[52:55], a[32:35], a[4:7], v[52:55]
  s_mov_b32 s37, 3932160
  buffer_load_dwordx4 v12, s[16:19], s37 offen offset:0 lds
  v_mfma_f32_16x16x32_bf16 v[76:79], a[32:35], a[8:11], v[76:79]
  ds_read_b128 a[20:23], v17 offset:51200
  v_mfma_f32_16x16x32_bf16 v[100:103], a[32:35], a[12:15], v[100:103]
  ds_read_b128 a[24:27], v17 offset:53248
  v_mfma_f32_16x16x32_bf16 v[104:107], a[36:39], a[12:15], v[104:107]
  ds_read_b128 a[28:31], v17 offset:55296
  v_mfma_f32_16x16x32_bf16 v[80:83], a[36:39], a[8:11], v[80:83]
  buffer_load_dwordx4 v13, s[16:19], s37 offen offset:1024 lds
  v_mfma_f32_16x16x32_bf16 v[56:59], a[36:39], a[4:7], v[56:59]
  ds_read_b64_tr_b16 a[56:57], v18 offset:12288
  v_mfma_f32_16x16x32_bf16 v[32:35], a[36:39], a[0:3], v[32:35]
  ds_read_b64_tr_b16 a[58:59], v18 offset:12800
  v_mfma_f32_16x16x32_bf16 v[36:39], a[40:43], a[0:3], v[36:39]
  ds_read_b64_tr_b16 a[60:61], v19 offset:12288
  v_mfma_f32_16x16x32_bf16 v[60:63], a[40:43], a[4:7], v[60:63]
  ds_read_b64_tr_b16 a[62:63], v19 offset:12800
  v_mfma_f32_16x16x32_bf16 v[84:87], a[40:43], a[8:11], v[84:87]
  buffer_load_dwordx4 v14, s[16:19], s37 offen offset:2048 lds
  s_add_u32 m0, s40, 32768
  v_mfma_f32_16x16x32_bf16 v[108:111], a[40:43], a[12:15], v[108:111]
  s_mov_b32 s36, 1280
  ds_read_b64_tr_b16 a[64:65], v18 offset:16384
  v_mfma_f32_16x16x32_bf16 v[112:115], a[44:47], a[12:15], v[112:115]
  ds_read_b64_tr_b16 a[66:67], v18 offset:16896
  v_mfma_f32_16x16x32_bf16 v[88:91], a[44:47], a[8:11], v[88:91]
  ds_read_b64_tr_b16 a[68:69], v19 offset:16384
  v_mfma_f32_16x16x32_bf16 v[64:67], a[44:47], a[4:7], v[64:67]
  ds_read_b64_tr_b16 a[70:71], v19 offset:16896
  v_mfma_f32_16x16x32_bf16 v[40:43], a[44:47], a[0:3], v[40:43]
  buffer_load_dwordx4 v10, s[12:15], s36 offen offset:2048 lds
  v_mfma_f32_16x16x32_bf16 v[44:47], a[0:3], a[48:51], v[44:47]
  ds_read_b64_tr_b16 a[72:73], v18 offset:20480
  v_mfma_f32_16x16x32_bf16 v[68:71], a[4:7], a[48:51], v[68:71]
  ds_read_b64_tr_b16 a[74:75], v18 offset:20992
  v_mfma_f32_16x16x32_bf16 v[92:95], a[8:11], a[48:51], v[92:95]
  ds_read_b64_tr_b16 a[76:77], v19 offset:20480
  v_mfma_f32_16x16x32_bf16 v[116:119], a[12:15], a[48:51], v[116:119]
  ds_read_b64_tr_b16 a[78:79], v19 offset:20992
  v_mfma_f32_16x16x32_bf16 v[120:123], a[12:15], a[52:55], v[120:123]
  buffer_load_dwordx4 v11, s[12:15], s36 offen offset:3072 lds
  s_waitcnt vmcnt(5)
  v_mfma_f32_16x16x32_bf16 v[96:99], a[8:11], a[52:55], v[96:99]
  v_cmp_eq_u32 vcc, 0, v182
  s_nop 1
  s_cmp_lg_u64 vcc, 0
  s_cbranch_scc1 L_p1d_spin
L_p1d_back:
  v_mfma_f32_16x16x32_bf16 v[72:75], a[4:7], a[52:55], v[72:75]
  v_mfma_f32_16x16x32_bf16 v[48:51], a[0:3], a[52:55], v[48:51]
  s_waitcnt vmcnt(18) lgkmcnt(0)
  s_barrier
  v_mfma_f32_16x16x32_bf16 v[28:31], a[56:59], a[16:19], v[28:31]
  s_add_u32 m0, s41, 0
  ds_read_b128 a[0:3], v16 offset:0
  ds_read_b128 a[4:7], v16 offset:2048
  v_mfma_f32_16x16x32_bf16 v[52:55], a[56:59], a[20:23], v[52:55]
  s_mov_b32 s37, 4128768
  buffer_load_dwordx4 v12, s[16:19], s37 offen offset:0 lds
  ds_read_b128 a[8:11], v16 offset:4096
  v_mfma_f32_16x16x32_bf16 v[76:79], a[56:59], a[24:27], v[76:79]
  ds_read_b128 a[12:15], v16 offset:6144
  ds_read_b64_tr_b16 a[32:33], v18 offset:24576
  v_mfma_f32_16x16x32_bf16 v[100:103], a[56:59], a[28:31], v[100:103]
  ds_read_b64_tr_b16 a[34:35], v18 offset:25088
  ds_read_b64_tr_b16 a[36:37], v19 offset:24576
  v_mfma_f32_16x16x32_bf16 v[104:107], a[60:63], a[28:31], v[104:107]
  buffer_load_dwordx4 v13, s[16:19], s37 offen offset:1024 lds
  ds_read_b64_tr_b16 a[38:39], v19 offset:25088
  v_mfma_f32_16x16x32_bf16 v[80:83], a[60:63], a[24:27], v[80:83]
  ds_read_b64_tr_b16 a[40:41], v18 offset:28672
  ds_read_b64_tr_b16 a[42:43], v18 offset:29184
  v_mfma_f32_16x16x32_bf16 v[56:59], a[60:63], a[20:23], v[56:59]
  ds_read_b64_tr_b16 a[44:45], v19 offset:28672
  ds_read_b64_tr_b16 a[46:47], v19 offset:29184
  v_mfma_f32_16x16x32_bf16 v[32:35], a[60:63], a[16:19], v[32:35]
  buffer_load_dwordx4 v14, s[16:19], s37 offen offset:2048 lds
  s_add_u32 m0, s40, 49152
  ds_read_b64_tr_b16 a[48:49], v18 offset:32768
  v_mfma_f32_16x16x32_bf16 v[36:39], a[64:67], a[16:19], v[36:39]
  s_mov_b32 s36, 1408
  ds_read_b64_tr_b16 a[50:51], v18 offset:33280
  ds_read_b64_tr_b16 a[52:53], v19 offset:32768
  v_mfma_f32_16x16x32_bf16 v[60:63], a[64:67], a[20:23], v[60:63]
  ds_read_b64_tr_b16 a[54:55], v19 offset:33280
  buffer_load_dwordx4 v8, s[12:15], s36 offen offset:0 lds
  v_mfma_f32_16x16x32_bf16 v[84:87], a[64:67], a[24:27], v[84:87]
  buffer_load_dwordx4 v9, s[12:15], s36 offen offset:1024 lds
  v_mov_b32 v22, 1
  v_mfma_f32_16x16x32_bf16 v[108:111], a[64:67], a[28:31], v[108:111]
  v_mov_b32 v23, 0
  v_mfma_f32_16x16x32_bf16 v[112:115], a[68:71], a[28:31], v[112:115]
  s_lshl_b32 s28, s32, 7
  v_mfma_f32_16x16x32_bf16 v[88:91], a[68:71], a[24:27], v[88:91]
  s_lshl_b32 s29, s33, 2
  v_mfma_f32_16x16x32_bf16 v[64:67], a[68:71], a[20:23], v[64:67]
  s_add_u32 s28, s28, s29
  v_mfma_f32_16x16x32_bf16 v[40:43], a[68:71], a[16:19], v[40:43]
  s_add_u32 s28, s28, 39845888
  v_mfma_f32_16x16x32_bf16 v[44:47], a[16:19], a[72:75], v[44:47]
  s_cmp_eq_u32 s5, 0
  s_cselect_b32 s28, s28, 2146435072
  buffer_store_dword v22, v23, s[8:11], s28 offen sc1
  v_mfma_f32_16x16x32_bf16 v[68:71], a[20:23], a[72:75], v[68:71]
  s_lshl_b32 s28, s33, 7
  v_mfma_f32_16x16x32_bf16 v[92:95], a[24:27], a[72:75], v[92:95]
  s_lshl_b32 s29, s32, 2
  v_mfma_f32_16x16x32_bf16 v[116:119], a[28:31], a[72:75], v[116:119]
  s_add_u32 s28, s28, s29
  v_mfma_f32_16x16x32_bf16 v[120:123], a[28:31], a[76:79], v[120:123]
  s_add_u32 s28, s28, 39847936
  v_mfma_f32_16x16x32_bf16 v[96:99], a[24:27], a[76:79], v[96:99]
  s_cmp_eq_u32 s5, 0
  s_cselect_b32 s28, s28, 2146435072
  buffer_store_dword v22, v23, s[8:11], s28 offen sc1
  v_mfma_f32_16x16x32_bf16 v[72:75], a[20:23], a[76:79], v[72:75]
  v_mfma_f32_16x16x32_bf16 v[48:51], a[16:19], a[76:79], v[48:51]
  s_waitcnt lgkmcnt(0)
  v_mfma_f32_16x16x32_bf16 v[28:31], a[32:35], a[0:3], v[28:31]
  s_add_u32 m0, s41, 12288
  ds_read_b128 a[16:19], v17 offset:0
  v_mfma_f32_16x16x32_bf16 v[52:55], a[32:35], a[4:7], v[52:55]
  s_mov_b32 s37, 4325376
  buffer_load_dwordx4 v12, s[16:19], s37 offen offset:0 lds
  v_mfma_f32_16x16x32_bf16 v[76:79], a[32:35], a[8:11], v[76:79]
  ds_read_b128 a[20:23], v17 offset:2048
  v_mfma_f32_16x16x32_bf16 v[100:103], a[32:35], a[12:15], v[100:103]
  ds_read_b128 a[24:27], v17 offset:4096
  v_mfma_f32_16x16x32_bf16 v[104:107], a[36:39], a[12:15], v[104:107]
  ds_read_b128 a[28:31], v17 offset:6144
  v_mfma_f32_16x16x32_bf16 v[80:83], a[36:39], a[8:11], v[80:83]
  buffer_load_dwordx4 v13, s[16:19], s37 offen offset:1024 lds
  v_mfma_f32_16x16x32_bf16 v[56:59], a[36:39], a[4:7], v[56:59]
  ds_read_b64_tr_b16 a[56:57], v18 offset:36864
  v_mfma_f32_16x16x32_bf16 v[32:35], a[36:39], a[0:3], v[32:35]
  ds_read_b64_tr_b16 a[58:59], v18 offset:37376
  v_mfma_f32_16x16x32_bf16 v[36:39], a[40:43], a[0:3], v[36:39]
  ds_read_b64_tr_b16 a[60:61], v19 offset:36864
  v_mfma_f32_16x16x32_bf16 v[60:63], a[40:43], a[4:7], v[60:63]
  ds_read_b64_tr_b16 a[62:63], v19 offset:37376
  v_mfma_f32_16x16x32_bf16 v[84:87], a[40:43], a[8:11], v[84:87]
  buffer_load_dwordx4 v14, s[16:19], s37 offen offset:2048 lds
  s_add_u32 m0, s40, 49152
  v_mfma_f32_16x16x32_bf16 v[108:111], a[40:43], a[12:15], v[108:111]
  s_mov_b32 s36, 1408
  ds_read_b64_tr_b16 a[64:65], v18 offset:40960
  v_mfma_f32_16x16x32_bf16 v[112:115], a[44:47], a[12:15], v[112:115]
  ds_read_b64_tr_b16 a[66:67], v18 offset:41472
  v_mfma_f32_16x16x32_bf16 v[88:91], a[44:47], a[8:11], v[88:91]
  ds_read_b64_tr_b16 a[68:69], v19 offset:40960
  v_mfma_f32_16x16x32_bf16 v[64:67], a[44:47], a[4:7], v[64:67]
  ds_read_b64_tr_b16 a[70:71], v19 offset:41472
  v_mfma_f32_16x16x32_bf16 v[40:43], a[44:47], a[0:3], v[40:43]
  buffer_load_dwordx4 v10, s[12:15], s36 offen offset:2048 lds
  v_mfma_f32_16x16x32_bf16 v[44:47], a[0:3], a[48:51], v[44:47]
  ds_read_b64_tr_b16 a[72:73], v18 offset:45056
  v_mfma_f32_16x16x32_bf16 v[68:71], a[4:7], a[48:51], v[68:71]
  ds_read_b64_tr_b16 a[74:75], v18 offset:45568
  v_mfma_f32_16x16x32_bf16 v[92:95], a[8:11], a[48:51], v[92:95]
  ds_read_b64_tr_b16 a[76:77], v19 offset:45056
  v_mfma_f32_16x16x32_bf16 v[116:119], a[12:15], a[48:51], v[116:119]
  ds_read_b64_tr_b16 a[78:79], v19 offset:45568
  v_mfma_f32_16x16x32_bf16 v[120:123], a[12:15], a[52:55], v[120:123]
  buffer_load_dwordx4 v11, s[12:15], s36 offen offset:3072 lds
  v_mfma_f32_16x16x32_bf16 v[96:99], a[8:11], a[52:55], v[96:99]
  v_mfma_f32_16x16x32_bf16 v[72:75], a[4:7], a[52:55], v[72:75]
  v_mfma_f32_16x16x32_bf16 v[48:51], a[0:3], a[52:55], v[48:51]
  s_waitcnt vmcnt(20) lgkmcnt(0)
  s_barrier
  v_mfma_f32_16x16x32_bf16 v[28:31], a[56:59], a[16:19], v[28:31]
  s_add_u32 m0, s41, 24576
  ds_read_b128 a[0:3], v16 offset:16384
  v_mfma_f32_16x16x32_bf16 v[52:55], a[56:59], a[20:23], v[52:55]
  s_mov_b32 s37, 4521984
  buffer_load_dwordx4 v12, s[16:19], s37 offen offset:0 lds
  v_mfma_f32_16x16x32_bf16 v[76:79], a[56:59], a[24:27], v[76:79]
  ds_read_b128 a[4:7], v16 offset:18432
  v_mfma_f32_16x16x32_bf16 v[100:103], a[56:59], a[28:31], v[100:103]
  ds_read_b128 a[8:11], v16 offset:20480
  v_mfma_f32_16x16x32_bf16 v[104:107], a[60:63], a[28:31], v[104:107]
  ds_read_b128 a[12:15], v16 offset:22528
  v_mfma_f32_16x16x32_bf16 v[80:83], a[60:63], a[24:27], v[80:83]
  buffer_load_dwordx4 v13, s[16:19], s37 offen offset:1024 lds
  v_mfma_f32_16x16x32_bf16 v[56:59], a[60:63], a[20:23], v[56:59]
  ds_read_b64_tr_b16 a[32:33], v20 offset:0
  v_mfma_f32_16x16x32_bf16 v[32:35], a[60:63], a[16:19], v[32:35]
  ds_read_b64_tr_b16 a[34:35], v20 offset:512
  v_mfma_f32_16x16x32_bf16 v[36:39], a[64:67], a[16:19], v[36:39]
  ds_read_b64_tr_b16 a[36:37], v21 offset:0
  v_mfma_f32_16x16x32_bf16 v[60:63], a[64:67], a[20:23], v[60:63]
  ds_read_b64_tr_b16 a[38:39], v21 offset:512
  v_mfma_f32_16x16x32_bf16 v[84:87], a[64:67], a[24:27], v[84:87]
  buffer_load_dwordx4 v14, s[16:19], s37 offen offset:2048 lds
  s_add_u32 m0, s40, 0
  v_mfma_f32_16x16x32_bf16 v[108:111], a[64:67], a[28:31], v[108:111]
  s_mov_b32 s36, 1536
  ds_read_b64_tr_b16 a[40:41], v20 offset:4096
  v_mfma_f32_16x16x32_bf16 v[112:115], a[68:71], a[28:31], v[112:115]
  ds_read_b64_tr_b16 a[42:43], v20 offset:4608
  v_mfma_f32_16x16x32_bf16 v[88:91], a[68:71], a[24:27], v[88:91]
  ds_read_b64_tr_b16 a[44:45], v21 offset:4096
  v_mfma_f32_16x16x32_bf16 v[64:67], a[68:71], a[20:23], v[64:67]
  ds_read_b64_tr_b16 a[46:47], v21 offset:4608
  v_mfma_f32_16x16x32_bf16 v[40:43], a[68:71], a[16:19], v[40:43]
  buffer_load_dwordx4 v8, s[12:15], s36 offen offset:0 lds
  v_mfma_f32_16x16x32_bf16 v[44:47], a[16:19], a[72:75], v[44:47]
  ds_read_b64_tr_b16 a[48:49], v20 offset:8192
  v_mfma_f32_16x16x32_bf16 v[68:71], a[20:23], a[72:75], v[68:71]
  ds_read_b64_tr_b16 a[50:51], v20 offset:8704
  v_mfma_f32_16x16x32_bf16 v[92:95], a[24:27], a[72:75], v[92:95]
  ds_read_b64_tr_b16 a[52:53], v21 offset:8192
  v_mfma_f32_16x16x32_bf16 v[116:119], a[28:31], a[72:75], v[116:119]
  ds_read_b64_tr_b16 a[54:55], v21 offset:8704
  v_mfma_f32_16x16x32_bf16 v[120:123], a[28:31], a[76:79], v[120:123]
  buffer_load_dwordx4 v9, s[12:15], s36 offen offset:1024 lds
  v_mfma_f32_16x16x32_bf16 v[96:99], a[24:27], a[76:79], v[96:99]
  v_mfma_f32_16x16x32_bf16 v[72:75], a[20:23], a[76:79], v[72:75]
  v_mfma_f32_16x16x32_bf16 v[48:51], a[16:19], a[76:79], v[48:51]
  s_waitcnt lgkmcnt(0)
  v_mfma_f32_16x16x32_bf16 v[28:31], a[32:35], a[0:3], v[28:31]
  s_add_u32 m0, s41, 36864
  ds_read_b128 a[16:19], v17 offset:16384
  v_mfma_f32_16x16x32_bf16 v[52:55], a[32:35], a[4:7], v[52:55]
  s_mov_b32 s37, 4718592
  buffer_load_dwordx4 v12, s[16:19], s37 offen offset:0 lds
  v_mfma_f32_16x16x32_bf16 v[76:79], a[32:35], a[8:11], v[76:79]
  ds_read_b128 a[20:23], v17 offset:18432
  v_mfma_f32_16x16x32_bf16 v[100:103], a[32:35], a[12:15], v[100:103]
  ds_read_b128 a[24:27], v17 offset:20480
  v_mfma_f32_16x16x32_bf16 v[104:107], a[36:39], a[12:15], v[104:107]
  ds_read_b128 a[28:31], v17 offset:22528
  v_mfma_f32_16x16x32_bf16 v[80:83], a[36:39], a[8:11], v[80:83]
  buffer_load_dwordx4 v13, s[16:19], s37 offen offset:1024 lds
  v_mfma_f32_16x16x32_bf16 v[56:59], a[36:39], a[4:7], v[56:59]
  ds_read_b64_tr_b16 a[56:57], v20 offset:12288
  v_mfma_f32_16x16x32_bf16 v[32:35], a[36:39], a[0:3], v[32:35]
  ds_read_b64_tr_b16 a[58:59], v20 offset:12800
  v_mfma_f32_16x16x32_bf16 v[36:39], a[40:43], a[0:3], v[36:39]
  ds_read_b64_tr_b16 a[60:61], v21 offset:12288
  v_mfma_f32_16x16x32_bf16 v[60:63], a[40:43], a[4:7], v[60:63]
  ds_read_b64_tr_b16 a[62:63], v21 offset:12800
  v_mfma_f32_16x16x32_bf16 v[84:87], a[40:43], a[8:11], v[84:87]
  buffer_load_dwordx4 v14, s[16:19], s37 offen offset:2048 lds
  s_add_u32 m0, s40, 0
  v_mfma_f32_16x16x32_bf16 v[108:111], a[40:43], a[12:15], v[108:111]
  s_mov_b32 s36, 1536
  ds_read_b64_tr_b16 a[64:65], v20 offset:16384
  v_mfma_f32_16x16x32_bf16 v[112:115], a[44:47], a[12:15], v[112:115]
  ds_read_b64_tr_b16 a[66:67], v20 offset:16896
  v_mfma_f32_16x16x32_bf16 v[88:91], a[44:47], a[8:11], v[88:91]
  ds_read_b64_tr_b16 a[68:69], v21 offset:16384
  v_mfma_f32_16x16x32_bf16 v[64:67], a[44:47], a[4:7], v[64:67]
  ds_read_b64_tr_b16 a[70:71], v21 offset:16896
  v_mfma_f32_16x16x32_bf16 v[40:43], a[44:47], a[0:3], v[40:43]
  buffer_load_dwordx4 v10, s[12:15], s36 offen offset:2048 lds
  v_mfma_f32_16x16x32_bf16 v[44:47], a[0:3], a[48:51], v[44:47]
  ds_read_b64_tr_b16 a[72:73], v20 offset:20480
  v_mfma_f32_16x16x32_bf16 v[68:71], a[4:7], a[48:51], v[68:71]
  ds_read_b64_tr_b16 a[74:75], v20 offset:20992
  v_mfma_f32_16x16x32_bf16 v[92:95], a[8:11], a[48:51], v[92:95]
  ds_read_b64_tr_b16 a[76:77], v21 offset:20480
  v_mfma_f32_16x16x32_bf16 v[116:119], a[12:15], a[48:51], v[116:119]
  ds_read_b64_tr_b16 a[78:79], v21 offset:20992
  v_mfma_f32_16x16x32_bf16 v[120:123], a[12:15], a[52:55], v[120:123]
  buffer_load_dwordx4 v11, s[12:15], s36 offen offset:3072 lds
  v_mfma_f32_16x16x32_bf16 v[96:99], a[8:11], a[52:55], v[96:99]
  v_mfma_f32_16x16x32_bf16 v[72:75], a[4:7], a[52:55], v[72:75]
  v_mfma_f32_16x16x32_bf16 v[48:51], a[0:3], a[52:55], v[48:51]
  s_waitcnt vmcnt(19) lgkmcnt(0)
  s_barrier
  v_mfma_f32_16x16x32_bf16 v[28:31], a[56:59], a[16:19], v[28:31]
  s_add_u32 m0, s41, 49152
  ds_read_b128 a[0:3], v16 offset:32768
  v_mfma_f32_16x16x32_bf16 v[52:55], a[56:59], a[20:23], v[52:55]
  s_mov_b32 s37, 4915200
  buffer_load_dwordx4 v12, s[16:19], s37 offen offset:0 lds
  v_mfma_f32_16x16x32_bf16 v[76:79], a[56:59], a[24:27], v[76:79]
  ds_read_b128 a[4:7], v16 offset:34816
  v_mfma_f32_16x16x32_bf16 v[100:103], a[56:59], a[28:31], v[100:103]
  ds_read_b128 a[8:11], v16 offset:36864
  v_mfma_f32_16x16x32_bf16 v[104:107], a[60:63], a[28:31], v[104:107]
  ds_read_b128 a[12:15], v16 offset:38912
  v_mfma_f32_16x16x32_bf16 v[80:83], a[60:63], a[24:27], v[80:83]
  buffer_load_dwordx4 v13, s[16:19], s37 offen offset:1024 lds
  v_mfma_f32_16x16x32_bf16 v[56:59], a[60:63], a[20:23], v[56:59]
  ds_read_b64_tr_b16 a[32:33], v20 offset:24576
  v_mfma_f32_16x16x32_bf16 v[32:35], a[60:63], a[16:19], v[32:35]
  ds_read_b64_tr_b16 a[34:35], v20 offset:25088
  v_mfma_f32_16x16x32_bf16 v[36:39], a[64:67], a[16:19], v[36:39]
  ds_read_b64_tr_b16 a[36:37], v21 offset:24576
  v_mfma_f32_16x16x32_bf16 v[60:63], a[64:67], a[20:23], v[60:63]
  ds_read_b64_tr_b16 a[38:39], v21 offset:25088
  v_mfma_f32_16x16x32_bf16 v[84:87], a[64:67], a[24:27], v[84:87]
  buffer_load_dwordx4 v14, s[16:19], s37 offen offset:2048 lds
  s_add_u32 m0, s40, 16384
  v_mfma_f32_16x16x32_bf16 v[108:111], a[64:67], a[28:31], v[108:111]
  s_mov_b32 s36, 1664
  ds_read_b64_tr_b16 a[40:41], v20 offset:28672
  v_mfma_f32_16x16x32_bf16 v[112:115], a[68:71], a[28:31], v[112:115]
  ds_read_b64_tr_b16 a[42:43], v20 offset:29184
  v_mfma_f32_16x16x32_bf16 v[88:91], a[68:71], a[24:27], v[88:91]
  ds_read_b64_tr_b16 a[44:45], v21 offset:28672
  v_mfma_f32_16x16x32_bf16 v[64:67], a[68:71], a[20:23], v[64:67]
  ds_read_b64_tr_b16 a[46:47], v21 offset:29184
  v_mfma_f32_16x16x32_bf16 v[40:43], a[68:71], a[16:19], v[40:43]
  buffer_load_dwordx4 v8, s[12:15], s36 offen offset:0 lds
  v_mfma_f32_16x16x32_bf16 v[44:47], a[16:19], a[72:75], v[44:47]
  ds_read_b64_tr_b16 a[48:49], v20 offset:32768
  v_mfma_f32_16x16x32_bf16 v[68:71], a[20:23], a[72:75], v[68:71]
  ds_read_b64_tr_b16 a[50:51], v20 offset:33280
  v_mfma_f32_16x16x32_bf16 v[92:95], a[24:27], a[72:75], v[92:95]
  ds_read_b64_tr_b16 a[52:53], v21 offset:32768
  v_mfma_f32_16x16x32_bf16 v[116:119], a[28:31], a[72:75], v[116:119]
  ds_read_b64_tr_b16 a[54:55], v21 offset:33280
  v_mfma_f32_16x16x32_bf16 v[120:123], a[28:31], a[76:79], v[120:123]
  buffer_load_dwordx4 v9, s[12:15], s36 offen offset:1024 lds
  v_mfma_f32_16x16x32_bf16 v[96:99], a[24:27], a[76:79], v[96:99]
  v_mfma_f32_16x16x32_bf16 v[72:75], a[20:23], a[76:79], v[72:75]
  v_mfma_f32_16x16x32_bf16 v[48:51], a[16:19], a[76:79], v[48:51]
  s_waitcnt lgkmcnt(0)
  v_mfma_f32_16x16x32_bf16 v[28:31], a[32:35], a[0:3], v[28:31]
  s_add_u32 m0, s41, 61440
  ds_read_b128 a[16:19], v17 offset:32768
  ds_read_b128 a[20:23], v17 offset:34816
  v_mfma_f32_16x16x32_bf16 v[52:55], a[32:35], a[4:7], v[52:55]
  s_mov_b32 s37, 5111808
  buffer_load_dwordx4 v12, s[16:19], s37 offen offset:0 lds
  ds_read_b128 a[24:27], v17 offset:36864
  v_mfma_f32_16x16x32_bf16 v[76:79], a[32:35], a[8:11], v[76:79]
  ds_read_b128 a[28:31], v17 offset:38912
  ds_read_b64_tr_b16 a[56:57], v18 offset:0
  v_mfma_f32_16x16x32_bf16 v[100:103], a[32:35], a[12:15], v[100:103]
  ds_read_b64_tr_b16 a[58:59], v18 offset:512
  ds_read_b64_tr_b16 a[60:61], v19 offset:0
  v_mfma_f32_16x16x32_bf16 v[104:107], a[36:39], a[12:15], v[104:107]
  buffer_load_dwordx4 v13, s[16:19], s37 offen offset:1024 lds
  ds_read_b64_tr_b16 a[62:63], v19 offset:512
  v_mfma_f32_16x16x32_bf16 v[80:83], a[36:39], a[8:11], v[80:83]
  ds_read_b64_tr_b16 a[64:65], v18 offset:4096
  ds_read_b64_tr_b16 a[66:67], v18 offset:4608
  v_mfma_f32_16x16x32_bf16 v[56:59], a[36:39], a[4:7], v[56:59]
  ds_read_b64_tr_b16 a[68:69], v19 offset:4096
  ds_read_b64_tr_b16 a[70:71], v19 offset:4608
  v_mfma_f32_16x16x32_bf16 v[32:35], a[36:39], a[0:3], v[32:35]
  ds_read_b64_tr_b16 a[72:73], v18 offset:8192
  ds_read_b64_tr_b16 a[74:75], v18 offset:8704
  v_mfma_f32_16x16x32_bf16 v[36:39], a[40:43], a[0:3], v[36:39]
  buffer_load_dwordx4 v14, s[16:19], s37 offen offset:2048 lds
  s_add_u32 m0, s40, 16384
  ds_read_b64_tr_b16 a[76:77], v19 offset:8192
  v_mfma_f32_16x16x32_bf16 v[60:63], a[40:43], a[4:7], v[60:63]
  s_mov_b32 s36, 1664
  ds_read_b64_tr_b16 a[78:79], v19 offset:8704
  buffer_load_dwordx4 v10, s[12:15], s36 offen offset:2048 lds
  v_mfma_f32_16x16x32_bf16 v[84:87], a[40:43], a[8:11], v[84:87]
  buffer_load_dwordx4 v11, s[12:15], s36 offen offset:3072 lds
  s_lshl_b32 s28, s32, 7
  v_mfma_f32_16x16x32_bf16 v[108:111], a[40:43], a[12:15], v[108:111]
  s_add_u32 s28, s28, 39845888
  v_mfma_f32_16x16x32_bf16 v[112:115], a[44:47], a[12:15], v[112:115]
  s_lshl_b32 s29, s33, 7
  v_mfma_f32_16x16x32_bf16 v[88:91], a[44:47], a[8:11], v[88:91]
  s_add_u32 s29, s29, 39847936
  v_mfma_f32_16x16x32_bf16 v[64:67], a[44:47], a[4:7], v[64:67]
  v_and_b32 v24, 1, v4
  v_mfma_f32_16x16x32_bf16 v[40:43], a[44:47], a[0:3], v[40:43]
  v_mov_b32 v25, s28
  v_mfma_f32_16x16x32_bf16 v[44:47], a[0:3], a[48:51], v[44:47]
  v_mov_b32 v182, s29
  v_mfma_f32_16x16x32_bf16 v[68:71], a[4:7], a[48:51], v[68:71]
  v_cmp_eq_u32 vcc, 0, v24
  s_nop 1
  v_cndmask_b32 v25, v182, v25, vcc
  v_mfma_f32_16x16x32_bf16 v[92:95], a[8:11], a[48:51], v[92:95]
  v_lshl_add_u32 v25, v3, 2, v25
  v_mfma_f32_16x16x32_bf16 v[116:119], a[12:15], a[48:51], v[116:119]
  v_mov_b32 v182, 1
  s_cmp_lg_u32 s5, 0
  s_cbranch_scc1 L_p1_nf
  buffer_load_dword v182, v25, s[8:11], 0 offen sc1
L_p1_nf:
  v_mfma_f32_16x16x32_bf16 v[120:123], a[12:15], a[52:55], v[120:123]
  v_mfma_f32_16x16x32_bf16 v[96:99], a[8:11], a[52:55], v[96:99]
  v_mfma_f32_16x16x32_bf16 v[72:75], a[4:7], a[52:55], v[72:75]
  v_mfma_f32_16x16x32_bf16 v[48:51], a[0:3], a[52:55], v[48:51]
  s_waitcnt vmcnt(17) lgkmcnt(0)
  s_barrier
  v_mfma_f32_16x16x32_bf16 v[28:31], a[56:59], a[16:19], v[28:31]
  s_add_u32 m0, s41, 73728
  ds_read_b128 a[0:3], v16 offset:49152
  v_mfma_f32_16x16x32_bf16 v[52:55], a[56:59], a[20:23], v[52:55]
  s_mov_b32 s37, 5308416
  buffer_load_dwordx4 v12, s[16:19], s37 offen offset:0 lds
  v_mfma_f32_16x16x32_bf16 v[76:79], a[56:59], a[24:27], v[76:79]
  ds_read_b128 a[4:7], v16 offset:51200
  v_mfma_f32_16x16x32_bf16 v[100:103], a[56:59], a[28:31], v[100:103]
  ds_read_b128 a[8:11], v16 offset:53248
  v_mfma_f32_16x16x32_bf16 v[104:107], a[60:63], a[28:31], v[104:107]
  ds_read_b128 a[12:15], v16 offset:55296
  v_mfma_f32_16x16x32_bf16 v[80:83], a[60:63], a[24:27], v[80:83]
  buffer_load_dwordx4 v13, s[16:19], s37 offen offset:1024 lds
  v_mfma_f32_16x16x32_bf16 v[56:59], a[60:63], a[20:23], v[56:59]
  ds_read_b64_tr_b16 a[32:33], v18 offset:12288
  v_mfma_f32_16x16x32_bf16 v[32:35], a[60:63], a[16:19], v[32:35]
  ds_read_b64_tr_b16 a[34:35], v18 offset:12800
  v_mfma_f32_16x16x32_bf16 v[36:39], a[64:67], a[16:19], v[36:39]
  ds_read_b64_tr_b16 a[36:37], v19 offset:12288
  v_mfma_f32_16x16x32_bf16 v[60:63], a[64:67], a[20:23], v[60:63]
  ds_read_b64_tr_b16 a[38:39], v19 offset:12800
  v_mfma_f32_16x16x32_bf16 v[84:87], a[64:67], a[24:27], v[84:87]
  buffer_load_dwordx4 v14, s[16:19], s37 offen offset:2048 lds
  s_add_u32 m0, s40, 32768
  v_mfma_f32_16x16x32_bf16 v[108:111], a[64:67], a[28:31], v[108:111]
  s_mov_b32 s36, 1792
  ds_read_b64_tr_b16 a[40:41], v18 offset:16384
  v_mfma_f32_16x16x32_bf16 v[112:115], a[68:71], a[28:31], v[112:115]
  ds_read_b64_tr_b16 a[42:43], v18 offset:16896
  v_mfma_f32_16x16x32_bf16 v[88:91], a[68:71], a[24:27], v[88:91]
  ds_read_b64_tr_b16 a[44:45], v19 offset:16384
  v_mfma_f32_16x16x32_bf16 v[64:67], a[68:71], a[20:23], v[64:67]
  ds_read_b64_tr_b16 a[46:47], v19 offset:16896
  v_mfma_f32_16x16x32_bf16 v[40:43], a[68:71], a[16:19], v[40:43]
  buffer_load_dwordx4 v8, s[12:15], s36 offen offset:0 lds
  v_mfma_f32_16x16x32_bf16 v[44:47], a[16:19], a[72:75], v[44:47]
  ds_read_b64_tr_b16 a[48:49], v18 offset:20480
  v_mfma_f32_16x16x32_bf16 v[68:71], a[20:23], a[72:75], v[68:71]
  ds_read_b64_tr_b16 a[50:51], v18 offset:20992
  v_mfma_f32_16x16x32_bf16 v[92:95], a[24:27], a[72:75], v[92:95]
  ds_read_b64_tr_b16 a[52:53], v19 offset:20480
  v_mfma_f32_16x16x32_bf16 v[116:119], a[28:31], a[72:75], v[116:119]
  ds_read_b64_tr_b16 a[54:55], v19 offset:20992
  v_mfma_f32_16x16x32_bf16 v[120:123], a[28:31], a[76:79], v[120:123]
  buffer_load_dwordx4 v9, s[12:15], s36 offen offset:1024 lds
  v_mfma_f32_16x16x32_bf16 v[96:99], a[24:27], a[76:79], v[96:99]
  v_mfma_f32_16x16x32_bf16 v[72:75], a[20:23], a[76:79], v[72:75]
  v_mfma_f32_16x16x32_bf16 v[48:51], a[16:19], a[76:79], v[48:51]
  s_waitcnt lgkmcnt(0)
  v_mfma_f32_16x16x32_bf16 v[28:31], a[32:35], a[0:3], v[28:31]
  s_add_u32 m0, s41, 0
  ds_read_b128 a[16:19], v17 offset:49152
  v_mfma_f32_16x16x32_bf16 v[52:55], a[32:35], a[4:7], v[52:55]
  s_mov_b32 s37, 5505024
  buffer_load_dwordx4 v12, s[16:19], s37 offen offset:0 lds
  v_mfma_f32_16x16x32_bf16 v[76:79], a[32:35], a[8:11], v[76:79]
  ds_read_b128 a[20:23], v17 offset:51200
  v_mfma_f32_16x16x32_bf16 v[100:103], a[32:35], a[12:15], v[100:103]
  ds_read_b128 a[24:27], v17 offset:53248
  v_mfma_f32_16x16x32_bf16 v[104:107], a[36:39], a[12:15], v[104:107]
  ds_read_b128 a[28:31], v17 offset:55296
  v_mfma_f32_16x16x32_bf16 v[80:83], a[36:39], a[8:11], v[80:83]
  buffer_load_dwordx4 v13, s[16:19], s37 offen offset:1024 lds
  v_mfma_f32_16x16x32_bf16 v[56:59], a[36:39], a[4:7], v[56:59]
  ds_read_b64_tr_b16 a[56:57], v18 offset:24576
  v_mfma_f32_16x16x32_bf16 v[32:35], a[36:39], a[0:3], v[32:35]
  ds_read_b64_tr_b16 a[58:59], v18 offset:25088
  v_mfma_f32_16x16x32_bf16 v[36:39], a[40:43], a[0:3], v[36:39]
  ds_read_b64_tr_b16 a[60:61], v19 offset:24576
  v_mfma_f32_16x16x32_bf16 v[60:63], a[40:43], a[4:7], v[60:63]
  ds_read_b64_tr_b16 a[62:63], v19 offset:25088
  v_mfma_f32_16x16x32_bf16 v[84:87], a[40:43], a[8:11], v[84:87]
  buffer_load_dwordx4 v14, s[16:19], s37 offen offset:2048 lds
  s_add_u32 m0, s40, 32768
  v_mfma_f32_16x16x32_bf16 v[108:111], a[40:43], a[12:15], v[108:111]
  s_mov_b32 s36, 1792
  ds_read_b64_tr_b16 a[64:65], v18 offset:28672
  v_mfma_f32_16x16x32_bf16 v[112:115], a[44:47], a[12:15], v[112:115]
  ds_read_b64_tr_b16 a[66:67], v18 offset:29184
  v_mfma_f32_16x16x32_bf16 v[88:91], a[44:47], a[8:11], v[88:91]
  ds_read_b64_tr_b16 a[68:69], v19 offset:28672
  v_mfma_f32_16x16x32_bf16 v[64:67], a[44:47], a[4:7], v[64:67]
  ds_read_b64_tr_b16 a[70:71], v19 offset:29184
  v_mfma_f32_16x16x32_bf16 v[40:43], a[44:47], a[0:3], v[40:43]
  buffer_load_dwordx4 v10, s[12:15], s36 offen offset:2048 lds
  v_mfma_f32_16x16x32_bf16 v[44:47], a[0:3], a[48:51], v[44:47]
  ds_read_b64_tr_b16 a[72:73], v18 offset:32768
  v_mfma_f32_16x16x32_bf16 v[68:71], a[4:7], a[48:51], v[68:71]
  ds_read_b64_tr_b16 a[74:75], v18 offset:33280
  v_mfma_f32_16x16x32_bf16 v[92:95], a[8:11], a[48:51], v[92:95]
  ds_read_b64_tr_b16 a[76:77], v19 offset:32768
  v_mfma_f32_16x16x32_bf16 v[116:119], a[12:15], a[48:51], v[116:119]
  ds_read_b64_tr_b16 a[78:79], v19 offset:33280
  v_mfma_f32_16x16x32_bf16 v[120:123], a[12:15], a[52:55], v[120:123]
  buffer_load_dwordx4 v11, s[12:15], s36 offen offset:3072 lds
  v_mfma_f32_16x16x32_bf16 v[96:99], a[8:11], a[52:55], v[96:99]
  v_mfma_f32_16x16x32_bf16 v[72:75], a[4:7], a[52:55], v[72:75]
  v_mfma_f32_16x16x32_bf16 v[48:51], a[0:3], a[52:55], v[48:51]
  s_waitcnt vmcnt(17) lgkmcnt(0)
  s_barrier
  v_mfma_f32_16x16x32_bf16 v[28:31], a[56:59], a[16:19], v[28:31]
  s_add_u32 m0, s41, 12288
  ds_read_b128 a[0:3], v16 offset:0
  v_mfma_f32_16x16x32_bf16 v[52:55], a[56:59], a[20:23], v[52:55]
  s_mov_b32 s37, 5701632
  buffer_load_dwordx4 v12, s[16:19], s37 offen offset:0 lds
  v_mfma_f32_16x16x32_bf16 v[76:79], a[56:59], a[24:27], v[76:79]
  ds_read_b128 a[4:7], v16 offset:2048
  v_mfma_f32_16x16x32_bf16 v[100:103], a[56:59], a[28:31], v[100:103]
  ds_read_b128 a[8:11], v16 offset:4096
  v_mfma_f32_16x16x32_bf16 v[104:107], a[60:63], a[28:31], v[104:107]
  ds_read_b128 a[12:15], v16 offset:6144
  v_mfma_f32_16x16x32_bf16 v[80:83], a[60:63], a[24:27], v[80:83]
  buffer_load_dwordx4 v13, s[16:19], s37 offen offset:1024 lds
  v_mfma_f32_16x16x32_bf16 v[56:59], a[60:63], a[20:23], v[56:59]
  ds_read_b64_tr_b16 a[32:33], v18 offset:36864
  v_mfma_f32_16x16x32_bf16 v[32:35], a[60:63], a[16:19], v[32:35]
  ds_read_b64_tr_b16 a[34:35], v18 offset:37376
  v_mfma_f32_16x16x32_bf16 v[36:39], a[64:67], a[16:19], v[36:39]
  ds_read_b64_tr_b16 a[36:37], v19 offset:36864
  v_mfma_f32_16x16x32_bf16 v[60:63], a[64:67], a[20:23], v[60:63]
  ds_read_b64_tr_b16 a[38:39], v19 offset:37376
  v_mfma_f32_16x16x32_bf16 v[84:87], a[64:67], a[24:27], v[84:87]
  buffer_load_dwordx4 v14, s[16:19], s37 offen offset:2048 lds
  s_add_u32 m0, s40, 49152
  v_mfma_f32_16x16x32_bf16 v[108:111], a[64:67], a[28:31], v[108:111]
  s_mov_b32 s36, 1920
  ds_read_b64_tr_b16 a[40:41], v18 offset:40960
  v_mfma_f32_16x16x32_bf16 v[112:115], a[68:71], a[28:31], v[112:115]
  ds_read_b64_tr_b16 a[42:43], v18 offset:41472
  v_mfma_f32_16x16x32_bf16 v[88:91], a[68:71], a[24:27], v[88:91]
  ds_read_b64_tr_b16 a[44:45], v19 offset:40960
  v_mfma_f32_16x16x32_bf16 v[64:67], a[68:71], a[20:23], v[64:67]
  ds_read_b64_tr_b16 a[46:47], v19 offset:41472
  v_mfma_f32_16x16x32_bf16 v[40:43], a[68:71], a[16:19], v[40:43]
  buffer_load_dwordx4 v8, s[12:15], s36 offen offset:0 lds
  v_mfma_f32_16x16x32_bf16 v[44:47], a[16:19], a[72:75], v[44:47]
  ds_read_b64_tr_b16 a[48:49], v18 offset:45056
  v_mfma_f32_16x16x32_bf16 v[68:71], a[20:23], a[72:75], v[68:71]
  ds_read_b64_tr_b16 a[50:51], v18 offset:45568
  v_mfma_f32_16x16x32_bf16 v[92:95], a[24:27], a[72:75], v[92:95]
  ds_read_b64_tr_b16 a[52:53], v19 offset:45056
  v_mfma_f32_16x16x32_bf16 v[116:119], a[28:31], a[72:75], v[116:119]
  ds_read_b64_tr_b16 a[54:55], v19 offset:45568
  v_mfma_f32_16x16x32_bf16 v[120:123], a[28:31], a[76:79], v[120:123]
  buffer_load_dwordx4 v9, s[12:15], s36 offen offset:1024 lds
  v_mfma_f32_16x16x32_bf16 v[96:99], a[24:27], a[76:79], v[96:99]
  v_mfma_f32_16x16x32_bf16 v[72:75], a[20:23], a[76:79], v[72:75]
  v_mfma_f32_16x16x32_bf16 v[48:51], a[16:19], a[76:79], v[48:51]
  s_waitcnt lgkmcnt(0)
  v_mfma_f32_16x16x32_bf16 v[28:31], a[32:35], a[0:3], v[28:31]
  s_add_u32 m0, s41, 24576
  ds_read_b128 a[16:19], v17 offset:0
  v_mfma_f32_16x16x32_bf16 v[52:55], a[32:35], a[4:7], v[52:55]
  s_mov_b32 s37, 5898240
  buffer_load_dwordx4 v12, s[16:19], s37 offen offset:0 lds
  v_mfma_f32_16x16x32_bf16 v[76:79], a[32:35], a[8:11], v[76:79]
  ds_read_b128 a[20:23], v17 offset:2048
  v_mfma_f32_16x16x32_bf16 v[100:103], a[32:35], a[12:15], v[100:103]
  ds_read_b128 a[24:27], v17 offset:4096
  v_mfma_f32_16x16x32_bf16 v[104:107], a[36:39], a[12:15], v[104:107]
  ds_read_b128 a[28:31], v17 offset:6144
  v_mfma_f32_16x16x32_bf16 v[80:83], a[36:39], a[8:11], v[80:83]
  buffer_load_dwordx4 v13, s[16:19], s37 offen offset:1024 lds
  v_mfma_f32_16x16x32_bf16 v[56:59], a[36:39], a[4:7], v[56:59]
  ds_read_b64_tr_b16 a[56:57], v20 offset:0
  v_mfma_f32_16x16x32_bf16 v[32:35], a[36:39], a[0:3], v[32:35]
  ds_read_b64_tr_b16 a[58:59], v20 offset:512
  v_mfma_f32_16x16x32_bf16 v[36:39], a[40:43], a[0:3], v[36:39]
  ds_read_b64_tr_b16 a[60:61], v21 offset:0
  v_mfma_f32_16x16x32_bf16 v[60:63], a[40:43], a[4:7], v[60:63]
  ds_read_b64_tr_b16 a[62:63], v21 offset:512
  v_mfma_f32_16x16x32_bf16 v[84:87], a[40:43], a[8:11], v[84:87]
  buffer_load_dwordx4 v14, s[16:19], s37 offen offset:2048 lds
  s_add_u32 m0, s40, 49152
  v_mfma_f32_16x16x32_bf16 v[108:111], a[40:43], a[12:15], v[108:111]
  s_mov_b32 s36, 1920
  ds_read_b64_tr_b16 a[64:65], v20 offset:4096
  v_mfma_f32_16x16x32_bf16 v[112:115], a[44:47], a[12:15], v[112:115]
  ds_read_b64_tr_b16 a[66:67], v20 offset:4608
  v_mfma_f32_16x16x32_bf16 v[88:91], a[44:47], a[8:11], v[88:91]
  ds_read_b64_tr_b16 a[68:69], v21 offset:4096
  v_mfma_f32_16x16x32_bf16 v[64:67], a[44:47], a[4:7], v[64:67]
  ds_read_b64_tr_b16 a[70:71], v21 offset:4608
  v_mfma_f32_16x16x32_bf16 v[40:43], a[44:47], a[0:3], v[40:43]
  buffer_load_dwordx4 v10, s[12:15], s36 offen offset:2048 lds
  v_mfma_f32_16x16x32_bf16 v[44:47], a[0:3], a[48:51], v[44:47]
  ds_read_b64_tr_b16 a[72:73], v20 offset:8192
  v_mfma_f32_16x16x32_bf16 v[68:71], a[4:7], a[48:51], v[68:71]
  ds_read_b64_tr_b16 a[74:75], v20 offset:8704
  v_mfma_f32_16x16x32_bf16 v[92:95], a[8:11], a[48:51], v[92:95]
  ds_read_b64_tr_b16 a[76:77], v21 offset:8192
  v_mfma_f32_16x16x32_bf16 v[116:119], a[12:15], a[48:51], v[116:119]
  ds_read_b64_tr_b16 a[78:79], v21 offset:8704
  v_mfma_f32_16x16x32_bf16 v[120:123], a[12:15], a[52:55], v[120:123]
  buffer_load_dwordx4 v11, s[12:15], s36 offen offset:3072 lds
  s_waitcnt vmcnt(17)
  v_mfma_f32_16x16x32_bf16 v[96:99], a[8:11], a[52:55], v[96:99]
  v_cmp_eq_u32 vcc, 0, v182
  s_nop 1
  s_cmp_lg_u64 vcc, 0
  s_cbranch_scc1 L_p1f_spin
L_p1f_back:
  v_mfma_f32_16x16x32_bf16 v[72:75], a[4:7], a[52:55], v[72:75]
  v_mfma_f32_16x16x32_bf16 v[48:51], a[0:3], a[52:55], v[48:51]
  s_waitcnt vmcnt(17) lgkmcnt(0)
  s_barrier
  v_mfma_f32_16x16x32_bf16 v[28:31], a[56:59], a[16:19], v[28:31]
  s_add_u32 m0, s41, 36864
  s_mov_b32 s37, 6094848
  buffer_load_dwordx4 v12, s[16:19], s37 offen offset:0 lds
  v_mfma_f32_16x16x32_bf16 v[52:55], a[56:59], a[20:23], v[52:55]
  ds_read_b128 a[0:3], v16 offset:16384
  v_mfma_f32_16x16x32_bf16 v[76:79], a[56:59], a[24:27], v[76:79]
  ds_read_b128 a[4:7], v16 offset:18432
  v_mfma_f32_16x16x32_bf16 v[100:103], a[56:59], a[28:31], v[100:103]
  buffer_load_dwordx4 v13, s[16:19], s37 offen offset:1024 lds
  v_mfma_f32_16x16x32_bf16 v[104:107], a[60:63], a[28:31], v[104:107]
  ds_read_b128 a[8:11], v16 offset:20480
  v_mfma_f32_16x16x32_bf16 v[80:83], a[60:63], a[24:27], v[80:83]
  ds_read_b128 a[12:15], v16 offset:22528
  v_mfma_f32_16x16x32_bf16 v[56:59], a[60:63], a[20:23], v[56:59]
  buffer_load_dwordx4 v14, s[16:19], s37 offen offset:2048 lds
  v_and_b32 v22, 127, v0
  v_lshlrev_b32 v22, 2, v22
  v_mfma_f32_16x16x32_bf16 v[32:35], a[60:63], a[16:19], v[32:35]
  v_lshrrev_b32 v23, 7, v0
  v_lshl_add_u32 v22, v23, 13, v22
  ds_read_b64_tr_b16 a[32:33], v20 offset:12288
  v_mfma_f32_16x16x32_bf16 v[36:39], a[64:67], a[16:19], v[36:39]
  s_lshl_b32 s28, s32, 9
  s_add_u32 s28, s28, 38862848
  ds_read_b64_tr_b16 a[34:35], v20 offset:12800
  v_mfma_f32_16x16x32_bf16 v[60:63], a[64:67], a[20:23], v[60:63]
  buffer_load_dword v164, v22, s[8:11], s28 offen sc1
  v_lshlrev_b32 v22, 2, v1
  s_min_u32 s29, s5, 2
  v_mfma_f32_16x16x32_bf16 v[84:87], a[64:67], a[24:27], v[84:87]
  s_mul_i32 s28, s29, 0
  s_add_u32 s28, s28, s33
  ds_read_b64_tr_b16 a[36:37], v21 offset:12288
  v_mfma_f32_16x16x32_bf16 v[108:111], a[64:67], a[28:31], v[108:111]
  s_and_b32 s28, s28, 3
  s_or_b32 s28, s28, s30
  ds_read_b64_tr_b16 a[38:39], v21 offset:12800
  v_mfma_f32_16x16x32_bf16 v[112:115], a[68:71], a[28:31], v[112:115]
  s_lshl_b32 s28, s28, 8
  s_lshl_b32 s29, s29, 12
  ds_read_b64_tr_b16 a[40:41], v20 offset:16384
  v_mfma_f32_16x16x32_bf16 v[88:91], a[68:71], a[24:27], v[88:91]
  s_add_u32 s28, s28, s29
  s_add_u32 s28, s28, 38879232
  ds_read_b64_tr_b16 a[42:43], v20 offset:16896
  v_mfma_f32_16x16x32_bf16 v[64:67], a[68:71], a[20:23], v[64:67]
  ds_read_b64_tr_b16 a[44:45], v21 offset:16384
  v_mfma_f32_16x16x32_bf16 v[40:43], a[68:71], a[16:19], v[40:43]
  ds_read_b64_tr_b16 a[46:47], v21 offset:16896
  v_mfma_f32_16x16x32_bf16 v[44:47], a[16:19], a[72:75], v[44:47]
  ds_read_b64_tr_b16 a[48:49], v20 offset:20480
  v_mfma_f32_16x16x32_bf16 v[68:71], a[20:23], a[72:75], v[68:71]
  ds_read_b64_tr_b16 a[50:51], v20 offset:20992
  v_mfma_f32_16x16x32_bf16 v[92:95], a[24:27], a[72:75], v[92:95]
  ds_read_b64_tr_b16 a[52:53], v21 offset:20480
  v_mfma_f32_16x16x32_bf16 v[116:119], a[28:31], a[72:75], v[116:119]
  ds_read_b64_tr_b16 a[54:55], v21 offset:20992
  v_mfma_f32_16x16x32_bf16 v[120:123], a[28:31], a[76:79], v[120:123]
  buffer_load_dword v165, v22, s[8:11], s28 offen sc1
  s_add_u32 s28, s28, 12288
  v_mfma_f32_16x16x32_bf16 v[96:99], a[24:27], a[76:79], v[96:99]
  buffer_load_dword v166, v22, s[8:11], s28 offen sc1
  s_add_u32 s28, s28, 12288
  v_mfma_f32_16x16x32_bf16 v[72:75], a[20:23], a[76:79], v[72:75]
  buffer_load_dword v167, v22, s[8:11], s28 offen sc1
  s_add_u32 s28, s28, 12288
  v_mfma_f32_16x16x32_bf16 v[48:51], a[16:19], a[76:79], v[48:51]
  buffer_load_dword v168, v22, s[8:11], s28 offen sc1
  s_add_u32 s28, s28, 12288
  s_waitcnt lgkmcnt(0)
  v_mfma_f32_16x16x32_bf16 v[28:31], a[32:35], a[0:3], v[28:31]
  ds_read_b128 a[16:19], v17 offset:16384
  v_mfma_f32_16x16x32_bf16 v[52:55], a[32:35], a[4:7], v[52:55]
  ds_read_b128 a[20:23], v17 offset:18432
  v_mfma_f32_16x16x32_bf16 v[76:79], a[32:35], a[8:11], v[76:79]
  ds_read_b128 a[24:27], v17 offset:20480
  v_mfma_f32_16x16x32_bf16 v[100:103], a[32:35], a[12:15], v[100:103]
  ds_read_b128 a[28:31], v17 offset:22528
  v_mfma_f32_16x16x32_bf16 v[104:107], a[36:39], a[12:15], v[104:107]
  ds_read_b64_tr_b16 a[56:57], v20 offset:24576
  v_mfma_f32_16x16x32_bf16 v[80:83], a[36:39], a[8:11], v[80:83]
  ds_read_b64_tr_b16 a[58:59], v20 offset:25088
  v_mfma_f32_16x16x32_bf16 v[56:59], a[36:39], a[4:7], v[56:59]
  ds_read_b64_tr_b16 a[60:61], v21 offset:24576
  v_mfma_f32_16x16x32_bf16 v[32:35], a[36:39], a[0:3], v[32:35]
  ds_read_b64_tr_b16 a[62:63], v21 offset:25088
  v_mfma_f32_16x16x32_bf16 v[36:39], a[40:43], a[0:3], v[36:39]
  ds_read_b64_tr_b16 a[64:65], v20 offset:28672
  v_mfma_f32_16x16x32_bf16 v[60:63], a[40:43], a[4:7], v[60:63]
  ds_read_b64_tr_b16 a[66:67], v20 offset:29184
  v_mfma_f32_16x16x32_bf16 v[84:87], a[40:43], a[8:11], v[84:87]
  ds_read_b64_tr_b16 a[68:69], v21 offset:28672
  v_mfma_f32_16x16x32_bf16 v[108:111], a[40:43], a[12:15], v[108:111]
  ds_read_b64_tr_b16 a[70:71], v21 offset:29184
  v_mfma_f32_16x16x32_bf16 v[112:115], a[44:47], a[12:15], v[112:115]
  ds_read_b64_tr_b16 a[72:73], v20 offset:32768
  v_mfma_f32_16x16x32_bf16 v[88:91], a[44:47], a[8:11], v[88:91]
  ds_read_b64_tr_b16 a[74:75], v20 offset:33280
  v_mfma_f32_16x16x32_bf16 v[64:67], a[44:47], a[4:7], v[64:67]
  ds_read_b64_tr_b16 a[76:77], v21 offset:32768
  v_mfma_f32_16x16x32_bf16 v[40:43], a[44:47], a[0:3], v[40:43]
  ds_read_b64_tr_b16 a[78:79], v21 offset:33280
  v_mfma_f32_16x16x32_bf16 v[44:47], a[0:3], a[48:51], v[44:47]
  v_mfma_f32_16x16x32_bf16 v[68:71], a[4:7], a[48:51], v[68:71]
  v_mfma_f32_16x16x32_bf16 v[92:95], a[8:11], a[48:51], v[92:95]
  v_mfma_f32_16x16x32_bf16 v[116:119], a[12:15], a[48:51], v[116:119]
  v_mfma_f32_16x16x32_bf16 v[120:123], a[12:15], a[52:55], v[120:123]
  v_mfma_f32_16x16x32_bf16 v[96:99], a[8:11], a[52:55], v[96:99]
  v_mfma_f32_16x16x32_bf16 v[72:75], a[4:7], a[52:55], v[72:75]
  v_mfma_f32_16x16x32_bf16 v[48:51], a[0:3], a[52:55], v[48:51]
  s_waitcnt vmcnt(15) lgkmcnt(0)
  s_barrier
  v_mfma_f32_16x16x32_bf16 v[28:31], a[56:59], a[16:19], v[28:31]
  ds_read_b128 a[0:3], v16 offset:32768
  v_mfma_f32_16x16x32_bf16 v[52:55], a[56:59], a[20:23], v[52:55]
  ds_read_b128 a[4:7], v16 offset:34816
  v_mfma_f32_16x16x32_bf16 v[76:79], a[56:59], a[24:27], v[76:79]
  ds_read_b128 a[8:11], v16 offset:36864
  v_mfma_f32_16x16x32_bf16 v[100:103], a[56:59], a[28:31], v[100:103]
  ds_read_b128 a[12:15], v16 offset:38912
  v_mfma_f32_16x16x32_bf16 v[104:107], a[60:63], a[28:31], v[104:107]
  ds_read_b64_tr_b16 a[32:33], v18 offset:0
  v_mfma_f32_16x16x32_bf16 v[80:83], a[60:63], a[24:27], v[80:83]
  ds_read_b64_tr_b16 a[34:35], v18 offset:512
  v_mfma_f32_16x16x32_bf16 v[56:59], a[60:63], a[20:23], v[56:59]
  ds_read_b64_tr_b16 a[36:37], v19 offset:0
  v_mfma_f32_16x16x32_bf16 v[32:35], a[60:63], a[16:19], v[32:35]
  ds_read_b64_tr_b16 a[38:39], v19 offset:512
  v_mfma_f32_16x16x32_bf16 v[36:39], a[64:67], a[16:19], v[36:39]
  ds_read_b64_tr_b16 a[40:41], v18 offset:4096
  v_mfma_f32_16x16x32_bf16 v[60:63], a[64:67], a[20:23], v[60:63]
  ds_read_b64_tr_b16 a[42:43], v18 offset:4608
  v_mfma_f32_16x16x32_bf16 v[84:87], a[64:67], a[24:27], v[84:87]
  ds_read_b64_tr_b16 a[44:45], v19 offset:4096
  v_mfma_f32_16x16x32_bf16 v[108:111], a[64:67], a[28:31], v[108:111]
  ds_read_b64_tr_b16 a[46:47], v19 offset:4608
  v_mfma_f32_16x16x32_bf16 v[112:115], a[68:71], a[28:31], v[112:115]
  ds_read_b64_tr_b16 a[48:49], v18 offset:8192
  v_mfma_f32_16x16x32_bf16 v[88:91], a[68:71], a[24:27], v[88:91]
  ds_read_b64_tr_b16 a[50:51], v18 offset:8704
  v_mfma_f32_16x16x32_bf16 v[64:67], a[68:71], a[20:23], v[64:67]
  ds_read_b64_tr_b16 a[52:53], v19 offset:8192
  v_mfma_f32_16x16x32_bf16 v[40:43], a[68:71], a[16:19], v[40:43]
  ds_read_b64_tr_b16 a[54:55], v19 offset:8704
  v_mfma_f32_16x16x32_bf16 v[44:47], a[16:19], a[72:75], v[44:47]
  v_mfma_f32_16x16x32_bf16 v[68:71], a[20:23], a[72:75], v[68:71]
  v_mfma_f32_16x16x32_bf16 v[92:95], a[24:27], a[72:75], v[92:95]
  v_mfma_f32_16x16x32_bf16 v[116:119], a[28:31], a[72:75], v[116:119]
  v_mfma_f32_16x16x32_bf16 v[120:123], a[28:31], a[76:79], v[120:123]
  v_mfma_f32_16x16x32_bf16 v[96:99], a[24:27], a[76:79], v[96:99]
  v_mfma_f32_16x16x32_bf16 v[72:75], a[20:23], a[76:79], v[72:75]
  v_mfma_f32_16x16x32_bf16 v[48:51], a[16:19], a[76:79], v[48:51]
  s_waitcnt lgkmcnt(0)
  v_mfma_f32_16x16x32_bf16 v[28:31], a[32:35], a[0:3], v[28:31]
  s_waitcnt vmcnt(0)
  ds_read_b128 a[16:19], v17 offset:32768
  v_mfma_f32_16x16x32_bf16 v[52:55], a[32:35], a[4:7], v[52:55]
  v_add_f32 v165, v165, v166
  ds_read_b128 a[20:23], v17 offset:34816
  v_mfma_f32_16x16x32_bf16 v[76:79], a[32:35], a[8:11], v[76:79]
  v_add_f32 v167, v167, v168
  ds_read_b128 a[24:27], v17 offset:36864
  v_mfma_f32_16x16x32_bf16 v[100:103], a[32:35], a[12:15], v[100:103]
  v_lshlrev_b32 v22, 2, v0
  ds_read_b128 a[28:31], v17 offset:38912
  v_mfma_f32_16x16x32_bf16 v[104:107], a[36:39], a[12:15], v[104:107]
  v_add_u32 v22, 151552, v22
  ds_read_b64_tr_b16 a[56:57], v18 offset:12288
  v_mfma_f32_16x16x32_bf16 v[80:83], a[36:39], a[8:11], v[80:83]
  v_add_f32 v165, v165, v167
  ds_write_b32 v22, v164
  v_mfma_f32_16x16x32_bf16 v[56:59], a[36:39], a[4:7], v[56:59]
  ds_read_b64_tr_b16 a[58:59], v18 offset:12800
  v_mfma_f32_16x16x32_bf16 v[32:35], a[36:39], a[0:3], v[32:35]
  ds_read_b64_tr_b16 a[60:61], v19 offset:12288
  v_mfma_f32_16x16x32_bf16 v[36:39], a[40:43], a[0:3], v[36:39]
  ds_read_b64_tr_b16 a[62:63], v19 offset:12800
  v_mfma_f32_16x16x32_bf16 v[60:63], a[40:43], a[4:7], v[60:63]
  ds_read_b64_tr_b16 a[64:65], v18 offset:16384
  v_mfma_f32_16x16x32_bf16 v[84:87], a[40:43], a[8:11], v[84:87]
  ds_read_b64_tr_b16 a[66:67], v18 offset:16896
  v_mfma_f32_16x16x32_bf16 v[108:111], a[40:43], a[12:15], v[108:111]
  ds_read_b64_tr_b16 a[68:69], v19 offset:16384
  v_mfma_f32_16x16x32_bf16 v[112:115], a[44:47], a[12:15], v[112:115]
  ds_write_b32 v22, v165 offset:1024
  v_mfma_f32_16x16x32_bf16 v[88:91], a[44:47], a[8:11], v[88:91]
  ds_read_b64_tr_b16 a[70:71], v19 offset:16896
  v_mfma_f32_16x16x32_bf16 v[64:67], a[44:47], a[4:7], v[64:67]
  ds_read_b64_tr_b16 a[72:73], v18 offset:20480
  v_mfma_f32_16x16x32_bf16 v[40:43], a[44:47], a[0:3], v[40:43]
  ds_read_b64_tr_b16 a[74:75], v18 offset:20992
  v_mfma_f32_16x16x32_bf16 v[44:47], a[0:3], a[48:51], v[44:47]
  ds_read_b64_tr_b16 a[76:77], v19 offset:20480
  v_mfma_f32_16x16x32_bf16 v[68:71], a[4:7], a[48:51], v[68:71]
  ds_read_b64_tr_b16 a[78:79], v19 offset:20992
  v_mfma_f32_16x16x32_bf16 v[92:95], a[8:11], a[48:51], v[92:95]
  v_mfma_f32_16x16x32_bf16 v[116:119], a[12:15], a[48:51], v[116:119]
  v_mfma_f32_16x16x32_bf16 v[120:123], a[12:15], a[52:55], v[120:123]
  v_mfma_f32_16x16x32_bf16 v[96:99], a[8:11], a[52:55], v[96:99]
  v_mfma_f32_16x16x32_bf16 v[72:75], a[4:7], a[52:55], v[72:75]
  v_mfma_f32_16x16x32_bf16 v[48:51], a[0:3], a[52:55], v[48:51]
  s_waitcnt vmcnt(5) lgkmcnt(0)
  s_barrier
  v_mfma_f32_16x16x32_bf16 v[28:31], a[56:59], a[16:19], v[28:31]
  s_add_u32 s56, s58, L_P2-L_base
  s_addc_u32 s57, s59, 0
  ds_read_b128 a[0:3], v16 offset:49152
  v_mfma_f32_16x16x32_bf16 v[52:55], a[56:59], a[20:23], v[52:55]
  v_and_b32 v182, 7, v0
  ds_read_b128 a[4:7], v16 offset:51200
  v_mfma_f32_16x16x32_bf16 v[76:79], a[56:59], a[24:27], v[76:79]
  v_lshl_add_u32 v182, v182, 5, s4
  ds_read_b128 a[8:11], v16 offset:53248
  v_mfma_f32_16x16x32_bf16 v[100:103], a[56:59], a[28:31], v[100:103]
  v_lshlrev_b32 v182, 7, v182
  ds_read_b128 a[12:15], v16 offset:55296
  v_mfma_f32_16x16x32_bf16 v[104:107], a[60:63], a[28:31], v[104:107]
  v_min_u32 v182, L_P4-L_P2-4, v182
  global_load_dword v182, v182, s[56:57]
  v_mfma_f32_16x16x32_bf16 v[80:83], a[60:63], a[24:27], v[80:83]
  ds_read_b64_tr_b16 a[32:33], v18 offset:24576
  v_mfma_f32_16x16x32_bf16 v[56:59], a[60:63], a[20:23], v[56:59]
  ds_read_b64_tr_b16 a[34:35], v18 offset:25088
  v_mfma_f32_16x16x32_bf16 v[32:35], a[60:63], a[16:19], v[32:35]
  ds_read_b64_tr_b16 a[36:37], v19 offset:24576
  v_mfma_f32_16x16x32_bf16 v[36:39], a[64:67], a[16:19], v[36:39]
  ds_read_b64_tr_b16 a[38:39], v19 offset:25088
  v_mfma_f32_16x16x32_bf16 v[60:63], a[64:67], a[20:23], v[60:63]
  ds_read_b64_tr_b16 a[40:41], v18 offset:28672
  v_mfma_f32_16x16x32_bf16 v[84:87], a[64:67], a[24:27], v[84:87]
  ds_read_b64_tr_b16 a[42:43], v18 offset:29184
  v_mfma_f32_16x16x32_bf16 v[108:111], a[64:67], a[28:31], v[108:111]
  ds_read_b64_tr_b16 a[44:45], v19 offset:28672
  v_mfma_f32_16x16x32_bf16 v[112:115], a[68:71], a[28:31], v[112:115]
  ds_read_b64_tr_b16 a[46:47], v19 offset:29184
  v_mfma_f32_16x16x32_bf16 v[88:91], a[68:71], a[24:27], v[88:91]
  ds_read_b64_tr_b16 a[48:49], v18 offset:32768
  v_mfma_f32_16x16x32_bf16 v[64:67], a[68:71], a[20:23], v[64:67]
  ds_read_b64_tr_b16 a[50:51], v18 offset:33280
  v_mfma_f32_16x16x32_bf16 v[40:43], a[68:71], a[16:19], v[40:43]
  ds_read_b64_tr_b16 a[52:53], v19 offset:32768
  v_mfma_f32_16x16x32_bf16 v[44:47], a[16:19], a[72:75], v[44:47]
  ds_read_b64_tr_b16 a[54:55], v19 offset:33280
  v_mfma_f32_16x16x32_bf16 v[68:71], a[20:23], a[72:75], v[68:71]
  v_mfma_f32_16x16x32_bf16 v[92:95], a[24:27], a[72:75], v[92:95]
  v_mfma_f32_16x16x32_bf16 v[116:119], a[28:31], a[72:75], v[116:119]
  v_mfma_f32_16x16x32_bf16 v[120:123], a[28:31], a[76:79], v[120:123]
  v_mfma_f32_16x16x32_bf16 v[96:99], a[24:27], a[76:79], v[96:99]
  v_mfma_f32_16x16x32_bf16 v[72:75], a[20:23], a[76:79], v[72:75]
  v_mfma_f32_16x16x32_bf16 v[48:51], a[16:19], a[76:79], v[48:51]
  s_waitcnt lgkmcnt(0)
  v_mfma_f32_16x16x32_bf16 v[28:31], a[32:35], a[0:3], v[28:31]
  s_lshl_b32 s28, s34, 8
  ds_read_b128 a[16:19], v17 offset:49152
  v_mfma_f32_16x16x32_bf16 v[52:55], a[32:35], a[4:7], v[52:55]
  s_add_u32 s28, s28, 151552
  ds_read_b128 a[20:23], v17 offset:51200
  v_mfma_f32_16x16x32_bf16 v[76:79], a[32:35], a[8:11], v[76:79]
  v_lshl_add_u32 v22, v3, 2, s28
  ds_read_b128 a[24:27], v17 offset:53248
  v_mfma_f32_16x16x32_bf16 v[100:103], a[32:35], a[12:15], v[100:103]
  v_lshl_add_u32 v23, v4, 4, s28
  ds_read_b128 a[28:31], v17 offset:55296
  v_mfma_f32_16x16x32_bf16 v[104:107], a[36:39], a[12:15], v[104:107]
  s_lshl_b32 s28, s35, 7
  ds_read_b64_tr_b16 a[56:57], v18 offset:36864
  v_mfma_f32_16x16x32_bf16 v[80:83], a[36:39], a[8:11], v[80:83]
  s_add_u32 s28, s28, 152576
  ds_read_b64_tr_b16 a[58:59], v18 offset:37376
  v_mfma_f32_16x16x32_bf16 v[56:59], a[36:39], a[4:7], v[56:59]
  v_lshl_add_u32 v24, v3, 2, s28
  ds_read_b64_tr_b16 a[60:61], v19 offset:36864
  v_mfma_f32_16x16x32_bf16 v[32:35], a[36:39], a[0:3], v[32:35]
  v_lshl_add_u32 v25, v4, 4, s28
  ds_read_b64_tr_b16 a[62:63], v19 offset:37376
  v_mfma_f32_16x16x32_bf16 v[36:39], a[40:43], a[0:3], v[36:39]
  ds_read_b64_tr_b16 a[64:65], v18 offset:40960
  v_mfma_f32_16x16x32_bf16 v[60:63], a[40:43], a[4:7], v[60:63]
  ds_read_b64_tr_b16 a[66:67], v18 offset:41472
  v_mfma_f32_16x16x32_bf16 v[84:87], a[40:43], a[8:11], v[84:87]
  ds_read_b64_tr_b16 a[68:69], v19 offset:40960
  v_mfma_f32_16x16x32_bf16 v[108:111], a[40:43], a[12:15], v[108:111]
  ds_read_b64_tr_b16 a[70:71], v19 offset:41472
  v_mfma_f32_16x16x32_bf16 v[112:115], a[44:47], a[12:15], v[112:115]
  ds_read_b64_tr_b16 a[72:73], v18 offset:45056
  v_mfma_f32_16x16x32_bf16 v[88:91], a[44:47], a[8:11], v[88:91]
  ds_read_b64_tr_b16 a[74:75], v18 offset:45568
  v_mfma_f32_16x16x32_bf16 v[64:67], a[44:47], a[4:7], v[64:67]
  ds_read_b64_tr_b16 a[76:77], v19 offset:45056
  v_mfma_f32_16x16x32_bf16 v[40:43], a[44:47], a[0:3], v[40:43]
  ds_read_b64_tr_b16 a[78:79], v19 offset:45568
  v_mfma_f32_16x16x32_bf16 v[44:47], a[0:3], a[48:51], v[44:47]
  v_mfma_f32_16x16x32_bf16 v[68:71], a[4:7], a[48:51], v[68:71]
  v_mfma_f32_16x16x32_bf16 v[92:95], a[8:11], a[48:51], v[92:95]
  v_mfma_f32_16x16x32_bf16 v[116:119], a[12:15], a[48:51], v[116:119]
  v_mfma_f32_16x16x32_bf16 v[120:123], a[12:15], a[52:55], v[120:123]
  v_mfma_f32_16x16x32_bf16 v[96:99], a[8:11], a[52:55], v[96:99]
  v_mfma_f32_16x16x32_bf16 v[72:75], a[4:7], a[52:55], v[72:75]
  v_mfma_f32_16x16x32_bf16 v[48:51], a[0:3], a[52:55], v[48:51]
  s_waitcnt lgkmcnt(0)
  v_mfma_f32_16x16x32_bf16 v[28:31], a[56:59], a[16:19], v[28:31]
  ds_read_b128 v[164:167], v25 offset:0
  v_mfma_f32_16x16x32_bf16 v[52:55], a[56:59], a[20:23], v[52:55]
  ds_read_b128 v[168:171], v25 offset:64
  v_mfma_f32_16x16x32_bf16 v[76:79], a[56:59], a[24:27], v[76:79]
  ds_read_b128 v[172:175], v25 offset:256
  v_mfma_f32_16x16x32_bf16 v[100:103], a[56:59], a[28:31], v[100:103]
  ds_read_b128 v[176:179], v25 offset:320
  v_mfma_f32_16x16x32_bf16 v[104:107], a[60:63], a[28:31], v[104:107]
  ds_read_b32 v156, v22 offset:0
  v_mfma_f32_16x16x32_bf16 v[80:83], a[60:63], a[24:27], v[80:83]
  ds_read_b32 v160, v22 offset:512
  v_mfma_f32_16x16x32_bf16 v[56:59], a[60:63], a[20:23], v[56:59]
  ds_read_b32 v157, v22 offset:64
  v_mfma_f32_16x16x32_bf16 v[32:35], a[60:63], a[16:19], v[32:35]
  ds_read_b32 v161, v22 offset:576
  v_mfma_f32_16x16x32_bf16 v[36:39], a[64:67], a[16:19], v[36:39]
  ds_read_b32 v158, v22 offset:128
  v_mfma_f32_16x16x32_bf16 v[60:63], a[64:67], a[20:23], v[60:63]
  ds_read_b32 v162, v22 offset:640
  v_mfma_f32_16x16x32_bf16 v[84:87], a[64:67], a[24:27], v[84:87]
  ds_read_b32 v159, v22 offset:192
  v_mfma_f32_16x16x32_bf16 v[108:111], a[64:67], a[28:31], v[108:111]
  ds_read_b32 v163, v22 offset:704
  v_mfma_f32_16x16x32_bf16 v[112:115], a[68:71], a[28:31], v[112:115]
  ds_read_b128 v[124:127], v23 offset:0
  v_mfma_f32_16x16x32_bf16 v[88:91], a[68:71], a[24:27], v[88:91]
  ds_read_b128 v[140:143], v23 offset:512
  v_mfma_f32_16x16x32_bf16 v[64:67], a[68:71], a[20:23], v[64:67]
  ds_read_b128 v[128:131], v23 offset:64
  v_mfma_f32_16x16x32_bf16 v[40:43], a[68:71], a[16:19], v[40:43]
  ds_read_b128 v[144:147], v23 offset:576
  v_mfma_f32_16x16x32_bf16 v[44:47], a[16:19], a[72:75], v[44:47]
  ds_read_b128 v[132:135], v23 offset:128
  v_mfma_f32_16x16x32_bf16 v[68:71], a[20:23], a[72:75], v[68:71]
  ds_read_b128 v[148:151], v23 offset:640
  v_mfma_f32_16x16x32_bf16 v[92:95], a[24:27], a[72:75], v[92:95]
  ds_read_b128 v[136:139], v23 offset:192
  v_mfma_f32_16x16x32_bf16 v[116:119], a[28:31], a[72:75], v[116:119]
  ds_read_b128 v[152:155], v23 offset:704
  v_mfma_f32_16x16x32_bf16 v[120:123], a[28:31], a[76:79], v[120:123]
  ds_read_b32 v180, v24 offset:512
  v_mfma_f32_16x16x32_bf16 v[96:99], a[24:27], a[76:79], v[96:99]
  ds_read_b32 v181, v24 offset:576
  v_mfma_f32_16x16x32_bf16 v[72:75], a[20:23], a[76:79], v[72:75]
  v_mfma_f32_16x16x32_bf16 v[48:51], a[16:19], a[76:79], v[48:51]
  s_waitcnt lgkmcnt(0)
  s_lshl_b32 s28, s35, 17
  s_lshl_b32 s29, s32, 13
  s_add_u32 s28, s28, s29
  s_lshl_b32 s29, s34, 12
  s_add_u32 s46, s28, s29
  v_lshlrev_b32 v22, 9, v4
  v_lshl_add_u32 v22, v3, 4, v22
  v_and_b32 v23, 1, v4
  v_lshlrev_b32 v23, 9, v23
  v_lshl_add_u32 v23, v6, 8, v23
  v_lshl_add_u32 v23, v3, 4, v23
  v_mul_f32 v8, 0x3e8293ee, v156
  v_mul_f32 v9, 0x3e8293ee, v157
  v_mul_f32 v10, 0x3e8293ee, v158
  v_mul_f32 v11, 0x3e8293ee, v159
  s_lshl_b32 s28, s61, 18
  s_add_u32 s28, s28, s46
  s_add_u32 s28, s28, 4194304
  v_pk_fma_f32 v[36:37], v[172:173], v[160:161], v[36:37] op_sel:[0,0,0] op_sel_hi:[1,0,1]
  v_pk_fma_f32 v[38:39], v[174:175], v[160:161], v[38:39] op_sel:[0,0,0] op_sel_hi:[1,0,1]
  v_pk_fma_f32 v[40:41], v[176:177], v[160:161], v[40:41] op_sel:[0,0,0] op_sel_hi:[1,0,1]
  v_pk_fma_f32 v[42:43], v[178:179], v[160:161], v[42:43] op_sel:[0,0,0] op_sel_hi:[1,0,1]
  v_pk_mul_f32 v[36:37], v[36:37], v[156:157] op_sel:[0,0] op_sel_hi:[1,0]
  v_pk_mul_f32 v[38:39], v[38:39], v[156:157] op_sel:[0,0] op_sel_hi:[1,0]
  v_pk_mul_f32 v[40:41], v[40:41], v[156:157] op_sel:[0,0] op_sel_hi:[1,0]
  v_pk_mul_f32 v[42:43], v[42:43], v[156:157] op_sel:[0,0] op_sel_hi:[1,0]
  v_cvt_pk_bf16_f32 v36, v36, v37
  v_cvt_pk_bf16_f32 v37, v38, v39
  v_cvt_pk_bf16_f32 v38, v40, v41
  v_cvt_pk_bf16_f32 v39, v42, v43
  buffer_store_dwordx4 v[36:39], v22, s[8:11], s28 offen offset:0 sc1
  v_pk_fma_f32 v[60:61], v[172:173], v[160:161], v[60:61] op_sel:[0,1,0] op_sel_hi:[1,1,1]
  v_pk_fma_f32 v[62:63], v[174:175], v[160:161], v[62:63] op_sel:[0,1,0] op_sel_hi:[1,1,1]
  v_pk_fma_f32 v[64:65], v[176:177], v[160:161], v[64:65] op_sel:[0,1,0] op_sel_hi:[1,1,1]
  v_pk_fma_f32 v[66:67], v[178:179], v[160:161], v[66:67] op_sel:[0,1,0] op_sel_hi:[1,1,1]
  v_pk_mul_f32 v[60:61], v[60:61], v[156:157] op_sel:[0,1] op_sel_hi:[1,1]
  v_pk_mul_f32 v[62:63], v[62:63], v[156:157] op_sel:[0,1] op_sel_hi:[1,1]
  v_pk_mul_f32 v[64:65], v[64:65], v[156:157] op_sel:[0,1] op_sel_hi:[1,1]
  v_pk_mul_f32 v[66:67], v[66:67], v[156:157] op_sel:[0,1] op_sel_hi:[1,1]
  v_cvt_pk_bf16_f32 v60, v60, v61
  v_cvt_pk_bf16_f32 v61, v62, v63
  v_cvt_pk_bf16_f32 v62, v64, v65
  v_cvt_pk_bf16_f32 v63, v66, v67
  buffer_store_dwordx4 v[60:63], v22, s[8:11], s28 offen offset:256 sc1
  v_pk_fma_f32 v[84:85], v[172:173], v[162:163], v[84:85] op_sel:[0,0,0] op_sel_hi:[1,0,1]
  v_pk_fma_f32 v[86:87], v[174:175], v[162:163], v[86:87] op_sel:[0,0,0] op_sel_hi:[1,0,1]
  v_pk_fma_f32 v[88:89], v[176:177], v[162:163], v[88:89] op_sel:[0,0,0] op_sel_hi:[1,0,1]
  v_pk_fma_f32 v[90:91], v[178:179], v[162:163], v[90:91] op_sel:[0,0,0] op_sel_hi:[1,0,1]
  v_pk_mul_f32 v[84:85], v[84:85], v[158:159] op_sel:[0,0] op_sel_hi:[1,0]
  v_pk_mul_f32 v[86:87], v[86:87], v[158:159] op_sel:[0,0] op_sel_hi:[1,0]
  v_pk_mul_f32 v[88:89], v[88:89], v[158:159] op_sel:[0,0] op_sel_hi:[1,0]
  v_pk_mul_f32 v[90:91], v[90:91], v[158:159] op_sel:[0,0] op_sel_hi:[1,0]
  v_cvt_pk_bf16_f32 v84, v84, v85
  v_cvt_pk_bf16_f32 v85, v86, v87
  v_cvt_pk_bf16_f32 v86, v88, v89
  v_cvt_pk_bf16_f32 v87, v90, v91
  buffer_store_dwordx4 v[84:87], v22, s[8:11], s28 offen offset:2048 sc1
  v_pk_fma_f32 v[108:109], v[172:173], v[162:163], v[108:109] op_sel:[0,1,0] op_sel_hi:[1,1,1]
  v_pk_fma_f32 v[110:111], v[174:175], v[162:163], v[110:111] op_sel:[0,1,0] op_sel_hi:[1,1,1]
  v_pk_fma_f32 v[112:113], v[176:177], v[162:163], v[112:113] op_sel:[0,1,0] op_sel_hi:[1,1,1]
  v_pk_fma_f32 v[114:115], v[178:179], v[162:163], v[114:115] op_sel:[0,1,0] op_sel_hi:[1,1,1]
  v_pk_mul_f32 v[108:109], v[108:109], v[158:159] op_sel:[0,1] op_sel_hi:[1,1]
  v_pk_mul_f32 v[110:111], v[110:111], v[158:159] op_sel:[0,1] op_sel_hi:[1,1]
  v_pk_mul_f32 v[112:113], v[112:113], v[158:159] op_sel:[0,1] op_sel_hi:[1,1]
  v_pk_mul_f32 v[114:115], v[114:115], v[158:159] op_sel:[0,1] op_sel_hi:[1,1]
  v_cvt_pk_bf16_f32 v108, v108, v109
  v_cvt_pk_bf16_f32 v109, v110, v111
  v_cvt_pk_bf16_f32 v110, v112, v113
  v_cvt_pk_bf16_f32 v111, v114, v115
  buffer_store_dwordx4 v[108:111], v22, s[8:11], s28 offen offset:2304 sc1
  s_lshl_b32 s28, s62, 18
  s_add_u32 s28, s28, s46
  s_add_u32 s28, s28, 8388608
  s_lshl_b32 s47, s33, 7
  s_lshl_b32 s29, s32, 2
  s_add_u32 s47, s47, s29
  s_add_u32 s47, s47, 39849984
  v_pk_fma_f32 v[44:45], v[140:141], v[180:181], v[44:45] op_sel:[0,0,0] op_sel_hi:[1,0,1]
  v_pk_fma_f32 v[46:47], v[142:143], v[180:181], v[46:47] op_sel:[0,0,0] op_sel_hi:[1,0,1]
  v_pk_fma_f32 v[48:49], v[140:141], v[180:181], v[48:49] op_sel:[0,1,0] op_sel_hi:[1,1,1]
  v_pk_fma_f32 v[50:51], v[142:143], v[180:181], v[50:51] op_sel:[0,1,0] op_sel_hi:[1,1,1]
  v_pk_mul_f32 v[44:45], v[44:45], v[124:125]
  v_pk_mul_f32 v[46:47], v[46:47], v[126:127]
  v_pk_mul_f32 v[48:49], v[48:49], v[124:125]
  v_pk_mul_f32 v[50:51], v[50:51], v[126:127]
  v_cvt_pk_bf16_f32 v44, v44, v45
  v_cvt_pk_bf16_f32 v45, v46, v47
  v_cvt_pk_bf16_f32 v46, v48, v49
  v_cvt_pk_bf16_f32 v47, v50, v51
  s_nop 1
  v_permlane32_swap_b32 v44, v46
  v_permlane32_swap_b32 v45, v47
  buffer_store_dwordx4 v[44:47], v23, s[8:11], s28 offen offset:0 sc1
  v_pk_fma_f32 v[68:69], v[144:145], v[180:181], v[68:69] op_sel:[0,0,0] op_sel_hi:[1,0,1]
  v_pk_fma_f32 v[70:71], v[146:147], v[180:181], v[70:71] op_sel:[0,0,0] op_sel_hi:[1,0,1]
  v_pk_fma_f32 v[72:73], v[144:145], v[180:181], v[72:73] op_sel:[0,1,0] op_sel_hi:[1,1,1]
  v_pk_fma_f32 v[74:75], v[146:147], v[180:181], v[74:75] op_sel:[0,1,0] op_sel_hi:[1,1,1]
  v_pk_mul_f32 v[68:69], v[68:69], v[128:129]
  v_pk_mul_f32 v[70:71], v[70:71], v[130:131]
  v_pk_mul_f32 v[72:73], v[72:73], v[128:129]
  v_pk_mul_f32 v[74:75], v[74:75], v[130:131]
  v_cvt_pk_bf16_f32 v68, v68, v69
  v_cvt_pk_bf16_f32 v69, v70, v71
  v_cvt_pk_bf16_f32 v70, v72, v73
  v_cvt_pk_bf16_f32 v71, v74, v75
  s_nop 1
  v_permlane32_swap_b32 v68, v70
  v_permlane32_swap_b32 v69, v71
  buffer_store_dwordx4 v[68:71], v23, s[8:11], s28 offen offset:1024 sc1
  v_pk_fma_f32 v[92:93], v[148:149], v[180:181], v[92:93] op_sel:[0,0,0] op_sel_hi:[1,0,1]
  v_pk_fma_f32 v[94:95], v[150:151], v[180:181], v[94:95] op_sel:[0,0,0] op_sel_hi:[1,0,1]
  v_pk_fma_f32 v[96:97], v[148:149], v[180:181], v[96:97] op_sel:[0,1,0] op_sel_hi:[1,1,1]
  v_pk_fma_f32 v[98:99], v[150:151], v[180:181], v[98:99] op_sel:[0,1,0] op_sel_hi:[1,1,1]
  v_pk_mul_f32 v[92:93], v[92:93], v[132:133]
  v_pk_mul_f32 v[94:95], v[94:95], v[134:135]
  v_pk_mul_f32 v[96:97], v[96:97], v[132:133]
  v_pk_mul_f32 v[98:99], v[98:99], v[134:135]
  v_cvt_pk_bf16_f32 v92, v92, v93
  v_cvt_pk_bf16_f32 v93, v94, v95
  v_cvt_pk_bf16_f32 v94, v96, v97
  v_cvt_pk_bf16_f32 v95, v98, v99
  s_nop 1
  v_permlane32_swap_b32 v92, v94
  v_permlane32_swap_b32 v93, v95
  buffer_store_dwordx4 v[92:95], v23, s[8:11], s28 offen offset:2048 sc1
  v_pk_fma_f32 v[116:117], v[152:153], v[180:181], v[116:117] op_sel:[0,0,0] op_sel_hi:[1,0,1]
  v_pk_fma_f32 v[118:119], v[154:155], v[180:181], v[118:119] op_sel:[0,0,0] op_sel_hi:[1,0,1]
  v_pk_fma_f32 v[120:121], v[152:153], v[180:181], v[120:121] op_sel:[0,1,0] op_sel_hi:[1,1,1]
  v_pk_fma_f32 v[122:123], v[154:155], v[180:181], v[122:123] op_sel:[0,1,0] op_sel_hi:[1,1,1]
  v_pk_mul_f32 v[116:117], v[116:117], v[136:137]
  v_pk_mul_f32 v[118:119], v[118:119], v[138:139]
  v_pk_mul_f32 v[120:121], v[120:121], v[136:137]
  v_pk_mul_f32 v[122:123], v[122:123], v[138:139]
  v_cvt_pk_bf16_f32 v116, v116, v117
  v_cvt_pk_bf16_f32 v117, v118, v119
  v_cvt_pk_bf16_f32 v118, v120, v121
  v_cvt_pk_bf16_f32 v119, v122, v123
  s_nop 1
  v_permlane32_swap_b32 v116, v118
  v_permlane32_swap_b32 v117, v119
  buffer_store_dwordx4 v[116:119], v23, s[8:11], s28 offen offset:3072 sc1
  s_lshl_b32 s29, s5, 12
  v_add_u32 v24, s29, v22
  s_add_u32 s29, s29, 114688
  v_add_u32 v25, s29, v23
  ds_write_b128 v24, v[36:39] offset:0
  ds_write_b128 v25, v[44:47] offset:0
  ds_write_b128 v24, v[60:63] offset:256
  ds_write_b128 v25, v[68:71] offset:1024
  ds_write_b128 v24, v[84:87] offset:2048
  ds_write_b128 v25, v[92:95] offset:2048
  ds_write_b128 v24, v[108:111] offset:2304
  ds_write_b128 v25, v[116:119] offset:3072
  s_lshl_b32 s28, s35, 13
  s_lshl_b32 s29, s34, 12
  s_add_u32 s28, s28, s29
  s_add_u32 s28, s28, 16384
  v_add_u32 v22, s28, v22
  v_pk_fma_f32 v[28:29], v[164:165], v[160:161], v[28:29] op_sel:[0,0,0] op_sel_hi:[1,0,1]
  v_pk_fma_f32 v[30:31], v[166:167], v[160:161], v[30:31] op_sel:[0,0,0] op_sel_hi:[1,0,1]
  v_pk_fma_f32 v[32:33], v[168:169], v[160:161], v[32:33] op_sel:[0,0,0] op_sel_hi:[1,0,1]
  v_pk_fma_f32 v[34:35], v[170:171], v[160:161], v[34:35] op_sel:[0,0,0] op_sel_hi:[1,0,1]
  v_pk_mul_f32 v[28:29], v[28:29], v[8:9] op_sel:[0,0] op_sel_hi:[1,0]
  v_pk_mul_f32 v[30:31], v[30:31], v[8:9] op_sel:[0,0] op_sel_hi:[1,0]
  v_pk_mul_f32 v[32:33], v[32:33], v[8:9] op_sel:[0,0] op_sel_hi:[1,0]
  v_pk_mul_f32 v[34:35], v[34:35], v[8:9] op_sel:[0,0] op_sel_hi:[1,0]
  v_cvt_pk_bf16_f32 v28, v28, v29
  v_cvt_pk_bf16_f32 v29, v30, v31
  v_cvt_pk_bf16_f32 v30, v32, v33
  v_cvt_pk_bf16_f32 v31, v34, v35
  ds_write_b128 v22, v[28:31] offset:0
  v_pk_fma_f32 v[52:53], v[164:165], v[160:161], v[52:53] op_sel:[0,1,0] op_sel_hi:[1,1,1]
  v_pk_fma_f32 v[54:55], v[166:167], v[160:161], v[54:55] op_sel:[0,1,0] op_sel_hi:[1,1,1]
  v_pk_fma_f32 v[56:57], v[168:169], v[160:161], v[56:57] op_sel:[0,1,0] op_sel_hi:[1,1,1]
  v_pk_fma_f32 v[58:59], v[170:171], v[160:161], v[58:59] op_sel:[0,1,0] op_sel_hi:[1,1,1]
  v_pk_mul_f32 v[52:53], v[52:53], v[8:9] op_sel:[0,1] op_sel_hi:[1,1]
  v_pk_mul_f32 v[54:55], v[54:55], v[8:9] op_sel:[0,1] op_sel_hi:[1,1]
  v_pk_mul_f32 v[56:57], v[56:57], v[8:9] op_sel:[0,1] op_sel_hi:[1,1]
  v_pk_mul_f32 v[58:59], v[58:59], v[8:9] op_sel:[0,1] op_sel_hi:[1,1]
  v_cvt_pk_bf16_f32 v52, v52, v53
  v_cvt_pk_bf16_f32 v53, v54, v55
  v_cvt_pk_bf16_f32 v54, v56, v57
  v_cvt_pk_bf16_f32 v55, v58, v59
  ds_write_b128 v22, v[52:55] offset:256
  v_pk_fma_f32 v[76:77], v[164:165], v[162:163], v[76:77] op_sel:[0,0,0] op_sel_hi:[1,0,1]
  v_pk_fma_f32 v[78:79], v[166:167], v[162:163], v[78:79] op_sel:[0,0,0] op_sel_hi:[1,0,1]
  v_pk_fma_f32 v[80:81], v[168:169], v[162:163], v[80:81] op_sel:[0,0,0] op_sel_hi:[1,0,1]
  v_pk_fma_f32 v[82:83], v[170:171], v[162:163], v[82:83] op_sel:[0,0,0] op_sel_hi:[1,0,1]
  v_pk_mul_f32 v[76:77], v[76:77], v[10:11] op_sel:[0,0] op_sel_hi:[1,0]
  v_pk_mul_f32 v[78:79], v[78:79], v[10:11] op_sel:[0,0] op_sel_hi:[1,0]
  v_pk_mul_f32 v[80:81], v[80:81], v[10:11] op_sel:[0,0] op_sel_hi:[1,0]
  v_pk_mul_f32 v[82:83], v[82:83], v[10:11] op_sel:[0,0] op_sel_hi:[1,0]
  v_cvt_pk_bf16_f32 v76, v76, v77
  v_cvt_pk_bf16_f32 v77, v78, v79
  v_cvt_pk_bf16_f32 v78, v80, v81
  v_cvt_pk_bf16_f32 v79, v82, v83
  ds_write_b128 v22, v[76:79] offset:2048
  v_pk_fma_f32 v[100:101], v[164:165], v[162:163], v[100:101] op_sel:[0,1,0] op_sel_hi:[1,1,1]
  v_pk_fma_f32 v[102:103], v[166:167], v[162:163], v[102:103] op_sel:[0,1,0] op_sel_hi:[1,1,1]
  v_pk_fma_f32 v[104:105], v[168:169], v[162:163], v[104:105] op_sel:[0,1,0] op_sel_hi:[1,1,1]
  v_pk_fma_f32 v[106:107], v[170:171], v[162:163], v[106:107] op_sel:[0,1,0] op_sel_hi:[1,1,1]
  v_pk_mul_f32 v[100:101], v[100:101], v[10:11] op_sel:[0,1] op_sel_hi:[1,1]
  v_pk_mul_f32 v[102:103], v[102:103], v[10:11] op_sel:[0,1] op_sel_hi:[1,1]
  v_pk_mul_f32 v[104:105], v[104:105], v[10:11] op_sel:[0,1] op_sel_hi:[1,1]
  v_pk_mul_f32 v[106:107], v[106:107], v[10:11] op_sel:[0,1] op_sel_hi:[1,1]
  v_cvt_pk_bf16_f32 v100, v100, v101
  v_cvt_pk_bf16_f32 v101, v102, v103
  v_cvt_pk_bf16_f32 v102, v104, v105
  v_cvt_pk_bf16_f32 v103, v106, v107
  ds_write_b128 v22, v[100:103] offset:2304
  s_waitcnt lgkmcnt(0)
L_P2:
  s_lshl_b32 s28, s33, 7
  s_add_u32 s29, s28, 39847936
  s_add_u32 s28, s28, 39849984
  v_mov_b32 v156, s28
  v_mov_b32 v157, s29
  v_cmp_eq_u32 vcc, s32, v3
  s_mov_b32 s48, 2146435072
  s_xor_b32 s42, s34, 1
  v_cndmask_b32 v156, v156, v157, vcc
  v_lshl_add_u32 v156, v3, 2, v156
  v_mov_b32 v157, 1
  s_lshl_b32 s42, s42, 1
  s_lshl_b32 s28, s35, 13
  s_add_u32 s28, s28, 16384
  s_lshl_b32 s29, s42, 11
  s_add_u32 s30, s28, s29
  v_add_u32 v10, s30, v2
  v_xor_b32 v11, 4096, v10
  s_lshl_b32 s28, s5, 12
  v_add_u32 v12, s28, v2
  v_add_u32 v13, 114688, v12
  ds_read_b128 a[48:51], v12 offset:0
  ds_read_b128 a[116:119], v13 offset:0
  ds_read_b128 a[52:55], v12 offset:1024
  ds_read_b128 a[120:123], v13 offset:1024
  ds_read_b128 a[56:59], v12 offset:2048
  ds_read_b128 a[124:127], v13 offset:2048
  ds_read_b128 a[60:63], v12 offset:3072
  ds_read_b128 a[128:131], v13 offset:3072
  v_mov_b32 v116, 1
  v_mov_b32 v117, 0
  s_cmp_eq_u32 s5, 0
  s_cselect_b32 s47, s47, 2146435072
  s_waitcnt vmcnt(0)
  s_barrier
  buffer_store_dword v116, v117, s[8:11], s47 offen sc1
  ds_read_b128 a[0:3], v10 offset:0
  ds_read_b128 a[4:7], v10 offset:1024
  ds_read_b128 a[8:11], v10 offset:2048
  ds_read_b128 a[12:15], v10 offset:3072
  ds_read_b128 a[16:19], v11 offset:0
  ds_read_b128 a[20:23], v11 offset:1024
  ds_read_b128 a[24:27], v11 offset:2048
  ds_read_b128 a[28:31], v11 offset:3072
  s_lshl_b32 s36, s33, 1
  s_add_u32 s36, s36, s35
  s_lshl_b32 s40, s36, 17
  s_lshl_b32 s41, s32, 2
  s_add_u32 s92, s82, s40
  s_addc_u32 s93, s83, 0
  s_add_u32 s84, s92, 8388608
  s_addc_u32 s85, s93, 0
  s_add_u32 s92, s92, 4194304
  s_addc_u32 s93, s93, 0
  s_mov_b32 s86, 131072
  s_mov_b32 s87, 0x20000
  s_mov_b32 s94, 131072
  s_mov_b32 s95, 0x20000
  s_lshl_b32 s28, s34, 12
  s_sub_u32 s37, s28, 8192
  s_lshl_b32 s38, s32, 13
  s_add_u32 s38, s38, s28
  s_add_u32 s49, s38, 8192
  v_lshrrev_b32 v11, 2, v1
  v_xor_b32 v10, v4, v11
  v_and_b32 v10, 1, v10
  v_and_b32 v11, 3, v1
  v_or_b32 v10, v10, v11
  v_cmp_eq_u32 vcc, 0, v10
  v_mov_b32 v11, 0x3f803f80
  s_nop 0
  v_cndmask_b32 v16, 0, v11, vcc
  v_mov_b32 v17, v16
  v_mov_b32 v18, v16
  v_mov_b32 v19, v16
  s_mov_b32 s39, 0x07060302
  s_waitcnt lgkmcnt(0)
  v_mfma_f32_32x32x16_bf16 v[100:115], a[48:51], a[0:3], 0
  v_mfma_f32_32x32x16_bf16 v[100:115], a[52:55], a[4:7], v[100:115]
  v_accvgpr_write_b32 a32, 0
  v_accvgpr_write_b32 a36, 0
  v_accvgpr_write_b32 a40, 0
  v_accvgpr_write_b32 a44, 0
  v_accvgpr_write_b32 a33, 0
  v_accvgpr_write_b32 a37, 0
  v_accvgpr_write_b32 a41, 0
  v_accvgpr_write_b32 a45, 0
  v_accvgpr_write_b32 a34, 0
  v_accvgpr_write_b32 a38, 0
  v_accvgpr_write_b32 a42, 0
  v_accvgpr_write_b32 a46, 0
  v_accvgpr_write_b32 a35, 0
  v_accvgpr_write_b32 a39, 0
  v_accvgpr_write_b32 a43, 0
  v_accvgpr_write_b32 a47, 0
  v_mov_b32 v140, 0
  v_mov_b32 v141, 0
  v_mov_b32 v142, 0
  v_mov_b32 v143, 0
  v_mov_b32 v144, 0
  v_mov_b32 v145, 0
  v_mov_b32 v146, 0
  v_mov_b32 v147, 0
  v_mov_b32 v148, 0
  v_mov_b32 v149, 0
  v_mov_b32 v150, 0
  v_mov_b32 v151, 0
  v_mov_b32 v152, 0
  v_mov_b32 v153, 0
  v_mov_b32 v154, 0
  v_mov_b32 v155, 0
  s_and_b32 s50, s3, 3
  s_lshl_b32 s50, s50, 2
  s_and_b32 s29, s4, 3
  s_add_u32 s50, s50, s29
  s_lshr_b32 s51, s3, 2
  s_lshl_b32 s51, s51, 3
  s_lshr_b32 s29, s4, 2
  s_and_b32 s28, s29, 3
  s_cmp_eq_u32 s28, 3
  s_cselect_b32 s28, 4, 0
  s_xor_b32 s29, s29, s28
  s_add_u32 s51, s51, s29
  v_lshrrev_b32 v8, 3, v1
  v_and_b32 v11, 6, v8
  s_lshl_b32 s29, s5, 4
  v_add_u32 v8, s29, v8
  v_lshlrev_b32 v8, 11, v8
  v_and_b32 v250, 7, v1
  v_xor_b32 v11, v11, v250
  v_lshl_add_u32 v8, v11, 4, v8
  s_lshl_b32 s29, s51, 7
  v_add_u32 v250, s29, v8
  v_add_u32 v251, 15360, v250
  s_mov_b32 s12, s68
  s_mov_b32 s13, s69
  s_mov_b32 s14, 2097152
  s_mov_b32 s15, 0x20000
  s_cmp_ge_u32 s2, 112
  s_cselect_b32 s16, s74, s72
  s_cselect_b32 s17, s75, s73
  s_cselect_b32 s29, 112, 0
  s_cselect_b32 s62, 14336, 0
  s_mov_b32 s18, 7340032
  s_mov_b32 s19, 0x20000
  s_sub_u32 s28, s2, s29
  s_mul_i32 s60, s28, 147
  s_lshr_b32 s60, s60, 10
  s_mul_i32 s29, s60, 7
  s_sub_u32 s61, s28, s29
  s_lshl_b32 s28, s60, 2
  s_add_u32 s28, s28, s5
  s_mul_i32 s28, s28, 114688
  s_lshl_b32 s29, s61, 10
  s_add_u32 s45, s28, s29
  s_cmp_ge_u32 s2, 224
  s_cselect_b32 s45, 2146435072, s45
  s_lshl_b32 s28, s2, 2
  s_add_u32 s28, s28, s5
  s_lshl_b32 s63, s28, 11
  v_lshlrev_b32 v9, 7, v3
  s_mov_b32 s43, 0
  s_lshl_b32 s44, s5, 11
  s_mov_b32 s20, s76
  s_mov_b32 s21, s77
  s_mov_b32 s22, 7340032
  s_mov_b32 s23, 0x20000
  s_lshl_b32 s28, s2, 2
  s_add_u32 s28, s28, s5
  s_mul_i32 s47, s28, 7168
  v_min_u32 v12, 13, v1
  v_lshlrev_b32 v12, 7, v12
  v_mfma_f32_32x32x16_bf16 v[116:131], a[48:51], a[8:11], 0
  v_exp_f32 v100, v100
  v_exp_f32 v101, v101
  v_exp_f32 v102, v102
  v_exp_f32 v103, v103
  v_mfma_f32_32x32x16_bf16 v[116:131], a[52:55], a[12:15], v[116:131]
  v_exp_f32 v104, v104
  v_exp_f32 v105, v105
  v_exp_f32 v106, v106
  v_cvt_pk_bf16_f32 v132, v100, v101
  v_cvt_pk_bf16_f32 v133, v102, v103
  v_exp_f32 v107, v107
  v_exp_f32 v108, v108
  v_exp_f32 v109, v109
  v_cvt_pk_bf16_f32 v134, v104, v105
  v_cvt_pk_bf16_f32 v135, v106, v107
  v_exp_f32 v110, v110
  v_exp_f32 v111, v111
  v_mfma_f32_32x32x16_bf16 v[20:35], a[116:119], v[132:135], 0
  v_exp_f32 v112, v112
  v_exp_f32 v113, v113
  v_exp_f32 v114, v114
  v_cvt_pk_bf16_f32 v136, v108, v109
  v_cvt_pk_bf16_f32 v137, v110, v111
  v_mfma_f32_16x16x32_bf16 v[84:87], v[16:19], v[132:135], 0
  v_exp_f32 v115, v115
  v_cvt_pk_bf16_f32 v138, v112, v113
  v_cvt_pk_bf16_f32 v139, v114, v115
  v_mfma_f32_32x32x16_bf16 v[100:115], a[48:51], a[16:19], 0
  v_exp_f32 v116, v116
  v_exp_f32 v117, v117
  v_exp_f32 v118, v118
  v_exp_f32 v119, v119
  v_mfma_f32_32x32x16_bf16 v[100:115], a[52:55], a[20:23], v[100:115]
  v_exp_f32 v120, v120
  v_exp_f32 v121, v121
  v_exp_f32 v122, v122
  v_cvt_pk_bf16_f32 v132, v116, v117
  v_cvt_pk_bf16_f32 v133, v118, v119
  v_mfma_f32_32x32x16_bf16 v[20:35], a[120:123], v[136:139], v[20:35]
  v_exp_f32 v123, v123
  v_exp_f32 v124, v124
  v_exp_f32 v125, v125
  v_cvt_pk_bf16_f32 v134, v120, v121
  v_cvt_pk_bf16_f32 v135, v122, v123
  v_mfma_f32_16x16x32_bf16 v[84:87], v[16:19], v[136:139], v[84:87]
  v_exp_f32 v126, v126
  v_exp_f32 v127, v127
  v_mfma_f32_32x32x16_bf16 v[36:51], a[116:119], v[132:135], 0
  v_exp_f32 v128, v128
  v_exp_f32 v129, v129
  v_exp_f32 v130, v130
  v_cvt_pk_bf16_f32 v136, v124, v125
  v_cvt_pk_bf16_f32 v137, v126, v127
  v_mfma_f32_16x16x32_bf16 v[88:91], v[16:19], v[132:135], 0
  v_exp_f32 v131, v131
  v_cvt_pk_bf16_f32 v138, v128, v129
  v_cvt_pk_bf16_f32 v139, v130, v131
  s_cmp_lg_u32 s5, 0
  s_cbranch_scc1 L_p2_nf
  buffer_load_dword v157, v156, s[8:11], 0 offen sc1
L_p2_nf:
  buffer_load_dword a239, v2, s[8:11], s48 offen
  v_mfma_f32_32x32x16_bf16 v[116:131], a[48:51], a[24:27], 0
  v_exp_f32 v100, v100
  v_exp_f32 v101, v101
  v_exp_f32 v102, v102
  v_exp_f32 v103, v103
  v_mfma_f32_32x32x16_bf16 v[116:131], a[52:55], a[28:31], v[116:131]
  v_exp_f32 v104, v104
  v_exp_f32 v105, v105
  v_exp_f32 v106, v106
  v_cvt_pk_bf16_f32 v132, v100, v101
  v_cvt_pk_bf16_f32 v133, v102, v103
  v_mfma_f32_32x32x16_bf16 v[36:51], a[120:123], v[136:139], v[36:51]
  v_exp_f32 v107, v107
  v_exp_f32 v108, v108
  v_exp_f32 v109, v109
  v_cvt_pk_bf16_f32 v134, v104, v105
  v_cvt_pk_bf16_f32 v135, v106, v107
  v_mfma_f32_16x16x32_bf16 v[88:91], v[16:19], v[136:139], v[88:91]
  v_exp_f32 v110, v110
  v_exp_f32 v111, v111
  v_mfma_f32_32x32x16_bf16 v[52:67], a[116:119], v[132:135], 0
  v_exp_f32 v112, v112
  v_exp_f32 v113, v113
  v_exp_f32 v114, v114
  v_cvt_pk_bf16_f32 v136, v108, v109
  v_cvt_pk_bf16_f32 v137, v110, v111
  v_mfma_f32_16x16x32_bf16 v[92:95], v[16:19], v[132:135], 0
  v_exp_f32 v115, v115
  v_cvt_pk_bf16_f32 v138, v112, v113
  v_cvt_pk_bf16_f32 v139, v114, v115
  v_mfma_f32_32x32x16_bf16 v[100:115], a[56:59], a[0:3], 0
  v_exp_f32 v116, v116
  v_exp_f32 v117, v117
  v_exp_f32 v118, v118
  v_exp_f32 v119, v119
  buffer_load_dword a240, v2, s[8:11], s48 offen
  buffer_load_dword a248, v2, s[8:11], s48 offen
  v_mfma_f32_32x32x16_bf16 v[100:115], a[60:63], a[4:7], v[100:115]
  v_exp_f32 v120, v120
  v_exp_f32 v121, v121
  v_exp_f32 v122, v122
  v_cvt_pk_bf16_f32 v132, v116, v117
  v_cvt_pk_bf16_f32 v133, v118, v119
  v_mfma_f32_32x32x16_bf16 v[52:67], a[120:123], v[136:139], v[52:67]
  v_exp_f32 v123, v123
  v_exp_f32 v124, v124
  v_exp_f32 v125, v125
  v_cvt_pk_bf16_f32 v134, v120, v121
  v_cvt_pk_bf16_f32 v135, v122, v123
  v_mfma_f32_16x16x32_bf16 v[92:95], v[16:19], v[136:139], v[92:95]
  v_exp_f32 v126, v126
  v_exp_f32 v127, v127
  v_mfma_f32_32x32x16_bf16 v[68:83], a[116:119], v[132:135], 0
  v_exp_f32 v128, v128
  v_exp_f32 v129, v129
  v_exp_f32 v130, v130
  v_cvt_pk_bf16_f32 v136, v124, v125
  v_cvt_pk_bf16_f32 v137, v126, v127
  v_mfma_f32_16x16x32_bf16 v[96:99], v[16:19], v[132:135], 0
  v_exp_f32 v131, v131
  v_cvt_pk_bf16_f32 v138, v128, v129
  v_cvt_pk_bf16_f32 v139, v130, v131
  s_waitcnt vmcnt(2)
  v_cmp_eq_u32 vcc, 0, v157
  s_nop 1
  s_cmp_lg_u64 vcc, 0
  s_cbranch_scc1 L_p2f_spin
L_p2f_back:
  s_barrier
  s_add_u32 s37, s37, 8192
  s_cmp_eq_u32 s37, s38
  s_cmov_b32 s37, s49
  buffer_load_dwordx4 a[64:67], v2, s[92:95], s37 offen offset:0 sc1
  buffer_load_dwordx4 a[68:71], v2, s[92:95], s37 offen offset:1024 sc1
  buffer_load_dwordx4 a[132:135], v2, s[84:87], s37 offen offset:0 sc1
  buffer_load_dwordx4 a[136:139], v2, s[84:87], s37 offen offset:1024 sc1
  buffer_load_dwordx4 a[72:75], v2, s[92:95], s37 offen offset:2048 sc1
  buffer_load_dwordx4 a[76:79], v2, s[92:95], s37 offen offset:3072 sc1
  buffer_load_dwordx4 a[140:143], v2, s[84:87], s37 offen offset:2048 sc1
  buffer_load_dwordx4 a[144:147], v2, s[84:87], s37 offen offset:3072 sc1
  v_mfma_f32_32x32x16_bf16 v[116:131], a[56:59], a[8:11], 0
  v_exp_f32 v100, v100
  v_exp_f32 v101, v101
  v_exp_f32 v102, v102
  v_exp_f32 v103, v103
  s_add_u32 s37, s37, 8192
  s_cmp_eq_u32 s37, s38
  s_cmov_b32 s37, s49
  buffer_load_dwordx4 a[80:83], v2, s[92:95], s37 offen offset:0 sc1
  buffer_load_dwordx4 a[84:87], v2, s[92:95], s37 offen offset:1024 sc1
  buffer_load_dwordx4 a[148:151], v2, s[84:87], s37 offen offset:0 sc1
  buffer_load_dwordx4 a[152:155], v2, s[84:87], s37 offen offset:1024 sc1
  v_mfma_f32_32x32x16_bf16 v[116:131], a[60:63], a[12:15], v[116:131]
  v_exp_f32 v104, v104
  v_exp_f32 v105, v105
  v_exp_f32 v106, v106
  v_cvt_pk_bf16_f32 v132, v100, v101
  v_cvt_pk_bf16_f32 v133, v102, v103
  v_mfma_f32_32x32x16_bf16 v[68:83], a[120:123], v[136:139], v[68:83]
  v_exp_f32 v107, v107
  v_exp_f32 v108, v108
  v_exp_f32 v109, v109
  v_cvt_pk_bf16_f32 v134, v104, v105
  v_cvt_pk_bf16_f32 v135, v106, v107
  v_mfma_f32_16x16x32_bf16 v[96:99], v[16:19], v[136:139], v[96:99]
  v_exp_f32 v110, v110
  v_exp_f32 v111, v111
  v_mfma_f32_32x32x16_bf16 v[20:35], a[124:127], v[132:135], v[20:35]
  v_exp_f32 v112, v112
  v_exp_f32 v113, v113
  v_exp_f32 v114, v114
  v_cvt_pk_bf16_f32 v136, v108, v109
  v_cvt_pk_bf16_f32 v137, v110, v111
  v_mfma_f32_16x16x32_bf16 v[84:87], v[16:19], v[132:135], v[84:87]
  v_exp_f32 v115, v115
  v_cvt_pk_bf16_f32 v138, v112, v113
  v_cvt_pk_bf16_f32 v139, v114, v115
  v_mfma_f32_32x32x16_bf16 v[100:115], a[56:59], a[16:19], 0
  v_exp_f32 v116, v116
  v_exp_f32 v117, v117
  v_exp_f32 v118, v118
  v_exp_f32 v119, v119
  buffer_load_dwordx4 a[88:91], v2, s[92:95], s37 offen offset:2048 sc1
  buffer_load_dwordx4 a[92:95], v2, s[92:95], s37 offen offset:3072 sc1
  buffer_load_dwordx4 a[156:159], v2, s[84:87], s37 offen offset:2048 sc1
  buffer_load_dwordx4 a[160:163], v2, s[84:87], s37 offen offset:3072 sc1
  v_mfma_f32_32x32x16_bf16 v[100:115], a[60:63], a[20:23], v[100:115]
  v_exp_f32 v120, v120
  v_exp_f32 v121, v121
  v_exp_f32 v122, v122
  v_cvt_pk_bf16_f32 v132, v116, v117
  v_cvt_pk_bf16_f32 v133, v118, v119
  v_mfma_f32_32x32x16_bf16 v[20:35], a[128:131], v[136:139], v[20:35]
  v_exp_f32 v123, v123
  v_exp_f32 v124, v124
  v_exp_f32 v125, v125
  v_cvt_pk_bf16_f32 v134, v120, v121
  v_cvt_pk_bf16_f32 v135, v122, v123
  v_mfma_f32_16x16x32_bf16 v[84:87], v[16:19], v[136:139], v[84:87]
  v_exp_f32 v126, v126
  v_exp_f32 v127, v127
  v_mfma_f32_32x32x16_bf16 v[36:51], a[124:127], v[132:135], v[36:51]
  v_exp_f32 v128, v128
  v_exp_f32 v129, v129
  v_exp_f32 v130, v130
  v_cvt_pk_bf16_f32 v136, v124, v125
  v_cvt_pk_bf16_f32 v137, v126, v127
  v_mfma_f32_16x16x32_bf16 v[88:91], v[16:19], v[132:135], v[88:91]
  v_exp_f32 v131, v131
  v_cvt_pk_bf16_f32 v138, v128, v129
  v_cvt_pk_bf16_f32 v139, v130, v131
  v_mfma_f32_32x32x16_bf16 v[116:131], a[56:59], a[24:27], 0
  v_exp_f32 v100, v100
  v_exp_f32 v101, v101
  v_exp_f32 v102, v102
  v_exp_f32 v103, v103
  s_add_u32 s37, s37, 8192
  s_cmp_eq_u32 s37, s38
  s_cmov_b32 s37, s49
  buffer_load_dwordx4 a[96:99], v2, s[92:95], s37 offen offset:0 sc1
  buffer_load_dwordx4 a[100:103], v2, s[92:95], s37 offen offset:1024 sc1
  buffer_load_dwordx4 a[164:167], v2, s[84:87], s37 offen offset:0 sc1
  buffer_load_dwordx4 a[168:171], v2, s[84:87], s37 offen offset:1024 sc1
  v_mfma_f32_32x32x16_bf16 v[116:131], a[60:63], a[28:31], v[116:131]
  v_exp_f32 v104, v104
  v_exp_f32 v105, v105
  v_exp_f32 v106, v106
  v_cvt_pk_bf16_f32 v132, v100, v101
  v_cvt_pk_bf16_f32 v133, v102, v103
  v_mfma_f32_32x32x16_bf16 v[36:51], a[128:131], v[136:139], v[36:51]
  v_exp_f32 v107, v107
  v_exp_f32 v108, v108
  v_exp_f32 v109, v109
  v_cvt_pk_bf16_f32 v134, v104, v105
  v_cvt_pk_bf16_f32 v135, v106, v107
  v_mfma_f32_16x16x32_bf16 v[88:91], v[16:19], v[136:139], v[88:91]
  v_exp_f32 v110, v110
  v_exp_f32 v111, v111
  v_mfma_f32_32x32x16_bf16 v[52:67], a[124:127], v[132:135], v[52:67]
  v_exp_f32 v112, v112
  v_exp_f32 v113, v113
  v_exp_f32 v114, v114
  v_cvt_pk_bf16_f32 v136, v108, v109
  v_cvt_pk_bf16_f32 v137, v110, v111
  v_mfma_f32_16x16x32_bf16 v[92:95], v[16:19], v[132:135], v[92:95]
  v_exp_f32 v115, v115
  v_cvt_pk_bf16_f32 v138, v112, v113
  v_cvt_pk_bf16_f32 v139, v114, v115
  s_waitcnt vmcnt(16)
  v_mfma_f32_32x32x16_bf16 v[100:115], a[64:67], a[0:3], 0
  v_exp_f32 v116, v116
  v_exp_f32 v117, v117
  v_exp_f32 v118, v118
  v_exp_f32 v119, v119
  buffer_load_dwordx4 a[104:107], v2, s[92:95], s37 offen offset:2048 sc1
  buffer_load_dwordx4 a[108:111], v2, s[92:95], s37 offen offset:3072 sc1
  buffer_load_dwordx4 a[172:175], v2, s[84:87], s37 offen offset:2048 sc1
  buffer_load_dwordx4 a[176:179], v2, s[84:87], s37 offen offset:3072 sc1
  v_mfma_f32_32x32x16_bf16 v[100:115], a[68:71], a[4:7], v[100:115]
  v_exp_f32 v120, v120
  v_exp_f32 v121, v121
  v_exp_f32 v122, v122
  v_cvt_pk_bf16_f32 v132, v116, v117
  v_cvt_pk_bf16_f32 v133, v118, v119
  v_mfma_f32_32x32x16_bf16 v[52:67], a[128:131], v[136:139], v[52:67]
  v_exp_f32 v123, v123
  v_exp_f32 v124, v124
  v_exp_f32 v125, v125
  v_cvt_pk_bf16_f32 v134, v120, v121
  v_cvt_pk_bf16_f32 v135, v122, v123
  v_mfma_f32_16x16x32_bf16 v[92:95], v[16:19], v[136:139], v[92:95]
  v_exp_f32 v126, v126
  v_exp_f32 v127, v127
  v_mfma_f32_32x32x16_bf16 v[68:83], a[124:127], v[132:135], v[68:83]
  v_exp_f32 v128, v128
  v_exp_f32 v129, v129
  v_exp_f32 v130, v130
  v_cvt_pk_bf16_f32 v136, v124, v125
  v_cvt_pk_bf16_f32 v137, v126, v127
  v_mfma_f32_16x16x32_bf16 v[96:99], v[16:19], v[132:135], v[96:99]
  v_exp_f32 v131, v131
  v_cvt_pk_bf16_f32 v138, v128, v129
  v_cvt_pk_bf16_f32 v139, v130, v131
  v_mfma_f32_32x32x16_bf16 v[116:131], a[64:67], a[8:11], 0
  v_exp_f32 v100, v100
  v_exp_f32 v101, v101
  v_exp_f32 v102, v102
  v_exp_f32 v103, v103
  s_add_u32 s37, s37, 8192
  s_cmp_eq_u32 s37, s38
  s_cmov_b32 s37, s49
  buffer_load_dwordx4 a[48:51], v2, s[92:95], s37 offen offset:0 sc1
  buffer_load_dwordx4 a[52:55], v2, s[92:95], s37 offen offset:1024 sc1
  v_mfma_f32_32x32x16_bf16 v[116:131], a[68:71], a[12:15], v[116:131]
  v_exp_f32 v104, v104
  v_exp_f32 v105, v105
  v_exp_f32 v106, v106
  v_cvt_pk_bf16_f32 v132, v100, v101
  v_cvt_pk_bf16_f32 v133, v102, v103
  v_mfma_f32_32x32x16_bf16 v[68:83], a[128:131], v[136:139], v[68:83]
  v_exp_f32 v107, v107
  v_exp_f32 v108, v108
  v_exp_f32 v109, v109
  v_cvt_pk_bf16_f32 v134, v104, v105
  v_cvt_pk_bf16_f32 v135, v106, v107
  v_mfma_f32_16x16x32_bf16 v[96:99], v[16:19], v[136:139], v[96:99]
  v_exp_f32 v110, v110
  v_exp_f32 v111, v111
  v_mfma_f32_32x32x16_bf16 v[20:35], a[132:135], v[132:135], v[20:35]
  v_exp_f32 v112, v112
  v_exp_f32 v113, v113
  v_exp_f32 v114, v114
  v_cvt_pk_bf16_f32 v136, v108, v109
  v_cvt_pk_bf16_f32 v137, v110, v111
  v_mfma_f32_16x16x32_bf16 v[84:87], v[16:19], v[132:135], v[84:87]
  v_exp_f32 v115, v115
  v_cvt_pk_bf16_f32 v138, v112, v113
  v_cvt_pk_bf16_f32 v139, v114, v115
  v_mfma_f32_32x32x16_bf16 v[100:115], a[64:67], a[16:19], 0
  v_exp_f32 v116, v116
  v_exp_f32 v117, v117
  v_exp_f32 v118, v118
  v_exp_f32 v119, v119
  buffer_load_dwordx4 a[116:119], v2, s[84:87], s37 offen offset:0 sc1
  buffer_load_dwordx4 a[120:123], v2, s[84:87], s37 offen offset:1024 sc1
  buffer_load_dwordx4 a[56:59], v2, s[92:95], s37 offen offset:2048 sc1
  buffer_load_dwordx4 a[60:63], v2, s[92:95], s37 offen offset:3072 sc1
  v_mfma_f32_32x32x16_bf16 v[100:115], a[68:71], a[20:23], v[100:115]
  v_exp_f32 v120, v120
  v_exp_f32 v121, v121
  v_exp_f32 v122, v122
  v_cvt_pk_bf16_f32 v132, v116, v117
  v_cvt_pk_bf16_f32 v133, v118, v119
  v_mfma_f32_32x32x16_bf16 v[20:35], a[136:139], v[136:139], v[20:35]
  v_exp_f32 v123, v123
  v_exp_f32 v124, v124
  v_exp_f32 v125, v125
  v_cvt_pk_bf16_f32 v134, v120, v121
  v_cvt_pk_bf16_f32 v135, v122, v123
  v_mfma_f32_16x16x32_bf16 v[84:87], v[16:19], v[136:139], v[84:87]
  v_exp_f32 v126, v126
  v_exp_f32 v127, v127
  v_mfma_f32_32x32x16_bf16 v[36:51], a[132:135], v[132:135], v[36:51]
  v_exp_f32 v128, v128
  v_exp_f32 v129, v129
  v_exp_f32 v130, v130
  v_cvt_pk_bf16_f32 v136, v124, v125
  v_cvt_pk_bf16_f32 v137, v126, v127
  v_mfma_f32_16x16x32_bf16 v[88:91], v[16:19], v[132:135], v[88:91]
  v_exp_f32 v131, v131
  v_cvt_pk_bf16_f32 v138, v128, v129
  v_cvt_pk_bf16_f32 v139, v130, v131
  v_mfma_f32_32x32x16_bf16 v[116:131], a[64:67], a[24:27], 0
  v_exp_f32 v100, v100
  v_exp_f32 v101, v101
  v_exp_f32 v102, v102
  v_exp_f32 v103, v103
  v_mfma_f32_32x32x16_bf16 v[116:131], a[68:71], a[28:31], v[116:131]
  v_exp_f32 v104, v104
  v_exp_f32 v105, v105
  v_exp_f32 v106, v106
  v_cvt_pk_bf16_f32 v132, v100, v101
  v_cvt_pk_bf16_f32 v133, v102, v103
  v_mfma_f32_32x32x16_bf16 v[36:51], a[136:139], v[136:139], v[36:51]
  v_exp_f32 v107, v107
  v_exp_f32 v108, v108
  v_exp_f32 v109, v109
  v_cvt_pk_bf16_f32 v134, v104, v105
  v_cvt_pk_bf16_f32 v135, v106, v107
  v_mfma_f32_16x16x32_bf16 v[88:91], v[16:19], v[136:139], v[88:91]
  v_exp_f32 v110, v110
  v_exp_f32 v111, v111
  v_mfma_f32_32x32x16_bf16 v[52:67], a[132:135], v[132:135], v[52:67]
  v_exp_f32 v112, v112
  v_exp_f32 v113, v113
  v_exp_f32 v114, v114
  v_cvt_pk_bf16_f32 v136, v108, v109
  v_cvt_pk_bf16_f32 v137, v110, v111
  v_mfma_f32_16x16x32_bf16 v[92:95], v[16:19], v[132:135], v[92:95]
  v_exp_f32 v115, v115
  v_cvt_pk_bf16_f32 v138, v112, v113
  v_cvt_pk_bf16_f32 v139, v114, v115
  s_waitcnt vmcnt(22)
  v_mfma_f32_32x32x16_bf16 v[100:115], a[72:75], a[0:3], 0
  v_exp_f32 v116, v116
  v_exp_f32 v117, v117
  v_exp_f32 v118, v118
  v_exp_f32 v119, v119
  v_mfma_f32_32x32x16_bf16 v[140:155], a[112:115], a[32:35], v[140:155]
  buffer_load_dwordx4 a[124:127], v2, s[84:87], s37 offen offset:2048 sc1
  buffer_load_dwordx4 a[128:131], v2, s[84:87], s37 offen offset:3072 sc1
  s_add_u32 s37, s37, 8192
  s_cmp_eq_u32 s37, s38
  s_cmov_b32 s37, s49
  buffer_load_dwordx4 a[64:67], v2, s[92:95], s37 offen offset:0 sc1
  buffer_load_dwordx4 a[68:71], v2, s[92:95], s37 offen offset:1024 sc1
  buffer_load_dword a242, v2, s[8:11], s48 offen
  buffer_load_dword a250, v2, s[8:11], s48 offen
  buffer_load_dword v13, v9, s[12:15], s63 offen
  buffer_load_dwordx4 a[32:35], v2, s[16:19], s45 offen
  s_add_u32 s45, s45, 7168
  v_mfma_f32_32x32x16_bf16 v[100:115], a[76:79], a[4:7], v[100:115]
  v_exp_f32 v120, v120
  v_exp_f32 v121, v121
  v_exp_f32 v122, v122
  v_cvt_pk_bf16_f32 v132, v116, v117
  v_cvt_pk_bf16_f32 v133, v118, v119
  v_mfma_f32_32x32x16_bf16 v[52:67], a[136:139], v[136:139], v[52:67]
  v_exp_f32 v123, v123
  v_exp_f32 v124, v124
  v_exp_f32 v125, v125
  v_cvt_pk_bf16_f32 v134, v120, v121
  v_cvt_pk_bf16_f32 v135, v122, v123
  v_mfma_f32_16x16x32_bf16 v[92:95], v[16:19], v[136:139], v[92:95]
  v_exp_f32 v126, v126
  v_exp_f32 v127, v127
  v_mfma_f32_32x32x16_bf16 v[68:83], a[132:135], v[132:135], v[68:83]
  v_exp_f32 v128, v128
  v_exp_f32 v129, v129
  v_exp_f32 v130, v130
  v_cvt_pk_bf16_f32 v136, v124, v125
  v_cvt_pk_bf16_f32 v137, v126, v127
  v_mfma_f32_16x16x32_bf16 v[96:99], v[16:19], v[132:135], v[96:99]
  v_exp_f32 v131, v131
  v_cvt_pk_bf16_f32 v138, v128, v129
  v_cvt_pk_bf16_f32 v139, v130, v131
  v_mfma_f32_32x32x16_bf16 v[116:131], a[72:75], a[8:11], 0
  v_exp_f32 v100, v100
  v_exp_f32 v101, v101
  v_exp_f32 v102, v102
  v_exp_f32 v103, v103
  v_mfma_f32_32x32x16_bf16 v[116:131], a[76:79], a[12:15], v[116:131]
  v_exp_f32 v104, v104
  v_exp_f32 v105, v105
  v_exp_f32 v106, v106
  v_cvt_pk_bf16_f32 v132, v100, v101
  v_cvt_pk_bf16_f32 v133, v102, v103
  v_mfma_f32_32x32x16_bf16 v[68:83], a[136:139], v[136:139], v[68:83]
  v_exp_f32 v107, v107
  v_exp_f32 v108, v108
  v_exp_f32 v109, v109
  v_cvt_pk_bf16_f32 v134, v104, v105
  v_cvt_pk_bf16_f32 v135, v106, v107
  v_mfma_f32_16x16x32_bf16 v[96:99], v[16:19], v[136:139], v[96:99]
  v_exp_f32 v110, v110
  v_exp_f32 v111, v111
  v_mfma_f32_32x32x16_bf16 v[20:35], a[140:143], v[132:135], v[20:35]
  v_exp_f32 v112, v112
  v_exp_f32 v113, v113
  v_exp_f32 v114, v114
  v_cvt_pk_bf16_f32 v136, v108, v109
  v_cvt_pk_bf16_f32 v137, v110, v111
  v_mfma_f32_16x16x32_bf16 v[84:87], v[16:19], v[132:135], v[84:87]
  v_exp_f32 v115, v115
  v_cvt_pk_bf16_f32 v138, v112, v113
  v_cvt_pk_bf16_f32 v139, v114, v115
  v_mfma_f32_32x32x16_bf16 v[100:115], a[72:75], a[16:19], 0
  v_exp_f32 v116, v116
  v_exp_f32 v117, v117
  v_exp_f32 v118, v118
  v_exp_f32 v119, v119
  v_mfma_f32_32x32x16_bf16 v[100:115], a[76:79], a[20:23], v[100:115]
  v_exp_f32 v120, v120
  v_exp_f32 v121, v121
  v_exp_f32 v122, v122
  v_cvt_pk_bf16_f32 v132, v116, v117
  v_cvt_pk_bf16_f32 v133, v118, v119
  v_mfma_f32_32x32x16_bf16 v[20:35], a[144:147], v[136:139], v[20:35]
  v_exp_f32 v123, v123
  v_exp_f32 v124, v124
  v_exp_f32 v125, v125
  v_cvt_pk_bf16_f32 v134, v120, v121
  v_cvt_pk_bf16_f32 v135, v122, v123
  v_mfma_f32_16x16x32_bf16 v[84:87], v[16:19], v[136:139], v[84:87]
  v_exp_f32 v126, v126
  v_exp_f32 v127, v127
  v_mfma_f32_32x32x16_bf16 v[36:51], a[140:143], v[132:135], v[36:51]
  v_exp_f32 v128, v128
  v_exp_f32 v129, v129
  v_exp_f32 v130, v130
  v_cvt_pk_bf16_f32 v136, v124, v125
  v_cvt_pk_bf16_f32 v137, v126, v127
  v_mfma_f32_16x16x32_bf16 v[88:91], v[16:19], v[132:135], v[88:91]
  v_exp_f32 v131, v131
  v_cvt_pk_bf16_f32 v138, v128, v129
  v_cvt_pk_bf16_f32 v139, v130, v131
  v_mfma_f32_32x32x16_bf16 v[116:131], a[72:75], a[24:27], 0
  v_exp_f32 v100, v100
  v_exp_f32 v101, v101
  v_exp_f32 v102, v102
  v_exp_f32 v103, v103
  v_mfma_f32_32x32x16_bf16 v[116:131], a[76:79], a[28:31], v[116:131]
  v_exp_f32 v104, v104
  v_exp_f32 v105, v105
  v_exp_f32 v106, v106
  v_cvt_pk_bf16_f32 v132, v100, v101
  v_cvt_pk_bf16_f32 v133, v102, v103
  v_mfma_f32_32x32x16_bf16 v[36:51], a[144:147], v[136:139], v[36:51]
  v_exp_f32 v107, v107
  v_exp_f32 v108, v108
  v_exp_f32 v109, v109
  v_cvt_pk_bf16_f32 v134, v104, v105
  v_cvt_pk_bf16_f32 v135, v106, v107
  v_mfma_f32_16x16x32_bf16 v[88:91], v[16:19], v[136:139], v[88:91]
  v_exp_f32 v110, v110
  v_exp_f32 v111, v111
  v_mfma_f32_32x32x16_bf16 v[52:67], a[140:143], v[132:135], v[52:67]
  v_exp_f32 v112, v112
  v_exp_f32 v113, v113
  v_exp_f32 v114, v114
  v_cvt_pk_bf16_f32 v136, v108, v109
  v_cvt_pk_bf16_f32 v137, v110, v111
  v_mfma_f32_16x16x32_bf16 v[92:95], v[16:19], v[132:135], v[92:95]
  v_exp_f32 v115, v115
  v_cvt_pk_bf16_f32 v138, v112, v113
  v_cvt_pk_bf16_f32 v139, v114, v115
  s_waitcnt vmcnt(26)
  v_mfma_f32_32x32x16_bf16 v[100:115], a[80:83], a[0:3], 0
  v_exp_f32 v116, v116
  v_exp_f32 v117, v117
  v_exp_f32 v118, v118
  v_exp_f32 v119, v119
  v_mfma_f32_32x32x16_bf16 v[140:155], a[112:115], a[36:39], v[140:155]
  buffer_load_dwordx4 a[132:135], v2, s[84:87], s37 offen offset:0 sc1
  buffer_load_dwordx4 a[136:139], v2, s[84:87], s37 offen offset:1024 sc1
  buffer_load_dwordx4 a[72:75], v2, s[92:95], s37 offen offset:2048 sc1
  buffer_load_dwordx4 a[76:79], v2, s[92:95], s37 offen offset:3072 sc1
  buffer_load_dwordx4 a[36:39], v2, s[16:19], s45 offen
  s_add_u32 s45, s45, 7168
  v_mfma_f32_32x32x16_bf16 v[100:115], a[84:87], a[4:7], v[100:115]
  v_exp_f32 v120, v120
  v_exp_f32 v121, v121
  v_exp_f32 v122, v122
  v_cvt_pk_bf16_f32 v132, v116, v117
  v_cvt_pk_bf16_f32 v133, v118, v119
  v_mfma_f32_32x32x16_bf16 v[52:67], a[144:147], v[136:139], v[52:67]
  v_exp_f32 v123, v123
  v_exp_f32 v124, v124
  v_exp_f32 v125, v125
  v_cvt_pk_bf16_f32 v134, v120, v121
  v_cvt_pk_bf16_f32 v135, v122, v123
  v_mfma_f32_16x16x32_bf16 v[92:95], v[16:19], v[136:139], v[92:95]
  v_exp_f32 v126, v126
  v_exp_f32 v127, v127
  v_mfma_f32_32x32x16_bf16 v[68:83], a[140:143], v[132:135], v[68:83]
  v_exp_f32 v128, v128
  v_exp_f32 v129, v129
  v_exp_f32 v130, v130
  v_cvt_pk_bf16_f32 v136, v124, v125
  v_cvt_pk_bf16_f32 v137, v126, v127
  v_mfma_f32_16x16x32_bf16 v[96:99], v[16:19], v[132:135], v[96:99]
  v_exp_f32 v131, v131
  v_cvt_pk_bf16_f32 v138, v128, v129
  v_cvt_pk_bf16_f32 v139, v130, v131
  v_mfma_f32_32x32x16_bf16 v[116:131], a[80:83], a[8:11], 0
  v_exp_f32 v100, v100
  v_exp_f32 v101, v101
  v_exp_f32 v102, v102
  v_exp_f32 v103, v103
  v_mfma_f32_32x32x16_bf16 v[116:131], a[84:87], a[12:15], v[116:131]
  v_exp_f32 v104, v104
  v_exp_f32 v105, v105
  v_exp_f32 v106, v106
  v_cvt_pk_bf16_f32 v132, v100, v101
  v_cvt_pk_bf16_f32 v133, v102, v103
  v_mfma_f32_32x32x16_bf16 v[68:83], a[144:147], v[136:139], v[68:83]
  v_exp_f32 v107, v107
  v_exp_f32 v108, v108
  v_exp_f32 v109, v109
  v_cvt_pk_bf16_f32 v134, v104, v105
  v_cvt_pk_bf16_f32 v135, v106, v107
  v_mfma_f32_16x16x32_bf16 v[96:99], v[16:19], v[136:139], v[96:99]
  v_exp_f32 v110, v110
  v_exp_f32 v111, v111
  v_mfma_f32_32x32x16_bf16 v[20:35], a[148:151], v[132:135], v[20:35]
  v_exp_f32 v112, v112
  v_exp_f32 v113, v113
  v_exp_f32 v114, v114
  v_cvt_pk_bf16_f32 v136, v108, v109
  v_cvt_pk_bf16_f32 v137, v110, v111
  v_mfma_f32_16x16x32_bf16 v[84:87], v[16:19], v[132:135], v[84:87]
  v_exp_f32 v115, v115
  v_cvt_pk_bf16_f32 v138, v112, v113
  v_cvt_pk_bf16_f32 v139, v114, v115
  v_mfma_f32_32x32x16_bf16 v[100:115], a[80:83], a[16:19], 0
  v_exp_f32 v116, v116
  v_exp_f32 v117, v117
  v_exp_f32 v118, v118
  v_exp_f32 v119, v119
  v_mfma_f32_32x32x16_bf16 v[100:115], a[84:87], a[20:23], v[100:115]
  v_exp_f32 v120, v120
  v_exp_f32 v121, v121
  v_exp_f32 v122, v122
  v_cvt_pk_bf16_f32 v132, v116, v117
  v_cvt_pk_bf16_f32 v133, v118, v119
  v_mfma_f32_32x32x16_bf16 v[20:35], a[152:155], v[136:139], v[20:35]
  v_exp_f32 v123, v123
  v_exp_f32 v124, v124
  v_exp_f32 v125, v125
  v_cvt_pk_bf16_f32 v134, v120, v121
  v_cvt_pk_bf16_f32 v135, v122, v123
  v_mfma_f32_16x16x32_bf16 v[84:87], v[16:19], v[136:139], v[84:87]
  v_exp_f32 v126, v126
  v_exp_f32 v127, v127
  v_mfma_f32_32x32x16_bf16 v[36:51], a[148:151], v[132:135], v[36:51]
  v_exp_f32 v128, v128
  v_exp_f32 v129, v129
  v_exp_f32 v130, v130
  v_cvt_pk_bf16_f32 v136, v124, v125
  v_cvt_pk_bf16_f32 v137, v126, v127
  v_mfma_f32_16x16x32_bf16 v[88:91], v[16:19], v[132:135], v[88:91]
  v_exp_f32 v131, v131
  v_cvt_pk_bf16_f32 v138, v128, v129
  v_cvt_pk_bf16_f32 v139, v130, v131
  v_mfma_f32_32x32x16_bf16 v[116:131], a[80:83], a[24:27], 0
  v_exp_f32 v100, v100
  v_exp_f32 v101, v101
  v_exp_f32 v102, v102
  v_exp_f32 v103, v103
  v_mfma_f32_32x32x16_bf16 v[116:131], a[84:87], a[28:31], v[116:131]
  v_exp_f32 v104, v104
  v_exp_f32 v105, v105
  v_exp_f32 v106, v106
  v_cvt_pk_bf16_f32 v132, v100, v101
  v_cvt_pk_bf16_f32 v133, v102, v103
  v_mfma_f32_32x32x16_bf16 v[36:51], a[152:155], v[136:139], v[36:51]
  v_exp_f32 v107, v107
  v_exp_f32 v108, v108
  v_exp_f32 v109, v109
  v_cvt_pk_bf16_f32 v134, v104, v105
  v_cvt_pk_bf16_f32 v135, v106, v107
  v_mfma_f32_16x16x32_bf16 v[88:91], v[16:19], v[136:139], v[88:91]
  v_exp_f32 v110, v110
  v_exp_f32 v111, v111
  v_mfma_f32_32x32x16_bf16 v[52:67], a[148:151], v[132:135], v[52:67]
  v_exp_f32 v112, v112
  v_exp_f32 v113, v113
  v_exp_f32 v114, v114
  v_cvt_pk_bf16_f32 v136, v108, v109
  v_cvt_pk_bf16_f32 v137, v110, v111
  v_mfma_f32_16x16x32_bf16 v[92:95], v[16:19], v[132:135], v[92:95]
  v_exp_f32 v115, v115
  v_cvt_pk_bf16_f32 v138, v112, v113
  v_cvt_pk_bf16_f32 v139, v114, v115
  s_waitcnt vmcnt(27)
  v_mfma_f32_32x32x16_bf16 v[100:115], a[88:91], a[0:3], 0
  v_exp_f32 v116, v116
  v_exp_f32 v117, v117
  v_exp_f32 v118, v118
  v_exp_f32 v119, v119
  v_mfma_f32_32x32x16_bf16 v[140:155], a[112:115], a[40:43], v[140:155]
  buffer_load_dwordx4 a[140:143], v2, s[84:87], s37 offen offset:2048 sc1
  buffer_load_dwordx4 a[144:147], v2, s[84:87], s37 offen offset:3072 sc1
  s_add_u32 s37, s37, 8192
  s_cmp_eq_u32 s37, s38
  s_cmov_b32 s37, s49
  buffer_load_dwordx4 a[80:83], v2, s[92:95], s37 offen offset:0 sc1
  buffer_load_dwordx4 a[84:87], v2, s[92:95], s37 offen offset:1024 sc1
  buffer_load_dword a244, v2, s[8:11], s48 offen
  buffer_load_dword a252, v2, s[8:11], s48 offen
  buffer_load_dwordx4 a[40:43], v2, s[16:19], s45 offen
  s_add_u32 s45, s45, 7168
  v_mfma_f32_32x32x16_bf16 v[100:115], a[92:95], a[4:7], v[100:115]
  v_exp_f32 v120, v120
  v_exp_f32 v121, v121
  v_exp_f32 v122, v122
  v_cvt_pk_bf16_f32 v132, v116, v117
  v_cvt_pk_bf16_f32 v133, v118, v119
  v_mfma_f32_32x32x16_bf16 v[52:67], a[152:155], v[136:139], v[52:67]
  v_exp_f32 v123, v123
  v_exp_f32 v124, v124
  v_exp_f32 v125, v125
  v_cvt_pk_bf16_f32 v134, v120, v121
  v_cvt_pk_bf16_f32 v135, v122, v123
  v_mfma_f32_16x16x32_bf16 v[92:95], v[16:19], v[136:139], v[92:95]
  v_exp_f32 v126, v126
  v_exp_f32 v127, v127
  v_mfma_f32_32x32x16_bf16 v[68:83], a[148:151], v[132:135], v[68:83]
  v_exp_f32 v128, v128
  v_exp_f32 v129, v129
  v_exp_f32 v130, v130
  v_cvt_pk_bf16_f32 v136, v124, v125
  v_cvt_pk_bf16_f32 v137, v126, v127
  v_mfma_f32_16x16x32_bf16 v[96:99], v[16:19], v[132:135], v[96:99]
  v_exp_f32 v131, v131
  v_cvt_pk_bf16_f32 v138, v128, v129
  v_cvt_pk_bf16_f32 v139, v130, v131
  v_mfma_f32_32x32x16_bf16 v[116:131], a[88:91], a[8:11], 0
  v_exp_f32 v100, v100
  v_exp_f32 v101, v101
  v_exp_f32 v102, v102
  v_exp_f32 v103, v103
  v_mfma_f32_32x32x16_bf16 v[116:131], a[92:95], a[12:15], v[116:131]
  v_exp_f32 v104, v104
  v_exp_f32 v105, v105
  v_exp_f32 v106, v106
  v_cvt_pk_bf16_f32 v132, v100, v101
  v_cvt_pk_bf16_f32 v133, v102, v103
  v_mfma_f32_32x32x16_bf16 v[68:83], a[152:155], v[136:139], v[68:83]
  v_exp_f32 v107, v107
  v_exp_f32 v108, v108
  v_exp_f32 v109, v109
  v_cvt_pk_bf16_f32 v134, v104, v105
  v_cvt_pk_bf16_f32 v135, v106, v107
  v_mfma_f32_16x16x32_bf16 v[96:99], v[16:19], v[136:139], v[96:99]
  v_exp_f32 v110, v110
  v_exp_f32 v111, v111
  v_mfma_f32_32x32x16_bf16 v[20:35], a[156:159], v[132:135], v[20:35]
  v_exp_f32 v112, v112
  v_exp_f32 v113, v113
  v_exp_f32 v114, v114
  v_cvt_pk_bf16_f32 v136, v108, v109
  v_cvt_pk_bf16_f32 v137, v110, v111
  v_mfma_f32_16x16x32_bf16 v[84:87], v[16:19], v[132:135], v[84:87]
  v_exp_f32 v115, v115
  v_cvt_pk_bf16_f32 v138, v112, v113
  v_cvt_pk_bf16_f32 v139, v114, v115
  v_mfma_f32_32x32x16_bf16 v[100:115], a[88:91], a[16:19], 0
  v_exp_f32 v116, v116
  v_exp_f32 v117, v117
  v_exp_f32 v118, v118
  v_exp_f32 v119, v119
  v_mfma_f32_32x32x16_bf16 v[100:115], a[92:95], a[20:23], v[100:115]
  v_exp_f32 v120, v120
  v_exp_f32 v121, v121
  v_exp_f32 v122, v122
  v_cvt_pk_bf16_f32 v132, v116, v117
  v_cvt_pk_bf16_f32 v133, v118, v119
  v_mfma_f32_32x32x16_bf16 v[20:35], a[160:163], v[136:139], v[20:35]
  v_exp_f32 v123, v123
  v_exp_f32 v124, v124
  v_exp_f32 v125, v125
  v_cvt_pk_bf16_f32 v134, v120, v121
  v_cvt_pk_bf16_f32 v135, v122, v123
  v_mfma_f32_16x16x32_bf16 v[84:87], v[16:19], v[136:139], v[84:87]
  v_exp_f32 v126, v126
  v_exp_f32 v127, v127
  v_mfma_f32_32x32x16_bf16 v[36:51], a[156:159], v[132:135], v[36:51]
  v_exp_f32 v128, v128
  v_exp_f32 v129, v129
  v_exp_f32 v130, v130
  v_cvt_pk_bf16_f32 v136, v124, v125
  v_cvt_pk_bf16_f32 v137, v126, v127
  v_mfma_f32_16x16x32_bf16 v[88:91], v[16:19], v[132:135], v[88:91]
  v_exp_f32 v131, v131
  v_cvt_pk_bf16_f32 v138, v128, v129
  v_cvt_pk_bf16_f32 v139, v130, v131
  v_mfma_f32_32x32x16_bf16 v[116:131], a[88:91], a[24:27], 0
  v_exp_f32 v100, v100
  v_exp_f32 v101, v101
  v_exp_f32 v102, v102
  v_exp_f32 v103, v103
  v_mfma_f32_32x32x16_bf16 v[116:131], a[92:95], a[28:31], v[116:131]
  v_exp_f32 v104, v104
  v_exp_f32 v105, v105
  v_exp_f32 v106, v106
  v_cvt_pk_bf16_f32 v132, v100, v101
  v_cvt_pk_bf16_f32 v133, v102, v103
  v_mfma_f32_32x32x16_bf16 v[36:51], a[160:163], v[136:139], v[36:51]
  v_exp_f32 v107, v107
  v_exp_f32 v108, v108
  v_exp_f32 v109, v109
  v_cvt_pk_bf16_f32 v134, v104, v105
  v_cvt_pk_bf16_f32 v135, v106, v107
  v_mfma_f32_16x16x32_bf16 v[88:91], v[16:19], v[136:139], v[88:91]
  v_exp_f32 v110, v110
  v_exp_f32 v111, v111
  v_mfma_f32_32x32x16_bf16 v[52:67], a[156:159], v[132:135], v[52:67]
  v_exp_f32 v112, v112
  v_exp_f32 v113, v113
  v_exp_f32 v114, v114
  v_cvt_pk_bf16_f32 v136, v108, v109
  v_cvt_pk_bf16_f32 v137, v110, v111
  v_mfma_f32_16x16x32_bf16 v[92:95], v[16:19], v[132:135], v[92:95]
  v_exp_f32 v115, v115
  v_cvt_pk_bf16_f32 v138, v112, v113
  v_cvt_pk_bf16_f32 v139, v114, v115
  s_waitcnt vmcnt(30)
  v_mfma_f32_32x32x16_bf16 v[100:115], a[96:99], a[0:3], 0
  v_exp_f32 v116, v116
  v_exp_f32 v117, v117
  v_exp_f32 v118, v118
  v_exp_f32 v119, v119
  v_mfma_f32_32x32x16_bf16 v[140:155], a[112:115], a[44:47], v[140:155]
  buffer_load_dwordx4 a[148:151], v2, s[84:87], s37 offen offset:0 sc1
  buffer_load_dwordx4 a[152:155], v2, s[84:87], s37 offen offset:1024 sc1
  buffer_load_dwordx4 a[88:91], v2, s[92:95], s37 offen offset:2048 sc1
  buffer_load_dwordx4 a[92:95], v2, s[92:95], s37 offen offset:3072 sc1
  buffer_load_dwordx4 a[44:47], v2, s[16:19], s45 offen
  s_add_u32 s45, s45, 7168
  v_mfma_f32_32x32x16_bf16 v[100:115], a[100:103], a[4:7], v[100:115]
  v_exp_f32 v120, v120
  v_exp_f32 v121, v121
  v_exp_f32 v122, v122
  v_cvt_pk_bf16_f32 v132, v116, v117
  v_cvt_pk_bf16_f32 v133, v118, v119
  v_mfma_f32_32x32x16_bf16 v[52:67], a[160:163], v[136:139], v[52:67]
  v_exp_f32 v123, v123
  v_exp_f32 v124, v124
  v_exp_f32 v125, v125
  v_cvt_pk_bf16_f32 v134, v120, v121
  v_cvt_pk_bf16_f32 v135, v122, v123
  v_mfma_f32_16x16x32_bf16 v[92:95], v[16:19], v[136:139], v[92:95]
  v_exp_f32 v126, v126
  v_exp_f32 v127, v127
  v_mfma_f32_32x32x16_bf16 v[68:83], a[156:159], v[132:135], v[68:83]
  v_exp_f32 v128, v128
  v_exp_f32 v129, v129
  v_exp_f32 v130, v130
  v_cvt_pk_bf16_f32 v136, v124, v125
  v_cvt_pk_bf16_f32 v137, v126, v127
  v_mfma_f32_16x16x32_bf16 v[96:99], v[16:19], v[132:135], v[96:99]
  v_exp_f32 v131, v131
  v_cvt_pk_bf16_f32 v138, v128, v129
  v_cvt_pk_bf16_f32 v139, v130, v131
  v_mfma_f32_32x32x16_bf16 v[116:131], a[96:99], a[8:11], 0
  v_exp_f32 v100, v100
  v_exp_f32 v101, v101
  v_exp_f32 v102, v102
  v_exp_f32 v103, v103
  v_mfma_f32_32x32x16_bf16 v[116:131], a[100:103], a[12:15], v[116:131]
  v_exp_f32 v104, v104
  v_exp_f32 v105, v105
  v_exp_f32 v106, v106
  v_cvt_pk_bf16_f32 v132, v100, v101
  v_cvt_pk_bf16_f32 v133, v102, v103
  v_mfma_f32_32x32x16_bf16 v[68:83], a[160:163], v[136:139], v[68:83]
  v_exp_f32 v107, v107
  v_exp_f32 v108, v108
  v_exp_f32 v109, v109
  v_cvt_pk_bf16_f32 v134, v104, v105
  v_cvt_pk_bf16_f32 v135, v106, v107
  v_mfma_f32_16x16x32_bf16 v[96:99], v[16:19], v[136:139], v[96:99]
  v_exp_f32 v110, v110
  v_exp_f32 v111, v111
  v_mfma_f32_32x32x16_bf16 v[20:35], a[164:167], v[132:135], v[20:35]
  v_exp_f32 v112, v112
  v_exp_f32 v113, v113
  v_exp_f32 v114, v114
  v_cvt_pk_bf16_f32 v136, v108, v109
  v_cvt_pk_bf16_f32 v137, v110, v111
  v_mfma_f32_16x16x32_bf16 v[84:87], v[16:19], v[132:135], v[84:87]
  v_exp_f32 v115, v115
  v_cvt_pk_bf16_f32 v138, v112, v113
  v_cvt_pk_bf16_f32 v139, v114, v115
  v_mfma_f32_32x32x16_bf16 v[100:115], a[96:99], a[16:19], 0
  v_exp_f32 v116, v116
  v_exp_f32 v117, v117
  v_exp_f32 v118, v118
  v_exp_f32 v119, v119
  v_mfma_f32_32x32x16_bf16 v[100:115], a[100:103], a[20:23], v[100:115]
  v_exp_f32 v120, v120
  v_exp_f32 v121, v121
  v_exp_f32 v122, v122
  v_cvt_pk_bf16_f32 v132, v116, v117
  v_cvt_pk_bf16_f32 v133, v118, v119
  v_mfma_f32_32x32x16_bf16 v[20:35], a[168:171], v[136:139], v[20:35]
  v_exp_f32 v123, v123
  v_exp_f32 v124, v124
  v_exp_f32 v125, v125
  v_cvt_pk_bf16_f32 v134, v120, v121
  v_cvt_pk_bf16_f32 v135, v122, v123
  v_mfma_f32_16x16x32_bf16 v[84:87], v[16:19], v[136:139], v[84:87]
  v_exp_f32 v126, v126
  v_exp_f32 v127, v127
  v_mfma_f32_32x32x16_bf16 v[36:51], a[164:167], v[132:135], v[36:51]
  v_exp_f32 v128, v128
  v_exp_f32 v129, v129
  v_exp_f32 v130, v130
  v_cvt_pk_bf16_f32 v136, v124, v125
  v_cvt_pk_bf16_f32 v137, v126, v127
  v_mfma_f32_16x16x32_bf16 v[88:91], v[16:19], v[132:135], v[88:91]
  v_exp_f32 v131, v131
  v_cvt_pk_bf16_f32 v138, v128, v129
  v_cvt_pk_bf16_f32 v139, v130, v131
  v_mfma_f32_32x32x16_bf16 v[116:131], a[96:99], a[24:27], 0
  v_exp_f32 v100, v100
  v_exp_f32 v101, v101
  v_exp_f32 v102, v102
  v_exp_f32 v103, v103
  v_mfma_f32_32x32x16_bf16 v[116:131], a[100:103], a[28:31], v[116:131]
  v_exp_f32 v104, v104
  v_exp_f32 v105, v105
  v_exp_f32 v106, v106
  v_cvt_pk_bf16_f32 v132, v100, v101
  v_cvt_pk_bf16_f32 v133, v102, v103
  v_mfma_f32_32x32x16_bf16 v[36:51], a[168:171], v[136:139], v[36:51]
  v_exp_f32 v107, v107
  v_exp_f32 v108, v108
  v_exp_f32 v109, v109
  v_cvt_pk_bf16_f32 v134, v104, v105
  v_cvt_pk_bf16_f32 v135, v106, v107
  v_mfma_f32_16x16x32_bf16 v[88:91], v[16:19], v[136:139], v[88:91]
  v_exp_f32 v110, v110
  v_exp_f32 v111, v111
  v_mfma_f32_32x32x16_bf16 v[52:67], a[164:167], v[132:135], v[52:67]
  v_exp_f32 v112, v112
  v_exp_f32 v113, v113
  v_exp_f32 v114, v114
  v_cvt_pk_bf16_f32 v136, v108, v109
  v_cvt_pk_bf16_f32 v137, v110, v111
  v_mfma_f32_16x16x32_bf16 v[92:95], v[16:19], v[132:135], v[92:95]
  v_exp_f32 v115, v115
  v_cvt_pk_bf16_f32 v138, v112, v113
  v_cvt_pk_bf16_f32 v139, v114, v115
  s_waitcnt vmcnt(31)
  v_mfma_f32_32x32x16_bf16 v[100:115], a[104:107], a[0:3], 0
  v_exp_f32 v116, v116
  v_exp_f32 v117, v117
  v_exp_f32 v118, v118
  v_exp_f32 v119, v119
  buffer_load_dwordx4 a[156:159], v2, s[84:87], s37 offen offset:2048 sc1
  buffer_load_dwordx4 a[160:163], v2, s[84:87], s37 offen offset:3072 sc1
  s_add_u32 s37, s37, 8192
  s_cmp_eq_u32 s37, s38
  s_cmov_b32 s37, s49
  buffer_load_dwordx4 a[96:99], v2, s[92:95], s37 offen offset:0 sc1
  buffer_load_dwordx4 a[100:103], v2, s[92:95], s37 offen offset:1024 sc1
  buffer_load_dword a246, v2, s[8:11], s48 offen
  buffer_load_dword a254, v2, s[8:11], s48 offen
  buffer_load_dword a238, v12, s[20:23], s47 offen
  s_add_u32 s47, s47, 1792
  v_mfma_f32_32x32x16_bf16 v[100:115], a[108:111], a[4:7], v[100:115]
  v_exp_f32 v120, v120
  v_exp_f32 v121, v121
  v_exp_f32 v122, v122
  v_cvt_pk_bf16_f32 v132, v116, v117
  v_cvt_pk_bf16_f32 v133, v118, v119
  v_mfma_f32_32x32x16_bf16 v[52:67], a[168:171], v[136:139], v[52:67]
  v_exp_f32 v123, v123
  v_exp_f32 v124, v124
  v_exp_f32 v125, v125
  v_cvt_pk_bf16_f32 v134, v120, v121
  v_cvt_pk_bf16_f32 v135, v122, v123
  v_mfma_f32_16x16x32_bf16 v[92:95], v[16:19], v[136:139], v[92:95]
  v_exp_f32 v126, v126
  v_exp_f32 v127, v127
  v_mfma_f32_32x32x16_bf16 v[68:83], a[164:167], v[132:135], v[68:83]
  v_exp_f32 v128, v128
  v_exp_f32 v129, v129
  v_exp_f32 v130, v130
  v_cvt_pk_bf16_f32 v136, v124, v125
  v_cvt_pk_bf16_f32 v137, v126, v127
  v_mfma_f32_16x16x32_bf16 v[96:99], v[16:19], v[132:135], v[96:99]
  v_exp_f32 v131, v131
  v_cvt_pk_bf16_f32 v138, v128, v129
  v_cvt_pk_bf16_f32 v139, v130, v131
  v_mfma_f32_32x32x16_bf16 v[116:131], a[104:107], a[8:11], 0
  v_exp_f32 v100, v100
  v_exp_f32 v101, v101
  v_exp_f32 v102, v102
  v_exp_f32 v103, v103
  v_mfma_f32_32x32x16_bf16 v[116:131], a[108:111], a[12:15], v[116:131]
  v_exp_f32 v104, v104
  v_exp_f32 v105, v105
  v_exp_f32 v106, v106
  v_cvt_pk_bf16_f32 v132, v100, v101
  v_cvt_pk_bf16_f32 v133, v102, v103
  v_mfma_f32_32x32x16_bf16 v[68:83], a[168:171], v[136:139], v[68:83]
  v_exp_f32 v107, v107
  v_exp_f32 v108, v108
  v_exp_f32 v109, v109
  v_cvt_pk_bf16_f32 v134, v104, v105
  v_cvt_pk_bf16_f32 v135, v106, v107
  v_mfma_f32_16x16x32_bf16 v[96:99], v[16:19], v[136:139], v[96:99]
  v_exp_f32 v110, v110
  v_exp_f32 v111, v111
  v_mfma_f32_32x32x16_bf16 v[20:35], a[172:175], v[132:135], v[20:35]
  v_exp_f32 v112, v112
  v_exp_f32 v113, v113
  v_exp_f32 v114, v114
  v_cvt_pk_bf16_f32 v136, v108, v109
  v_cvt_pk_bf16_f32 v137, v110, v111
  v_mfma_f32_16x16x32_bf16 v[84:87], v[16:19], v[132:135], v[84:87]
  v_exp_f32 v115, v115
  v_cvt_pk_bf16_f32 v138, v112, v113
  v_cvt_pk_bf16_f32 v139, v114, v115
  v_mfma_f32_32x32x16_bf16 v[100:115], a[104:107], a[16:19], 0
  v_exp_f32 v116, v116
  v_exp_f32 v117, v117
  v_exp_f32 v118, v118
  v_exp_f32 v119, v119
  v_mfma_f32_32x32x16_bf16 v[100:115], a[108:111], a[20:23], v[100:115]
  v_exp_f32 v120, v120
  v_exp_f32 v121, v121
  v_exp_f32 v122, v122
  v_cvt_pk_bf16_f32 v132, v116, v117
  v_cvt_pk_bf16_f32 v133, v118, v119
  v_mfma_f32_32x32x16_bf16 v[20:35], a[176:179], v[136:139], v[20:35]
  v_exp_f32 v123, v123
  v_exp_f32 v124, v124
  v_exp_f32 v125, v125
  v_cvt_pk_bf16_f32 v134, v120, v121
  v_cvt_pk_bf16_f32 v135, v122, v123
  v_mfma_f32_16x16x32_bf16 v[84:87], v[16:19], v[136:139], v[84:87]
  v_exp_f32 v126, v126
  v_exp_f32 v127, v127
  v_mfma_f32_32x32x16_bf16 v[36:51], a[172:175], v[132:135], v[36:51]
  v_exp_f32 v128, v128
  v_exp_f32 v129, v129
  v_exp_f32 v130, v130
  v_cvt_pk_bf16_f32 v136, v124, v125
  v_cvt_pk_bf16_f32 v137, v126, v127
  v_mfma_f32_16x16x32_bf16 v[88:91], v[16:19], v[132:135], v[88:91]
  v_exp_f32 v131, v131
  v_cvt_pk_bf16_f32 v138, v128, v129
  v_cvt_pk_bf16_f32 v139, v130, v131
  v_mfma_f32_32x32x16_bf16 v[116:131], a[104:107], a[24:27], 0
  v_exp_f32 v100, v100
  v_exp_f32 v101, v101
  v_exp_f32 v102, v102
  v_exp_f32 v103, v103
  v_mfma_f32_32x32x16_bf16 v[116:131], a[108:111], a[28:31], v[116:131]
  v_exp_f32 v104, v104
  v_exp_f32 v105, v105
  v_exp_f32 v106, v106
  v_cvt_pk_bf16_f32 v132, v100, v101
  v_cvt_pk_bf16_f32 v133, v102, v103
  v_mfma_f32_32x32x16_bf16 v[36:51], a[176:179], v[136:139], v[36:51]
  v_exp_f32 v107, v107
  v_exp_f32 v108, v108
  v_exp_f32 v109, v109
  v_cvt_pk_bf16_f32 v134, v104, v105
  v_cvt_pk_bf16_f32 v135, v106, v107
  v_mfma_f32_16x16x32_bf16 v[88:91], v[16:19], v[136:139], v[88:91]
  v_exp_f32 v110, v110
  v_exp_f32 v111, v111
  v_mfma_f32_32x32x16_bf16 v[52:67], a[172:175], v[132:135], v[52:67]
  v_exp_f32 v112, v112
  v_exp_f32 v113, v113
  v_exp_f32 v114, v114
  v_cvt_pk_bf16_f32 v136, v108, v109
  v_cvt_pk_bf16_f32 v137, v110, v111
  v_mfma_f32_16x16x32_bf16 v[92:95], v[16:19], v[132:135], v[92:95]
  v_exp_f32 v115, v115
  v_cvt_pk_bf16_f32 v138, v112, v113
  v_cvt_pk_bf16_f32 v139, v114, v115
  s_waitcnt vmcnt(34)
  v_mfma_f32_32x32x16_bf16 v[100:115], a[48:51], a[0:3], 0
  v_exp_f32 v116, v116
  v_exp_f32 v117, v117
  v_exp_f32 v118, v118
  v_exp_f32 v119, v119
  buffer_load_dwordx4 a[164:167], v2, s[84:87], s37 offen offset:0 sc1
  buffer_load_dwordx4 a[168:171], v2, s[84:87], s37 offen offset:1024 sc1
  buffer_load_dwordx4 a[104:107], v2, s[92:95], s37 offen offset:2048 sc1
  buffer_load_dwordx4 a[108:111], v2, s[92:95], s37 offen offset:3072 sc1
  buffer_load_dword a247, v2, s[8:11], s48 offen
  buffer_load_dword a255, v2, s[8:11], s48 offen
  v_mfma_f32_32x32x16_bf16 v[100:115], a[52:55], a[4:7], v[100:115]
  v_exp_f32 v120, v120
  v_exp_f32 v121, v121
  v_exp_f32 v122, v122
  v_cvt_pk_bf16_f32 v132, v116, v117
  v_cvt_pk_bf16_f32 v133, v118, v119
  v_mfma_f32_32x32x16_bf16 v[52:67], a[176:179], v[136:139], v[52:67]
  v_exp_f32 v123, v123
  v_exp_f32 v124, v124
  v_exp_f32 v125, v125
  v_cvt_pk_bf16_f32 v134, v120, v121
  v_cvt_pk_bf16_f32 v135, v122, v123
  v_mfma_f32_16x16x32_bf16 v[92:95], v[16:19], v[136:139], v[92:95]
  v_exp_f32 v126, v126
  v_exp_f32 v127, v127
  v_mfma_f32_32x32x16_bf16 v[68:83], a[172:175], v[132:135], v[68:83]
  v_exp_f32 v128, v128
  v_exp_f32 v129, v129
  v_exp_f32 v130, v130
  v_cvt_pk_bf16_f32 v136, v124, v125
  v_cvt_pk_bf16_f32 v137, v126, v127
  v_mfma_f32_16x16x32_bf16 v[96:99], v[16:19], v[132:135], v[96:99]
  v_exp_f32 v131, v131
  v_cvt_pk_bf16_f32 v138, v128, v129
  v_cvt_pk_bf16_f32 v139, v130, v131
  s_mov_b32 s24, 3
.p2align 4
L_p2_1:
  v_mfma_f32_32x32x16_bf16 v[116:131], a[48:51], a[8:11], 0
  v_exp_f32 v100, v100
  v_exp_f32 v101, v101
  v_exp_f32 v102, v102
  v_exp_f32 v103, v103
  v_mfma_f32_32x32x16_bf16 v[116:131], a[52:55], a[12:15], v[116:131]
  v_exp_f32 v104, v104
  v_exp_f32 v105, v105
  v_exp_f32 v106, v106
  v_cvt_pk_bf16_f32 v132, v100, v101
  v_cvt_pk_bf16_f32 v133, v102, v103
  v_mfma_f32_32x32x16_bf16 v[68:83], a[176:179], v[136:139], v[68:83]
  v_exp_f32 v107, v107
  v_exp_f32 v108, v108
  v_exp_f32 v109, v109
  v_cvt_pk_bf16_f32 v134, v104, v105
  v_cvt_pk_bf16_f32 v135, v106, v107
  v_mfma_f32_16x16x32_bf16 v[96:99], v[16:19], v[136:139], v[96:99]
  v_exp_f32 v110, v110
  v_exp_f32 v111, v111
  v_mfma_f32_32x32x16_bf16 v[20:35], a[116:119], v[132:135], v[20:35]
  v_exp_f32 v112, v112
  v_exp_f32 v113, v113
  v_exp_f32 v114, v114
  v_cvt_pk_bf16_f32 v136, v108, v109
  v_cvt_pk_bf16_f32 v137, v110, v111
  v_mfma_f32_16x16x32_bf16 v[84:87], v[16:19], v[132:135], v[84:87]
  v_exp_f32 v115, v115
  v_cvt_pk_bf16_f32 v138, v112, v113
  v_cvt_pk_bf16_f32 v139, v114, v115
  v_mfma_f32_32x32x16_bf16 v[100:115], a[48:51], a[16:19], 0
  v_exp_f32 v116, v116
  v_exp_f32 v117, v117
  v_exp_f32 v118, v118
  v_exp_f32 v119, v119
  v_mfma_f32_32x32x16_bf16 v[100:115], a[52:55], a[20:23], v[100:115]
  v_exp_f32 v120, v120
  v_exp_f32 v121, v121
  v_exp_f32 v122, v122
  v_cvt_pk_bf16_f32 v132, v116, v117
  v_cvt_pk_bf16_f32 v133, v118, v119
  v_mfma_f32_32x32x16_bf16 v[20:35], a[120:123], v[136:139], v[20:35]
  v_exp_f32 v123, v123
  v_exp_f32 v124, v124
  v_exp_f32 v125, v125
  v_cvt_pk_bf16_f32 v134, v120, v121
  v_cvt_pk_bf16_f32 v135, v122, v123
  v_mfma_f32_16x16x32_bf16 v[84:87], v[16:19], v[136:139], v[84:87]
  v_exp_f32 v126, v126
  v_exp_f32 v127, v127
  v_mfma_f32_32x32x16_bf16 v[36:51], a[116:119], v[132:135], v[36:51]
  v_exp_f32 v128, v128
  v_exp_f32 v129, v129
  v_exp_f32 v130, v130
  v_cvt_pk_bf16_f32 v136, v124, v125
  v_cvt_pk_bf16_f32 v137, v126, v127
  v_mfma_f32_16x16x32_bf16 v[88:91], v[16:19], v[132:135], v[88:91]
  v_exp_f32 v131, v131
  v_cvt_pk_bf16_f32 v138, v128, v129
  v_cvt_pk_bf16_f32 v139, v130, v131
  v_mfma_f32_32x32x16_bf16 v[116:131], a[48:51], a[24:27], 0
  v_exp_f32 v100, v100
  v_exp_f32 v101, v101
  v_exp_f32 v102, v102
  v_exp_f32 v103, v103
  v_mfma_f32_32x32x16_bf16 v[116:131], a[52:55], a[28:31], v[116:131]
  v_exp_f32 v104, v104
  v_exp_f32 v105, v105
  v_exp_f32 v106, v106
  v_cvt_pk_bf16_f32 v132, v100, v101
  v_cvt_pk_bf16_f32 v133, v102, v103
  v_mfma_f32_32x32x16_bf16 v[36:51], a[120:123], v[136:139], v[36:51]
  v_exp_f32 v107, v107
  v_exp_f32 v108, v108
  v_exp_f32 v109, v109
  v_cvt_pk_bf16_f32 v134, v104, v105
  v_cvt_pk_bf16_f32 v135, v106, v107
  v_mfma_f32_16x16x32_bf16 v[88:91], v[16:19], v[136:139], v[88:91]
  v_exp_f32 v110, v110
  v_exp_f32 v111, v111
  v_mfma_f32_32x32x16_bf16 v[52:67], a[116:119], v[132:135], v[52:67]
  v_exp_f32 v112, v112
  v_exp_f32 v113, v113
  v_exp_f32 v114, v114
  v_cvt_pk_bf16_f32 v136, v108, v109
  v_cvt_pk_bf16_f32 v137, v110, v111
  v_mfma_f32_16x16x32_bf16 v[92:95], v[16:19], v[132:135], v[92:95]
  v_exp_f32 v115, v115
  v_cvt_pk_bf16_f32 v138, v112, v113
  v_cvt_pk_bf16_f32 v139, v114, v115
  s_waitcnt vmcnt(35)
  v_mfma_f32_32x32x16_bf16 v[100:115], a[56:59], a[0:3], 0
  v_exp_f32 v116, v116
  v_exp_f32 v117, v117
  v_exp_f32 v118, v118
  v_exp_f32 v119, v119
  s_mov_b32 m0, s44
  s_add_u32 s44, s44, 8192
  buffer_load_dwordx4 a[172:175], v2, s[84:87], s37 offen offset:2048 sc1
  buffer_load_dwordx4 a[176:179], v2, s[84:87], s37 offen offset:3072 sc1
  s_add_u32 s37, s37, 8192
  s_cmp_eq_u32 s37, s38
  s_cmov_b32 s37, s49
  buffer_load_dwordx4 a[48:51], v2, s[92:95], s37 offen offset:0 sc1
  buffer_load_dwordx4 a[52:55], v2, s[92:95], s37 offen offset:1024 sc1
  buffer_load_dwordx4 v250, s[12:15], s43 offen lds
  buffer_load_dwordx4 v251, s[12:15], s43 offen offset:1024 lds
  s_add_u32 s43, s43, 131072
  v_mfma_f32_32x32x16_bf16 v[100:115], a[60:63], a[4:7], v[100:115]
  v_exp_f32 v120, v120
  v_exp_f32 v121, v121
  v_exp_f32 v122, v122
  v_cvt_pk_bf16_f32 v132, v116, v117
  v_cvt_pk_bf16_f32 v133, v118, v119
  v_mfma_f32_32x32x16_bf16 v[52:67], a[120:123], v[136:139], v[52:67]
  v_exp_f32 v123, v123
  v_exp_f32 v124, v124
  v_exp_f32 v125, v125
  v_cvt_pk_bf16_f32 v134, v120, v121
  v_cvt_pk_bf16_f32 v135, v122, v123
  v_mfma_f32_16x16x32_bf16 v[92:95], v[16:19], v[136:139], v[92:95]
  v_exp_f32 v126, v126
  v_exp_f32 v127, v127
  v_mfma_f32_32x32x16_bf16 v[68:83], a[116:119], v[132:135], v[68:83]
  v_exp_f32 v128, v128
  v_exp_f32 v129, v129
  v_exp_f32 v130, v130
  v_cvt_pk_bf16_f32 v136, v124, v125
  v_cvt_pk_bf16_f32 v137, v126, v127
  v_mfma_f32_16x16x32_bf16 v[96:99], v[16:19], v[132:135], v[96:99]
  v_exp_f32 v131, v131
  v_cvt_pk_bf16_f32 v138, v128, v129
  v_cvt_pk_bf16_f32 v139, v130, v131
  v_mfma_f32_32x32x16_bf16 v[116:131], a[56:59], a[8:11], 0
  v_exp_f32 v100, v100
  v_exp_f32 v101, v101
  v_exp_f32 v102, v102
  v_exp_f32 v103, v103
  v_mfma_f32_32x32x16_bf16 v[116:131], a[60:63], a[12:15], v[116:131]
  v_exp_f32 v104, v104
  v_exp_f32 v105, v105
  v_exp_f32 v106, v106
  v_cvt_pk_bf16_f32 v132, v100, v101
  v_cvt_pk_bf16_f32 v133, v102, v103
  v_mfma_f32_32x32x16_bf16 v[68:83], a[120:123], v[136:139], v[68:83]
  v_exp_f32 v107, v107
  v_exp_f32 v108, v108
  v_exp_f32 v109, v109
  v_cvt_pk_bf16_f32 v134, v104, v105
  v_cvt_pk_bf16_f32 v135, v106, v107
  v_mfma_f32_16x16x32_bf16 v[96:99], v[16:19], v[136:139], v[96:99]
  v_exp_f32 v110, v110
  v_exp_f32 v111, v111
  v_mfma_f32_32x32x16_bf16 v[20:35], a[124:127], v[132:135], v[20:35]
  v_exp_f32 v112, v112
  v_exp_f32 v113, v113
  v_exp_f32 v114, v114
  v_cvt_pk_bf16_f32 v136, v108, v109
  v_cvt_pk_bf16_f32 v137, v110, v111
  v_mfma_f32_16x16x32_bf16 v[84:87], v[16:19], v[132:135], v[84:87]
  v_exp_f32 v115, v115
  v_cvt_pk_bf16_f32 v138, v112, v113
  v_cvt_pk_bf16_f32 v139, v114, v115
  v_mfma_f32_32x32x16_bf16 v[100:115], a[56:59], a[16:19], 0
  v_exp_f32 v116, v116
  v_exp_f32 v117, v117
  v_exp_f32 v118, v118
  v_exp_f32 v119, v119
  v_mfma_f32_32x32x16_bf16 v[100:115], a[60:63], a[20:23], v[100:115]
  v_exp_f32 v120, v120
  v_exp_f32 v121, v121
  v_exp_f32 v122, v122
  v_cvt_pk_bf16_f32 v132, v116, v117
  v_cvt_pk_bf16_f32 v133, v118, v119
  v_mfma_f32_32x32x16_bf16 v[20:35], a[128:131], v[136:139], v[20:35]
  v_exp_f32 v123, v123
  v_exp_f32 v124, v124
  v_exp_f32 v125, v125
  v_cvt_pk_bf16_f32 v134, v120, v121
  v_cvt_pk_bf16_f32 v135, v122, v123
  v_mfma_f32_16x16x32_bf16 v[84:87], v[16:19], v[136:139], v[84:87]
  v_exp_f32 v126, v126
  v_exp_f32 v127, v127
  v_mfma_f32_32x32x16_bf16 v[36:51], a[124:127], v[132:135], v[36:51]
  v_exp_f32 v128, v128
  v_exp_f32 v129, v129
  v_exp_f32 v130, v130
  v_cvt_pk_bf16_f32 v136, v124, v125
  v_cvt_pk_bf16_f32 v137, v126, v127
  v_mfma_f32_16x16x32_bf16 v[88:91], v[16:19], v[132:135], v[88:91]
  v_exp_f32 v131, v131
  v_cvt_pk_bf16_f32 v138, v128, v129
  v_cvt_pk_bf16_f32 v139, v130, v131
  v_mfma_f32_32x32x16_bf16 v[116:131], a[56:59], a[24:27], 0
  v_exp_f32 v100, v100
  v_exp_f32 v101, v101
  v_exp_f32 v102, v102
  v_exp_f32 v103, v103
  v_mfma_f32_32x32x16_bf16 v[116:131], a[60:63], a[28:31], v[116:131]
  v_exp_f32 v104, v104
  v_exp_f32 v105, v105
  v_exp_f32 v106, v106
  v_cvt_pk_bf16_f32 v132, v100, v101
  v_cvt_pk_bf16_f32 v133, v102, v103
  v_mfma_f32_32x32x16_bf16 v[36:51], a[128:131], v[136:139], v[36:51]
  v_exp_f32 v107, v107
  v_exp_f32 v108, v108
  v_exp_f32 v109, v109
  v_cvt_pk_bf16_f32 v134, v104, v105
  v_cvt_pk_bf16_f32 v135, v106, v107
  v_mfma_f32_16x16x32_bf16 v[88:91], v[16:19], v[136:139], v[88:91]
  v_exp_f32 v110, v110
  v_exp_f32 v111, v111
  v_mfma_f32_32x32x16_bf16 v[52:67], a[124:127], v[132:135], v[52:67]
  v_exp_f32 v112, v112
  v_exp_f32 v113, v113
  v_exp_f32 v114, v114
  v_cvt_pk_bf16_f32 v136, v108, v109
  v_cvt_pk_bf16_f32 v137, v110, v111
  v_mfma_f32_16x16x32_bf16 v[92:95], v[16:19], v[132:135], v[92:95]
  v_exp_f32 v115, v115
  v_cvt_pk_bf16_f32 v138, v112, v113
  v_cvt_pk_bf16_f32 v139, v114, v115
  s_waitcnt vmcnt(34)
  v_mfma_f32_32x32x16_bf16 v[100:115], a[64:67], a[0:3], 0
  v_exp_f32 v116, v116
  v_exp_f32 v117, v117
  v_exp_f32 v118, v118
  v_exp_f32 v119, v119
  buffer_load_dwordx4 a[116:119], v2, s[84:87], s37 offen offset:0 sc1
  buffer_load_dwordx4 a[120:123], v2, s[84:87], s37 offen offset:1024 sc1
  buffer_load_dwordx4 a[56:59], v2, s[92:95], s37 offen offset:2048 sc1
  buffer_load_dwordx4 a[60:63], v2, s[92:95], s37 offen offset:3072 sc1
  v_mfma_f32_32x32x16_bf16 v[100:115], a[68:71], a[4:7], v[100:115]
  v_exp_f32 v120, v120
  v_exp_f32 v121, v121
  v_exp_f32 v122, v122
  v_cvt_pk_bf16_f32 v132, v116, v117
  v_cvt_pk_bf16_f32 v133, v118, v119
  v_mfma_f32_32x32x16_bf16 v[52:67], a[128:131], v[136:139], v[52:67]
  v_exp_f32 v123, v123
  v_exp_f32 v124, v124
  v_exp_f32 v125, v125
  v_cvt_pk_bf16_f32 v134, v120, v121
  v_cvt_pk_bf16_f32 v135, v122, v123
  v_mfma_f32_16x16x32_bf16 v[92:95], v[16:19], v[136:139], v[92:95]
  v_exp_f32 v126, v126
  v_exp_f32 v127, v127
  v_mfma_f32_32x32x16_bf16 v[68:83], a[124:127], v[132:135], v[68:83]
  v_exp_f32 v128, v128
  v_exp_f32 v129, v129
  v_exp_f32 v130, v130
  v_cvt_pk_bf16_f32 v136, v124, v125
  v_cvt_pk_bf16_f32 v137, v126, v127
  v_mfma_f32_16x16x32_bf16 v[96:99], v[16:19], v[132:135], v[96:99]
  v_exp_f32 v131, v131
  v_cvt_pk_bf16_f32 v138, v128, v129
  v_cvt_pk_bf16_f32 v139, v130, v131
  v_mfma_f32_32x32x16_bf16 v[116:131], a[64:67], a[8:11], 0
  v_exp_f32 v100, v100
  v_exp_f32 v101, v101
  v_exp_f32 v102, v102
  v_exp_f32 v103, v103
  v_mfma_f32_32x32x16_bf16 v[116:131], a[68:71], a[12:15], v[116:131]
  v_exp_f32 v104, v104
  v_exp_f32 v105, v105
  v_exp_f32 v106, v106
  v_cvt_pk_bf16_f32 v132, v100, v101
  v_cvt_pk_bf16_f32 v133, v102, v103
  v_mfma_f32_32x32x16_bf16 v[68:83], a[128:131], v[136:139], v[68:83]
  v_exp_f32 v107, v107
  v_exp_f32 v108, v108
  v_exp_f32 v109, v109
  v_cvt_pk_bf16_f32 v134, v104, v105
  v_cvt_pk_bf16_f32 v135, v106, v107
  v_mfma_f32_16x16x32_bf16 v[96:99], v[16:19], v[136:139], v[96:99]
  v_exp_f32 v110, v110
  v_exp_f32 v111, v111
  v_mfma_f32_32x32x16_bf16 v[20:35], a[132:135], v[132:135], v[20:35]
  v_exp_f32 v112, v112
  v_exp_f32 v113, v113
  v_exp_f32 v114, v114
  v_cvt_pk_bf16_f32 v136, v108, v109
  v_cvt_pk_bf16_f32 v137, v110, v111
  v_mfma_f32_16x16x32_bf16 v[84:87], v[16:19], v[132:135], v[84:87]
  v_exp_f32 v115, v115
  v_cvt_pk_bf16_f32 v138, v112, v113
  v_cvt_pk_bf16_f32 v139, v114, v115
  v_mfma_f32_32x32x16_bf16 v[100:115], a[64:67], a[16:19], 0
  v_exp_f32 v116, v116
  v_exp_f32 v117, v117
  v_exp_f32 v118, v118
  v_exp_f32 v119, v119
  v_mfma_f32_32x32x16_bf16 v[100:115], a[68:71], a[20:23], v[100:115]
  v_exp_f32 v120, v120
  v_exp_f32 v121, v121
  v_exp_f32 v122, v122
  v_cvt_pk_bf16_f32 v132, v116, v117
  v_cvt_pk_bf16_f32 v133, v118, v119
  v_mfma_f32_32x32x16_bf16 v[20:35], a[136:139], v[136:139], v[20:35]
  v_exp_f32 v123, v123
  v_exp_f32 v124, v124
  v_exp_f32 v125, v125
  v_cvt_pk_bf16_f32 v134, v120, v121
  v_cvt_pk_bf16_f32 v135, v122, v123
  v_mfma_f32_16x16x32_bf16 v[84:87], v[16:19], v[136:139], v[84:87]
  v_exp_f32 v126, v126
  v_exp_f32 v127, v127
  v_mfma_f32_32x32x16_bf16 v[36:51], a[132:135], v[132:135], v[36:51]
  v_exp_f32 v128, v128
  v_exp_f32 v129, v129
  v_exp_f32 v130, v130
  v_cvt_pk_bf16_f32 v136, v124, v125
  v_cvt_pk_bf16_f32 v137, v126, v127
  v_mfma_f32_16x16x32_bf16 v[88:91], v[16:19], v[132:135], v[88:91]
  v_exp_f32 v131, v131
  v_cvt_pk_bf16_f32 v138, v128, v129
  v_cvt_pk_bf16_f32 v139, v130, v131
  v_mfma_f32_32x32x16_bf16 v[116:131], a[64:67], a[24:27], 0
  v_exp_f32 v100, v100
  v_exp_f32 v101, v101
  v_exp_f32 v102, v102
  v_exp_f32 v103, v103
  v_mfma_f32_32x32x16_bf16 v[116:131], a[68:71], a[28:31], v[116:131]
  v_exp_f32 v104, v104
  v_exp_f32 v105, v105
  v_exp_f32 v106, v106
  v_cvt_pk_bf16_f32 v132, v100, v101
  v_cvt_pk_bf16_f32 v133, v102, v103
  v_mfma_f32_32x32x16_bf16 v[36:51], a[136:139], v[136:139], v[36:51]
  v_exp_f32 v107, v107
  v_exp_f32 v108, v108
  v_exp_f32 v109, v109
  v_cvt_pk_bf16_f32 v134, v104, v105
  v_cvt_pk_bf16_f32 v135, v106, v107
  v_mfma_f32_16x16x32_bf16 v[88:91], v[16:19], v[136:139], v[88:91]
  v_exp_f32 v110, v110
  v_exp_f32 v111, v111
  v_mfma_f32_32x32x16_bf16 v[52:67], a[132:135], v[132:135], v[52:67]
  v_exp_f32 v112, v112
  v_exp_f32 v113, v113
  v_exp_f32 v114, v114
  v_cvt_pk_bf16_f32 v136, v108, v109
  v_cvt_pk_bf16_f32 v137, v110, v111
  v_mfma_f32_16x16x32_bf16 v[92:95], v[16:19], v[132:135], v[92:95]
  v_exp_f32 v115, v115
  v_cvt_pk_bf16_f32 v138, v112, v113
  v_cvt_pk_bf16_f32 v139, v114, v115
  s_waitcnt vmcnt(33)
  v_mfma_f32_32x32x16_bf16 v[100:115], a[72:75], a[0:3], 0
  v_exp_f32 v116, v116
  v_exp_f32 v117, v117
  v_exp_f32 v118, v118
  v_exp_f32 v119, v119
  v_mfma_f32_32x32x16_bf16 v[140:155], a[112:115], a[32:35], v[140:155]
  s_mov_b32 m0, s44
  s_add_u32 s44, s44, 8192
  buffer_load_dwordx4 a[124:127], v2, s[84:87], s37 offen offset:2048 sc1
  buffer_load_dwordx4 a[128:131], v2, s[84:87], s37 offen offset:3072 sc1
  s_add_u32 s37, s37, 8192
  s_cmp_eq_u32 s37, s38
  s_cmov_b32 s37, s49
  buffer_load_dwordx4 a[64:67], v2, s[92:95], s37 offen offset:0 sc1
  buffer_load_dwordx4 a[68:71], v2, s[92:95], s37 offen offset:1024 sc1
  buffer_load_dwordx4 v250, s[12:15], s43 offen lds
  buffer_load_dwordx4 v251, s[12:15], s43 offen offset:1024 lds
  buffer_load_dwordx4 a[32:35], v2, s[16:19], s45 offen
  s_add_u32 s43, s43, 131072
  s_add_u32 s45, s45, 7168
  v_mfma_f32_32x32x16_bf16 v[100:115], a[76:79], a[4:7], v[100:115]
  v_exp_f32 v120, v120
  v_exp_f32 v121, v121
  v_exp_f32 v122, v122
  v_cvt_pk_bf16_f32 v132, v116, v117
  v_cvt_pk_bf16_f32 v133, v118, v119
  v_mfma_f32_32x32x16_bf16 v[52:67], a[136:139], v[136:139], v[52:67]
  v_exp_f32 v123, v123
  v_exp_f32 v124, v124
  v_exp_f32 v125, v125
  v_cvt_pk_bf16_f32 v134, v120, v121
  v_cvt_pk_bf16_f32 v135, v122, v123
  v_mfma_f32_16x16x32_bf16 v[92:95], v[16:19], v[136:139], v[92:95]
  v_exp_f32 v126, v126
  v_exp_f32 v127, v127
  v_mfma_f32_32x32x16_bf16 v[68:83], a[132:135], v[132:135], v[68:83]
  v_exp_f32 v128, v128
  v_exp_f32 v129, v129
  v_exp_f32 v130, v130
  v_cvt_pk_bf16_f32 v136, v124, v125
  v_cvt_pk_bf16_f32 v137, v126, v127
  v_mfma_f32_16x16x32_bf16 v[96:99], v[16:19], v[132:135], v[96:99]
  v_exp_f32 v131, v131
  v_cvt_pk_bf16_f32 v138, v128, v129
  v_cvt_pk_bf16_f32 v139, v130, v131
  v_mfma_f32_32x32x16_bf16 v[116:131], a[72:75], a[8:11], 0
  v_exp_f32 v100, v100
  v_exp_f32 v101, v101
  v_exp_f32 v102, v102
  v_exp_f32 v103, v103
  v_mfma_f32_32x32x16_bf16 v[116:131], a[76:79], a[12:15], v[116:131]
  v_exp_f32 v104, v104
  v_exp_f32 v105, v105
  v_exp_f32 v106, v106
  v_cvt_pk_bf16_f32 v132, v100, v101
  v_cvt_pk_bf16_f32 v133, v102, v103
  v_mfma_f32_32x32x16_bf16 v[68:83], a[136:139], v[136:139], v[68:83]
  v_exp_f32 v107, v107
  v_exp_f32 v108, v108
  v_exp_f32 v109, v109
  v_cvt_pk_bf16_f32 v134, v104, v105
  v_cvt_pk_bf16_f32 v135, v106, v107
  v_mfma_f32_16x16x32_bf16 v[96:99], v[16:19], v[136:139], v[96:99]
  v_exp_f32 v110, v110
  v_exp_f32 v111, v111
  v_mfma_f32_32x32x16_bf16 v[20:35], a[140:143], v[132:135], v[20:35]
  v_exp_f32 v112, v112
  v_exp_f32 v113, v113
  v_exp_f32 v114, v114
  v_cvt_pk_bf16_f32 v136, v108, v109
  v_cvt_pk_bf16_f32 v137, v110, v111
  v_mfma_f32_16x16x32_bf16 v[84:87], v[16:19], v[132:135], v[84:87]
  v_exp_f32 v115, v115
  v_cvt_pk_bf16_f32 v138, v112, v113
  v_cvt_pk_bf16_f32 v139, v114, v115
  v_mfma_f32_32x32x16_bf16 v[100:115], a[72:75], a[16:19], 0
  v_exp_f32 v116, v116
  v_exp_f32 v117, v117
  v_exp_f32 v118, v118
  v_exp_f32 v119, v119
  v_mfma_f32_32x32x16_bf16 v[100:115], a[76:79], a[20:23], v[100:115]
  v_exp_f32 v120, v120
  v_exp_f32 v121, v121
  v_exp_f32 v122, v122
  v_cvt_pk_bf16_f32 v132, v116, v117
  v_cvt_pk_bf16_f32 v133, v118, v119
  v_mfma_f32_32x32x16_bf16 v[20:35], a[144:147], v[136:139], v[20:35]
  v_exp_f32 v123, v123
  v_exp_f32 v124, v124
  v_exp_f32 v125, v125
  v_cvt_pk_bf16_f32 v134, v120, v121
  v_cvt_pk_bf16_f32 v135, v122, v123
  v_mfma_f32_16x16x32_bf16 v[84:87], v[16:19], v[136:139], v[84:87]
  v_exp_f32 v126, v126
  v_exp_f32 v127, v127
  v_mfma_f32_32x32x16_bf16 v[36:51], a[140:143], v[132:135], v[36:51]
  v_exp_f32 v128, v128
  v_exp_f32 v129, v129
  v_exp_f32 v130, v130
  v_cvt_pk_bf16_f32 v136, v124, v125
  v_cvt_pk_bf16_f32 v137, v126, v127
  v_mfma_f32_16x16x32_bf16 v[88:91], v[16:19], v[132:135], v[88:91]
  v_exp_f32 v131, v131
  v_cvt_pk_bf16_f32 v138, v128, v129
  v_cvt_pk_bf16_f32 v139, v130, v131
  v_mfma_f32_32x32x16_bf16 v[116:131], a[72:75], a[24:27], 0
  v_exp_f32 v100, v100
  v_exp_f32 v101, v101
  v_exp_f32 v102, v102
  v_exp_f32 v103, v103
  v_mfma_f32_32x32x16_bf16 v[116:131], a[76:79], a[28:31], v[116:131]
  v_exp_f32 v104, v104
  v_exp_f32 v105, v105
  v_exp_f32 v106, v106
  v_cvt_pk_bf16_f32 v132, v100, v101
  v_cvt_pk_bf16_f32 v133, v102, v103
  v_mfma_f32_32x32x16_bf16 v[36:51], a[144:147], v[136:139], v[36:51]
  v_exp_f32 v107, v107
  v_exp_f32 v108, v108
  v_exp_f32 v109, v109
  v_cvt_pk_bf16_f32 v134, v104, v105
  v_cvt_pk_bf16_f32 v135, v106, v107
  v_mfma_f32_16x16x32_bf16 v[88:91], v[16:19], v[136:139], v[88:91]
  v_exp_f32 v110, v110
  v_exp_f32 v111, v111
  v_mfma_f32_32x32x16_bf16 v[52:67], a[140:143], v[132:135], v[52:67]
  v_exp_f32 v112, v112
  v_exp_f32 v113, v113
  v_exp_f32 v114, v114
  v_cvt_pk_bf16_f32 v136, v108, v109
  v_cvt_pk_bf16_f32 v137, v110, v111
  v_mfma_f32_16x16x32_bf16 v[92:95], v[16:19], v[132:135], v[92:95]
  v_exp_f32 v115, v115
  v_cvt_pk_bf16_f32 v138, v112, v113
  v_cvt_pk_bf16_f32 v139, v114, v115
  s_waitcnt vmcnt(33)
  v_mfma_f32_32x32x16_bf16 v[100:115], a[80:83], a[0:3], 0
  v_exp_f32 v116, v116
  v_exp_f32 v117, v117
  v_exp_f32 v118, v118
  v_exp_f32 v119, v119
  v_mfma_f32_32x32x16_bf16 v[140:155], a[112:115], a[36:39], v[140:155]
  buffer_load_dwordx4 a[132:135], v2, s[84:87], s37 offen offset:0 sc1
  buffer_load_dwordx4 a[136:139], v2, s[84:87], s37 offen offset:1024 sc1
  buffer_load_dwordx4 a[72:75], v2, s[92:95], s37 offen offset:2048 sc1
  buffer_load_dwordx4 a[76:79], v2, s[92:95], s37 offen offset:3072 sc1
  buffer_load_dwordx4 a[36:39], v2, s[16:19], s45 offen
  s_add_u32 s45, s45, 7168
  v_mfma_f32_32x32x16_bf16 v[100:115], a[84:87], a[4:7], v[100:115]
  v_exp_f32 v120, v120
  v_exp_f32 v121, v121
  v_exp_f32 v122, v122
  v_cvt_pk_bf16_f32 v132, v116, v117
  v_cvt_pk_bf16_f32 v133, v118, v119
  v_mfma_f32_32x32x16_bf16 v[52:67], a[144:147], v[136:139], v[52:67]
  v_exp_f32 v123, v123
  v_exp_f32 v124, v124
  v_exp_f32 v125, v125
  v_cvt_pk_bf16_f32 v134, v120, v121
  v_cvt_pk_bf16_f32 v135, v122, v123
  v_mfma_f32_16x16x32_bf16 v[92:95], v[16:19], v[136:139], v[92:95]
  v_exp_f32 v126, v126
  v_exp_f32 v127, v127
  v_mfma_f32_32x32x16_bf16 v[68:83], a[140:143], v[132:135], v[68:83]
  v_exp_f32 v128, v128
  v_exp_f32 v129, v129
  v_exp_f32 v130, v130
  v_cvt_pk_bf16_f32 v136, v124, v125
  v_cvt_pk_bf16_f32 v137, v126, v127
  v_mfma_f32_16x16x32_bf16 v[96:99], v[16:19], v[132:135], v[96:99]
  v_exp_f32 v131, v131
  v_cvt_pk_bf16_f32 v138, v128, v129
  v_cvt_pk_bf16_f32 v139, v130, v131
  v_mfma_f32_32x32x16_bf16 v[116:131], a[80:83], a[8:11], 0
  v_exp_f32 v100, v100
  v_exp_f32 v101, v101
  v_exp_f32 v102, v102
  v_exp_f32 v103, v103
  v_mfma_f32_32x32x16_bf16 v[116:131], a[84:87], a[12:15], v[116:131]
  v_exp_f32 v104, v104
  v_exp_f32 v105, v105
  v_exp_f32 v106, v106
  v_cvt_pk_bf16_f32 v132, v100, v101
  v_cvt_pk_bf16_f32 v133, v102, v103
  v_mfma_f32_32x32x16_bf16 v[68:83], a[144:147], v[136:139], v[68:83]
  v_exp_f32 v107, v107
  v_exp_f32 v108, v108
  v_exp_f32 v109, v109
  v_cvt_pk_bf16_f32 v134, v104, v105
  v_cvt_pk_bf16_f32 v135, v106, v107
  v_mfma_f32_16x16x32_bf16 v[96:99], v[16:19], v[136:139], v[96:99]
  v_exp_f32 v110, v110
  v_exp_f32 v111, v111
  v_mfma_f32_32x32x16_bf16 v[20:35], a[148:151], v[132:135], v[20:35]
  v_exp_f32 v112, v112
  v_exp_f32 v113, v113
  v_exp_f32 v114, v114
  v_cvt_pk_bf16_f32 v136, v108, v109
  v_cvt_pk_bf16_f32 v137, v110, v111
  v_mfma_f32_16x16x32_bf16 v[84:87], v[16:19], v[132:135], v[84:87]
  v_exp_f32 v115, v115
  v_cvt_pk_bf16_f32 v138, v112, v113
  v_cvt_pk_bf16_f32 v139, v114, v115
  v_mfma_f32_32x32x16_bf16 v[100:115], a[80:83], a[16:19], 0
  v_exp_f32 v116, v116
  v_exp_f32 v117, v117
  v_exp_f32 v118, v118
  v_exp_f32 v119, v119
  v_mfma_f32_32x32x16_bf16 v[100:115], a[84:87], a[20:23], v[100:115]
  v_exp_f32 v120, v120
  v_exp_f32 v121, v121
  v_exp_f32 v122, v122
  v_cvt_pk_bf16_f32 v132, v116, v117
  v_cvt_pk_bf16_f32 v133, v118, v119
  v_mfma_f32_32x32x16_bf16 v[20:35], a[152:155], v[136:139], v[20:35]
  v_exp_f32 v123, v123
  v_exp_f32 v124, v124
  v_exp_f32 v125, v125
  v_cvt_pk_bf16_f32 v134, v120, v121
  v_cvt_pk_bf16_f32 v135, v122, v123
  v_mfma_f32_16x16x32_bf16 v[84:87], v[16:19], v[136:139], v[84:87]
  v_exp_f32 v126, v126
  v_exp_f32 v127, v127
  v_mfma_f32_32x32x16_bf16 v[36:51], a[148:151], v[132:135], v[36:51]
  v_exp_f32 v128, v128
  v_exp_f32 v129, v129
  v_exp_f32 v130, v130
  v_cvt_pk_bf16_f32 v136, v124, v125
  v_cvt_pk_bf16_f32 v137, v126, v127
  v_mfma_f32_16x16x32_bf16 v[88:91], v[16:19], v[132:135], v[88:91]
  v_exp_f32 v131, v131
  v_cvt_pk_bf16_f32 v138, v128, v129
  v_cvt_pk_bf16_f32 v139, v130, v131
  v_mfma_f32_32x32x16_bf16 v[116:131], a[80:83], a[24:27], 0
  v_exp_f32 v100, v100
  v_exp_f32 v101, v101
  v_exp_f32 v102, v102
  v_exp_f32 v103, v103
  v_mfma_f32_32x32x16_bf16 v[116:131], a[84:87], a[28:31], v[116:131]
  v_exp_f32 v104, v104
  v_exp_f32 v105, v105
  v_exp_f32 v106, v106
  v_cvt_pk_bf16_f32 v132, v100, v101
  v_cvt_pk_bf16_f32 v133, v102, v103
  v_mfma_f32_32x32x16_bf16 v[36:51], a[152:155], v[136:139], v[36:51]
  v_exp_f32 v107, v107
  v_exp_f32 v108, v108
  v_exp_f32 v109, v109
  v_cvt_pk_bf16_f32 v134, v104, v105
  v_cvt_pk_bf16_f32 v135, v106, v107
  v_mfma_f32_16x16x32_bf16 v[88:91], v[16:19], v[136:139], v[88:91]
  v_exp_f32 v110, v110
  v_exp_f32 v111, v111
  v_mfma_f32_32x32x16_bf16 v[52:67], a[148:151], v[132:135], v[52:67]
  v_exp_f32 v112, v112
  v_exp_f32 v113, v113
  v_exp_f32 v114, v114
  v_cvt_pk_bf16_f32 v136, v108, v109
  v_cvt_pk_bf16_f32 v137, v110, v111
  v_mfma_f32_16x16x32_bf16 v[92:95], v[16:19], v[132:135], v[92:95]
  v_exp_f32 v115, v115
  v_cvt_pk_bf16_f32 v138, v112, v113
  v_cvt_pk_bf16_f32 v139, v114, v115
  s_waitcnt vmcnt(33)
  v_mfma_f32_32x32x16_bf16 v[100:115], a[88:91], a[0:3], 0
  v_exp_f32 v116, v116
  v_exp_f32 v117, v117
  v_exp_f32 v118, v118
  v_exp_f32 v119, v119
  v_mfma_f32_32x32x16_bf16 v[140:155], a[112:115], a[40:43], v[140:155]
  s_mov_b32 m0, s44
  s_add_u32 s44, s44, 8192
  buffer_load_dwordx4 a[140:143], v2, s[84:87], s37 offen offset:2048 sc1
  buffer_load_dwordx4 a[144:147], v2, s[84:87], s37 offen offset:3072 sc1
  s_add_u32 s37, s37, 8192
  s_cmp_eq_u32 s37, s38
  s_cmov_b32 s37, s49
  buffer_load_dwordx4 a[80:83], v2, s[92:95], s37 offen offset:0 sc1
  buffer_load_dwordx4 a[84:87], v2, s[92:95], s37 offen offset:1024 sc1
  buffer_load_dwordx4 v250, s[12:15], s43 offen lds
  buffer_load_dwordx4 v251, s[12:15], s43 offen offset:1024 lds
  buffer_load_dwordx4 a[40:43], v2, s[16:19], s45 offen
  s_add_u32 s43, s43, 131072
  s_add_u32 s45, s45, 7168
  v_mfma_f32_32x32x16_bf16 v[100:115], a[92:95], a[4:7], v[100:115]
  v_exp_f32 v120, v120
  v_exp_f32 v121, v121
  v_exp_f32 v122, v122
  v_cvt_pk_bf16_f32 v132, v116, v117
  v_cvt_pk_bf16_f32 v133, v118, v119
  v_mfma_f32_32x32x16_bf16 v[52:67], a[152:155], v[136:139], v[52:67]
  v_exp_f32 v123, v123
  v_exp_f32 v124, v124
  v_exp_f32 v125, v125
  v_cvt_pk_bf16_f32 v134, v120, v121
  v_cvt_pk_bf16_f32 v135, v122, v123
  v_mfma_f32_16x16x32_bf16 v[92:95], v[16:19], v[136:139], v[92:95]
  v_exp_f32 v126, v126
  v_exp_f32 v127, v127
  v_mfma_f32_32x32x16_bf16 v[68:83], a[148:151], v[132:135], v[68:83]
  v_exp_f32 v128, v128
  v_exp_f32 v129, v129
  v_exp_f32 v130, v130
  v_cvt_pk_bf16_f32 v136, v124, v125
  v_cvt_pk_bf16_f32 v137, v126, v127
  v_mfma_f32_16x16x32_bf16 v[96:99], v[16:19], v[132:135], v[96:99]
  v_exp_f32 v131, v131
  v_cvt_pk_bf16_f32 v138, v128, v129
  v_cvt_pk_bf16_f32 v139, v130, v131
  v_mfma_f32_32x32x16_bf16 v[116:131], a[88:91], a[8:11], 0
  v_exp_f32 v100, v100
  v_exp_f32 v101, v101
  v_exp_f32 v102, v102
  v_exp_f32 v103, v103
  v_mfma_f32_32x32x16_bf16 v[116:131], a[92:95], a[12:15], v[116:131]
  v_exp_f32 v104, v104
  v_exp_f32 v105, v105
  v_exp_f32 v106, v106
  v_cvt_pk_bf16_f32 v132, v100, v101
  v_cvt_pk_bf16_f32 v133, v102, v103
  v_mfma_f32_32x32x16_bf16 v[68:83], a[152:155], v[136:139], v[68:83]
  v_exp_f32 v107, v107
  v_exp_f32 v108, v108
  v_exp_f32 v109, v109
  v_cvt_pk_bf16_f32 v134, v104, v105
  v_cvt_pk_bf16_f32 v135, v106, v107
  v_mfma_f32_16x16x32_bf16 v[96:99], v[16:19], v[136:139], v[96:99]
  v_exp_f32 v110, v110
  v_exp_f32 v111, v111
  v_mfma_f32_32x32x16_bf16 v[20:35], a[156:159], v[132:135], v[20:35]
  v_exp_f32 v112, v112
  v_exp_f32 v113, v113
  v_exp_f32 v114, v114
  v_cvt_pk_bf16_f32 v136, v108, v109
  v_cvt_pk_bf16_f32 v137, v110, v111
  v_mfma_f32_16x16x32_bf16 v[84:87], v[16:19], v[132:135], v[84:87]
  v_exp_f32 v115, v115
  v_cvt_pk_bf16_f32 v138, v112, v113
  v_cvt_pk_bf16_f32 v139, v114, v115
  v_mfma_f32_32x32x16_bf16 v[100:115], a[88:91], a[16:19], 0
  v_exp_f32 v116, v116
  v_exp_f32 v117, v117
  v_exp_f32 v118, v118
  v_exp_f32 v119, v119
  v_mfma_f32_32x32x16_bf16 v[100:115], a[92:95], a[20:23], v[100:115]
  v_exp_f32 v120, v120
  v_exp_f32 v121, v121
  v_exp_f32 v122, v122
  v_cvt_pk_bf16_f32 v132, v116, v117
  v_cvt_pk_bf16_f32 v133, v118, v119
  v_mfma_f32_32x32x16_bf16 v[20:35], a[160:163], v[136:139], v[20:35]
  v_exp_f32 v123, v123
  v_exp_f32 v124, v124
  v_exp_f32 v125, v125
  v_cvt_pk_bf16_f32 v134, v120, v121
  v_cvt_pk_bf16_f32 v135, v122, v123
  v_mfma_f32_16x16x32_bf16 v[84:87], v[16:19], v[136:139], v[84:87]
  v_exp_f32 v126, v126
  v_exp_f32 v127, v127
  v_mfma_f32_32x32x16_bf16 v[36:51], a[156:159], v[132:135], v[36:51]
  v_exp_f32 v128, v128
  v_exp_f32 v129, v129
  v_exp_f32 v130, v130
  v_cvt_pk_bf16_f32 v136, v124, v125
  v_cvt_pk_bf16_f32 v137, v126, v127
  v_mfma_f32_16x16x32_bf16 v[88:91], v[16:19], v[132:135], v[88:91]
  v_exp_f32 v131, v131
  v_cvt_pk_bf16_f32 v138, v128, v129
  v_cvt_pk_bf16_f32 v139, v130, v131
  v_mfma_f32_32x32x16_bf16 v[116:131], a[88:91], a[24:27], 0
  v_exp_f32 v100, v100
  v_exp_f32 v101, v101
  v_exp_f32 v102, v102
  v_exp_f32 v103, v103
  v_mfma_f32_32x32x16_bf16 v[116:131], a[92:95], a[28:31], v[116:131]
  v_exp_f32 v104, v104
  v_exp_f32 v105, v105
  v_exp_f32 v106, v106
  v_cvt_pk_bf16_f32 v132, v100, v101
  v_cvt_pk_bf16_f32 v133, v102, v103
  v_mfma_f32_32x32x16_bf16 v[36:51], a[160:163], v[136:139], v[36:51]
  v_exp_f32 v107, v107
  v_exp_f32 v108, v108
  v_exp_f32 v109, v109
  v_cvt_pk_bf16_f32 v134, v104, v105
  v_cvt_pk_bf16_f32 v135, v106, v107
  v_mfma_f32_16x16x32_bf16 v[88:91], v[16:19], v[136:139], v[88:91]
  v_exp_f32 v110, v110
  v_exp_f32 v111, v111
  v_mfma_f32_32x32x16_bf16 v[52:67], a[156:159], v[132:135], v[52:67]
  v_exp_f32 v112, v112
  v_exp_f32 v113, v113
  v_exp_f32 v114, v114
  v_cvt_pk_bf16_f32 v136, v108, v109
  v_cvt_pk_bf16_f32 v137, v110, v111
  v_mfma_f32_16x16x32_bf16 v[92:95], v[16:19], v[132:135], v[92:95]
  v_exp_f32 v115, v115
  v_cvt_pk_bf16_f32 v138, v112, v113
  v_cvt_pk_bf16_f32 v139, v114, v115
  s_waitcnt vmcnt(33)
  v_mfma_f32_32x32x16_bf16 v[100:115], a[96:99], a[0:3], 0
  v_exp_f32 v116, v116
  v_exp_f32 v117, v117
  v_exp_f32 v118, v118
  v_exp_f32 v119, v119
  v_mfma_f32_32x32x16_bf16 v[140:155], a[112:115], a[44:47], v[140:155]
  buffer_load_dwordx4 a[148:151], v2, s[84:87], s37 offen offset:0 sc1
  buffer_load_dwordx4 a[152:155], v2, s[84:87], s37 offen offset:1024 sc1
  buffer_load_dwordx4 a[88:91], v2, s[92:95], s37 offen offset:2048 sc1
  buffer_load_dwordx4 a[92:95], v2, s[92:95], s37 offen offset:3072 sc1
  buffer_load_dwordx4 a[44:47], v2, s[16:19], s45 offen
  s_add_u32 s45, s45, 7168
  v_mfma_f32_32x32x16_bf16 v[100:115], a[100:103], a[4:7], v[100:115]
  v_exp_f32 v120, v120
  v_exp_f32 v121, v121
  v_exp_f32 v122, v122
  v_cvt_pk_bf16_f32 v132, v116, v117
  v_cvt_pk_bf16_f32 v133, v118, v119
  v_mfma_f32_32x32x16_bf16 v[52:67], a[160:163], v[136:139], v[52:67]
  v_exp_f32 v123, v123
  v_exp_f32 v124, v124
  v_exp_f32 v125, v125
  v_cvt_pk_bf16_f32 v134, v120, v121
  v_cvt_pk_bf16_f32 v135, v122, v123
  v_mfma_f32_16x16x32_bf16 v[92:95], v[16:19], v[136:139], v[92:95]
  v_exp_f32 v126, v126
  v_exp_f32 v127, v127
  v_mfma_f32_32x32x16_bf16 v[68:83], a[156:159], v[132:135], v[68:83]
  v_exp_f32 v128, v128
  v_exp_f32 v129, v129
  v_exp_f32 v130, v130
  v_cvt_pk_bf16_f32 v136, v124, v125
  v_cvt_pk_bf16_f32 v137, v126, v127
  v_mfma_f32_16x16x32_bf16 v[96:99], v[16:19], v[132:135], v[96:99]
  v_exp_f32 v131, v131
  v_cvt_pk_bf16_f32 v138, v128, v129
  v_cvt_pk_bf16_f32 v139, v130, v131
  v_mfma_f32_32x32x16_bf16 v[116:131], a[96:99], a[8:11], 0
  v_exp_f32 v100, v100
  v_exp_f32 v101, v101
  v_exp_f32 v102, v102
  v_exp_f32 v103, v103
  v_mfma_f32_32x32x16_bf16 v[116:131], a[100:103], a[12:15], v[116:131]
  v_exp_f32 v104, v104
  v_exp_f32 v105, v105
  v_exp_f32 v106, v106
  v_cvt_pk_bf16_f32 v132, v100, v101
  v_cvt_pk_bf16_f32 v133, v102, v103
  v_mfma_f32_32x32x16_bf16 v[68:83], a[160:163], v[136:139], v[68:83]
  v_exp_f32 v107, v107
  v_exp_f32 v108, v108
  v_exp_f32 v109, v109
  v_cvt_pk_bf16_f32 v134, v104, v105
  v_cvt_pk_bf16_f32 v135, v106, v107
  v_mfma_f32_16x16x32_bf16 v[96:99], v[16:19], v[136:139], v[96:99]
  v_exp_f32 v110, v110
  v_exp_f32 v111, v111
  v_mfma_f32_32x32x16_bf16 v[20:35], a[164:167], v[132:135], v[20:35]
  v_exp_f32 v112, v112
  v_exp_f32 v113, v113
  v_exp_f32 v114, v114
  v_cvt_pk_bf16_f32 v136, v108, v109
  v_cvt_pk_bf16_f32 v137, v110, v111
  v_mfma_f32_16x16x32_bf16 v[84:87], v[16:19], v[132:135], v[84:87]
  v_exp_f32 v115, v115
  v_cvt_pk_bf16_f32 v138, v112, v113
  v_cvt_pk_bf16_f32 v139, v114, v115
  v_mfma_f32_32x32x16_bf16 v[100:115], a[96:99], a[16:19], 0
  v_exp_f32 v116, v116
  v_exp_f32 v117, v117
  v_exp_f32 v118, v118
  v_exp_f32 v119, v119
  v_mfma_f32_32x32x16_bf16 v[100:115], a[100:103], a[20:23], v[100:115]
  v_exp_f32 v120, v120
  v_exp_f32 v121, v121
  v_exp_f32 v122, v122
  v_cvt_pk_bf16_f32 v132, v116, v117
  v_cvt_pk_bf16_f32 v133, v118, v119
  v_mfma_f32_32x32x16_bf16 v[20:35], a[168:171], v[136:139], v[20:35]
  v_exp_f32 v123, v123
  v_exp_f32 v124, v124
  v_exp_f32 v125, v125
  v_cvt_pk_bf16_f32 v134, v120, v121
  v_cvt_pk_bf16_f32 v135, v122, v123
  v_mfma_f32_16x16x32_bf16 v[84:87], v[16:19], v[136:139], v[84:87]
  v_exp_f32 v126, v126
  v_exp_f32 v127, v127
  v_mfma_f32_32x32x16_bf16 v[36:51], a[164:167], v[132:135], v[36:51]
  v_exp_f32 v128, v128
  v_exp_f32 v129, v129
  v_exp_f32 v130, v130
  v_cvt_pk_bf16_f32 v136, v124, v125
  v_cvt_pk_bf16_f32 v137, v126, v127
  v_mfma_f32_16x16x32_bf16 v[88:91], v[16:19], v[132:135], v[88:91]
  v_exp_f32 v131, v131
  v_cvt_pk_bf16_f32 v138, v128, v129
  v_cvt_pk_bf16_f32 v139, v130, v131
  v_mfma_f32_32x32x16_bf16 v[116:131], a[96:99], a[24:27], 0
  v_exp_f32 v100, v100
  v_exp_f32 v101, v101
  v_exp_f32 v102, v102
  v_exp_f32 v103, v103
  v_mfma_f32_32x32x16_bf16 v[116:131], a[100:103], a[28:31], v[116:131]
  v_exp_f32 v104, v104
  v_exp_f32 v105, v105
  v_exp_f32 v106, v106
  v_cvt_pk_bf16_f32 v132, v100, v101
  v_cvt_pk_bf16_f32 v133, v102, v103
  v_mfma_f32_32x32x16_bf16 v[36:51], a[168:171], v[136:139], v[36:51]
  v_exp_f32 v107, v107
  v_exp_f32 v108, v108
  v_exp_f32 v109, v109
  v_cvt_pk_bf16_f32 v134, v104, v105
  v_cvt_pk_bf16_f32 v135, v106, v107
  v_mfma_f32_16x16x32_bf16 v[88:91], v[16:19], v[136:139], v[88:91]
  v_exp_f32 v110, v110
  v_exp_f32 v111, v111
  v_mfma_f32_32x32x16_bf16 v[52:67], a[164:167], v[132:135], v[52:67]
  v_exp_f32 v112, v112
  v_exp_f32 v113, v113
  v_exp_f32 v114, v114
  v_cvt_pk_bf16_f32 v136, v108, v109
  v_cvt_pk_bf16_f32 v137, v110, v111
  v_mfma_f32_16x16x32_bf16 v[92:95], v[16:19], v[132:135], v[92:95]
  v_exp_f32 v115, v115
  v_cvt_pk_bf16_f32 v138, v112, v113
  v_cvt_pk_bf16_f32 v139, v114, v115
  s_waitcnt vmcnt(32)
  v_mfma_f32_32x32x16_bf16 v[100:115], a[104:107], a[0:3], 0
  v_exp_f32 v116, v116
  v_exp_f32 v117, v117
  v_exp_f32 v118, v118
  v_exp_f32 v119, v119
  s_mov_b32 m0, s44
  s_add_u32 s44, s44, 8192
  buffer_load_dwordx4 a[156:159], v2, s[84:87], s37 offen offset:2048 sc1
  buffer_load_dwordx4 a[160:163], v2, s[84:87], s37 offen offset:3072 sc1
  s_add_u32 s37, s37, 8192
  s_cmp_eq_u32 s37, s38
  s_cmov_b32 s37, s49
  buffer_load_dwordx4 a[96:99], v2, s[92:95], s37 offen offset:0 sc1
  buffer_load_dwordx4 a[100:103], v2, s[92:95], s37 offen offset:1024 sc1
  buffer_load_dwordx4 v250, s[12:15], s43 offen lds
  buffer_load_dwordx4 v251, s[12:15], s43 offen offset:1024 lds
  buffer_load_dword a238, v12, s[20:23], s47 offen
  s_add_u32 s43, s43, 131072
  s_add_u32 s47, s47, 1792
  v_mfma_f32_32x32x16_bf16 v[100:115], a[108:111], a[4:7], v[100:115]
  v_exp_f32 v120, v120
  v_exp_f32 v121, v121
  v_exp_f32 v122, v122
  v_cvt_pk_bf16_f32 v132, v116, v117
  v_cvt_pk_bf16_f32 v133, v118, v119
  v_mfma_f32_32x32x16_bf16 v[52:67], a[168:171], v[136:139], v[52:67]
  v_exp_f32 v123, v123
  v_exp_f32 v124, v124
  v_exp_f32 v125, v125
  v_cvt_pk_bf16_f32 v134, v120, v121
  v_cvt_pk_bf16_f32 v135, v122, v123
  v_mfma_f32_16x16x32_bf16 v[92:95], v[16:19], v[136:139], v[92:95]
  v_exp_f32 v126, v126
  v_exp_f32 v127, v127
  v_mfma_f32_32x32x16_bf16 v[68:83], a[164:167], v[132:135], v[68:83]
  v_exp_f32 v128, v128
  v_exp_f32 v129, v129
  v_exp_f32 v130, v130
  v_cvt_pk_bf16_f32 v136, v124, v125
  v_cvt_pk_bf16_f32 v137, v126, v127
  v_mfma_f32_16x16x32_bf16 v[96:99], v[16:19], v[132:135], v[96:99]
  v_exp_f32 v131, v131
  v_cvt_pk_bf16_f32 v138, v128, v129
  v_cvt_pk_bf16_f32 v139, v130, v131
  v_mfma_f32_32x32x16_bf16 v[116:131], a[104:107], a[8:11], 0
  v_exp_f32 v100, v100
  v_exp_f32 v101, v101
  v_exp_f32 v102, v102
  v_exp_f32 v103, v103
  v_mfma_f32_32x32x16_bf16 v[116:131], a[108:111], a[12:15], v[116:131]
  v_exp_f32 v104, v104
  v_exp_f32 v105, v105
  v_exp_f32 v106, v106
  v_cvt_pk_bf16_f32 v132, v100, v101
  v_cvt_pk_bf16_f32 v133, v102, v103
  v_mfma_f32_32x32x16_bf16 v[68:83], a[168:171], v[136:139], v[68:83]
  v_exp_f32 v107, v107
  v_exp_f32 v108, v108
  v_exp_f32 v109, v109
  v_cvt_pk_bf16_f32 v134, v104, v105
  v_cvt_pk_bf16_f32 v135, v106, v107
  v_mfma_f32_16x16x32_bf16 v[96:99], v[16:19], v[136:139], v[96:99]
  v_exp_f32 v110, v110
  v_exp_f32 v111, v111
  v_mfma_f32_32x32x16_bf16 v[20:35], a[172:175], v[132:135], v[20:35]
  v_exp_f32 v112, v112
  v_exp_f32 v113, v113
  v_exp_f32 v114, v114
  v_cvt_pk_bf16_f32 v136, v108, v109
  v_cvt_pk_bf16_f32 v137, v110, v111
  v_mfma_f32_16x16x32_bf16 v[84:87], v[16:19], v[132:135], v[84:87]
  v_exp_f32 v115, v115
  v_cvt_pk_bf16_f32 v138, v112, v113
  v_cvt_pk_bf16_f32 v139, v114, v115
  v_mfma_f32_32x32x16_bf16 v[100:115], a[104:107], a[16:19], 0
  v_exp_f32 v116, v116
  v_exp_f32 v117, v117
  v_exp_f32 v118, v118
  v_exp_f32 v119, v119
  v_mfma_f32_32x32x16_bf16 v[100:115], a[108:111], a[20:23], v[100:115]
  v_exp_f32 v120, v120
  v_exp_f32 v121, v121
  v_exp_f32 v122, v122
  v_cvt_pk_bf16_f32 v132, v116, v117
  v_cvt_pk_bf16_f32 v133, v118, v119
  v_mfma_f32_32x32x16_bf16 v[20:35], a[176:179], v[136:139], v[20:35]
  v_exp_f32 v123, v123
  v_exp_f32 v124, v124
  v_exp_f32 v125, v125
  v_cvt_pk_bf16_f32 v134, v120, v121
  v_cvt_pk_bf16_f32 v135, v122, v123
  v_mfma_f32_16x16x32_bf16 v[84:87], v[16:19], v[136:139], v[84:87]
  v_exp_f32 v126, v126
  v_exp_f32 v127, v127
  v_mfma_f32_32x32x16_bf16 v[36:51], a[172:175], v[132:135], v[36:51]
  v_exp_f32 v128, v128
  v_exp_f32 v129, v129
  v_exp_f32 v130, v130
  v_cvt_pk_bf16_f32 v136, v124, v125
  v_cvt_pk_bf16_f32 v137, v126, v127
  v_mfma_f32_16x16x32_bf16 v[88:91], v[16:19], v[132:135], v[88:91]
  v_exp_f32 v131, v131
  v_cvt_pk_bf16_f32 v138, v128, v129
  v_cvt_pk_bf16_f32 v139, v130, v131
  v_mfma_f32_32x32x16_bf16 v[116:131], a[104:107], a[24:27], 0
  v_exp_f32 v100, v100
  v_exp_f32 v101, v101
  v_exp_f32 v102, v102
  v_exp_f32 v103, v103
  v_mfma_f32_32x32x16_bf16 v[116:131], a[108:111], a[28:31], v[116:131]
  v_exp_f32 v104, v104
  v_exp_f32 v105, v105
  v_exp_f32 v106, v106
  v_cvt_pk_bf16_f32 v132, v100, v101
  v_cvt_pk_bf16_f32 v133, v102, v103
  v_mfma_f32_32x32x16_bf16 v[36:51], a[176:179], v[136:139], v[36:51]
  v_exp_f32 v107, v107
  v_exp_f32 v108, v108
  v_exp_f32 v109, v109
  v_cvt_pk_bf16_f32 v134, v104, v105
  v_cvt_pk_bf16_f32 v135, v106, v107
  v_mfma_f32_16x16x32_bf16 v[88:91], v[16:19], v[136:139], v[88:91]
  v_exp_f32 v110, v110
  v_exp_f32 v111, v111
  v_mfma_f32_32x32x16_bf16 v[52:67], a[172:175], v[132:135], v[52:67]
  v_exp_f32 v112, v112
  v_exp_f32 v113, v113
  v_exp_f32 v114, v114
  v_cvt_pk_bf16_f32 v136, v108, v109
  v_cvt_pk_bf16_f32 v137, v110, v111
  v_mfma_f32_16x16x32_bf16 v[92:95], v[16:19], v[132:135], v[92:95]
  v_exp_f32 v115, v115
  v_cvt_pk_bf16_f32 v138, v112, v113
  v_cvt_pk_bf16_f32 v139, v114, v115
  s_waitcnt vmcnt(33)
  v_mfma_f32_32x32x16_bf16 v[100:115], a[48:51], a[0:3], 0
  v_exp_f32 v116, v116
  v_exp_f32 v117, v117
  v_exp_f32 v118, v118
  v_exp_f32 v119, v119
  s_mov_b32 m0, s44
  s_add_u32 s44, s44, 8192
  buffer_load_dwordx4 a[164:167], v2, s[84:87], s37 offen offset:0 sc1
  buffer_load_dwordx4 a[168:171], v2, s[84:87], s37 offen offset:1024 sc1
  buffer_load_dwordx4 a[104:107], v2, s[92:95], s37 offen offset:2048 sc1
  buffer_load_dwordx4 a[108:111], v2, s[92:95], s37 offen offset:3072 sc1
  buffer_load_dwordx4 v250, s[12:15], s43 offen lds
  buffer_load_dwordx4 v251, s[12:15], s43 offen offset:1024 lds
  s_add_u32 s43, s43, 131072
  v_mfma_f32_32x32x16_bf16 v[100:115], a[52:55], a[4:7], v[100:115]
  v_exp_f32 v120, v120
  v_exp_f32 v121, v121
  v_exp_f32 v122, v122
  v_cvt_pk_bf16_f32 v132, v116, v117
  v_cvt_pk_bf16_f32 v133, v118, v119
  v_mfma_f32_32x32x16_bf16 v[52:67], a[176:179], v[136:139], v[52:67]
  v_exp_f32 v123, v123
  v_exp_f32 v124, v124
  v_exp_f32 v125, v125
  v_cvt_pk_bf16_f32 v134, v120, v121
  v_cvt_pk_bf16_f32 v135, v122, v123
  v_mfma_f32_16x16x32_bf16 v[92:95], v[16:19], v[136:139], v[92:95]
  v_exp_f32 v126, v126
  v_exp_f32 v127, v127
  v_mfma_f32_32x32x16_bf16 v[68:83], a[172:175], v[132:135], v[68:83]
  v_exp_f32 v128, v128
  v_exp_f32 v129, v129
  v_exp_f32 v130, v130
  v_cvt_pk_bf16_f32 v136, v124, v125
  v_cvt_pk_bf16_f32 v137, v126, v127
  v_mfma_f32_16x16x32_bf16 v[96:99], v[16:19], v[132:135], v[96:99]
  v_exp_f32 v131, v131
  v_cvt_pk_bf16_f32 v138, v128, v129
  v_cvt_pk_bf16_f32 v139, v130, v131
  s_sub_u32 s24, s24, 1
  s_cmp_lg_u32 s24, 0
  s_cbranch_scc1 L_p2_1
  s_nop 0
  v_mfma_f32_32x32x16_bf16 v[68:83], a[176:179], v[136:139], v[68:83]
  v_mfma_f32_16x16x32_bf16 v[96:99], v[16:19], v[136:139], v[96:99]
  s_lshl_b32 s28, s5, 13
  s_add_u32 s28, s28, 131072
  v_add_u32 v10, s28, v2
  s_xor_b32 s46, s28, 0x2000
  v_add_u32 v11, s46, v2
  s_lshl_b32 s28, s5, 9
  s_add_u32 s28, s28, 122880
  v_lshlrev_b32 v13, 2, v1
  v_add_u32 v13, s28, v13
  v_xor_b32 v12, 0x200, v13
  ds_write_b128 v10, v[20:23] offset:0
  ds_write_b128 v10, v[24:27] offset:1024
  ds_write_b128 v10, v[28:31] offset:2048
  ds_write_b128 v10, v[32:35] offset:3072
  ds_write_b32 v12, v84 offset:0
  ds_write_b128 v10, v[36:39] offset:4096
  ds_write_b128 v10, v[40:43] offset:5120
  ds_write_b128 v10, v[44:47] offset:6144
  ds_write_b128 v10, v[48:51] offset:7168
  ds_write_b32 v12, v88 offset:256
  s_waitcnt vmcnt(0)
  v_mfma_f32_32x32x16_bf16 v[140:155], a[112:115], a[32:35], v[140:155]
  v_mfma_f32_32x32x16_bf16 v[140:155], a[112:115], a[36:39], v[140:155]
  v_mfma_f32_32x32x16_bf16 v[140:155], a[112:115], a[40:43], v[140:155]
  v_mfma_f32_32x32x16_bf16 v[140:155], a[112:115], a[44:47], v[140:155]
  s_nop 7
  s_nop 3
  s_cmp_eq_u32 s5, 0
  s_cbranch_scc1 L_p2_nocw
  s_lshl_b32 s28, s5, 11
  s_add_u32 s28, s28, 122880
  v_add_u32 v10, s28, v2
  ds_write_b128 v10, v[140:143]
  ds_write_b128 v10, v[144:147] offset:1024
L_p2_nocw:
  s_waitcnt lgkmcnt(0)
  s_barrier
  ds_read_b128 v[100:103], v11 offset:0
  ds_read_b128 v[104:107], v11 offset:1024
  ds_read_b128 v[108:111], v11 offset:2048
  ds_read_b128 v[112:115], v11 offset:3072
  ds_read_b32 v85, v13 offset:0
  ds_read_b128 v[116:119], v11 offset:4096
  ds_read_b128 v[120:123], v11 offset:5120
  ds_read_b128 v[124:127], v11 offset:6144
  ds_read_b128 v[128:131], v11 offset:7168
  ds_read_b32 v89, v13 offset:256
  s_cmp_lg_u32 s5, 0
  s_cbranch_scc1 L_p2_nocs
  v_add_u32 v10, 124928, v2
  ds_read_b128 v[148:151], v10 offset:0
  ds_read_b128 v[152:155], v10 offset:1024
  ds_read_b128 v[20:23], v10 offset:2048
  ds_read_b128 v[24:27], v10 offset:3072
  ds_read_b128 v[28:31], v10 offset:4096
  ds_read_b128 v[32:35], v10 offset:5120
  s_mul_i32 s28, s60, 28672
  s_lshl_b32 s29, s61, 11
  s_add_u32 s28, s28, s29
  s_add_u32 s28, s28, s62
  s_add_u32 s28, s28, 40894464
  s_cmp_ge_u32 s2, 224
  s_cselect_b32 s28, 2146435072, s28
  v_lshlrev_b32 v10, 5, v5
  v_lshl_add_u32 v10, v6, 4, v10
  s_waitcnt lgkmcnt(0)
  v_pk_add_f32 v[140:141], v[140:141], v[148:149]
  v_pk_add_f32 v[20:21], v[20:21], v[28:29]
  v_pk_add_f32 v[142:143], v[142:143], v[150:151]
  v_pk_add_f32 v[22:23], v[22:23], v[30:31]
  v_pk_add_f32 v[144:145], v[144:145], v[152:153]
  v_pk_add_f32 v[24:25], v[24:25], v[32:33]
  v_pk_add_f32 v[146:147], v[146:147], v[154:155]
  v_pk_add_f32 v[26:27], v[26:27], v[34:35]
  v_pk_add_f32 v[140:141], v[140:141], v[20:21]
  v_pk_add_f32 v[142:143], v[142:143], v[22:23]
  v_pk_add_f32 v[144:145], v[144:145], v[24:25]
  v_pk_add_f32 v[146:147], v[146:147], v[26:27]
  buffer_store_dwordx4 v[140:143], v10, s[8:11], s28 offen sc1
  buffer_store_dwordx4 v[144:147], v10, s[8:11], s28 offen offset:1024 sc1
L_p2_nocs:
  s_waitcnt lgkmcnt(0)
  v_add_f32 v92, v92, v85
  v_pk_add_f32 v[52:53], v[52:53], v[100:101]
  v_pk_add_f32 v[54:55], v[54:55], v[102:103]
  v_pk_add_f32 v[56:57], v[56:57], v[104:105]
  v_pk_add_f32 v[58:59], v[58:59], v[106:107]
  v_pk_add_f32 v[60:61], v[60:61], v[108:109]
  v_pk_add_f32 v[62:63], v[62:63], v[110:111]
  v_pk_add_f32 v[64:65], v[64:65], v[112:113]
  v_pk_add_f32 v[66:67], v[66:67], v[114:115]
  v_add_f32 v96, v96, v89
  v_pk_add_f32 v[68:69], v[68:69], v[116:117]
  v_pk_add_f32 v[70:71], v[70:71], v[118:119]
  v_pk_add_f32 v[72:73], v[72:73], v[120:121]
  v_pk_add_f32 v[74:75], v[74:75], v[122:123]
  v_pk_add_f32 v[76:77], v[76:77], v[124:125]
  v_pk_add_f32 v[78:79], v[78:79], v[126:127]
  v_pk_add_f32 v[80:81], v[80:81], v[128:129]
  v_pk_add_f32 v[82:83], v[82:83], v[130:131]
  s_mov_b32 s28, 0x21800000
  s_mov_b32 s29, 0x5d800000
  v_cmp_nge_f32 vcc, v92, s28
  v_cmp_nle_f32 s[52:53], v92, s29
  v_cmp_nge_f32 s[54:55], v96, s28
  v_cmp_nle_f32 s[56:57], v96, s29
  v_lshrrev_b32 v10, 4, v5
  v_lshlrev_b32 v10, 15, v10
  v_lshl_add_u32 v10, v6, 8, v10
  v_lshl_add_u32 v8, v3, 4, v10
  s_or_b64 s[52:53], s[52:53], vcc
  s_or_b64 s[54:55], s[54:55], s[56:57]
  s_or_b64 s[52:53], s[52:53], s[54:55]
  s_cbranch_scc1 L_p2_slow
L_p2_fin:
  s_lshl_b32 s47, s32, 7
  s_lshl_b32 s29, s33, 2
  s_add_u32 s47, s47, s29
  s_add_u32 s47, s47, 39852032
  s_lshl_b32 s48, s2, 2
  s_add_u32 s48, s48, 39854080
  v_rcp_f32 v94, v92
  s_xor_b32 s28, s42, 2
  s_add_u32 s28, s28, s41
  s_lshl_b32 s28, s28, 16
  s_lshl_b32 s29, s36, 10
  s_add_u32 s28, s28, s29
  s_add_u32 s28, s28, 12582912
  v_pk_mul_f32 v[52:53], v[52:53], v[94:95] op_sel_hi:[1,0]
  v_pk_mul_f32 v[54:55], v[54:55], v[94:95] op_sel_hi:[1,0]
  v_pk_mul_f32 v[56:57], v[56:57], v[94:95] op_sel_hi:[1,0]
  v_pk_mul_f32 v[58:59], v[58:59], v[94:95] op_sel_hi:[1,0]
  v_pk_mul_f32 v[60:61], v[60:61], v[94:95] op_sel_hi:[1,0]
  v_pk_mul_f32 v[62:63], v[62:63], v[94:95] op_sel_hi:[1,0]
  v_pk_mul_f32 v[64:65], v[64:65], v[94:95] op_sel_hi:[1,0]
  v_pk_mul_f32 v[66:67], v[66:67], v[94:95] op_sel_hi:[1,0]
  v_cvt_pk_bf16_f32 v52, v52, v53
  v_cvt_pk_bf16_f32 v53, v54, v55
  v_cvt_pk_bf16_f32 v54, v56, v57
  v_cvt_pk_bf16_f32 v55, v58, v59
  v_cvt_pk_bf16_f32 v56, v60, v61
  v_cvt_pk_bf16_f32 v57, v62, v63
  v_cvt_pk_bf16_f32 v58, v64, v65
  v_cvt_pk_bf16_f32 v59, v66, v67
  buffer_store_dwordx4 v[52:55], v8, s[8:11], s28 offen sc1
  buffer_store_dwordx4 v[56:59], v8, s[8:11], s28 offen offset:512 sc1
  v_rcp_f32 v98, v96
  s_xor_b32 s28, s42, 3
  s_add_u32 s28, s28, s41
  s_lshl_b32 s28, s28, 16
  s_lshl_b32 s29, s36, 10
  s_add_u32 s28, s28, s29
  s_add_u32 s28, s28, 12582912
  v_pk_mul_f32 v[68:69], v[68:69], v[98:99] op_sel_hi:[1,0]
  v_pk_mul_f32 v[70:71], v[70:71], v[98:99] op_sel_hi:[1,0]
  v_pk_mul_f32 v[72:73], v[72:73], v[98:99] op_sel_hi:[1,0]
  v_pk_mul_f32 v[74:75], v[74:75], v[98:99] op_sel_hi:[1,0]
  v_pk_mul_f32 v[76:77], v[76:77], v[98:99] op_sel_hi:[1,0]
  v_pk_mul_f32 v[78:79], v[78:79], v[98:99] op_sel_hi:[1,0]
  v_pk_mul_f32 v[80:81], v[80:81], v[98:99] op_sel_hi:[1,0]
  v_pk_mul_f32 v[82:83], v[82:83], v[98:99] op_sel_hi:[1,0]
  v_cvt_pk_bf16_f32 v68, v68, v69
  v_cvt_pk_bf16_f32 v69, v70, v71
  v_cvt_pk_bf16_f32 v70, v72, v73
  v_cvt_pk_bf16_f32 v71, v74, v75
  v_cvt_pk_bf16_f32 v72, v76, v77
  v_cvt_pk_bf16_f32 v73, v78, v79
  v_cvt_pk_bf16_f32 v74, v80, v81
  v_cvt_pk_bf16_f32 v75, v82, v83
  buffer_store_dwordx4 v[68:71], v8, s[8:11], s28 offen sc1
  buffer_store_dwordx4 v[72:75], v8, s[8:11], s28 offen offset:512 sc1
L_P3:
  s_lshl_b32 s32, s50, 3
  s_lshl_b32 s28, s5, 1
  s_add_u32 s32, s32, s28
  s_lshl_b32 s30, s32, 4
  s_mov_b32 s16, s64
  s_mov_b32 s17, s65
  s_mov_b32 s18, 4194304
  s_mov_b32 s19, 0x20000
  v_lshrrev_b32 v14, 3, v1
  v_add_u32 v15, s30, v14
  v_lshlrev_b32 v15, 11, v15
  s_lshl_b32 s29, s51, 7
  v_add_u32 v15, s29, v15
  v_and_b32 v16, 7, v1
  v_xor_b32 v16, v16, v4
  v_xor_b32 v17, 4, v16
  v_lshl_add_u32 v16, v16, 4, v15
  v_lshl_add_u32 v17, v17, 4, v15
  s_and_b32 s52, s4, 7
  s_lshr_b32 s29, s4, 3
  s_lshl_b32 s53, s3, 2
  s_add_u32 s53, s53, s29
  s_lshl_b32 s28, s50, 7
  s_add_u32 s28, s28, 39852032
  v_lshlrev_b32 v148, 2, v3
  v_add_u32 v148, s28, v148
  v_mov_b32 v164, 1
  v_mov_b32 v165, 0
  s_cmp_eq_u32 s5, 0
  s_cselect_b32 s47, s47, 2146435072
  s_cmp_eq_u32 s5, 0
  s_cselect_b32 s48, s48, 2146435072
  s_waitcnt vmcnt(0)
  s_barrier
  buffer_store_dword v164, v165, s[8:11], s47 offen sc1
  buffer_store_dword v164, v165, s[8:11], s48 offen sc1
  s_add_u32 s56, s58, L_P3-L_base
  s_addc_u32 s57, s59, 0
  v_and_b32 v166, 7, v0
  v_lshl_add_u32 v166, v166, 5, s4
  v_lshlrev_b32 v166, 7, v166
  v_min_u32 v166, L_P5-L_P3-4, v166
  global_load_dword v166, v166, s[56:57]
  s_lshl_b32 s28, s5, 11
  s_add_u32 m0, s28, 122880
  s_mov_b32 s28, 1966080
  buffer_load_dwordx4 v250, s[12:15], s28 offen lds
  buffer_load_dwordx4 v251, s[12:15], s28 offen offset:1024 lds
  s_mov_b32 m0, s46
  s_mov_b32 s29, 0
  buffer_load_dwordx4 v16, s[16:19], s29 offen offset:0 lds
  s_mov_b32 s29, 15360
  buffer_load_dwordx4 v17, s[16:19], s29 offen offset:1024 lds
  s_mov_b32 s29, 30720
  buffer_load_dwordx4 v16, s[16:19], s29 offen offset:2048 lds
  s_mov_b32 s29, 46080
  buffer_load_dwordx4 v17, s[16:19], s29 offen offset:3072 lds
  s_lshl_b32 s28, s2, 14
  s_lshl_b32 s29, s5, 12
  s_add_u32 s28, s28, s29
  s_add_u32 s28, s28, 41943040
  v_mov_b32 v180, -1
  v_mov_b32 v181, -1
  v_mov_b32 v182, -1
  v_mov_b32 v183, -1
  buffer_store_dwordx4 v[180:183], v2, s[8:11], s28 offen offset:0 sc1
  buffer_store_dwordx4 v[180:183], v2, s[8:11], s28 offen offset:1024 sc1
  buffer_store_dwordx4 v[180:183], v2, s[8:11], s28 offen offset:2048 sc1
  buffer_store_dwordx4 v[180:183], v2, s[8:11], s28 offen offset:3072 sc1
  s_and_b32 s29, s5, 1
  s_mul_i32 s29, s29, 448
  v_add_u32 v14, s29, v1
  s_mov_b32 s28, 306783379
  s_mul_i32 s30, s53, 224
  s_movk_i32 s31, 6944
  v_add_u32 v15, 0, v14
  v_mul_hi_u32 v10, v15, s28
  v_mul_lo_u32 v10, v10, s31
  v_lshl_add_u32 v10, v15, 4, v10
  s_sub_u32 s29, s30, 0
  v_add_u32 v244, s29, v10
  v_add_u32 v15, 64, v14
  v_mul_hi_u32 v10, v15, s28
  v_mul_lo_u32 v10, v10, s31
  v_lshl_add_u32 v10, v15, 4, v10
  s_sub_u32 s29, s30, 1024
  v_add_u32 v245, s29, v10
  v_add_u32 v15, 128, v14
  v_mul_hi_u32 v10, v15, s28
  v_mul_lo_u32 v10, v10, s31
  v_lshl_add_u32 v10, v15, 4, v10
  s_sub_u32 s29, s30, 2048
  v_add_u32 v246, s29, v10
  v_add_u32 v15, 192, v14
  v_mul_hi_u32 v10, v15, s28
  v_mul_lo_u32 v10, v10, s31
  v_lshl_add_u32 v10, v15, 4, v10
  s_sub_u32 s29, s30, 3072
  v_add_u32 v247, s29, v10
  v_add_u32 v15, 256, v14
  v_mul_hi_u32 v10, v15, s28
  v_mul_lo_u32 v10, v10, s31
  v_lshl_add_u32 v10, v15, 4, v10
  s_sub_u32 s29, s30, 0
  v_add_u32 v248, s29, v10
  v_add_u32 v15, 320, v14
  v_mul_hi_u32 v10, v15, s28
  v_mul_lo_u32 v10, v10, s31
  v_lshl_add_u32 v10, v15, 4, v10
  s_sub_u32 s29, s30, 1024
  v_add_u32 v249, s29, v10
  v_add_u32 v15, 384, v14
  v_mul_hi_u32 v10, v15, s28
  v_mul_lo_u32 v10, v10, s31
  v_lshl_add_u32 v10, v15, 4, v10
  s_sub_u32 s29, s30, 2048
  v_add_u32 v250, s29, v10
  s_cmp_lt_u32 s5, 2
  s_cselect_b32 s12, s72, s74
  s_cselect_b32 s13, s73, s75
  s_mov_b32 s14, 7340032
  s_mov_b32 s15, 0x20000
  s_mul_i32 s37, s5, 7168
  s_mov_b32 s35, 0
  s_mov_b32 s36, 0
  s_mov_b32 s39, 0
  v_lshrrev_b32 v14, 2, v1
  v_and_b32 v14, 3, v14
  v_and_b32 v15, 1, v4
  v_lshl_add_u32 v11, v15, 2, v14
  v_lshl_add_u32 v11, v6, 4, v11
  v_lshlrev_b32 v11, 7, v11
  v_lshrrev_b32 v14, 1, v14
  v_lshl_add_u32 v14, v15, 1, v14
  v_lshl_add_u32 v11, v14, 5, v11
  v_and_b32 v14, 3, v1
  v_lshl_add_u32 v10, v14, 3, v11
  v_xor_b32 v11, 32, v10
  v_xor_b32 v12, 64, v10
  v_xor_b32 v13, 96, v10
  s_lshl_b32 s33, s32, 15
  s_add_u32 s33, s33, 12582912
  s_add_u32 s34, s33, 32768
  v_mov_b32 v8, v2
  v_add_u32 v9, 32768, v2
  s_mov_b32 s40, s33
  s_and_b32 s41, s51, 3
  s_lshl_b32 s28, s41, 15
  s_lshl_b32 s41, s41, 13
  s_add_u32 s42, s41, 32768
  s_add_u32 s33, s33, s41
  v_add_u32 v10, s28, v10
  v_add_u32 v11, s28, v11
  v_add_u32 v12, s28, v12
  v_add_u32 v13, s28, v13
  v_lshrrev_b32 v14, 1, v3
  v_xor_b32 v14, v14, v6
  v_lshlrev_b32 v14, 4, v14
  v_and_b32 v15, 1, v4
  v_lshlrev_b32 v15, 3, v15
  v_lshl_add_u32 v15, v3, 7, v15
  v_add_u32 v15, s46, v15
  v_xor_b32 v168, 0, v14
  v_add_u32 v168, v168, v15
  v_xor_b32 v169, 32, v14
  v_add_u32 v169, v169, v15
  v_xor_b32 v170, 64, v14
  v_add_u32 v170, v170, v15
  v_xor_b32 v171, 96, v14
  v_add_u32 v171, v171, v15
  s_cmp_lg_u32 s5, 0
  s_cbranch_scc1 L_p3_ok
  s_mov_b32 s26, 400000
L_p3_poll:
  buffer_load_dword v164, v148, s[8:11], 0 offen sc1
  s_waitcnt vmcnt(0)
  v_cmp_eq_u32 vcc, 0, v164
  s_sub_u32 s26, s26, 1
  s_cselect_b32 s27, 0, vcc_lo
  s_cselect_b32 s28, 0, vcc_hi
  s_or_b32 s27, s27, s28
  s_cbranch_scc0 L_p3_ok
  s_sleep 1
  s_branch L_p3_poll
L_p3_ok:
  s_barrier
  buffer_load_dwordx4 v[84:87], v8, s[8:11], s33 offen offset:0 sc1
  buffer_load_dwordx4 v[88:91], v9, s[8:11], s33 offen offset:0 sc1
  buffer_load_dwordx4 v[92:95], v8, s[8:11], s33 offen offset:1024 sc1
  buffer_load_dwordx4 v[96:99], v9, s[8:11], s33 offen offset:1024 sc1
  buffer_load_dwordx4 v[100:103], v8, s[8:11], s33 offen offset:2048 sc1
  buffer_load_dwordx4 v[104:107], v9, s[8:11], s33 offen offset:2048 sc1
  buffer_load_dwordx4 v[108:111], v8, s[8:11], s33 offen offset:3072 sc1
  buffer_load_dwordx4 v[112:115], v9, s[8:11], s33 offen offset:3072 sc1
  s_add_u32 s41, s41, 4096
  s_and_b32 s28, s41, 0x7fff
  s_add_u32 s33, s40, s28
  s_cmp_ge_u32 s41, s42
  s_cselect_b32 s33, 2146435072, s33
  buffer_load_dwordx4 v[116:119], v8, s[8:11], s33 offen offset:0 sc1
  buffer_load_dwordx4 v[120:123], v9, s[8:11], s33 offen offset:0 sc1
  buffer_load_dwordx4 v[124:127], v8, s[8:11], s33 offen offset:1024 sc1
  buffer_load_dwordx4 v[128:131], v9, s[8:11], s33 offen offset:1024 sc1
  buffer_load_dwordx4 v[132:135], v8, s[8:11], s33 offen offset:2048 sc1
  buffer_load_dwordx4 v[136:139], v9, s[8:11], s33 offen offset:2048 sc1
  s_waitcnt vmcnt(18)
  ds_read_b64 v[148:149], v168 offset:0
  ds_read_b64 v[156:157], v168 offset:2048
  ds_read_b64 v[150:151], v169 offset:0
  ds_read_b64 v[158:159], v169 offset:2048
  ds_read_b64 v[152:153], v170 offset:0
  ds_read_b64 v[160:161], v170 offset:2048
  ds_read_b64 v[154:155], v171 offset:0
  ds_read_b64 v[162:163], v171 offset:2048
  ds_read_b64_tr_b16 v[52:53], v10 offset:0
  ds_read_b64_tr_b16 v[54:55], v10 offset:1024
  ds_read_b64_tr_b16 v[56:57], v11 offset:0
  ds_read_b64_tr_b16 v[58:59], v11 offset:1024
  ds_read_b64_tr_b16 v[60:61], v12 offset:0
  ds_read_b64_tr_b16 v[62:63], v12 offset:1024
  ds_read_b64_tr_b16 v[64:65], v13 offset:0
  ds_read_b64_tr_b16 v[66:67], v13 offset:1024
  s_waitcnt lgkmcnt(8)
  v_lshlrev_b32 v20, 16, v148
  v_and_b32 v21, 0xffff0000, v148
  v_lshlrev_b32 v22, 16, v149
  v_and_b32 v23, 0xffff0000, v149
  v_lshlrev_b32 v24, 16, v150
  v_and_b32 v25, 0xffff0000, v150
  v_lshlrev_b32 v26, 16, v151
  v_and_b32 v27, 0xffff0000, v151
  v_lshlrev_b32 v28, 16, v152
  v_and_b32 v29, 0xffff0000, v152
  v_lshlrev_b32 v30, 16, v153
  v_and_b32 v31, 0xffff0000, v153
  v_lshlrev_b32 v32, 16, v154
  v_and_b32 v33, 0xffff0000, v154
  v_lshlrev_b32 v34, 16, v155
  v_and_b32 v35, 0xffff0000, v155
  v_lshlrev_b32 v36, 16, v156
  v_and_b32 v37, 0xffff0000, v156
  v_lshlrev_b32 v38, 16, v157
  v_and_b32 v39, 0xffff0000, v157
  v_lshlrev_b32 v40, 16, v158
  v_and_b32 v41, 0xffff0000, v158
  v_lshlrev_b32 v42, 16, v159
  v_and_b32 v43, 0xffff0000, v159
  v_lshlrev_b32 v44, 16, v160
  v_and_b32 v45, 0xffff0000, v160
  v_lshlrev_b32 v46, 16, v161
  v_and_b32 v47, 0xffff0000, v161
  v_lshlrev_b32 v48, 16, v162
  v_and_b32 v49, 0xffff0000, v162
  v_lshlrev_b32 v50, 16, v163
  v_and_b32 v51, 0xffff0000, v163
  s_mov_b32 s24, 4
.p2align 4
L_p3_2:
  s_waitcnt vmcnt(12) lgkmcnt(4)
  v_mfma_f32_16x16x32_bf16 v[20:23], v[52:55], v[84:87], v[20:23]
  ds_read_b64_tr_b16 v[68:69], v10 offset:4096
  v_mfma_f32_16x16x32_bf16 v[36:39], v[52:55], v[88:91], v[36:39]
  ds_read_b64_tr_b16 v[70:71], v10 offset:5120
  v_mfma_f32_16x16x32_bf16 v[40:43], v[56:59], v[88:91], v[40:43]
  ds_read_b64_tr_b16 v[72:73], v11 offset:4096
  buffer_load_dwordx4 v[140:143], v8, s[8:11], s33 offen offset:3072 sc1
  v_mfma_f32_16x16x32_bf16 v[24:27], v[56:59], v[84:87], v[24:27]
  ds_read_b64_tr_b16 v[74:75], v11 offset:5120
  s_waitcnt lgkmcnt(4)
  v_mfma_f32_16x16x32_bf16 v[28:31], v[60:63], v[84:87], v[28:31]
  ds_read_b64_tr_b16 v[76:77], v12 offset:4096
  v_mfma_f32_16x16x32_bf16 v[44:47], v[60:63], v[88:91], v[44:47]
  ds_read_b64_tr_b16 v[78:79], v12 offset:5120
  v_mfma_f32_16x16x32_bf16 v[48:51], v[64:67], v[88:91], v[48:51]
  ds_read_b64_tr_b16 v[80:81], v13 offset:4096
  buffer_load_dwordx4 v[144:147], v9, s[8:11], s33 offen offset:3072 sc1
  v_mfma_f32_16x16x32_bf16 v[32:35], v[64:67], v[84:87], v[32:35]
  ds_read_b64_tr_b16 v[82:83], v13 offset:5120
  s_waitcnt vmcnt(12) lgkmcnt(4)
  v_mfma_f32_16x16x32_bf16 v[20:23], v[68:71], v[92:95], v[20:23]
  ds_read_b64_tr_b16 v[52:53], v10 offset:8192
  v_mfma_f32_16x16x32_bf16 v[36:39], v[68:71], v[96:99], v[36:39]
  ds_read_b64_tr_b16 v[54:55], v10 offset:9216
  s_add_u32 s41, s41, 4096
  s_and_b32 s28, s41, 0x7fff
  s_add_u32 s33, s40, s28
  s_cmp_ge_u32 s41, s42
  s_cselect_b32 s33, 2146435072, s33
  v_mfma_f32_16x16x32_bf16 v[40:43], v[72:75], v[96:99], v[40:43]
  ds_read_b64_tr_b16 v[56:57], v11 offset:8192
  buffer_load_dwordx4 v[84:87], v8, s[8:11], s33 offen offset:0 sc1
  v_mfma_f32_16x16x32_bf16 v[24:27], v[72:75], v[92:95], v[24:27]
  ds_read_b64_tr_b16 v[58:59], v11 offset:9216
  s_waitcnt lgkmcnt(4)
  v_mfma_f32_16x16x32_bf16 v[28:31], v[76:79], v[92:95], v[28:31]
  ds_read_b64_tr_b16 v[60:61], v12 offset:8192
  v_mfma_f32_16x16x32_bf16 v[44:47], v[76:79], v[96:99], v[44:47]
  ds_read_b64_tr_b16 v[62:63], v12 offset:9216
  v_mfma_f32_16x16x32_bf16 v[48:51], v[80:83], v[96:99], v[48:51]
  ds_read_b64_tr_b16 v[64:65], v13 offset:8192
  buffer_load_dwordx4 v[88:91], v9, s[8:11], s33 offen offset:0 sc1
  v_mfma_f32_16x16x32_bf16 v[32:35], v[80:83], v[92:95], v[32:35]
  ds_read_b64_tr_b16 v[66:67], v13 offset:9216
  s_waitcnt vmcnt(12) lgkmcnt(4)
  v_mfma_f32_16x16x32_bf16 v[20:23], v[52:55], v[100:103], v[20:23]
  ds_read_b64_tr_b16 v[68:69], v10 offset:12288
  v_mfma_f32_16x16x32_bf16 v[36:39], v[52:55], v[104:107], v[36:39]
  ds_read_b64_tr_b16 v[70:71], v10 offset:13312
  v_mfma_f32_16x16x32_bf16 v[40:43], v[56:59], v[104:107], v[40:43]
  ds_read_b64_tr_b16 v[72:73], v11 offset:12288
  buffer_load_dwordx4 v[92:95], v8, s[8:11], s33 offen offset:1024 sc1
  v_mfma_f32_16x16x32_bf16 v[24:27], v[56:59], v[100:103], v[24:27]
  ds_read_b64_tr_b16 v[74:75], v11 offset:13312
  s_waitcnt lgkmcnt(4)
  v_mfma_f32_16x16x32_bf16 v[28:31], v[60:63], v[100:103], v[28:31]
  ds_read_b64_tr_b16 v[76:77], v12 offset:12288
  v_mfma_f32_16x16x32_bf16 v[44:47], v[60:63], v[104:107], v[44:47]
  ds_read_b64_tr_b16 v[78:79], v12 offset:13312
  v_mfma_f32_16x16x32_bf16 v[48:51], v[64:67], v[104:107], v[48:51]
  ds_read_b64_tr_b16 v[80:81], v13 offset:12288
  buffer_load_dwordx4 v[96:99], v9, s[8:11], s33 offen offset:1024 sc1
  v_mfma_f32_16x16x32_bf16 v[32:35], v[64:67], v[100:103], v[32:35]
  ds_read_b64_tr_b16 v[82:83], v13 offset:13312
  s_waitcnt vmcnt(12) lgkmcnt(4)
  s_barrier
  v_mfma_f32_16x16x32_bf16 v[20:23], v[68:71], v[108:111], v[20:23]
  ds_read_b64_tr_b16 v[52:53], v10 offset:16384
  v_mfma_f32_16x16x32_bf16 v[36:39], v[68:71], v[112:115], v[36:39]
  ds_read_b64_tr_b16 v[54:55], v10 offset:17408
  v_mfma_f32_16x16x32_bf16 v[40:43], v[72:75], v[112:115], v[40:43]
  ds_read_b64_tr_b16 v[56:57], v11 offset:16384
  buffer_load_dwordx4 v[100:103], v8, s[8:11], s33 offen offset:2048 sc1
  v_mfma_f32_16x16x32_bf16 v[24:27], v[72:75], v[108:111], v[24:27]
  ds_read_b64_tr_b16 v[58:59], v11 offset:17408
  s_waitcnt lgkmcnt(4)
  v_mfma_f32_16x16x32_bf16 v[28:31], v[76:79], v[108:111], v[28:31]
  ds_read_b64_tr_b16 v[60:61], v12 offset:16384
  v_mfma_f32_16x16x32_bf16 v[44:47], v[76:79], v[112:115], v[44:47]
  ds_read_b64_tr_b16 v[62:63], v12 offset:17408
  v_mfma_f32_16x16x32_bf16 v[48:51], v[80:83], v[112:115], v[48:51]
  ds_read_b64_tr_b16 v[64:65], v13 offset:16384
  buffer_load_dwordx4 v[104:107], v9, s[8:11], s33 offen offset:2048 sc1
  v_mfma_f32_16x16x32_bf16 v[32:35], v[80:83], v[108:111], v[32:35]
  ds_read_b64_tr_b16 v[66:67], v13 offset:17408
  s_waitcnt vmcnt(12) lgkmcnt(4)
  v_mfma_f32_16x16x32_bf16 v[20:23], v[52:55], v[116:119], v[20:23]
  ds_read_b64_tr_b16 v[68:69], v10 offset:20480
  v_mfma_f32_16x16x32_bf16 v[36:39], v[52:55], v[120:123], v[36:39]
  ds_read_b64_tr_b16 v[70:71], v10 offset:21504
  v_mfma_f32_16x16x32_bf16 v[40:43], v[56:59], v[120:123], v[40:43]
  ds_read_b64_tr_b16 v[72:73], v11 offset:20480
  buffer_load_dwordx4 v[108:111], v8, s[8:11], s33 offen offset:3072 sc1
  v_mfma_f32_16x16x32_bf16 v[24:27], v[56:59], v[116:119], v[24:27]
  ds_read_b64_tr_b16 v[74:75], v11 offset:21504
  s_waitcnt lgkmcnt(4)
  v_mfma_f32_16x16x32_bf16 v[28:31], v[60:63], v[116:119], v[28:31]
  ds_read_b64_tr_b16 v[76:77], v12 offset:20480
  v_mfma_f32_16x16x32_bf16 v[44:47], v[60:63], v[120:123], v[44:47]
  ds_read_b64_tr_b16 v[78:79], v12 offset:21504
  v_mfma_f32_16x16x32_bf16 v[48:51], v[64:67], v[120:123], v[48:51]
  ds_read_b64_tr_b16 v[80:81], v13 offset:20480
  buffer_load_dwordx4 v[112:115], v9, s[8:11], s33 offen offset:3072 sc1
  v_mfma_f32_16x16x32_bf16 v[32:35], v[64:67], v[116:119], v[32:35]
  ds_read_b64_tr_b16 v[82:83], v13 offset:21504
  s_waitcnt vmcnt(12) lgkmcnt(4)
  v_mfma_f32_16x16x32_bf16 v[20:23], v[68:71], v[124:127], v[20:23]
  ds_read_b64_tr_b16 v[52:53], v10 offset:24576
  v_mfma_f32_16x16x32_bf16 v[36:39], v[68:71], v[128:131], v[36:39]
  ds_read_b64_tr_b16 v[54:55], v10 offset:25600
  s_add_u32 s41, s41, 4096
  s_and_b32 s28, s41, 0x7fff
  s_add_u32 s33, s40, s28
  s_cmp_ge_u32 s41, s42
  s_cselect_b32 s33, 2146435072, s33
  v_mfma_f32_16x16x32_bf16 v[40:43], v[72:75], v[128:131], v[40:43]
  ds_read_b64_tr_b16 v[56:57], v11 offset:24576
  buffer_load_dwordx4 v[116:119], v8, s[8:11], s33 offen offset:0 sc1
  v_mfma_f32_16x16x32_bf16 v[24:27], v[72:75], v[124:127], v[24:27]
  ds_read_b64_tr_b16 v[58:59], v11 offset:25600
  s_waitcnt lgkmcnt(4)
  v_mfma_f32_16x16x32_bf16 v[28:31], v[76:79], v[124:127], v[28:31]
  ds_read_b64_tr_b16 v[60:61], v12 offset:24576
  v_mfma_f32_16x16x32_bf16 v[44:47], v[76:79], v[128:131], v[44:47]
  ds_read_b64_tr_b16 v[62:63], v12 offset:25600
  v_mfma_f32_16x16x32_bf16 v[48:51], v[80:83], v[128:131], v[48:51]
  ds_read_b64_tr_b16 v[64:65], v13 offset:24576
  buffer_load_dwordx4 v[120:123], v9, s[8:11], s33 offen offset:0 sc1
  v_mfma_f32_16x16x32_bf16 v[32:35], v[80:83], v[124:127], v[32:35]
  ds_read_b64_tr_b16 v[66:67], v13 offset:25600
  s_waitcnt vmcnt(12) lgkmcnt(4)
  v_mfma_f32_16x16x32_bf16 v[20:23], v[52:55], v[132:135], v[20:23]
  ds_read_b64_tr_b16 v[68:69], v10 offset:28672
  v_mfma_f32_16x16x32_bf16 v[36:39], v[52:55], v[136:139], v[36:39]
  ds_read_b64_tr_b16 v[70:71], v10 offset:29696
  v_mfma_f32_16x16x32_bf16 v[40:43], v[56:59], v[136:139], v[40:43]
  ds_read_b64_tr_b16 v[72:73], v11 offset:28672
  buffer_load_dwordx4 v[124:127], v8, s[8:11], s33 offen offset:1024 sc1
  v_mfma_f32_16x16x32_bf16 v[24:27], v[56:59], v[132:135], v[24:27]
  ds_read_b64_tr_b16 v[74:75], v11 offset:29696
  s_waitcnt lgkmcnt(4)
  v_mfma_f32_16x16x32_bf16 v[28:31], v[60:63], v[132:135], v[28:31]
  ds_read_b64_tr_b16 v[76:77], v12 offset:28672
  v_mfma_f32_16x16x32_bf16 v[44:47], v[60:63], v[136:139], v[44:47]
  ds_read_b64_tr_b16 v[78:79], v12 offset:29696
  v_mfma_f32_16x16x32_bf16 v[48:51], v[64:67], v[136:139], v[48:51]
  ds_read_b64_tr_b16 v[80:81], v13 offset:28672
  buffer_load_dwordx4 v[128:131], v9, s[8:11], s33 offen offset:1024 sc1
  v_mfma_f32_16x16x32_bf16 v[32:35], v[64:67], v[132:135], v[32:35]
  ds_read_b64_tr_b16 v[82:83], v13 offset:29696
  s_waitcnt vmcnt(12) lgkmcnt(4)
  v_mfma_f32_16x16x32_bf16 v[20:23], v[68:71], v[140:143], v[20:23]
  v_add_u32 v10, 0x8000, v10
  v_and_b32 v10, 0x1ffff, v10
  ds_read_b64_tr_b16 v[52:53], v10 offset:0
  v_mfma_f32_16x16x32_bf16 v[36:39], v[68:71], v[144:147], v[36:39]
  ds_read_b64_tr_b16 v[54:55], v10 offset:1024
  v_mfma_f32_16x16x32_bf16 v[40:43], v[72:75], v[144:147], v[40:43]
  v_add_u32 v11, 0x8000, v11
  v_and_b32 v11, 0x1ffff, v11
  ds_read_b64_tr_b16 v[56:57], v11 offset:0
  buffer_load_dwordx4 v[132:135], v8, s[8:11], s33 offen offset:2048 sc1
  v_mfma_f32_16x16x32_bf16 v[24:27], v[72:75], v[140:143], v[24:27]
  ds_read_b64_tr_b16 v[58:59], v11 offset:1024
  s_waitcnt lgkmcnt(4)
  v_mfma_f32_16x16x32_bf16 v[28:31], v[76:79], v[140:143], v[28:31]
  v_add_u32 v12, 0x8000, v12
  v_and_b32 v12, 0x1ffff, v12
  ds_read_b64_tr_b16 v[60:61], v12 offset:0
  v_mfma_f32_16x16x32_bf16 v[44:47], v[76:79], v[144:147], v[44:47]
  ds_read_b64_tr_b16 v[62:63], v12 offset:1024
  v_mfma_f32_16x16x32_bf16 v[48:51], v[80:83], v[144:147], v[48:51]
  v_add_u32 v13, 0x8000, v13
  v_and_b32 v13, 0x1ffff, v13
  ds_read_b64_tr_b16 v[64:65], v13 offset:0
  buffer_load_dwordx4 v[136:139], v9, s[8:11], s33 offen offset:2048 sc1
  v_mfma_f32_16x16x32_bf16 v[32:35], v[80:83], v[140:143], v[32:35]
  ds_read_b64_tr_b16 v[66:67], v13 offset:1024
  s_sub_u32 s24, s24, 1
  s_cmp_lg_u32 s24, 0
  s_cbranch_scc1 L_p3_2
  s_waitcnt vmcnt(0) lgkmcnt(0)
  s_lshl_b32 s28, s32, 15
  s_lshl_b32 s29, s51, 11
  s_add_u32 s28, s28, s29
  s_add_u32 s28, s28, 33554432
  s_nop 2
  v_cvt_pk_bf16_f32 v180, v20, v21
  v_cvt_pk_bf16_f32 v181, v22, v23
  v_cvt_pk_bf16_f32 v182, v24, v25
  v_cvt_pk_bf16_f32 v183, v26, v27
  v_cvt_pk_bf16_f32 v184, v28, v29
  v_cvt_pk_bf16_f32 v185, v30, v31
  v_cvt_pk_bf16_f32 v186, v32, v33
  v_cvt_pk_bf16_f32 v187, v34, v35
  v_cvt_pk_bf16_f32 v188, v36, v37
  v_cvt_pk_bf16_f32 v189, v38, v39
  v_cvt_pk_bf16_f32 v190, v40, v41
  v_cvt_pk_bf16_f32 v191, v42, v43
  v_cvt_pk_bf16_f32 v192, v44, v45
  v_cvt_pk_bf16_f32 v193, v46, v47
  v_cvt_pk_bf16_f32 v194, v48, v49
  v_cvt_pk_bf16_f32 v195, v50, v51
  buffer_store_dwordx4 v[180:183], v8, s[8:11], s28 offen offset:0 sc1
  buffer_store_dwordx4 v[184:187], v8, s[8:11], s28 offen offset:1024 sc1
  buffer_store_dwordx4 v[188:191], v9, s[8:11], s28 offen offset:0 sc1
  buffer_store_dwordx4 v[192:195], v9, s[8:11], s28 offen offset:1024 sc1
  v_mov_b32 v15, 0x3f803f80
  v_mov_b32 v164, 0
  v_mov_b32 v165, 0
  v_mov_b32 v166, 0
  v_mov_b32 v167, 0
  v_dot2c_f32_bf16 v164, v180, v15
  v_dot2c_f32_bf16 v165, v180, v180
  v_dot2c_f32_bf16 v166, v188, v15
  v_dot2c_f32_bf16 v167, v188, v188
  v_dot2c_f32_bf16 v164, v181, v15
  v_dot2c_f32_bf16 v165, v181, v181
  v_dot2c_f32_bf16 v166, v189, v15
  v_dot2c_f32_bf16 v167, v189, v189
  v_dot2c_f32_bf16 v164, v182, v15
  v_dot2c_f32_bf16 v165, v182, v182
  v_dot2c_f32_bf16 v166, v190, v15
  v_dot2c_f32_bf16 v167, v190, v190
  v_dot2c_f32_bf16 v164, v183, v15
  v_dot2c_f32_bf16 v165, v183, v183
  v_dot2c_f32_bf16 v166, v191, v15
  v_dot2c_f32_bf16 v167, v191, v191
  v_dot2c_f32_bf16 v164, v184, v15
  v_dot2c_f32_bf16 v165, v184, v184
  v_dot2c_f32_bf16 v166, v192, v15
  v_dot2c_f32_bf16 v167, v192, v192
  v_dot2c_f32_bf16 v164, v185, v15
  v_dot2c_f32_bf16 v165, v185, v185
  v_dot2c_f32_bf16 v166, v193, v15
  v_dot2c_f32_bf16 v167, v193, v193
  v_dot2c_f32_bf16 v164, v186, v15
  v_dot2c_f32_bf16 v165, v186, v186
  v_dot2c_f32_bf16 v166, v194, v15
  v_dot2c_f32_bf16 v167, v194, v194
  v_dot2c_f32_bf16 v164, v187, v15
  v_dot2c_f32_bf16 v165, v187, v187
  v_dot2c_f32_bf16 v166, v195, v15
  v_dot2c_f32_bf16 v167, v195, v195
  s_nop 2
  v_mov_b32 v168, v164
  v_mov_b32 v169, v165
  v_mov_b32 v170, v166
  v_mov_b32 v171, v167
  s_nop 0
  v_permlane16_swap_b32 v164, v168
  v_permlane16_swap_b32 v165, v169
  v_permlane16_swap_b32 v166, v170
  v_permlane16_swap_b32 v167, v171
  v_add_f32 v164, v164, v168
  v_add_f32 v165, v165, v169
  v_add_f32 v166, v166, v170
  v_add_f32 v167, v167, v171
  v_mov_b32 v168, v164
  v_mov_b32 v169, v165
  v_mov_b32 v170, v166
  v_mov_b32 v171, v167
  s_nop 0
  v_permlane32_swap_b32 v164, v168
  v_permlane32_swap_b32 v165, v169
  v_permlane32_swap_b32 v166, v170
  v_permlane32_swap_b32 v167, v171
  v_add_f32 v164, v164, v168
  v_add_f32 v165, v165, v169
  v_add_f32 v166, v166, v170
  v_add_f32 v167, v167, v171
  v_and_b32 v14, 1, v4
  v_cmp_eq_u32 vcc, 1, v14
  v_lshlrev_b32 v14, 3, v5
  s_lshl_b32 s28, s51, 14
  s_lshl_b32 s29, s32, 7
  s_add_u32 s28, s28, s29
  s_add_u32 s28, s28, 37748736
  v_cndmask_b32 v164, v164, v166, vcc
  v_cndmask_b32 v165, v165, v167, vcc
  buffer_store_dwordx2 v[164:165], v14, s[8:11], s28 offen sc1
  s_lshr_b32 s47, s50, 1
  s_lshl_b32 s47, s47, 7
  s_and_b32 s29, s50, 1
  s_lshl_b32 s29, s29, 6
  s_add_u32 s47, s47, s29
  s_lshl_b32 s29, s51, 2
  s_add_u32 s47, s47, s29
  s_add_u32 s47, s47, 39855104
L_P4:
  s_lshl_b32 s28, s52, 7
  s_add_u32 s28, s28, 39855104
  v_lshlrev_b32 v132, 2, v5
  v_add_u32 v132, s28, v132
  s_mul_i32 s28, s53, 112
  s_add_u32 s29, s28, 111
  s_lshr_b32 s28, s28, 9
  s_lshr_b32 s29, s29, 9
  s_sub_u32 s29, s29, s28
  v_mul_u32_u24 v133, 7, v3
  v_and_b32 v252, 1, v4
  v_mul_u32_u24 v252, 112, v252
  v_mul_u32_u24 v253, s29, v6
  v_add3_u32 v133, v133, v252, v253
  v_add_u32 v133, s28, v133
  v_lshlrev_b32 v133, 2, v133
  v_add_u32 v133, 39854080, v133
  v_mov_b32 v136, 1
  v_mov_b32 v137, 0
  s_cmp_eq_u32 s5, 0
  s_cselect_b32 s47, s47, 2146435072
  s_waitcnt vmcnt(0)
  s_barrier
  buffer_store_dword v136, v137, s[8:11], s47 offen sc1
  s_add_u32 m0, s36, s37
  s_add_u32 s38, s36, s37
  buffer_load_dwordx4 v244, s[12:15], s35 offen offset:0 lds
  buffer_load_dwordx4 v245, s[12:15], s35 offen offset:1024 lds
  buffer_load_dwordx4 v246, s[12:15], s35 offen offset:2048 lds
  buffer_load_dwordx4 v247, s[12:15], s35 offen offset:3072 lds
  s_add_u32 m0, s38, 4096
  s_add_u32 s36, s36, 28672
  buffer_load_dwordx4 v248, s[12:15], s35 offen offset:0 lds
  buffer_load_dwordx4 v249, s[12:15], s35 offen offset:1024 lds
  buffer_load_dwordx4 v250, s[12:15], s35 offen offset:2048 lds
  s_cmp_ge_u32 s36, 114688
  s_cselect_b32 s36, 0, s36
  s_add_u32 s35, s35, 458752
  s_add_u32 m0, s36, s37
  s_add_u32 s38, s36, s37
  buffer_load_dwordx4 v244, s[12:15], s35 offen offset:0 lds
  buffer_load_dwordx4 v245, s[12:15], s35 offen offset:1024 lds
  buffer_load_dwordx4 v246, s[12:15], s35 offen offset:2048 lds
  buffer_load_dwordx4 v247, s[12:15], s35 offen offset:3072 lds
  s_add_u32 m0, s38, 4096
  s_add_u32 s36, s36, 28672
  buffer_load_dwordx4 v248, s[12:15], s35 offen offset:0 lds
  buffer_load_dwordx4 v249, s[12:15], s35 offen offset:1024 lds
  buffer_load_dwordx4 v250, s[12:15], s35 offen offset:2048 lds
  s_cmp_ge_u32 s36, 114688
  s_cselect_b32 s36, 0, s36
  s_add_u32 s35, s35, 458752
  s_add_u32 m0, s36, s37
  s_add_u32 s38, s36, s37
  buffer_load_dwordx4 v244, s[12:15], s35 offen offset:0 lds
  buffer_load_dwordx4 v245, s[12:15], s35 offen offset:1024 lds
  buffer_load_dwordx4 v246, s[12:15], s35 offen offset:2048 lds
  buffer_load_dwordx4 v247, s[12:15], s35 offen offset:3072 lds
  s_add_u32 m0, s38, 4096
  s_add_u32 s36, s36, 28672
  buffer_load_dwordx4 v248, s[12:15], s35 offen offset:0 lds
  buffer_load_dwordx4 v249, s[12:15], s35 offen offset:1024 lds
  buffer_load_dwordx4 v250, s[12:15], s35 offen offset:2048 lds
  s_cmp_ge_u32 s36, 114688
  s_cselect_b32 s36, 0, s36
  s_add_u32 s35, s35, 458752
  s_lshl_b32 s32, s52, 4
  s_lshl_b32 s28, s5, 2
  s_add_u32 s32, s32, s28
  s_lshl_b32 s33, s32, 15
  s_add_u32 s33, s33, 33554432
  v_mov_b32 v8, v2
  v_add_u32 v9, 32768, v2
  v_add_u32 v10, 65536, v2
  v_add_u32 v11, 98304, v2
  v_lshrrev_b32 v252, 2, v1
  v_and_b32 v252, 3, v252
  v_lshl_add_u32 v252, v4, 2, v252
  v_mul_u32_u24 v252, 224, v252
  v_and_b32 v253, 3, v1
  v_lshl_add_u32 v12, v253, 3, v252
  v_mov_b32 v20, 0
  v_mov_b32 v21, 0
  v_mov_b32 v22, 0
  v_mov_b32 v23, 0
  v_mov_b32 v24, 0
  v_mov_b32 v25, 0
  v_mov_b32 v26, 0
  v_mov_b32 v27, 0
  v_mov_b32 v28, 0
  v_mov_b32 v29, 0
  v_mov_b32 v30, 0
  v_mov_b32 v31, 0
  v_mov_b32 v32, 0
  v_mov_b32 v33, 0
  v_mov_b32 v34, 0
  v_mov_b32 v35, 0
  v_mov_b32 v36, 0
  v_mov_b32 v37, 0
  v_mov_b32 v38, 0
  v_mov_b32 v39, 0
  v_mov_b32 v40, 0
  v_mov_b32 v41, 0
  v_mov_b32 v42, 0
  v_mov_b32 v43, 0
  v_mov_b32 v44, 0
  v_mov_b32 v45, 0
  v_mov_b32 v46, 0
  v_mov_b32 v47, 0
  v_mov_b32 v48, 0
  v_mov_b32 v49, 0
  v_mov_b32 v50, 0
  v_mov_b32 v51, 0
  v_mov_b32 v52, 0
  v_mov_b32 v53, 0
  v_mov_b32 v54, 0
  v_mov_b32 v55, 0
  v_mov_b32 v56, 0
  v_mov_b32 v57, 0
  v_mov_b32 v58, 0
  v_mov_b32 v59, 0
  v_mov_b32 v60, 0
  v_mov_b32 v61, 0
  v_mov_b32 v62, 0
  v_mov_b32 v63, 0
  v_mov_b32 v64, 0
  v_mov_b32 v65, 0
  v_mov_b32 v66, 0
  v_mov_b32 v67, 0
  v_mov_b32 v68, 0
  v_mov_b32 v69, 0
  v_mov_b32 v70, 0
  v_mov_b32 v71, 0
  v_mov_b32 v72, 0
  v_mov_b32 v73, 0
  v_mov_b32 v74, 0
  v_mov_b32 v75, 0
  v_mov_b32 v76, 0
  v_mov_b32 v77, 0
  v_mov_b32 v78, 0
  v_mov_b32 v79, 0
  v_mov_b32 v80, 0
  v_mov_b32 v81, 0
  v_mov_b32 v82, 0
  v_mov_b32 v83, 0
  v_mov_b32 v84, 0
  v_mov_b32 v85, 0
  v_mov_b32 v86, 0
  v_mov_b32 v87, 0
  v_mov_b32 v88, 0
  v_mov_b32 v89, 0
  v_mov_b32 v90, 0
  v_mov_b32 v91, 0
  v_mov_b32 v92, 0
  v_mov_b32 v93, 0
  v_mov_b32 v94, 0
  v_mov_b32 v95, 0
  v_mov_b32 v96, 0
  v_mov_b32 v97, 0
  v_mov_b32 v98, 0
  v_mov_b32 v99, 0
  v_mov_b32 v100, 0
  v_mov_b32 v101, 0
  v_mov_b32 v102, 0
  v_mov_b32 v103, 0
  v_mov_b32 v104, 0
  v_mov_b32 v105, 0
  v_mov_b32 v106, 0
  v_mov_b32 v107, 0
  v_mov_b32 v108, 0
  v_mov_b32 v109, 0
  v_mov_b32 v110, 0
  v_mov_b32 v111, 0
  v_mov_b32 v112, 0
  v_mov_b32 v113, 0
  v_mov_b32 v114, 0
  v_mov_b32 v115, 0
  v_mov_b32 v116, 0
  v_mov_b32 v117, 0
  v_mov_b32 v118, 0
  v_mov_b32 v119, 0
  v_mov_b32 v120, 0
  v_mov_b32 v121, 0
  v_mov_b32 v122, 0
  v_mov_b32 v123, 0
  v_mov_b32 v124, 0
  v_mov_b32 v125, 0
  v_mov_b32 v126, 0
  v_mov_b32 v127, 0
  v_mov_b32 v128, 0
  v_mov_b32 v129, 0
  v_mov_b32 v130, 0
  v_mov_b32 v131, 0
  v_mov_b32 v140, 0
  v_mov_b32 v141, 0
  v_mov_b32 v142, 0
  v_mov_b32 v143, 0
  v_mov_b32 v144, 0
  v_mov_b32 v145, 0
  v_mov_b32 v146, 0
  v_mov_b32 v147, 0
  v_mov_b32 v148, 0
  v_mov_b32 v149, 0
  v_mov_b32 v150, 0
  v_mov_b32 v151, 0
  v_mov_b32 v152, 0
  v_mov_b32 v153, 0
  v_mov_b32 v154, 0
  v_mov_b32 v155, 0
  v_mov_b32 v156, 0
  v_mov_b32 v157, 0
  v_mov_b32 v158, 0
  v_mov_b32 v159, 0
  v_mov_b32 v160, 0
  v_mov_b32 v161, 0
  v_mov_b32 v162, 0
  v_mov_b32 v163, 0
  v_mov_b32 v164, 0
  v_mov_b32 v165, 0
  v_mov_b32 v166, 0
  v_mov_b32 v167, 0
  v_mov_b32 v168, 0
  v_mov_b32 v169, 0
  v_mov_b32 v170, 0
  v_mov_b32 v171, 0
  v_mov_b32 v172, 0
  v_mov_b32 v173, 0
  v_mov_b32 v174, 0
  v_mov_b32 v175, 0
  v_mov_b32 v176, 0
  v_mov_b32 v177, 0
  v_mov_b32 v178, 0
  v_mov_b32 v179, 0
  v_mov_b32 v180, 0
  v_mov_b32 v181, 0
  v_mov_b32 v182, 0
  v_mov_b32 v183, 0
  v_mov_b32 v184, 0
  v_mov_b32 v185, 0
  v_mov_b32 v186, 0
  v_mov_b32 v187, 0
  v_mov_b32 v188, 0
  v_mov_b32 v189, 0
  v_mov_b32 v190, 0
  v_mov_b32 v191, 0
  v_mov_b32 v192, 0
  v_mov_b32 v193, 0
  v_mov_b32 v194, 0
  v_mov_b32 v195, 0
  v_mov_b32 v196, 0
  v_mov_b32 v197, 0
  v_mov_b32 v198, 0
  v_mov_b32 v199, 0
  v_mov_b32 v200, 0
  v_mov_b32 v201, 0
  v_mov_b32 v202, 0
  v_mov_b32 v203, 0
  v_mov_b32 v204, 0
  v_mov_b32 v205, 0
  v_mov_b32 v206, 0
  v_mov_b32 v207, 0
  v_mov_b32 v208, 0
  v_mov_b32 v209, 0
  v_mov_b32 v210, 0
  v_mov_b32 v211, 0
  v_mov_b32 v212, 0
  v_mov_b32 v213, 0
  v_mov_b32 v214, 0
  v_mov_b32 v215, 0
  v_mov_b32 v216, 0
  v_mov_b32 v217, 0
  v_mov_b32 v218, 0
  v_mov_b32 v219, 0
  v_mov_b32 v220, 0
  v_mov_b32 v221, 0
  v_mov_b32 v222, 0
  v_mov_b32 v223, 0
  v_mov_b32 v224, 0
  v_mov_b32 v225, 0
  v_mov_b32 v226, 0
  v_mov_b32 v227, 0
  v_mov_b32 v228, 0
  v_mov_b32 v229, 0
  v_mov_b32 v230, 0
  v_mov_b32 v231, 0
  v_mov_b32 v232, 0
  v_mov_b32 v233, 0
  v_mov_b32 v234, 0
  v_mov_b32 v235, 0
  v_mov_b32 v236, 0
  v_mov_b32 v237, 0
  v_mov_b32 v238, 0
  v_mov_b32 v239, 0
  v_mov_b32 v240, 0
  v_mov_b32 v241, 0
  v_mov_b32 v242, 0
  v_mov_b32 v243, 0
  s_waitcnt vmcnt(14)
  s_cmp_lg_u32 s5, 0
  s_cbranch_scc1 L_p4_ok
  s_mov_b32 s26, 400000
L_p4_poll:
  buffer_load_dword v136, v132, s[8:11], 0 offen sc1
  buffer_load_dword v137, v133, s[8:11], 0 offen sc1
  s_waitcnt vmcnt(0)
  v_min_u32 v136, v136, v137
  v_cmp_eq_u32 vcc, 0, v136
  s_sub_u32 s26, s26, 1
  s_cselect_b32 s27, 0, vcc_lo
  s_cselect_b32 s28, 0, vcc_hi
  s_or_b32 s27, s27, s28
  s_cbranch_scc0 L_p4_ok
  s_sleep 1
  s_branch L_p4_poll
L_p4_ok:
  s_barrier
  buffer_load_dwordx4 a[112:115], v8, s[8:11], s33 offen offset:0 sc1
  buffer_load_dwordx4 a[116:119], v9, s[8:11], s33 offen offset:0 sc1
  buffer_load_dwordx4 a[120:123], v10, s[8:11], s33 offen offset:0 sc1
  buffer_load_dwordx4 a[124:127], v11, s[8:11], s33 offen offset:0 sc1
  s_add_u32 m0, s36, s37
  s_add_u32 s38, s36, s37
  buffer_load_dwordx4 v244, s[12:15], s35 offen offset:0 lds
  buffer_load_dwordx4 v245, s[12:15], s35 offen offset:1024 lds
  buffer_load_dwordx4 v246, s[12:15], s35 offen offset:2048 lds
  buffer_load_dwordx4 v247, s[12:15], s35 offen offset:3072 lds
  buffer_load_dwordx4 a[128:131], v8, s[8:11], s33 offen offset:1024 sc1
  buffer_load_dwordx4 a[132:135], v9, s[8:11], s33 offen offset:1024 sc1
  buffer_load_dwordx4 a[136:139], v10, s[8:11], s33 offen offset:1024 sc1
  buffer_load_dwordx4 a[140:143], v11, s[8:11], s33 offen offset:1024 sc1
  ds_read_b64_tr_b16 a[0:1], v12 offset:0
  ds_read_b64_tr_b16 a[2:3], v12 offset:3584
  ds_read_b64_tr_b16 a[4:5], v12 offset:32
  ds_read_b64_tr_b16 a[6:7], v12 offset:3616
  ds_read_b64_tr_b16 a[8:9], v12 offset:64
  ds_read_b64_tr_b16 a[10:11], v12 offset:3648
  ds_read_b64_tr_b16 a[12:13], v12 offset:96
  ds_read_b64_tr_b16 a[14:15], v12 offset:3680
  ds_read_b64_tr_b16 a[16:17], v12 offset:128
  ds_read_b64_tr_b16 a[18:19], v12 offset:3712
  ds_read_b64_tr_b16 a[20:21], v12 offset:160
  ds_read_b64_tr_b16 a[22:23], v12 offset:3744
  ds_read_b64_tr_b16 a[24:25], v12 offset:192
  ds_read_b64_tr_b16 a[26:27], v12 offset:3776
  ds_read_b64_tr_b16 a[28:29], v12 offset:14336
  ds_read_b64_tr_b16 a[30:31], v12 offset:17920
  ds_read_b64_tr_b16 a[32:33], v12 offset:14368
  ds_read_b64_tr_b16 a[34:35], v12 offset:17952
  ds_read_b64_tr_b16 a[36:37], v12 offset:14400
  ds_read_b64_tr_b16 a[38:39], v12 offset:17984
  ds_read_b64_tr_b16 a[40:41], v12 offset:14432
  ds_read_b64_tr_b16 a[42:43], v12 offset:18016
  ds_read_b64_tr_b16 a[44:45], v12 offset:14464
  ds_read_b64_tr_b16 a[46:47], v12 offset:18048
  ds_read_b64_tr_b16 a[48:49], v12 offset:14496
  ds_read_b64_tr_b16 a[50:51], v12 offset:18080
  ds_read_b64_tr_b16 a[52:53], v12 offset:14528
  ds_read_b64_tr_b16 a[54:55], v12 offset:18112
  buffer_load_dwordx4 a[144:147], v8, s[8:11], s33 offen offset:2048 sc1
  buffer_load_dwordx4 a[148:151], v9, s[8:11], s33 offen offset:2048 sc1
  buffer_load_dwordx4 a[152:155], v10, s[8:11], s33 offen offset:2048 sc1
  buffer_load_dwordx4 a[156:159], v11, s[8:11], s33 offen offset:2048 sc1
  v_mov_b32 v132, 0
  v_mov_b32 v133, 0
  v_mov_b32 v134, 0
  v_mov_b32 v135, 0
  v_mov_b32 v136, 0
  v_mov_b32 v137, 0
  v_mov_b32 v138, 0
  v_mov_b32 v139, 0
  s_waitcnt vmcnt(12) lgkmcnt(0)
  v_mfma_f32_16x16x32_bf16 v[20:23], a[0:3], a[112:115], v[20:23]
  buffer_load_dwordx4 a[160:163], v8, s[8:11], s33 offen offset:3072 sc1
  v_mfma_f32_16x16x32_bf16 v[76:79], a[0:3], a[116:119], v[76:79]
  v_mfma_f32_16x16x32_bf16 v[132:135], a[0:3], a[120:123], v[132:135]
  ds_read_b64_tr_b16 a[56:57], v12 offset:7168
  v_mfma_f32_16x16x32_bf16 v[188:191], a[0:3], a[124:127], v[188:191]
  ds_read_b64_tr_b16 a[58:59], v12 offset:10752
  v_mfma_f32_16x16x32_bf16 v[192:195], a[4:7], a[124:127], v[192:195]
  ds_read_b64_tr_b16 a[60:61], v12 offset:7200
  v_mfma_f32_16x16x32_bf16 v[136:139], a[4:7], a[120:123], v[136:139]
  ds_read_b64_tr_b16 a[62:63], v12 offset:10784
  v_mfma_f32_16x16x32_bf16 v[80:83], a[4:7], a[116:119], v[80:83]
  ds_read_b64_tr_b16 a[64:65], v12 offset:7232
  v_mfma_f32_16x16x32_bf16 v[24:27], a[4:7], a[112:115], v[24:27]
  buffer_load_dwordx4 a[164:167], v9, s[8:11], s33 offen offset:3072 sc1
  v_mfma_f32_16x16x32_bf16 v[28:31], a[8:11], a[112:115], v[28:31]
  v_mfma_f32_16x16x32_bf16 v[84:87], a[8:11], a[116:119], v[84:87]
  ds_read_b64_tr_b16 a[66:67], v12 offset:10816
  v_mfma_f32_16x16x32_bf16 v[140:143], a[8:11], a[120:123], v[140:143]
  ds_read_b64_tr_b16 a[68:69], v12 offset:7264
  v_mfma_f32_16x16x32_bf16 v[196:199], a[8:11], a[124:127], v[196:199]
  ds_read_b64_tr_b16 a[70:71], v12 offset:10848
  v_mfma_f32_16x16x32_bf16 v[200:203], a[12:15], a[124:127], v[200:203]
  ds_read_b64_tr_b16 a[72:73], v12 offset:7296
  v_mfma_f32_16x16x32_bf16 v[144:147], a[12:15], a[120:123], v[144:147]
  buffer_load_dwordx4 a[168:171], v10, s[8:11], s33 offen offset:3072 sc1
  v_mfma_f32_16x16x32_bf16 v[88:91], a[12:15], a[116:119], v[88:91]
  v_mfma_f32_16x16x32_bf16 v[32:35], a[12:15], a[112:115], v[32:35]
  ds_read_b64_tr_b16 a[74:75], v12 offset:10880
  v_mfma_f32_16x16x32_bf16 v[36:39], a[16:19], a[112:115], v[36:39]
  ds_read_b64_tr_b16 a[76:77], v12 offset:7328
  v_mfma_f32_16x16x32_bf16 v[92:95], a[16:19], a[116:119], v[92:95]
  ds_read_b64_tr_b16 a[78:79], v12 offset:10912
  v_mfma_f32_16x16x32_bf16 v[148:151], a[16:19], a[120:123], v[148:151]
  ds_read_b64_tr_b16 a[80:81], v12 offset:7360
  v_mfma_f32_16x16x32_bf16 v[204:207], a[16:19], a[124:127], v[204:207]
  buffer_load_dwordx4 a[172:175], v11, s[8:11], s33 offen offset:3072 sc1
  v_mfma_f32_16x16x32_bf16 v[208:211], a[20:23], a[124:127], v[208:211]
  v_mfma_f32_16x16x32_bf16 v[152:155], a[20:23], a[120:123], v[152:155]
  ds_read_b64_tr_b16 a[82:83], v12 offset:10944
  s_add_u32 m0, s38, 4096
  v_mfma_f32_16x16x32_bf16 v[96:99], a[20:23], a[116:119], v[96:99]
  ds_read_b64_tr_b16 a[84:85], v12 offset:21504
  s_add_u32 s36, s36, 28672
  v_mfma_f32_16x16x32_bf16 v[40:43], a[20:23], a[112:115], v[40:43]
  ds_read_b64_tr_b16 a[86:87], v12 offset:25088
  v_mfma_f32_16x16x32_bf16 v[44:47], a[24:27], a[112:115], v[44:47]
  ds_read_b64_tr_b16 a[88:89], v12 offset:21536
  v_mfma_f32_16x16x32_bf16 v[100:103], a[24:27], a[116:119], v[100:103]
  ds_read_b64_tr_b16 a[90:91], v12 offset:25120
  v_mfma_f32_16x16x32_bf16 v[156:159], a[24:27], a[120:123], v[156:159]
  buffer_load_dwordx4 v248, s[12:15], s35 offen offset:0 lds
  v_mfma_f32_16x16x32_bf16 v[212:215], a[24:27], a[124:127], v[212:215]
  v_mfma_f32_16x16x32_bf16 v[216:219], a[28:31], a[124:127], v[216:219]
  ds_read_b64_tr_b16 a[92:93], v12 offset:21568
  v_mfma_f32_16x16x32_bf16 v[160:163], a[28:31], a[120:123], v[160:163]
  ds_read_b64_tr_b16 a[94:95], v12 offset:25152
  v_mfma_f32_16x16x32_bf16 v[104:107], a[28:31], a[116:119], v[104:107]
  ds_read_b64_tr_b16 a[96:97], v12 offset:21600
  v_mfma_f32_16x16x32_bf16 v[48:51], a[28:31], a[112:115], v[48:51]
  ds_read_b64_tr_b16 a[98:99], v12 offset:25184
  v_mfma_f32_16x16x32_bf16 v[52:55], a[32:35], a[112:115], v[52:55]
  buffer_load_dwordx4 v249, s[12:15], s35 offen offset:1024 lds
  v_mfma_f32_16x16x32_bf16 v[108:111], a[32:35], a[116:119], v[108:111]
  v_mfma_f32_16x16x32_bf16 v[164:167], a[32:35], a[120:123], v[164:167]
  ds_read_b64_tr_b16 a[100:101], v12 offset:21632
  v_mfma_f32_16x16x32_bf16 v[220:223], a[32:35], a[124:127], v[220:223]
  ds_read_b64_tr_b16 a[102:103], v12 offset:25216
  v_mfma_f32_16x16x32_bf16 v[224:227], a[36:39], a[124:127], v[224:227]
  ds_read_b64_tr_b16 a[104:105], v12 offset:21664
  v_mfma_f32_16x16x32_bf16 v[168:171], a[36:39], a[120:123], v[168:171]
  ds_read_b64_tr_b16 a[106:107], v12 offset:25248
  v_mfma_f32_16x16x32_bf16 v[112:115], a[36:39], a[116:119], v[112:115]
  buffer_load_dwordx4 v250, s[12:15], s35 offen offset:2048 lds
  v_mfma_f32_16x16x32_bf16 v[56:59], a[36:39], a[112:115], v[56:59]
  v_mfma_f32_16x16x32_bf16 v[60:63], a[40:43], a[112:115], v[60:63]
  ds_read_b64_tr_b16 a[108:109], v12 offset:21696
  s_cmp_ge_u32 s36, 114688
  s_cselect_b32 s36, 0, s36
  v_mfma_f32_16x16x32_bf16 v[116:119], a[40:43], a[116:119], v[116:119]
  ds_read_b64_tr_b16 a[110:111], v12 offset:25280
  s_add_u32 s35, s35, 458752
  v_mfma_f32_16x16x32_bf16 v[172:175], a[40:43], a[120:123], v[172:175]
  v_mfma_f32_16x16x32_bf16 v[228:231], a[40:43], a[124:127], v[228:231]
  v_mfma_f32_16x16x32_bf16 v[232:235], a[44:47], a[124:127], v[232:235]
  v_mfma_f32_16x16x32_bf16 v[176:179], a[44:47], a[120:123], v[176:179]
  v_mfma_f32_16x16x32_bf16 v[120:123], a[44:47], a[116:119], v[120:123]
  v_mfma_f32_16x16x32_bf16 v[64:67], a[44:47], a[112:115], v[64:67]
  v_mfma_f32_16x16x32_bf16 v[68:71], a[48:51], a[112:115], v[68:71]
  v_mfma_f32_16x16x32_bf16 v[124:127], a[48:51], a[116:119], v[124:127]
  v_mfma_f32_16x16x32_bf16 v[180:183], a[48:51], a[120:123], v[180:183]
  s_add_u32 s44, s39, 28672
  v_mfma_f32_16x16x32_bf16 v[236:239], a[48:51], a[124:127], v[236:239]
  s_cmp_ge_u32 s44, 114688
  s_cselect_b32 s44, 0, s44
  v_mfma_f32_16x16x32_bf16 v[240:243], a[52:55], a[124:127], v[240:243]
  s_sub_u32 s45, s44, s39
  v_mfma_f32_16x16x32_bf16 v[184:187], a[52:55], a[120:123], v[184:187]
  s_mov_b32 s39, s44
  v_mfma_f32_16x16x32_bf16 v[128:131], a[52:55], a[116:119], v[128:131]
  v_add_u32 v12, s45, v12
  v_mfma_f32_16x16x32_bf16 v[72:75], a[52:55], a[112:115], v[72:75]
  s_waitcnt vmcnt(11) lgkmcnt(0)
  s_barrier
  v_mfma_f32_16x16x32_bf16 v[20:23], a[56:59], a[128:131], v[20:23]
  ds_read_b64_tr_b16 a[0:1], v12 offset:0
  s_add_u32 s33, s33, 4096
  v_mfma_f32_16x16x32_bf16 v[76:79], a[56:59], a[132:135], v[76:79]
  buffer_load_dwordx4 a[112:115], v8, s[8:11], s33 offen offset:0 sc1
  v_mfma_f32_16x16x32_bf16 v[132:135], a[56:59], a[136:139], v[132:135]
  v_mfma_f32_16x16x32_bf16 v[188:191], a[56:59], a[140:143], v[188:191]
  ds_read_b64_tr_b16 a[2:3], v12 offset:3584
  v_mfma_f32_16x16x32_bf16 v[192:195], a[60:63], a[140:143], v[192:195]
  ds_read_b64_tr_b16 a[4:5], v12 offset:32
  v_mfma_f32_16x16x32_bf16 v[136:139], a[60:63], a[136:139], v[136:139]
  ds_read_b64_tr_b16 a[6:7], v12 offset:3616
  v_mfma_f32_16x16x32_bf16 v[80:83], a[60:63], a[132:135], v[80:83]
  buffer_load_dwordx4 a[116:119], v9, s[8:11], s33 offen offset:0 sc1
  v_mfma_f32_16x16x32_bf16 v[24:27], a[60:63], a[128:131], v[24:27]
  v_mfma_f32_16x16x32_bf16 v[28:31], a[64:67], a[128:131], v[28:31]
  ds_read_b64_tr_b16 a[8:9], v12 offset:64
  v_mfma_f32_16x16x32_bf16 v[84:87], a[64:67], a[132:135], v[84:87]
  ds_read_b64_tr_b16 a[10:11], v12 offset:3648
  v_mfma_f32_16x16x32_bf16 v[140:143], a[64:67], a[136:139], v[140:143]
  ds_read_b64_tr_b16 a[12:13], v12 offset:96
  v_mfma_f32_16x16x32_bf16 v[196:199], a[64:67], a[140:143], v[196:199]
  buffer_load_dwordx4 a[120:123], v10, s[8:11], s33 offen offset:0 sc1
  v_mfma_f32_16x16x32_bf16 v[200:203], a[68:71], a[140:143], v[200:203]
  v_mfma_f32_16x16x32_bf16 v[144:147], a[68:71], a[136:139], v[144:147]
  ds_read_b64_tr_b16 a[14:15], v12 offset:3680
  v_mfma_f32_16x16x32_bf16 v[88:91], a[68:71], a[132:135], v[88:91]
  ds_read_b64_tr_b16 a[16:17], v12 offset:128
  v_mfma_f32_16x16x32_bf16 v[32:35], a[68:71], a[128:131], v[32:35]
  ds_read_b64_tr_b16 a[18:19], v12 offset:3712
  v_mfma_f32_16x16x32_bf16 v[36:39], a[72:75], a[128:131], v[36:39]
  ds_read_b64_tr_b16 a[20:21], v12 offset:160
  v_mfma_f32_16x16x32_bf16 v[92:95], a[72:75], a[132:135], v[92:95]
  buffer_load_dwordx4 a[124:127], v11, s[8:11], s33 offen offset:0 sc1
  v_mfma_f32_16x16x32_bf16 v[148:151], a[72:75], a[136:139], v[148:151]
  v_mfma_f32_16x16x32_bf16 v[204:207], a[72:75], a[140:143], v[204:207]
  ds_read_b64_tr_b16 a[22:23], v12 offset:3744
  s_add_u32 m0, s36, s37
  v_mfma_f32_16x16x32_bf16 v[208:211], a[76:79], a[140:143], v[208:211]
  ds_read_b64_tr_b16 a[24:25], v12 offset:192
  s_add_u32 s38, s36, s37
  v_mfma_f32_16x16x32_bf16 v[152:155], a[76:79], a[136:139], v[152:155]
  ds_read_b64_tr_b16 a[26:27], v12 offset:3776
  v_mfma_f32_16x16x32_bf16 v[96:99], a[76:79], a[132:135], v[96:99]
  buffer_load_dwordx4 v244, s[12:15], s35 offen offset:0 lds
  v_mfma_f32_16x16x32_bf16 v[40:43], a[76:79], a[128:131], v[40:43]
  v_mfma_f32_16x16x32_bf16 v[44:47], a[80:83], a[128:131], v[44:47]
  ds_read_b64_tr_b16 a[28:29], v12 offset:14336
  v_mfma_f32_16x16x32_bf16 v[100:103], a[80:83], a[132:135], v[100:103]
  ds_read_b64_tr_b16 a[30:31], v12 offset:17920
  v_mfma_f32_16x16x32_bf16 v[156:159], a[80:83], a[136:139], v[156:159]
  ds_read_b64_tr_b16 a[32:33], v12 offset:14368
  v_mfma_f32_16x16x32_bf16 v[212:215], a[80:83], a[140:143], v[212:215]
  ds_read_b64_tr_b16 a[34:35], v12 offset:17952
  v_mfma_f32_16x16x32_bf16 v[216:219], a[84:87], a[140:143], v[216:219]
  buffer_load_dwordx4 v245, s[12:15], s35 offen offset:1024 lds
  v_mfma_f32_16x16x32_bf16 v[160:163], a[84:87], a[136:139], v[160:163]
  v_mfma_f32_16x16x32_bf16 v[104:107], a[84:87], a[132:135], v[104:107]
  ds_read_b64_tr_b16 a[36:37], v12 offset:14400
  v_mfma_f32_16x16x32_bf16 v[48:51], a[84:87], a[128:131], v[48:51]
  ds_read_b64_tr_b16 a[38:39], v12 offset:17984
  v_mfma_f32_16x16x32_bf16 v[52:55], a[88:91], a[128:131], v[52:55]
  ds_read_b64_tr_b16 a[40:41], v12 offset:14432
  v_mfma_f32_16x16x32_bf16 v[108:111], a[88:91], a[132:135], v[108:111]
  buffer_load_dwordx4 v246, s[12:15], s35 offen offset:2048 lds
  v_mfma_f32_16x16x32_bf16 v[164:167], a[88:91], a[136:139], v[164:167]
  v_mfma_f32_16x16x32_bf16 v[220:223], a[88:91], a[140:143], v[220:223]
  ds_read_b64_tr_b16 a[42:43], v12 offset:18016
  v_mfma_f32_16x16x32_bf16 v[224:227], a[92:95], a[140:143], v[224:227]
  ds_read_b64_tr_b16 a[44:45], v12 offset:14464
  v_mfma_f32_16x16x32_bf16 v[168:171], a[92:95], a[136:139], v[168:171]
  ds_read_b64_tr_b16 a[46:47], v12 offset:18048
  v_mfma_f32_16x16x32_bf16 v[112:115], a[92:95], a[132:135], v[112:115]
  ds_read_b64_tr_b16 a[48:49], v12 offset:14496
  v_mfma_f32_16x16x32_bf16 v[56:59], a[92:95], a[128:131], v[56:59]
  buffer_load_dwordx4 v247, s[12:15], s35 offen offset:3072 lds
  v_mfma_f32_16x16x32_bf16 v[60:63], a[96:99], a[128:131], v[60:63]
  v_mfma_f32_16x16x32_bf16 v[116:119], a[96:99], a[132:135], v[116:119]
  ds_read_b64_tr_b16 a[50:51], v12 offset:18080
  v_mfma_f32_16x16x32_bf16 v[172:175], a[96:99], a[136:139], v[172:175]
  ds_read_b64_tr_b16 a[52:53], v12 offset:14528
  v_mfma_f32_16x16x32_bf16 v[228:231], a[96:99], a[140:143], v[228:231]
  ds_read_b64_tr_b16 a[54:55], v12 offset:18112
  v_mfma_f32_16x16x32_bf16 v[232:235], a[100:103], a[140:143], v[232:235]
  v_mfma_f32_16x16x32_bf16 v[176:179], a[100:103], a[136:139], v[176:179]
  v_mfma_f32_16x16x32_bf16 v[120:123], a[100:103], a[132:135], v[120:123]
  v_mfma_f32_16x16x32_bf16 v[64:67], a[100:103], a[128:131], v[64:67]
  v_mfma_f32_16x16x32_bf16 v[68:71], a[104:107], a[128:131], v[68:71]
  v_mfma_f32_16x16x32_bf16 v[124:127], a[104:107], a[132:135], v[124:127]
  v_mfma_f32_16x16x32_bf16 v[180:183], a[104:107], a[136:139], v[180:183]
  v_mfma_f32_16x16x32_bf16 v[236:239], a[104:107], a[140:143], v[236:239]
  v_mfma_f32_16x16x32_bf16 v[240:243], a[108:111], a[140:143], v[240:243]
  v_mfma_f32_16x16x32_bf16 v[184:187], a[108:111], a[136:139], v[184:187]
  v_mfma_f32_16x16x32_bf16 v[128:131], a[108:111], a[132:135], v[128:131]
  v_mfma_f32_16x16x32_bf16 v[72:75], a[108:111], a[128:131], v[72:75]
  s_waitcnt vmcnt(15) lgkmcnt(0)
  v_mfma_f32_16x16x32_bf16 v[20:23], a[0:3], a[144:147], v[20:23]
  buffer_load_dwordx4 a[128:131], v8, s[8:11], s33 offen offset:1024 sc1
  v_mfma_f32_16x16x32_bf16 v[76:79], a[0:3], a[148:151], v[76:79]
  v_mfma_f32_16x16x32_bf16 v[132:135], a[0:3], a[152:155], v[132:135]
  ds_read_b64_tr_b16 a[56:57], v12 offset:7168
  v_mfma_f32_16x16x32_bf16 v[188:191], a[0:3], a[156:159], v[188:191]
  ds_read_b64_tr_b16 a[58:59], v12 offset:10752
  v_mfma_f32_16x16x32_bf16 v[192:195], a[4:7], a[156:159], v[192:195]
  ds_read_b64_tr_b16 a[60:61], v12 offset:7200
  v_mfma_f32_16x16x32_bf16 v[136:139], a[4:7], a[152:155], v[136:139]
  ds_read_b64_tr_b16 a[62:63], v12 offset:10784
  v_mfma_f32_16x16x32_bf16 v[80:83], a[4:7], a[148:151], v[80:83]
  ds_read_b64_tr_b16 a[64:65], v12 offset:7232
  v_mfma_f32_16x16x32_bf16 v[24:27], a[4:7], a[144:147], v[24:27]
  buffer_load_dwordx4 a[132:135], v9, s[8:11], s33 offen offset:1024 sc1
  v_mfma_f32_16x16x32_bf16 v[28:31], a[8:11], a[144:147], v[28:31]
  v_mfma_f32_16x16x32_bf16 v[84:87], a[8:11], a[148:151], v[84:87]
  ds_read_b64_tr_b16 a[66:67], v12 offset:10816
  v_mfma_f32_16x16x32_bf16 v[140:143], a[8:11], a[152:155], v[140:143]
  ds_read_b64_tr_b16 a[68:69], v12 offset:7264
  v_mfma_f32_16x16x32_bf16 v[196:199], a[8:11], a[156:159], v[196:199]
  ds_read_b64_tr_b16 a[70:71], v12 offset:10848
  v_mfma_f32_16x16x32_bf16 v[200:203], a[12:15], a[156:159], v[200:203]
  ds_read_b64_tr_b16 a[72:73], v12 offset:7296
  v_mfma_f32_16x16x32_bf16 v[144:147], a[12:15], a[152:155], v[144:147]
  buffer_load_dwordx4 a[136:139], v10, s[8:11], s33 offen offset:1024 sc1
  v_mfma_f32_16x16x32_bf16 v[88:91], a[12:15], a[148:151], v[88:91]
  v_mfma_f32_16x16x32_bf16 v[32:35], a[12:15], a[144:147], v[32:35]
  ds_read_b64_tr_b16 a[74:75], v12 offset:10880
  v_mfma_f32_16x16x32_bf16 v[36:39], a[16:19], a[144:147], v[36:39]
  ds_read_b64_tr_b16 a[76:77], v12 offset:7328
  v_mfma_f32_16x16x32_bf16 v[92:95], a[16:19], a[148:151], v[92:95]
  ds_read_b64_tr_b16 a[78:79], v12 offset:10912
  v_mfma_f32_16x16x32_bf16 v[148:151], a[16:19], a[152:155], v[148:151]
  ds_read_b64_tr_b16 a[80:81], v12 offset:7360
  v_mfma_f32_16x16x32_bf16 v[204:207], a[16:19], a[156:159], v[204:207]
  buffer_load_dwordx4 a[140:143], v11, s[8:11], s33 offen offset:1024 sc1
  v_mfma_f32_16x16x32_bf16 v[208:211], a[20:23], a[156:159], v[208:211]
  v_mfma_f32_16x16x32_bf16 v[152:155], a[20:23], a[152:155], v[152:155]
  ds_read_b64_tr_b16 a[82:83], v12 offset:10944
  s_add_u32 m0, s38, 4096
  v_mfma_f32_16x16x32_bf16 v[96:99], a[20:23], a[148:151], v[96:99]
  ds_read_b64_tr_b16 a[84:85], v12 offset:21504
  s_add_u32 s36, s36, 28672
  v_mfma_f32_16x16x32_bf16 v[40:43], a[20:23], a[144:147], v[40:43]
  ds_read_b64_tr_b16 a[86:87], v12 offset:25088
  v_mfma_f32_16x16x32_bf16 v[44:47], a[24:27], a[144:147], v[44:47]
  ds_read_b64_tr_b16 a[88:89], v12 offset:21536
  v_mfma_f32_16x16x32_bf16 v[100:103], a[24:27], a[148:151], v[100:103]
  ds_read_b64_tr_b16 a[90:91], v12 offset:25120
  v_mfma_f32_16x16x32_bf16 v[156:159], a[24:27], a[152:155], v[156:159]
  buffer_load_dwordx4 v248, s[12:15], s35 offen offset:0 lds
  v_mfma_f32_16x16x32_bf16 v[212:215], a[24:27], a[156:159], v[212:215]
  v_mfma_f32_16x16x32_bf16 v[216:219], a[28:31], a[156:159], v[216:219]
  ds_read_b64_tr_b16 a[92:93], v12 offset:21568
  v_mfma_f32_16x16x32_bf16 v[160:163], a[28:31], a[152:155], v[160:163]
  ds_read_b64_tr_b16 a[94:95], v12 offset:25152
  v_mfma_f32_16x16x32_bf16 v[104:107], a[28:31], a[148:151], v[104:107]
  ds_read_b64_tr_b16 a[96:97], v12 offset:21600
  v_mfma_f32_16x16x32_bf16 v[48:51], a[28:31], a[144:147], v[48:51]
  ds_read_b64_tr_b16 a[98:99], v12 offset:25184
  v_mfma_f32_16x16x32_bf16 v[52:55], a[32:35], a[144:147], v[52:55]
  buffer_load_dwordx4 v249, s[12:15], s35 offen offset:1024 lds
  v_mfma_f32_16x16x32_bf16 v[108:111], a[32:35], a[148:151], v[108:111]
  v_mfma_f32_16x16x32_bf16 v[164:167], a[32:35], a[152:155], v[164:167]
  ds_read_b64_tr_b16 a[100:101], v12 offset:21632
  v_mfma_f32_16x16x32_bf16 v[220:223], a[32:35], a[156:159], v[220:223]
  ds_read_b64_tr_b16 a[102:103], v12 offset:25216
  v_mfma_f32_16x16x32_bf16 v[224:227], a[36:39], a[156:159], v[224:227]
  ds_read_b64_tr_b16 a[104:105], v12 offset:21664
  v_mfma_f32_16x16x32_bf16 v[168:171], a[36:39], a[152:155], v[168:171]
  ds_read_b64_tr_b16 a[106:107], v12 offset:25248
  v_mfma_f32_16x16x32_bf16 v[112:115], a[36:39], a[148:151], v[112:115]
  buffer_load_dwordx4 v250, s[12:15], s35 offen offset:2048 lds
  v_mfma_f32_16x16x32_bf16 v[56:59], a[36:39], a[144:147], v[56:59]
  v_mfma_f32_16x16x32_bf16 v[60:63], a[40:43], a[144:147], v[60:63]
  ds_read_b64_tr_b16 a[108:109], v12 offset:21696
  s_cmp_ge_u32 s36, 114688
  s_cselect_b32 s36, 0, s36
  v_mfma_f32_16x16x32_bf16 v[116:119], a[40:43], a[148:151], v[116:119]
  ds_read_b64_tr_b16 a[110:111], v12 offset:25280
  s_add_u32 s35, s35, 458752
  v_mfma_f32_16x16x32_bf16 v[172:175], a[40:43], a[152:155], v[172:175]
  v_mfma_f32_16x16x32_bf16 v[228:231], a[40:43], a[156:159], v[228:231]
  v_mfma_f32_16x16x32_bf16 v[232:235], a[44:47], a[156:159], v[232:235]
  v_mfma_f32_16x16x32_bf16 v[176:179], a[44:47], a[152:155], v[176:179]
  v_mfma_f32_16x16x32_bf16 v[120:123], a[44:47], a[148:151], v[120:123]
  v_mfma_f32_16x16x32_bf16 v[64:67], a[44:47], a[144:147], v[64:67]
  v_mfma_f32_16x16x32_bf16 v[68:71], a[48:51], a[144:147], v[68:71]
  v_mfma_f32_16x16x32_bf16 v[124:127], a[48:51], a[148:151], v[124:127]
  v_mfma_f32_16x16x32_bf16 v[180:183], a[48:51], a[152:155], v[180:183]
  s_add_u32 s44, s39, 28672
  v_mfma_f32_16x16x32_bf16 v[236:239], a[48:51], a[156:159], v[236:239]
  s_cmp_ge_u32 s44, 114688
  s_cselect_b32 s44, 0, s44
  v_mfma_f32_16x16x32_bf16 v[240:243], a[52:55], a[156:159], v[240:243]
  s_sub_u32 s45, s44, s39
  v_mfma_f32_16x16x32_bf16 v[184:187], a[52:55], a[152:155], v[184:187]
  s_mov_b32 s39, s44
  v_mfma_f32_16x16x32_bf16 v[128:131], a[52:55], a[148:151], v[128:131]
  v_add_u32 v12, s45, v12
  v_mfma_f32_16x16x32_bf16 v[72:75], a[52:55], a[144:147], v[72:75]
  s_waitcnt vmcnt(18) lgkmcnt(0)
  s_barrier
  v_mfma_f32_16x16x32_bf16 v[20:23], a[56:59], a[160:163], v[20:23]
  buffer_load_dwordx4 a[144:147], v8, s[8:11], s33 offen offset:2048 sc1
  v_mfma_f32_16x16x32_bf16 v[76:79], a[56:59], a[164:167], v[76:79]
  v_mfma_f32_16x16x32_bf16 v[132:135], a[56:59], a[168:171], v[132:135]
  ds_read_b64_tr_b16 a[0:1], v12 offset:0
  v_mfma_f32_16x16x32_bf16 v[188:191], a[56:59], a[172:175], v[188:191]
  ds_read_b64_tr_b16 a[2:3], v12 offset:3584
  v_mfma_f32_16x16x32_bf16 v[192:195], a[60:63], a[172:175], v[192:195]
  ds_read_b64_tr_b16 a[4:5], v12 offset:32
  v_mfma_f32_16x16x32_bf16 v[136:139], a[60:63], a[168:171], v[136:139]
  ds_read_b64_tr_b16 a[6:7], v12 offset:3616
  v_mfma_f32_16x16x32_bf16 v[80:83], a[60:63], a[164:167], v[80:83]
  buffer_load_dwordx4 a[148:151], v9, s[8:11], s33 offen offset:2048 sc1
  v_mfma_f32_16x16x32_bf16 v[24:27], a[60:63], a[160:163], v[24:27]
  v_mfma_f32_16x16x32_bf16 v[28:31], a[64:67], a[160:163], v[28:31]
  ds_read_b64_tr_b16 a[8:9], v12 offset:64
  v_mfma_f32_16x16x32_bf16 v[84:87], a[64:67], a[164:167], v[84:87]
  ds_read_b64_tr_b16 a[10:11], v12 offset:3648
  v_mfma_f32_16x16x32_bf16 v[140:143], a[64:67], a[168:171], v[140:143]
  ds_read_b64_tr_b16 a[12:13], v12 offset:96
  v_mfma_f32_16x16x32_bf16 v[196:199], a[64:67], a[172:175], v[196:199]
  buffer_load_dwordx4 a[152:155], v10, s[8:11], s33 offen offset:2048 sc1
  v_mfma_f32_16x16x32_bf16 v[200:203], a[68:71], a[172:175], v[200:203]
  v_mfma_f32_16x16x32_bf16 v[144:147], a[68:71], a[168:171], v[144:147]
  ds_read_b64_tr_b16 a[14:15], v12 offset:3680
  v_mfma_f32_16x16x32_bf16 v[88:91], a[68:71], a[164:167], v[88:91]
  ds_read_b64_tr_b16 a[16:17], v12 offset:128
  v_mfma_f32_16x16x32_bf16 v[32:35], a[68:71], a[160:163], v[32:35]
  ds_read_b64_tr_b16 a[18:19], v12 offset:3712
  v_mfma_f32_16x16x32_bf16 v[36:39], a[72:75], a[160:163], v[36:39]
  ds_read_b64_tr_b16 a[20:21], v12 offset:160
  v_mfma_f32_16x16x32_bf16 v[92:95], a[72:75], a[164:167], v[92:95]
  buffer_load_dwordx4 a[156:159], v11, s[8:11], s33 offen offset:2048 sc1
  v_mfma_f32_16x16x32_bf16 v[148:151], a[72:75], a[168:171], v[148:151]
  v_mfma_f32_16x16x32_bf16 v[204:207], a[72:75], a[172:175], v[204:207]
  ds_read_b64_tr_b16 a[22:23], v12 offset:3744
  s_add_u32 m0, s36, s37
  v_mfma_f32_16x16x32_bf16 v[208:211], a[76:79], a[172:175], v[208:211]
  ds_read_b64_tr_b16 a[24:25], v12 offset:192
  s_add_u32 s38, s36, s37
  v_mfma_f32_16x16x32_bf16 v[152:155], a[76:79], a[168:171], v[152:155]
  ds_read_b64_tr_b16 a[26:27], v12 offset:3776
  v_mfma_f32_16x16x32_bf16 v[96:99], a[76:79], a[164:167], v[96:99]
  buffer_load_dwordx4 v244, s[12:15], s35 offen offset:0 lds
  v_mfma_f32_16x16x32_bf16 v[40:43], a[76:79], a[160:163], v[40:43]
  v_mfma_f32_16x16x32_bf16 v[44:47], a[80:83], a[160:163], v[44:47]
  ds_read_b64_tr_b16 a[28:29], v12 offset:14336
  v_mfma_f32_16x16x32_bf16 v[100:103], a[80:83], a[164:167], v[100:103]
  ds_read_b64_tr_b16 a[30:31], v12 offset:17920
  v_mfma_f32_16x16x32_bf16 v[156:159], a[80:83], a[168:171], v[156:159]
  ds_read_b64_tr_b16 a[32:33], v12 offset:14368
  v_mfma_f32_16x16x32_bf16 v[212:215], a[80:83], a[172:175], v[212:215]
  ds_read_b64_tr_b16 a[34:35], v12 offset:17952
  v_mfma_f32_16x16x32_bf16 v[216:219], a[84:87], a[172:175], v[216:219]
  buffer_load_dwordx4 v245, s[12:15], s35 offen offset:1024 lds
  v_mfma_f32_16x16x32_bf16 v[160:163], a[84:87], a[168:171], v[160:163]
  v_mfma_f32_16x16x32_bf16 v[104:107], a[84:87], a[164:167], v[104:107]
  ds_read_b64_tr_b16 a[36:37], v12 offset:14400
  v_mfma_f32_16x16x32_bf16 v[48:51], a[84:87], a[160:163], v[48:51]
  ds_read_b64_tr_b16 a[38:39], v12 offset:17984
  v_mfma_f32_16x16x32_bf16 v[52:55], a[88:91], a[160:163], v[52:55]
  ds_read_b64_tr_b16 a[40:41], v12 offset:14432
  v_mfma_f32_16x16x32_bf16 v[108:111], a[88:91], a[164:167], v[108:111]
  buffer_load_dwordx4 v246, s[12:15], s35 offen offset:2048 lds
  v_mfma_f32_16x16x32_bf16 v[164:167], a[88:91], a[168:171], v[164:167]
  v_mfma_f32_16x16x32_bf16 v[220:223], a[88:91], a[172:175], v[220:223]
  ds_read_b64_tr_b16 a[42:43], v12 offset:18016
  v_mfma_f32_16x16x32_bf16 v[224:227], a[92:95], a[172:175], v[224:227]
  ds_read_b64_tr_b16 a[44:45], v12 offset:14464
  v_mfma_f32_16x16x32_bf16 v[168:171], a[92:95], a[168:171], v[168:171]
  ds_read_b64_tr_b16 a[46:47], v12 offset:18048
  v_mfma_f32_16x16x32_bf16 v[112:115], a[92:95], a[164:167], v[112:115]
  ds_read_b64_tr_b16 a[48:49], v12 offset:14496
  v_mfma_f32_16x16x32_bf16 v[56:59], a[92:95], a[160:163], v[56:59]
  buffer_load_dwordx4 v247, s[12:15], s35 offen offset:3072 lds
  v_mfma_f32_16x16x32_bf16 v[60:63], a[96:99], a[160:163], v[60:63]
  v_mfma_f32_16x16x32_bf16 v[116:119], a[96:99], a[164:167], v[116:119]
  ds_read_b64_tr_b16 a[50:51], v12 offset:18080
  v_mfma_f32_16x16x32_bf16 v[172:175], a[96:99], a[168:171], v[172:175]
  ds_read_b64_tr_b16 a[52:53], v12 offset:14528
  v_mfma_f32_16x16x32_bf16 v[228:231], a[96:99], a[172:175], v[228:231]
  ds_read_b64_tr_b16 a[54:55], v12 offset:18112
  v_mfma_f32_16x16x32_bf16 v[232:235], a[100:103], a[172:175], v[232:235]
  v_mfma_f32_16x16x32_bf16 v[176:179], a[100:103], a[168:171], v[176:179]
  v_mfma_f32_16x16x32_bf16 v[120:123], a[100:103], a[164:167], v[120:123]
  v_mfma_f32_16x16x32_bf16 v[64:67], a[100:103], a[160:163], v[64:67]
  v_mfma_f32_16x16x32_bf16 v[68:71], a[104:107], a[160:163], v[68:71]
  v_mfma_f32_16x16x32_bf16 v[124:127], a[104:107], a[164:167], v[124:127]
  v_mfma_f32_16x16x32_bf16 v[180:183], a[104:107], a[168:171], v[180:183]
  v_mfma_f32_16x16x32_bf16 v[236:239], a[104:107], a[172:175], v[236:239]
  v_mfma_f32_16x16x32_bf16 v[240:243], a[108:111], a[172:175], v[240:243]
  v_mfma_f32_16x16x32_bf16 v[184:187], a[108:111], a[168:171], v[184:187]
  v_mfma_f32_16x16x32_bf16 v[128:131], a[108:111], a[164:167], v[128:131]
  v_mfma_f32_16x16x32_bf16 v[72:75], a[108:111], a[160:163], v[72:75]
  s_mov_b32 s24, 5
.p2align 4
L_p4_3:
  s_waitcnt vmcnt(19) lgkmcnt(0)
  v_mfma_f32_16x16x32_bf16 v[20:23], a[0:3], a[112:115], v[20:23]
  buffer_load_dwordx4 a[160:163], v8, s[8:11], s33 offen offset:3072 sc1
  v_mfma_f32_16x16x32_bf16 v[76:79], a[0:3], a[116:119], v[76:79]
  v_mfma_f32_16x16x32_bf16 v[132:135], a[0:3], a[120:123], v[132:135]
  ds_read_b64_tr_b16 a[56:57], v12 offset:7168
  v_mfma_f32_16x16x32_bf16 v[188:191], a[0:3], a[124:127], v[188:191]
  ds_read_b64_tr_b16 a[58:59], v12 offset:10752
  v_mfma_f32_16x16x32_bf16 v[192:195], a[4:7], a[124:127], v[192:195]
  ds_read_b64_tr_b16 a[60:61], v12 offset:7200
  v_mfma_f32_16x16x32_bf16 v[136:139], a[4:7], a[120:123], v[136:139]
  ds_read_b64_tr_b16 a[62:63], v12 offset:10784
  v_mfma_f32_16x16x32_bf16 v[80:83], a[4:7], a[116:119], v[80:83]
  ds_read_b64_tr_b16 a[64:65], v12 offset:7232
  v_mfma_f32_16x16x32_bf16 v[24:27], a[4:7], a[112:115], v[24:27]
  buffer_load_dwordx4 a[164:167], v9, s[8:11], s33 offen offset:3072 sc1
  v_mfma_f32_16x16x32_bf16 v[28:31], a[8:11], a[112:115], v[28:31]
  v_mfma_f32_16x16x32_bf16 v[84:87], a[8:11], a[116:119], v[84:87]
  ds_read_b64_tr_b16 a[66:67], v12 offset:10816
  v_mfma_f32_16x16x32_bf16 v[140:143], a[8:11], a[120:123], v[140:143]
  ds_read_b64_tr_b16 a[68:69], v12 offset:7264
  v_mfma_f32_16x16x32_bf16 v[196:199], a[8:11], a[124:127], v[196:199]
  ds_read_b64_tr_b16 a[70:71], v12 offset:10848
  v_mfma_f32_16x16x32_bf16 v[200:203], a[12:15], a[124:127], v[200:203]
  ds_read_b64_tr_b16 a[72:73], v12 offset:7296
  v_mfma_f32_16x16x32_bf16 v[144:147], a[12:15], a[120:123], v[144:147]
  buffer_load_dwordx4 a[168:171], v10, s[8:11], s33 offen offset:3072 sc1
  v_mfma_f32_16x16x32_bf16 v[88:91], a[12:15], a[116:119], v[88:91]
  v_mfma_f32_16x16x32_bf16 v[32:35], a[12:15], a[112:115], v[32:35]
  ds_read_b64_tr_b16 a[74:75], v12 offset:10880
  v_mfma_f32_16x16x32_bf16 v[36:39], a[16:19], a[112:115], v[36:39]
  ds_read_b64_tr_b16 a[76:77], v12 offset:7328
  v_mfma_f32_16x16x32_bf16 v[92:95], a[16:19], a[116:119], v[92:95]
  ds_read_b64_tr_b16 a[78:79], v12 offset:10912
  v_mfma_f32_16x16x32_bf16 v[148:151], a[16:19], a[120:123], v[148:151]
  ds_read_b64_tr_b16 a[80:81], v12 offset:7360
  v_mfma_f32_16x16x32_bf16 v[204:207], a[16:19], a[124:127], v[204:207]
  buffer_load_dwordx4 a[172:175], v11, s[8:11], s33 offen offset:3072 sc1
  v_mfma_f32_16x16x32_bf16 v[208:211], a[20:23], a[124:127], v[208:211]
  v_mfma_f32_16x16x32_bf16 v[152:155], a[20:23], a[120:123], v[152:155]
  ds_read_b64_tr_b16 a[82:83], v12 offset:10944
  s_add_u32 m0, s38, 4096
  v_mfma_f32_16x16x32_bf16 v[96:99], a[20:23], a[116:119], v[96:99]
  ds_read_b64_tr_b16 a[84:85], v12 offset:21504
  s_add_u32 s36, s36, 28672
  v_mfma_f32_16x16x32_bf16 v[40:43], a[20:23], a[112:115], v[40:43]
  ds_read_b64_tr_b16 a[86:87], v12 offset:25088
  v_mfma_f32_16x16x32_bf16 v[44:47], a[24:27], a[112:115], v[44:47]
  ds_read_b64_tr_b16 a[88:89], v12 offset:21536
  v_mfma_f32_16x16x32_bf16 v[100:103], a[24:27], a[116:119], v[100:103]
  ds_read_b64_tr_b16 a[90:91], v12 offset:25120
  v_mfma_f32_16x16x32_bf16 v[156:159], a[24:27], a[120:123], v[156:159]
  buffer_load_dwordx4 v248, s[12:15], s35 offen offset:0 lds
  v_mfma_f32_16x16x32_bf16 v[212:215], a[24:27], a[124:127], v[212:215]
  v_mfma_f32_16x16x32_bf16 v[216:219], a[28:31], a[124:127], v[216:219]
  ds_read_b64_tr_b16 a[92:93], v12 offset:21568
  v_mfma_f32_16x16x32_bf16 v[160:163], a[28:31], a[120:123], v[160:163]
  ds_read_b64_tr_b16 a[94:95], v12 offset:25152
  v_mfma_f32_16x16x32_bf16 v[104:107], a[28:31], a[116:119], v[104:107]
  ds_read_b64_tr_b16 a[96:97], v12 offset:21600
  v_mfma_f32_16x16x32_bf16 v[48:51], a[28:31], a[112:115], v[48:51]
  ds_read_b64_tr_b16 a[98:99], v12 offset:25184
  v_mfma_f32_16x16x32_bf16 v[52:55], a[32:35], a[112:115], v[52:55]
  buffer_load_dwordx4 v249, s[12:15], s35 offen offset:1024 lds
  v_mfma_f32_16x16x32_bf16 v[108:111], a[32:35], a[116:119], v[108:111]
  v_mfma_f32_16x16x32_bf16 v[164:167], a[32:35], a[120:123], v[164:167]
  ds_read_b64_tr_b16 a[100:101], v12 offset:21632
  v_mfma_f32_16x16x32_bf16 v[220:223], a[32:35], a[124:127], v[220:223]
  ds_read_b64_tr_b16 a[102:103], v12 offset:25216
  v_mfma_f32_16x16x32_bf16 v[224:227], a[36:39], a[124:127], v[224:227]
  ds_read_b64_tr_b16 a[104:105], v12 offset:21664
  v_mfma_f32_16x16x32_bf16 v[168:171], a[36:39], a[120:123], v[168:171]
  ds_read_b64_tr_b16 a[106:107], v12 offset:25248
  v_mfma_f32_16x16x32_bf16 v[112:115], a[36:39], a[116:119], v[112:115]
  buffer_load_dwordx4 v250, s[12:15], s35 offen offset:2048 lds
  v_mfma_f32_16x16x32_bf16 v[56:59], a[36:39], a[112:115], v[56:59]
  v_mfma_f32_16x16x32_bf16 v[60:63], a[40:43], a[112:115], v[60:63]
  ds_read_b64_tr_b16 a[108:109], v12 offset:21696
  s_cmp_ge_u32 s36, 114688
  s_cselect_b32 s36, 0, s36
  v_mfma_f32_16x16x32_bf16 v[116:119], a[40:43], a[116:119], v[116:119]
  ds_read_b64_tr_b16 a[110:111], v12 offset:25280
  s_add_u32 s35, s35, 458752
  v_mfma_f32_16x16x32_bf16 v[172:175], a[40:43], a[120:123], v[172:175]
  v_mfma_f32_16x16x32_bf16 v[228:231], a[40:43], a[124:127], v[228:231]
  v_mfma_f32_16x16x32_bf16 v[232:235], a[44:47], a[124:127], v[232:235]
  v_mfma_f32_16x16x32_bf16 v[176:179], a[44:47], a[120:123], v[176:179]
  v_mfma_f32_16x16x32_bf16 v[120:123], a[44:47], a[116:119], v[120:123]
  v_mfma_f32_16x16x32_bf16 v[64:67], a[44:47], a[112:115], v[64:67]
  v_mfma_f32_16x16x32_bf16 v[68:71], a[48:51], a[112:115], v[68:71]
  v_mfma_f32_16x16x32_bf16 v[124:127], a[48:51], a[116:119], v[124:127]
  v_mfma_f32_16x16x32_bf16 v[180:183], a[48:51], a[120:123], v[180:183]
  s_add_u32 s44, s39, 28672
  v_mfma_f32_16x16x32_bf16 v[236:239], a[48:51], a[124:127], v[236:239]
  s_cmp_ge_u32 s44, 114688
  s_cselect_b32 s44, 0, s44
  v_mfma_f32_16x16x32_bf16 v[240:243], a[52:55], a[124:127], v[240:243]
  s_sub_u32 s45, s44, s39
  v_mfma_f32_16x16x32_bf16 v[184:187], a[52:55], a[120:123], v[184:187]
  s_mov_b32 s39, s44
  v_mfma_f32_16x16x32_bf16 v[128:131], a[52:55], a[116:119], v[128:131]
  v_add_u32 v12, s45, v12
  v_mfma_f32_16x16x32_bf16 v[72:75], a[52:55], a[112:115], v[72:75]
  s_waitcnt vmcnt(18) lgkmcnt(0)
  s_barrier
  v_mfma_f32_16x16x32_bf16 v[20:23], a[56:59], a[128:131], v[20:23]
  ds_read_b64_tr_b16 a[0:1], v12 offset:0
  s_add_u32 s33, s33, 4096
  v_mfma_f32_16x16x32_bf16 v[76:79], a[56:59], a[132:135], v[76:79]
  buffer_load_dwordx4 a[112:115], v8, s[8:11], s33 offen offset:0 sc1
  v_mfma_f32_16x16x32_bf16 v[132:135], a[56:59], a[136:139], v[132:135]
  v_mfma_f32_16x16x32_bf16 v[188:191], a[56:59], a[140:143], v[188:191]
  ds_read_b64_tr_b16 a[2:3], v12 offset:3584
  v_mfma_f32_16x16x32_bf16 v[192:195], a[60:63], a[140:143], v[192:195]
  ds_read_b64_tr_b16 a[4:5], v12 offset:32
  v_mfma_f32_16x16x32_bf16 v[136:139], a[60:63], a[136:139], v[136:139]
  ds_read_b64_tr_b16 a[6:7], v12 offset:3616
  v_mfma_f32_16x16x32_bf16 v[80:83], a[60:63], a[132:135], v[80:83]
  buffer_load_dwordx4 a[116:119], v9, s[8:11], s33 offen offset:0 sc1
  v_mfma_f32_16x16x32_bf16 v[24:27], a[60:63], a[128:131], v[24:27]
  v_mfma_f32_16x16x32_bf16 v[28:31], a[64:67], a[128:131], v[28:31]
  ds_read_b64_tr_b16 a[8:9], v12 offset:64
  v_mfma_f32_16x16x32_bf16 v[84:87], a[64:67], a[132:135], v[84:87]
  ds_read_b64_tr_b16 a[10:11], v12 offset:3648
  v_mfma_f32_16x16x32_bf16 v[140:143], a[64:67], a[136:139], v[140:143]
  ds_read_b64_tr_b16 a[12:13], v12 offset:96
  v_mfma_f32_16x16x32_bf16 v[196:199], a[64:67], a[140:143], v[196:199]
  buffer_load_dwordx4 a[120:123], v10, s[8:11], s33 offen offset:0 sc1
  v_mfma_f32_16x16x32_bf16 v[200:203], a[68:71], a[140:143], v[200:203]
  v_mfma_f32_16x16x32_bf16 v[144:147], a[68:71], a[136:139], v[144:147]
  ds_read_b64_tr_b16 a[14:15], v12 offset:3680
  v_mfma_f32_16x16x32_bf16 v[88:91], a[68:71], a[132:135], v[88:91]
  ds_read_b64_tr_b16 a[16:17], v12 offset:128
  v_mfma_f32_16x16x32_bf16 v[32:35], a[68:71], a[128:131], v[32:35]
  ds_read_b64_tr_b16 a[18:19], v12 offset:3712
  v_mfma_f32_16x16x32_bf16 v[36:39], a[72:75], a[128:131], v[36:39]
  ds_read_b64_tr_b16 a[20:21], v12 offset:160
  v_mfma_f32_16x16x32_bf16 v[92:95], a[72:75], a[132:135], v[92:95]
  buffer_load_dwordx4 a[124:127], v11, s[8:11], s33 offen offset:0 sc1
  v_mfma_f32_16x16x32_bf16 v[148:151], a[72:75], a[136:139], v[148:151]
  v_mfma_f32_16x16x32_bf16 v[204:207], a[72:75], a[140:143], v[204:207]
  ds_read_b64_tr_b16 a[22:23], v12 offset:3744
  s_add_u32 m0, s36, s37
  v_mfma_f32_16x16x32_bf16 v[208:211], a[76:79], a[140:143], v[208:211]
  ds_read_b64_tr_b16 a[24:25], v12 offset:192
  s_add_u32 s38, s36, s37
  v_mfma_f32_16x16x32_bf16 v[152:155], a[76:79], a[136:139], v[152:155]
  ds_read_b64_tr_b16 a[26:27], v12 offset:3776
  v_mfma_f32_16x16x32_bf16 v[96:99], a[76:79], a[132:135], v[96:99]
  buffer_load_dwordx4 v244, s[12:15], s35 offen offset:0 lds
  v_mfma_f32_16x16x32_bf16 v[40:43], a[76:79], a[128:131], v[40:43]
  v_mfma_f32_16x16x32_bf16 v[44:47], a[80:83], a[128:131], v[44:47]
  ds_read_b64_tr_b16 a[28:29], v12 offset:14336
  v_mfma_f32_16x16x32_bf16 v[100:103], a[80:83], a[132:135], v[100:103]
  ds_read_b64_tr_b16 a[30:31], v12 offset:17920
  v_mfma_f32_16x16x32_bf16 v[156:159], a[80:83], a[136:139], v[156:159]
  ds_read_b64_tr_b16 a[32:33], v12 offset:14368
  v_mfma_f32_16x16x32_bf16 v[212:215], a[80:83], a[140:143], v[212:215]
  ds_read_b64_tr_b16 a[34:35], v12 offset:17952
  v_mfma_f32_16x16x32_bf16 v[216:219], a[84:87], a[140:143], v[216:219]
  buffer_load_dwordx4 v245, s[12:15], s35 offen offset:1024 lds
  v_mfma_f32_16x16x32_bf16 v[160:163], a[84:87], a[136:139], v[160:163]
  v_mfma_f32_16x16x32_bf16 v[104:107], a[84:87], a[132:135], v[104:107]
  ds_read_b64_tr_b16 a[36:37], v12 offset:14400
  v_mfma_f32_16x16x32_bf16 v[48:51], a[84:87], a[128:131], v[48:51]
  ds_read_b64_tr_b16 a[38:39], v12 offset:17984
  v_mfma_f32_16x16x32_bf16 v[52:55], a[88:91], a[128:131], v[52:55]
  ds_read_b64_tr_b16 a[40:41], v12 offset:14432
  v_mfma_f32_16x16x32_bf16 v[108:111], a[88:91], a[132:135], v[108:111]
  buffer_load_dwordx4 v246, s[12:15], s35 offen offset:2048 lds
  v_mfma_f32_16x16x32_bf16 v[164:167], a[88:91], a[136:139], v[164:167]
  v_mfma_f32_16x16x32_bf16 v[220:223], a[88:91], a[140:143], v[220:223]
  ds_read_b64_tr_b16 a[42:43], v12 offset:18016
  v_mfma_f32_16x16x32_bf16 v[224:227], a[92:95], a[140:143], v[224:227]
  ds_read_b64_tr_b16 a[44:45], v12 offset:14464
  v_mfma_f32_16x16x32_bf16 v[168:171], a[92:95], a[136:139], v[168:171]
  ds_read_b64_tr_b16 a[46:47], v12 offset:18048
  v_mfma_f32_16x16x32_bf16 v[112:115], a[92:95], a[132:135], v[112:115]
  ds_read_b64_tr_b16 a[48:49], v12 offset:14496
  v_mfma_f32_16x16x32_bf16 v[56:59], a[92:95], a[128:131], v[56:59]
  buffer_load_dwordx4 v247, s[12:15], s35 offen offset:3072 lds
  v_mfma_f32_16x16x32_bf16 v[60:63], a[96:99], a[128:131], v[60:63]
  v_mfma_f32_16x16x32_bf16 v[116:119], a[96:99], a[132:135], v[116:119]
  ds_read_b64_tr_b16 a[50:51], v12 offset:18080
  v_mfma_f32_16x16x32_bf16 v[172:175], a[96:99], a[136:139], v[172:175]
  ds_read_b64_tr_b16 a[52:53], v12 offset:14528
  v_mfma_f32_16x16x32_bf16 v[228:231], a[96:99], a[140:143], v[228:231]
  ds_read_b64_tr_b16 a[54:55], v12 offset:18112
  v_mfma_f32_16x16x32_bf16 v[232:235], a[100:103], a[140:143], v[232:235]
  v_mfma_f32_16x16x32_bf16 v[176:179], a[100:103], a[136:139], v[176:179]
  v_mfma_f32_16x16x32_bf16 v[120:123], a[100:103], a[132:135], v[120:123]
  v_mfma_f32_16x16x32_bf16 v[64:67], a[100:103], a[128:131], v[64:67]
  v_mfma_f32_16x16x32_bf16 v[68:71], a[104:107], a[128:131], v[68:71]
  v_mfma_f32_16x16x32_bf16 v[124:127], a[104:107], a[132:135], v[124:127]
  v_mfma_f32_16x16x32_bf16 v[180:183], a[104:107], a[136:139], v[180:183]
  v_mfma_f32_16x16x32_bf16 v[236:239], a[104:107], a[140:143], v[236:239]
  v_mfma_f32_16x16x32_bf16 v[240:243], a[108:111], a[140:143], v[240:243]
  v_mfma_f32_16x16x32_bf16 v[184:187], a[108:111], a[136:139], v[184:187]
  v_mfma_f32_16x16x32_bf16 v[128:131], a[108:111], a[132:135], v[128:131]
  v_mfma_f32_16x16x32_bf16 v[72:75], a[108:111], a[128:131], v[72:75]
  s_waitcnt vmcnt(19) lgkmcnt(0)
  v_mfma_f32_16x16x32_bf16 v[20:23], a[0:3], a[144:147], v[20:23]
  buffer_load_dwordx4 a[128:131], v8, s[8:11], s33 offen offset:1024 sc1
  v_mfma_f32_16x16x32_bf16 v[76:79], a[0:3], a[148:151], v[76:79]
  v_mfma_f32_16x16x32_bf16 v[132:135], a[0:3], a[152:155], v[132:135]
  ds_read_b64_tr_b16 a[56:57], v12 offset:7168
  v_mfma_f32_16x16x32_bf16 v[188:191], a[0:3], a[156:159], v[188:191]
  ds_read_b64_tr_b16 a[58:59], v12 offset:10752
  v_mfma_f32_16x16x32_bf16 v[192:195], a[4:7], a[156:159], v[192:195]
  ds_read_b64_tr_b16 a[60:61], v12 offset:7200
  v_mfma_f32_16x16x32_bf16 v[136:139], a[4:7], a[152:155], v[136:139]
  ds_read_b64_tr_b16 a[62:63], v12 offset:10784
  v_mfma_f32_16x16x32_bf16 v[80:83], a[4:7], a[148:151], v[80:83]
  ds_read_b64_tr_b16 a[64:65], v12 offset:7232
  v_mfma_f32_16x16x32_bf16 v[24:27], a[4:7], a[144:147], v[24:27]
  buffer_load_dwordx4 a[132:135], v9, s[8:11], s33 offen offset:1024 sc1
  v_mfma_f32_16x16x32_bf16 v[28:31], a[8:11], a[144:147], v[28:31]
  v_mfma_f32_16x16x32_bf16 v[84:87], a[8:11], a[148:151], v[84:87]
  ds_read_b64_tr_b16 a[66:67], v12 offset:10816
  v_mfma_f32_16x16x32_bf16 v[140:143], a[8:11], a[152:155], v[140:143]
  ds_read_b64_tr_b16 a[68:69], v12 offset:7264
  v_mfma_f32_16x16x32_bf16 v[196:199], a[8:11], a[156:159], v[196:199]
  ds_read_b64_tr_b16 a[70:71], v12 offset:10848
  v_mfma_f32_16x16x32_bf16 v[200:203], a[12:15], a[156:159], v[200:203]
  ds_read_b64_tr_b16 a[72:73], v12 offset:7296
  v_mfma_f32_16x16x32_bf16 v[144:147], a[12:15], a[152:155], v[144:147]
  buffer_load_dwordx4 a[136:139], v10, s[8:11], s33 offen offset:1024 sc1
  v_mfma_f32_16x16x32_bf16 v[88:91], a[12:15], a[148:151], v[88:91]
  v_mfma_f32_16x16x32_bf16 v[32:35], a[12:15], a[144:147], v[32:35]
  ds_read_b64_tr_b16 a[74:75], v12 offset:10880
  v_mfma_f32_16x16x32_bf16 v[36:39], a[16:19], a[144:147], v[36:39]
  ds_read_b64_tr_b16 a[76:77], v12 offset:7328
  v_mfma_f32_16x16x32_bf16 v[92:95], a[16:19], a[148:151], v[92:95]
  ds_read_b64_tr_b16 a[78:79], v12 offset:10912
  v_mfma_f32_16x16x32_bf16 v[148:151], a[16:19], a[152:155], v[148:151]
  ds_read_b64_tr_b16 a[80:81], v12 offset:7360
  v_mfma_f32_16x16x32_bf16 v[204:207], a[16:19], a[156:159], v[204:207]
  buffer_load_dwordx4 a[140:143], v11, s[8:11], s33 offen offset:1024 sc1
  v_mfma_f32_16x16x32_bf16 v[208:211], a[20:23], a[156:159], v[208:211]
  v_mfma_f32_16x16x32_bf16 v[152:155], a[20:23], a[152:155], v[152:155]
  ds_read_b64_tr_b16 a[82:83], v12 offset:10944
  s_add_u32 m0, s38, 4096
  v_mfma_f32_16x16x32_bf16 v[96:99], a[20:23], a[148:151], v[96:99]
  ds_read_b64_tr_b16 a[84:85], v12 offset:21504
  s_add_u32 s36, s36, 28672
  v_mfma_f32_16x16x32_bf16 v[40:43], a[20:23], a[144:147], v[40:43]
  ds_read_b64_tr_b16 a[86:87], v12 offset:25088
  v_mfma_f32_16x16x32_bf16 v[44:47], a[24:27], a[144:147], v[44:47]
  ds_read_b64_tr_b16 a[88:89], v12 offset:21536
  v_mfma_f32_16x16x32_bf16 v[100:103], a[24:27], a[148:151], v[100:103]
  ds_read_b64_tr_b16 a[90:91], v12 offset:25120
  v_mfma_f32_16x16x32_bf16 v[156:159], a[24:27], a[152:155], v[156:159]
  buffer_load_dwordx4 v248, s[12:15], s35 offen offset:0 lds
  v_mfma_f32_16x16x32_bf16 v[212:215], a[24:27], a[156:159], v[212:215]
  v_mfma_f32_16x16x32_bf16 v[216:219], a[28:31], a[156:159], v[216:219]
  ds_read_b64_tr_b16 a[92:93], v12 offset:21568
  v_mfma_f32_16x16x32_bf16 v[160:163], a[28:31], a[152:155], v[160:163]
  ds_read_b64_tr_b16 a[94:95], v12 offset:25152
  v_mfma_f32_16x16x32_bf16 v[104:107], a[28:31], a[148:151], v[104:107]
  ds_read_b64_tr_b16 a[96:97], v12 offset:21600
  v_mfma_f32_16x16x32_bf16 v[48:51], a[28:31], a[144:147], v[48:51]
  ds_read_b64_tr_b16 a[98:99], v12 offset:25184
  v_mfma_f32_16x16x32_bf16 v[52:55], a[32:35], a[144:147], v[52:55]
  buffer_load_dwordx4 v249, s[12:15], s35 offen offset:1024 lds
  v_mfma_f32_16x16x32_bf16 v[108:111], a[32:35], a[148:151], v[108:111]
  v_mfma_f32_16x16x32_bf16 v[164:167], a[32:35], a[152:155], v[164:167]
  ds_read_b64_tr_b16 a[100:101], v12 offset:21632
  v_mfma_f32_16x16x32_bf16 v[220:223], a[32:35], a[156:159], v[220:223]
  ds_read_b64_tr_b16 a[102:103], v12 offset:25216
  v_mfma_f32_16x16x32_bf16 v[224:227], a[36:39], a[156:159], v[224:227]
  ds_read_b64_tr_b16 a[104:105], v12 offset:21664
  v_mfma_f32_16x16x32_bf16 v[168:171], a[36:39], a[152:155], v[168:171]
  ds_read_b64_tr_b16 a[106:107], v12 offset:25248
  v_mfma_f32_16x16x32_bf16 v[112:115], a[36:39], a[148:151], v[112:115]
  buffer_load_dwordx4 v250, s[12:15], s35 offen offset:2048 lds
  v_mfma_f32_16x16x32_bf16 v[56:59], a[36:39], a[144:147], v[56:59]
  v_mfma_f32_16x16x32_bf16 v[60:63], a[40:43], a[144:147], v[60:63]
  ds_read_b64_tr_b16 a[108:109], v12 offset:21696
  s_cmp_ge_u32 s36, 114688
  s_cselect_b32 s36, 0, s36
  v_mfma_f32_16x16x32_bf16 v[116:119], a[40:43], a[148:151], v[116:119]
  ds_read_b64_tr_b16 a[110:111], v12 offset:25280
  s_add_u32 s35, s35, 458752
  v_mfma_f32_16x16x32_bf16 v[172:175], a[40:43], a[152:155], v[172:175]
  v_mfma_f32_16x16x32_bf16 v[228:231], a[40:43], a[156:159], v[228:231]
  v_mfma_f32_16x16x32_bf16 v[232:235], a[44:47], a[156:159], v[232:235]
  v_mfma_f32_16x16x32_bf16 v[176:179], a[44:47], a[152:155], v[176:179]
  v_mfma_f32_16x16x32_bf16 v[120:123], a[44:47], a[148:151], v[120:123]
  v_mfma_f32_16x16x32_bf16 v[64:67], a[44:47], a[144:147], v[64:67]
  v_mfma_f32_16x16x32_bf16 v[68:71], a[48:51], a[144:147], v[68:71]
  v_mfma_f32_16x16x32_bf16 v[124:127], a[48:51], a[148:151], v[124:127]
  v_mfma_f32_16x16x32_bf16 v[180:183], a[48:51], a[152:155], v[180:183]
  s_add_u32 s44, s39, 28672
  v_mfma_f32_16x16x32_bf16 v[236:239], a[48:51], a[156:159], v[236:239]
  s_cmp_ge_u32 s44, 114688
  s_cselect_b32 s44, 0, s44
  v_mfma_f32_16x16x32_bf16 v[240:243], a[52:55], a[156:159], v[240:243]
  s_sub_u32 s45, s44, s39
  v_mfma_f32_16x16x32_bf16 v[184:187], a[52:55], a[152:155], v[184:187]
  s_mov_b32 s39, s44
  v_mfma_f32_16x16x32_bf16 v[128:131], a[52:55], a[148:151], v[128:131]
  v_add_u32 v12, s45, v12
  v_mfma_f32_16x16x32_bf16 v[72:75], a[52:55], a[144:147], v[72:75]
  s_waitcnt vmcnt(18) lgkmcnt(0)
  s_barrier
  v_mfma_f32_16x16x32_bf16 v[20:23], a[56:59], a[160:163], v[20:23]
  buffer_load_dwordx4 a[144:147], v8, s[8:11], s33 offen offset:2048 sc1
  v_mfma_f32_16x16x32_bf16 v[76:79], a[56:59], a[164:167], v[76:79]
  v_mfma_f32_16x16x32_bf16 v[132:135], a[56:59], a[168:171], v[132:135]
  ds_read_b64_tr_b16 a[0:1], v12 offset:0
  v_mfma_f32_16x16x32_bf16 v[188:191], a[56:59], a[172:175], v[188:191]
  ds_read_b64_tr_b16 a[2:3], v12 offset:3584
  v_mfma_f32_16x16x32_bf16 v[192:195], a[60:63], a[172:175], v[192:195]
  ds_read_b64_tr_b16 a[4:5], v12 offset:32
  v_mfma_f32_16x16x32_bf16 v[136:139], a[60:63], a[168:171], v[136:139]
  ds_read_b64_tr_b16 a[6:7], v12 offset:3616
  v_mfma_f32_16x16x32_bf16 v[80:83], a[60:63], a[164:167], v[80:83]
  buffer_load_dwordx4 a[148:151], v9, s[8:11], s33 offen offset:2048 sc1
  v_mfma_f32_16x16x32_bf16 v[24:27], a[60:63], a[160:163], v[24:27]
  v_mfma_f32_16x16x32_bf16 v[28:31], a[64:67], a[160:163], v[28:31]
  ds_read_b64_tr_b16 a[8:9], v12 offset:64
  v_mfma_f32_16x16x32_bf16 v[84:87], a[64:67], a[164:167], v[84:87]
  ds_read_b64_tr_b16 a[10:11], v12 offset:3648
  v_mfma_f32_16x16x32_bf16 v[140:143], a[64:67], a[168:171], v[140:143]
  ds_read_b64_tr_b16 a[12:13], v12 offset:96
  v_mfma_f32_16x16x32_bf16 v[196:199], a[64:67], a[172:175], v[196:199]
  buffer_load_dwordx4 a[152:155], v10, s[8:11], s33 offen offset:2048 sc1
  v_mfma_f32_16x16x32_bf16 v[200:203], a[68:71], a[172:175], v[200:203]
  v_mfma_f32_16x16x32_bf16 v[144:147], a[68:71], a[168:171], v[144:147]
  ds_read_b64_tr_b16 a[14:15], v12 offset:3680
  v_mfma_f32_16x16x32_bf16 v[88:91], a[68:71], a[164:167], v[88:91]
  ds_read_b64_tr_b16 a[16:17], v12 offset:128
  v_mfma_f32_16x16x32_bf16 v[32:35], a[68:71], a[160:163], v[32:35]
  ds_read_b64_tr_b16 a[18:19], v12 offset:3712
  v_mfma_f32_16x16x32_bf16 v[36:39], a[72:75], a[160:163], v[36:39]
  ds_read_b64_tr_b16 a[20:21], v12 offset:160
  v_mfma_f32_16x16x32_bf16 v[92:95], a[72:75], a[164:167], v[92:95]
  buffer_load_dwordx4 a[156:159], v11, s[8:11], s33 offen offset:2048 sc1
  v_mfma_f32_16x16x32_bf16 v[148:151], a[72:75], a[168:171], v[148:151]
  v_mfma_f32_16x16x32_bf16 v[204:207], a[72:75], a[172:175], v[204:207]
  ds_read_b64_tr_b16 a[22:23], v12 offset:3744
  s_add_u32 m0, s36, s37
  v_mfma_f32_16x16x32_bf16 v[208:211], a[76:79], a[172:175], v[208:211]
  ds_read_b64_tr_b16 a[24:25], v12 offset:192
  s_add_u32 s38, s36, s37
  v_mfma_f32_16x16x32_bf16 v[152:155], a[76:79], a[168:171], v[152:155]
  ds_read_b64_tr_b16 a[26:27], v12 offset:3776
  v_mfma_f32_16x16x32_bf16 v[96:99], a[76:79], a[164:167], v[96:99]
  buffer_load_dwordx4 v244, s[12:15], s35 offen offset:0 lds
  v_mfma_f32_16x16x32_bf16 v[40:43], a[76:79], a[160:163], v[40:43]
  v_mfma_f32_16x16x32_bf16 v[44:47], a[80:83], a[160:163], v[44:47]
  ds_read_b64_tr_b16 a[28:29], v12 offset:14336
  v_mfma_f32_16x16x32_bf16 v[100:103], a[80:83], a[164:167], v[100:103]
  ds_read_b64_tr_b16 a[30:31], v12 offset:17920
  v_mfma_f32_16x16x32_bf16 v[156:159], a[80:83], a[168:171], v[156:159]
  ds_read_b64_tr_b16 a[32:33], v12 offset:14368
  v_mfma_f32_16x16x32_bf16 v[212:215], a[80:83], a[172:175], v[212:215]
  ds_read_b64_tr_b16 a[34:35], v12 offset:17952
  v_mfma_f32_16x16x32_bf16 v[216:219], a[84:87], a[172:175], v[216:219]
  buffer_load_dwordx4 v245, s[12:15], s35 offen offset:1024 lds
  v_mfma_f32_16x16x32_bf16 v[160:163], a[84:87], a[168:171], v[160:163]
  v_mfma_f32_16x16x32_bf16 v[104:107], a[84:87], a[164:167], v[104:107]
  ds_read_b64_tr_b16 a[36:37], v12 offset:14400
  v_mfma_f32_16x16x32_bf16 v[48:51], a[84:87], a[160:163], v[48:51]
  ds_read_b64_tr_b16 a[38:39], v12 offset:17984
  v_mfma_f32_16x16x32_bf16 v[52:55], a[88:91], a[160:163], v[52:55]
  ds_read_b64_tr_b16 a[40:41], v12 offset:14432
  v_mfma_f32_16x16x32_bf16 v[108:111], a[88:91], a[164:167], v[108:111]
  buffer_load_dwordx4 v246, s[12:15], s35 offen offset:2048 lds
  v_mfma_f32_16x16x32_bf16 v[164:167], a[88:91], a[168:171], v[164:167]
  v_mfma_f32_16x16x32_bf16 v[220:223], a[88:91], a[172:175], v[220:223]
  ds_read_b64_tr_b16 a[42:43], v12 offset:18016
  v_mfma_f32_16x16x32_bf16 v[224:227], a[92:95], a[172:175], v[224:227]
  ds_read_b64_tr_b16 a[44:45], v12 offset:14464
  v_mfma_f32_16x16x32_bf16 v[168:171], a[92:95], a[168:171], v[168:171]
  ds_read_b64_tr_b16 a[46:47], v12 offset:18048
  v_mfma_f32_16x16x32_bf16 v[112:115], a[92:95], a[164:167], v[112:115]
  ds_read_b64_tr_b16 a[48:49], v12 offset:14496
  v_mfma_f32_16x16x32_bf16 v[56:59], a[92:95], a[160:163], v[56:59]
  buffer_load_dwordx4 v247, s[12:15], s35 offen offset:3072 lds
  v_mfma_f32_16x16x32_bf16 v[60:63], a[96:99], a[160:163], v[60:63]
  v_mfma_f32_16x16x32_bf16 v[116:119], a[96:99], a[164:167], v[116:119]
  ds_read_b64_tr_b16 a[50:51], v12 offset:18080
  v_mfma_f32_16x16x32_bf16 v[172:175], a[96:99], a[168:171], v[172:175]
  ds_read_b64_tr_b16 a[52:53], v12 offset:14528
  v_mfma_f32_16x16x32_bf16 v[228:231], a[96:99], a[172:175], v[228:231]
  ds_read_b64_tr_b16 a[54:55], v12 offset:18112
  v_mfma_f32_16x16x32_bf16 v[232:235], a[100:103], a[172:175], v[232:235]
  v_mfma_f32_16x16x32_bf16 v[176:179], a[100:103], a[168:171], v[176:179]
  v_mfma_f32_16x16x32_bf16 v[120:123], a[100:103], a[164:167], v[120:123]
  v_mfma_f32_16x16x32_bf16 v[64:67], a[100:103], a[160:163], v[64:67]
  v_mfma_f32_16x16x32_bf16 v[68:71], a[104:107], a[160:163], v[68:71]
  v_mfma_f32_16x16x32_bf16 v[124:127], a[104:107], a[164:167], v[124:127]
  v_mfma_f32_16x16x32_bf16 v[180:183], a[104:107], a[168:171], v[180:183]
  v_mfma_f32_16x16x32_bf16 v[236:239], a[104:107], a[172:175], v[236:239]
  v_mfma_f32_16x16x32_bf16 v[240:243], a[108:111], a[172:175], v[240:243]
  v_mfma_f32_16x16x32_bf16 v[184:187], a[108:111], a[168:171], v[184:187]
  v_mfma_f32_16x16x32_bf16 v[128:131], a[108:111], a[164:167], v[128:131]
  v_mfma_f32_16x16x32_bf16 v[72:75], a[108:111], a[160:163], v[72:75]
  s_sub_u32 s24, s24, 1
  s_cmp_lg_u32 s24, 0
  s_cbranch_scc1 L_p4_3
  s_waitcnt vmcnt(19) lgkmcnt(0)
  v_mfma_f32_16x16x32_bf16 v[20:23], a[0:3], a[112:115], v[20:23]
  buffer_load_dwordx4 a[160:163], v8, s[8:11], s33 offen offset:3072 sc1
  v_mfma_f32_16x16x32_bf16 v[76:79], a[0:3], a[116:119], v[76:79]
  ds_read_b64_tr_b16 a[56:57], v12 offset:7168
  v_mfma_f32_16x16x32_bf16 v[132:135], a[0:3], a[120:123], v[132:135]
  ds_read_b64_tr_b16 a[58:59], v12 offset:10752
  v_mfma_f32_16x16x32_bf16 v[188:191], a[0:3], a[124:127], v[188:191]
  ds_read_b64_tr_b16 a[60:61], v12 offset:7200
  v_mfma_f32_16x16x32_bf16 v[192:195], a[4:7], a[124:127], v[192:195]
  buffer_load_dwordx4 a[164:167], v9, s[8:11], s33 offen offset:3072 sc1
  v_mfma_f32_16x16x32_bf16 v[136:139], a[4:7], a[120:123], v[136:139]
  ds_read_b64_tr_b16 a[62:63], v12 offset:10784
  v_mfma_f32_16x16x32_bf16 v[80:83], a[4:7], a[116:119], v[80:83]
  ds_read_b64_tr_b16 a[64:65], v12 offset:7232
  v_mfma_f32_16x16x32_bf16 v[24:27], a[4:7], a[112:115], v[24:27]
  buffer_load_dwordx4 a[168:171], v10, s[8:11], s33 offen offset:3072 sc1
  v_mfma_f32_16x16x32_bf16 v[28:31], a[8:11], a[112:115], v[28:31]
  ds_read_b64_tr_b16 a[66:67], v12 offset:10816
  v_mfma_f32_16x16x32_bf16 v[84:87], a[8:11], a[116:119], v[84:87]
  ds_read_b64_tr_b16 a[68:69], v12 offset:7264
  v_mfma_f32_16x16x32_bf16 v[140:143], a[8:11], a[120:123], v[140:143]
  buffer_load_dwordx4 a[172:175], v11, s[8:11], s33 offen offset:3072 sc1
  s_add_u32 m0, s38, 4096
  v_mfma_f32_16x16x32_bf16 v[196:199], a[8:11], a[124:127], v[196:199]
  s_add_u32 s36, s36, 28672
  ds_read_b64_tr_b16 a[70:71], v12 offset:10848
  v_mfma_f32_16x16x32_bf16 v[200:203], a[12:15], a[124:127], v[200:203]
  ds_read_b64_tr_b16 a[72:73], v12 offset:7296
  v_mfma_f32_16x16x32_bf16 v[144:147], a[12:15], a[120:123], v[144:147]
  ds_read_b64_tr_b16 a[74:75], v12 offset:10880
  v_mfma_f32_16x16x32_bf16 v[88:91], a[12:15], a[116:119], v[88:91]
  buffer_load_dwordx4 v248, s[12:15], s35 offen offset:0 lds
  v_mfma_f32_16x16x32_bf16 v[32:35], a[12:15], a[112:115], v[32:35]
  ds_read_b64_tr_b16 a[76:77], v12 offset:7328
  v_mfma_f32_16x16x32_bf16 v[36:39], a[16:19], a[112:115], v[36:39]
  ds_read_b64_tr_b16 a[78:79], v12 offset:10912
  v_mfma_f32_16x16x32_bf16 v[92:95], a[16:19], a[116:119], v[92:95]
  buffer_load_dwordx4 v249, s[12:15], s35 offen offset:1024 lds
  v_mfma_f32_16x16x32_bf16 v[148:151], a[16:19], a[120:123], v[148:151]
  ds_read_b64_tr_b16 a[80:81], v12 offset:7360
  v_mfma_f32_16x16x32_bf16 v[204:207], a[16:19], a[124:127], v[204:207]
  ds_read_b64_tr_b16 a[82:83], v12 offset:10944
  v_mfma_f32_16x16x32_bf16 v[208:211], a[20:23], a[124:127], v[208:211]
  buffer_load_dwordx4 v250, s[12:15], s35 offen offset:2048 lds
  s_cmp_ge_u32 s36, 114688
  s_cselect_b32 s36, 0, s36
  v_mfma_f32_16x16x32_bf16 v[152:155], a[20:23], a[120:123], v[152:155]
  s_add_u32 s35, s35, 458752
  ds_read_b64_tr_b16 a[84:85], v12 offset:21504
  v_mfma_f32_16x16x32_bf16 v[96:99], a[20:23], a[116:119], v[96:99]
  v_lshrrev_b32 v252, 2, v1
  ds_read_b64_tr_b16 a[86:87], v12 offset:25088
  v_mfma_f32_16x16x32_bf16 v[40:43], a[20:23], a[112:115], v[40:43]
  v_min_u32 v252, 13, v252
  ds_read_b64_tr_b16 a[88:89], v12 offset:21536
  v_mfma_f32_16x16x32_bf16 v[44:47], a[24:27], a[112:115], v[44:47]
  v_lshlrev_b32 v252, 4, v252
  ds_read_b64_tr_b16 a[90:91], v12 offset:25120
  v_mfma_f32_16x16x32_bf16 v[100:103], a[24:27], a[116:119], v[100:103]
  v_and_b32 v253, 3, v1
  ds_read_b64_tr_b16 a[92:93], v12 offset:21568
  v_mfma_f32_16x16x32_bf16 v[156:159], a[24:27], a[120:123], v[156:159]
  v_mul_u32_u24 v253, 28672, v253
  ds_read_b64_tr_b16 a[94:95], v12 offset:25152
  v_mfma_f32_16x16x32_bf16 v[212:215], a[24:27], a[124:127], v[212:215]
  v_add_u32 v13, v252, v253
  ds_read_b64_tr_b16 a[96:97], v12 offset:21600
  v_mfma_f32_16x16x32_bf16 v[216:219], a[28:31], a[124:127], v[216:219]
  s_mul_i32 s29, s5, 224
  ds_read_b64_tr_b16 a[98:99], v12 offset:25184
  v_mfma_f32_16x16x32_bf16 v[160:163], a[28:31], a[120:123], v[160:163]
  s_add_u32 s29, s29, 28672
  ds_read_b64_tr_b16 a[100:101], v12 offset:21632
  v_mfma_f32_16x16x32_bf16 v[104:107], a[28:31], a[116:119], v[104:107]
  v_add_u32 v255, s29, v252
  ds_read_b64_tr_b16 a[102:103], v12 offset:25216
  v_mfma_f32_16x16x32_bf16 v[48:51], a[28:31], a[112:115], v[48:51]
  s_and_b32 s29, s5, 1
  ds_read_b64_tr_b16 a[104:105], v12 offset:21664
  v_mfma_f32_16x16x32_bf16 v[52:55], a[32:35], a[112:115], v[52:55]
  s_mul_i32 s29, s29, 224
  ds_read_b64_tr_b16 a[106:107], v12 offset:25248
  v_mfma_f32_16x16x32_bf16 v[108:111], a[32:35], a[116:119], v[108:111]
  s_lshr_b32 s28, s5, 1
  ds_read_b64_tr_b16 a[108:109], v12 offset:21696
  v_mfma_f32_16x16x32_bf16 v[164:167], a[32:35], a[120:123], v[164:167]
  s_mul_i32 s28, s28, 14336
  ds_read_b64_tr_b16 a[110:111], v12 offset:25280
  v_mfma_f32_16x16x32_bf16 v[220:223], a[32:35], a[124:127], v[220:223]
  s_add_u32 s28, s28, s29
  v_mfma_f32_16x16x32_bf16 v[224:227], a[36:39], a[124:127], v[224:227]
  s_mul_i32 s31, s53, 448
  v_mfma_f32_16x16x32_bf16 v[168:171], a[36:39], a[120:123], v[168:171]
  s_add_u32 s31, s31, s28
  v_mfma_f32_16x16x32_bf16 v[112:115], a[36:39], a[116:119], v[112:115]
  s_add_u32 s31, s31, 40894464
  v_mfma_f32_16x16x32_bf16 v[56:59], a[36:39], a[112:115], v[56:59]
  v_lshlrev_b32 v253, 3, v3
  v_mfma_f32_16x16x32_bf16 v[60:63], a[40:43], a[112:115], v[60:63]
  v_lshl_add_u32 v253, v4, 16, v253
  v_mfma_f32_16x16x32_bf16 v[116:119], a[40:43], a[116:119], v[116:119]
  s_lshl_b32 s30, s32, 7
  v_mfma_f32_16x16x32_bf16 v[172:175], a[40:43], a[120:123], v[172:175]
  s_add_u32 s30, s30, 37748736
  buffer_load_dword a176, v253, s[8:11], s30 offen offset:0 sc1
  v_mfma_f32_16x16x32_bf16 v[228:231], a[40:43], a[124:127], v[228:231]
  buffer_load_dword a180, v253, s[8:11], s30 offen offset:128 sc1
  v_mfma_f32_16x16x32_bf16 v[232:235], a[44:47], a[124:127], v[232:235]
  buffer_load_dword a184, v253, s[8:11], s30 offen offset:256 sc1
  v_mfma_f32_16x16x32_bf16 v[176:179], a[44:47], a[120:123], v[176:179]
  buffer_load_dword a188, v253, s[8:11], s30 offen offset:384 sc1
  s_add_u32 s30, s30, 16384
  v_mfma_f32_16x16x32_bf16 v[120:123], a[44:47], a[116:119], v[120:123]
  buffer_load_dword a177, v253, s[8:11], s30 offen offset:0 sc1
  v_mfma_f32_16x16x32_bf16 v[64:67], a[44:47], a[112:115], v[64:67]
  buffer_load_dword a181, v253, s[8:11], s30 offen offset:128 sc1
  v_mfma_f32_16x16x32_bf16 v[68:71], a[48:51], a[112:115], v[68:71]
  buffer_load_dword a185, v253, s[8:11], s30 offen offset:256 sc1
  v_mfma_f32_16x16x32_bf16 v[124:127], a[48:51], a[116:119], v[124:127]
  buffer_load_dword a189, v253, s[8:11], s30 offen offset:384 sc1
  s_add_u32 s30, s30, 16384
  v_mfma_f32_16x16x32_bf16 v[180:183], a[48:51], a[120:123], v[180:183]
  s_add_u32 s44, s39, 28672
  v_mfma_f32_16x16x32_bf16 v[236:239], a[48:51], a[124:127], v[236:239]
  s_cmp_ge_u32 s44, 114688
  s_cselect_b32 s44, 0, s44
  v_mfma_f32_16x16x32_bf16 v[240:243], a[52:55], a[124:127], v[240:243]
  s_sub_u32 s45, s44, s39
  v_mfma_f32_16x16x32_bf16 v[184:187], a[52:55], a[120:123], v[184:187]
  s_mov_b32 s39, s44
  v_mfma_f32_16x16x32_bf16 v[128:131], a[52:55], a[116:119], v[128:131]
  v_add_u32 v12, s45, v12
  v_mfma_f32_16x16x32_bf16 v[72:75], a[52:55], a[112:115], v[72:75]
  s_waitcnt vmcnt(26) lgkmcnt(0)
  s_barrier
  v_mfma_f32_16x16x32_bf16 v[20:23], a[56:59], a[128:131], v[20:23]
  ds_read_b64_tr_b16 a[0:1], v12 offset:0
  s_add_u32 s33, s33, 4096
  v_mfma_f32_16x16x32_bf16 v[76:79], a[56:59], a[132:135], v[76:79]
  buffer_load_dwordx4 a[112:115], v8, s[8:11], s33 offen offset:0 sc1
  v_mfma_f32_16x16x32_bf16 v[132:135], a[56:59], a[136:139], v[132:135]
  v_mfma_f32_16x16x32_bf16 v[188:191], a[56:59], a[140:143], v[188:191]
  ds_read_b64_tr_b16 a[2:3], v12 offset:3584
  v_mfma_f32_16x16x32_bf16 v[192:195], a[60:63], a[140:143], v[192:195]
  ds_read_b64_tr_b16 a[4:5], v12 offset:32
  v_mfma_f32_16x16x32_bf16 v[136:139], a[60:63], a[136:139], v[136:139]
  ds_read_b64_tr_b16 a[6:7], v12 offset:3616
  v_mfma_f32_16x16x32_bf16 v[80:83], a[60:63], a[132:135], v[80:83]
  buffer_load_dwordx4 a[116:119], v9, s[8:11], s33 offen offset:0 sc1
  v_mfma_f32_16x16x32_bf16 v[24:27], a[60:63], a[128:131], v[24:27]
  v_mfma_f32_16x16x32_bf16 v[28:31], a[64:67], a[128:131], v[28:31]
  ds_read_b64_tr_b16 a[8:9], v12 offset:64
  v_mfma_f32_16x16x32_bf16 v[84:87], a[64:67], a[132:135], v[84:87]
  ds_read_b64_tr_b16 a[10:11], v12 offset:3648
  v_mfma_f32_16x16x32_bf16 v[140:143], a[64:67], a[136:139], v[140:143]
  ds_read_b64_tr_b16 a[12:13], v12 offset:96
  v_mfma_f32_16x16x32_bf16 v[196:199], a[64:67], a[140:143], v[196:199]
  buffer_load_dwordx4 a[120:123], v10, s[8:11], s33 offen offset:0 sc1
  v_mfma_f32_16x16x32_bf16 v[200:203], a[68:71], a[140:143], v[200:203]
  v_mfma_f32_16x16x32_bf16 v[144:147], a[68:71], a[136:139], v[144:147]
  ds_read_b64_tr_b16 a[14:15], v12 offset:3680
  v_mfma_f32_16x16x32_bf16 v[88:91], a[68:71], a[132:135], v[88:91]
  ds_read_b64_tr_b16 a[16:17], v12 offset:128
  v_mfma_f32_16x16x32_bf16 v[32:35], a[68:71], a[128:131], v[32:35]
  ds_read_b64_tr_b16 a[18:19], v12 offset:3712
  v_mfma_f32_16x16x32_bf16 v[36:39], a[72:75], a[128:131], v[36:39]
  ds_read_b64_tr_b16 a[20:21], v12 offset:160
  v_mfma_f32_16x16x32_bf16 v[92:95], a[72:75], a[132:135], v[92:95]
  buffer_load_dwordx4 a[124:127], v11, s[8:11], s33 offen offset:0 sc1
  v_mfma_f32_16x16x32_bf16 v[148:151], a[72:75], a[136:139], v[148:151]
  v_mfma_f32_16x16x32_bf16 v[204:207], a[72:75], a[140:143], v[204:207]
  ds_read_b64_tr_b16 a[22:23], v12 offset:3744
  v_mfma_f32_16x16x32_bf16 v[208:211], a[76:79], a[140:143], v[208:211]
  ds_read_b64_tr_b16 a[24:25], v12 offset:192
  v_mfma_f32_16x16x32_bf16 v[152:155], a[76:79], a[136:139], v[152:155]
  ds_read_b64_tr_b16 a[26:27], v12 offset:3776
  v_mfma_f32_16x16x32_bf16 v[96:99], a[76:79], a[132:135], v[96:99]
  buffer_load_dwordx4 a[192:195], v13, s[8:11], s31 offen sc1
  v_mfma_f32_16x16x32_bf16 v[40:43], a[76:79], a[128:131], v[40:43]
  v_mfma_f32_16x16x32_bf16 v[44:47], a[80:83], a[128:131], v[44:47]
  ds_read_b64_tr_b16 a[28:29], v12 offset:14336
  s_add_u32 s31, s31, 114688
  v_mfma_f32_16x16x32_bf16 v[100:103], a[80:83], a[132:135], v[100:103]
  ds_read_b64_tr_b16 a[30:31], v12 offset:17920
  v_mfma_f32_16x16x32_bf16 v[156:159], a[80:83], a[136:139], v[156:159]
  ds_read_b64_tr_b16 a[32:33], v12 offset:14368
  v_mfma_f32_16x16x32_bf16 v[212:215], a[80:83], a[140:143], v[212:215]
  ds_read_b64_tr_b16 a[34:35], v12 offset:17952
  v_mfma_f32_16x16x32_bf16 v[216:219], a[84:87], a[140:143], v[216:219]
  buffer_load_dwordx4 a[196:199], v13, s[8:11], s31 offen sc1
  v_mfma_f32_16x16x32_bf16 v[160:163], a[84:87], a[136:139], v[160:163]
  v_mfma_f32_16x16x32_bf16 v[104:107], a[84:87], a[132:135], v[104:107]
  ds_read_b64_tr_b16 a[36:37], v12 offset:14400
  s_add_u32 s31, s31, 114688
  v_mfma_f32_16x16x32_bf16 v[48:51], a[84:87], a[128:131], v[48:51]
  ds_read_b64_tr_b16 a[38:39], v12 offset:17984
  v_mfma_f32_16x16x32_bf16 v[52:55], a[88:91], a[128:131], v[52:55]
  ds_read_b64_tr_b16 a[40:41], v12 offset:14432
  v_mfma_f32_16x16x32_bf16 v[108:111], a[88:91], a[132:135], v[108:111]
  buffer_load_dwordx4 a[200:203], v13, s[8:11], s31 offen sc1
  v_mfma_f32_16x16x32_bf16 v[164:167], a[88:91], a[136:139], v[164:167]
  v_mfma_f32_16x16x32_bf16 v[220:223], a[88:91], a[140:143], v[220:223]
  ds_read_b64_tr_b16 a[42:43], v12 offset:18016
  s_add_u32 s31, s31, 114688
  v_mfma_f32_16x16x32_bf16 v[224:227], a[92:95], a[140:143], v[224:227]
  ds_read_b64_tr_b16 a[44:45], v12 offset:14464
  v_mfma_f32_16x16x32_bf16 v[168:171], a[92:95], a[136:139], v[168:171]
  ds_read_b64_tr_b16 a[46:47], v12 offset:18048
  v_mfma_f32_16x16x32_bf16 v[112:115], a[92:95], a[132:135], v[112:115]
  ds_read_b64_tr_b16 a[48:49], v12 offset:14496
  v_mfma_f32_16x16x32_bf16 v[56:59], a[92:95], a[128:131], v[56:59]
  buffer_load_dwordx4 a[204:207], v13, s[8:11], s31 offen sc1
  v_mfma_f32_16x16x32_bf16 v[60:63], a[96:99], a[128:131], v[60:63]
  v_mfma_f32_16x16x32_bf16 v[116:119], a[96:99], a[132:135], v[116:119]
  ds_read_b64_tr_b16 a[50:51], v12 offset:18080
  s_add_u32 s31, s31, 114688
  v_mfma_f32_16x16x32_bf16 v[172:175], a[96:99], a[136:139], v[172:175]
  ds_read_b64_tr_b16 a[52:53], v12 offset:14528
  v_mfma_f32_16x16x32_bf16 v[228:231], a[96:99], a[140:143], v[228:231]
  ds_read_b64_tr_b16 a[54:55], v12 offset:18112
  v_mfma_f32_16x16x32_bf16 v[232:235], a[100:103], a[140:143], v[232:235]
  v_mfma_f32_16x16x32_bf16 v[176:179], a[100:103], a[136:139], v[176:179]
  v_mfma_f32_16x16x32_bf16 v[120:123], a[100:103], a[132:135], v[120:123]
  v_mfma_f32_16x16x32_bf16 v[64:67], a[100:103], a[128:131], v[64:67]
  v_mfma_f32_16x16x32_bf16 v[68:71], a[104:107], a[128:131], v[68:71]
  v_mfma_f32_16x16x32_bf16 v[124:127], a[104:107], a[132:135], v[124:127]
  v_mfma_f32_16x16x32_bf16 v[180:183], a[104:107], a[136:139], v[180:183]
  v_mfma_f32_16x16x32_bf16 v[236:239], a[104:107], a[140:143], v[236:239]
  v_mfma_f32_16x16x32_bf16 v[240:243], a[108:111], a[140:143], v[240:243]
  v_mfma_f32_16x16x32_bf16 v[184:187], a[108:111], a[136:139], v[184:187]
  v_mfma_f32_16x16x32_bf16 v[128:131], a[108:111], a[132:135], v[128:131]
  v_mfma_f32_16x16x32_bf16 v[72:75], a[108:111], a[128:131], v[72:75]
  s_waitcnt vmcnt(27) lgkmcnt(0)
  v_mfma_f32_16x16x32_bf16 v[20:23], a[0:3], a[144:147], v[20:23]
  buffer_load_dwordx4 a[128:131], v8, s[8:11], s33 offen offset:1024 sc1
  v_mfma_f32_16x16x32_bf16 v[76:79], a[0:3], a[148:151], v[76:79]
  ds_read_b64_tr_b16 a[56:57], v12 offset:7168
  v_mfma_f32_16x16x32_bf16 v[132:135], a[0:3], a[152:155], v[132:135]
  ds_read_b64_tr_b16 a[58:59], v12 offset:10752
  v_mfma_f32_16x16x32_bf16 v[188:191], a[0:3], a[156:159], v[188:191]
  ds_read_b64_tr_b16 a[60:61], v12 offset:7200
  v_mfma_f32_16x16x32_bf16 v[192:195], a[4:7], a[156:159], v[192:195]
  buffer_load_dwordx4 a[132:135], v9, s[8:11], s33 offen offset:1024 sc1
  v_mfma_f32_16x16x32_bf16 v[136:139], a[4:7], a[152:155], v[136:139]
  ds_read_b64_tr_b16 a[62:63], v12 offset:10784
  v_mfma_f32_16x16x32_bf16 v[80:83], a[4:7], a[148:151], v[80:83]
  ds_read_b64_tr_b16 a[64:65], v12 offset:7232
  v_mfma_f32_16x16x32_bf16 v[24:27], a[4:7], a[144:147], v[24:27]
  ds_read_b64_tr_b16 a[66:67], v12 offset:10816
  v_mfma_f32_16x16x32_bf16 v[28:31], a[8:11], a[144:147], v[28:31]
  buffer_load_dwordx4 a[136:139], v10, s[8:11], s33 offen offset:1024 sc1
  v_mfma_f32_16x16x32_bf16 v[84:87], a[8:11], a[148:151], v[84:87]
  ds_read_b64_tr_b16 a[68:69], v12 offset:7264
  v_mfma_f32_16x16x32_bf16 v[140:143], a[8:11], a[152:155], v[140:143]
  ds_read_b64_tr_b16 a[70:71], v12 offset:10848
  v_mfma_f32_16x16x32_bf16 v[196:199], a[8:11], a[156:159], v[196:199]
  ds_read_b64_tr_b16 a[72:73], v12 offset:7296
  v_mfma_f32_16x16x32_bf16 v[200:203], a[12:15], a[156:159], v[200:203]
  buffer_load_dwordx4 a[140:143], v11, s[8:11], s33 offen offset:1024 sc1
  v_mfma_f32_16x16x32_bf16 v[144:147], a[12:15], a[152:155], v[144:147]
  ds_read_b64_tr_b16 a[74:75], v12 offset:10880
  v_mfma_f32_16x16x32_bf16 v[88:91], a[12:15], a[148:151], v[88:91]
  ds_read_b64_tr_b16 a[76:77], v12 offset:7328
  v_mfma_f32_16x16x32_bf16 v[32:35], a[12:15], a[144:147], v[32:35]
  ds_read_b64_tr_b16 a[78:79], v12 offset:10912
  v_mfma_f32_16x16x32_bf16 v[36:39], a[16:19], a[144:147], v[36:39]
  buffer_load_dword a178, v253, s[8:11], s30 offen offset:0 sc1
  v_mfma_f32_16x16x32_bf16 v[92:95], a[16:19], a[148:151], v[92:95]
  ds_read_b64_tr_b16 a[80:81], v12 offset:7360
  v_mfma_f32_16x16x32_bf16 v[148:151], a[16:19], a[152:155], v[148:151]
  ds_read_b64_tr_b16 a[82:83], v12 offset:10944
  v_mfma_f32_16x16x32_bf16 v[204:207], a[16:19], a[156:159], v[204:207]
  ds_read_b64_tr_b16 a[84:85], v12 offset:21504
  v_mfma_f32_16x16x32_bf16 v[208:211], a[20:23], a[156:159], v[208:211]
  buffer_load_dword a182, v253, s[8:11], s30 offen offset:128 sc1
  v_mfma_f32_16x16x32_bf16 v[152:155], a[20:23], a[152:155], v[152:155]
  ds_read_b64_tr_b16 a[86:87], v12 offset:25088
  v_mfma_f32_16x16x32_bf16 v[96:99], a[20:23], a[148:151], v[96:99]
  ds_read_b64_tr_b16 a[88:89], v12 offset:21536
  v_mfma_f32_16x16x32_bf16 v[40:43], a[20:23], a[144:147], v[40:43]
  ds_read_b64_tr_b16 a[90:91], v12 offset:25120
  v_mfma_f32_16x16x32_bf16 v[44:47], a[24:27], a[144:147], v[44:47]
  buffer_load_dword a186, v253, s[8:11], s30 offen offset:256 sc1
  v_mfma_f32_16x16x32_bf16 v[100:103], a[24:27], a[148:151], v[100:103]
  ds_read_b64_tr_b16 a[92:93], v12 offset:21568
  v_mfma_f32_16x16x32_bf16 v[156:159], a[24:27], a[152:155], v[156:159]
  ds_read_b64_tr_b16 a[94:95], v12 offset:25152
  v_mfma_f32_16x16x32_bf16 v[212:215], a[24:27], a[156:159], v[212:215]
  buffer_load_dword a190, v253, s[8:11], s30 offen offset:384 sc1
  s_add_u32 s30, s30, 16384
  v_mfma_f32_16x16x32_bf16 v[216:219], a[28:31], a[156:159], v[216:219]
  ds_read_b64_tr_b16 a[96:97], v12 offset:21600
  v_mfma_f32_16x16x32_bf16 v[160:163], a[28:31], a[152:155], v[160:163]
  ds_read_b64_tr_b16 a[98:99], v12 offset:25184
  v_mfma_f32_16x16x32_bf16 v[104:107], a[28:31], a[148:151], v[104:107]
  ds_read_b64_tr_b16 a[100:101], v12 offset:21632
  v_mfma_f32_16x16x32_bf16 v[48:51], a[28:31], a[144:147], v[48:51]
  buffer_load_dword a179, v253, s[8:11], s30 offen offset:0 sc1
  v_mfma_f32_16x16x32_bf16 v[52:55], a[32:35], a[144:147], v[52:55]
  ds_read_b64_tr_b16 a[102:103], v12 offset:25216
  v_mfma_f32_16x16x32_bf16 v[108:111], a[32:35], a[148:151], v[108:111]
  ds_read_b64_tr_b16 a[104:105], v12 offset:21664
  v_mfma_f32_16x16x32_bf16 v[164:167], a[32:35], a[152:155], v[164:167]
  ds_read_b64_tr_b16 a[106:107], v12 offset:25248
  v_mfma_f32_16x16x32_bf16 v[220:223], a[32:35], a[156:159], v[220:223]
  buffer_load_dword a183, v253, s[8:11], s30 offen offset:128 sc1
  v_mfma_f32_16x16x32_bf16 v[224:227], a[36:39], a[156:159], v[224:227]
  ds_read_b64_tr_b16 a[108:109], v12 offset:21696
  v_mfma_f32_16x16x32_bf16 v[168:171], a[36:39], a[152:155], v[168:171]
  ds_read_b64_tr_b16 a[110:111], v12 offset:25280
  v_mfma_f32_16x16x32_bf16 v[112:115], a[36:39], a[148:151], v[112:115]
  buffer_load_dword a187, v253, s[8:11], s30 offen offset:256 sc1
  v_mfma_f32_16x16x32_bf16 v[56:59], a[36:39], a[144:147], v[56:59]
  buffer_load_dword a191, v253, s[8:11], s30 offen offset:384 sc1
  s_add_u32 s30, s30, 16384
  v_mfma_f32_16x16x32_bf16 v[60:63], a[40:43], a[144:147], v[60:63]
  s_add_u32 s56, s58, L_P5-L_base
  s_addc_u32 s57, s59, 0
  v_mfma_f32_16x16x32_bf16 v[116:119], a[40:43], a[148:151], v[116:119]
  v_and_b32 v13, 7, v0
  v_mfma_f32_16x16x32_bf16 v[172:175], a[40:43], a[152:155], v[172:175]
  v_lshl_add_u32 v13, v13, 5, s4
  v_mfma_f32_16x16x32_bf16 v[228:231], a[40:43], a[156:159], v[228:231]
  v_lshlrev_b32 v13, 7, v13
  v_mfma_f32_16x16x32_bf16 v[232:235], a[44:47], a[156:159], v[232:235]
  v_min_u32 v13, L_end-L_P5-4, v13
  global_load_dword v13, v13, s[56:57]
  v_mfma_f32_16x16x32_bf16 v[176:179], a[44:47], a[152:155], v[176:179]
  v_mfma_f32_16x16x32_bf16 v[120:123], a[44:47], a[148:151], v[120:123]
  v_mfma_f32_16x16x32_bf16 v[64:67], a[44:47], a[144:147], v[64:67]
  v_mfma_f32_16x16x32_bf16 v[68:71], a[48:51], a[144:147], v[68:71]
  v_mfma_f32_16x16x32_bf16 v[124:127], a[48:51], a[148:151], v[124:127]
  v_mfma_f32_16x16x32_bf16 v[180:183], a[48:51], a[152:155], v[180:183]
  s_add_u32 s44, s39, 28672
  v_mfma_f32_16x16x32_bf16 v[236:239], a[48:51], a[156:159], v[236:239]
  s_cmp_ge_u32 s44, 114688
  s_cselect_b32 s44, 0, s44
  v_mfma_f32_16x16x32_bf16 v[240:243], a[52:55], a[156:159], v[240:243]
  s_sub_u32 s45, s44, s39
  v_mfma_f32_16x16x32_bf16 v[184:187], a[52:55], a[152:155], v[184:187]
  s_mov_b32 s39, s44
  v_mfma_f32_16x16x32_bf16 v[128:131], a[52:55], a[148:151], v[128:131]
  v_add_u32 v12, s45, v12
  v_mfma_f32_16x16x32_bf16 v[72:75], a[52:55], a[144:147], v[72:75]
  s_waitcnt vmcnt(32) lgkmcnt(0)
  s_barrier
  v_mfma_f32_16x16x32_bf16 v[20:23], a[56:59], a[160:163], v[20:23]
  buffer_load_dwordx4 a[144:147], v8, s[8:11], s33 offen offset:2048 sc1
  ds_read_b64_tr_b16 a[0:1], v12 offset:0
  v_mfma_f32_16x16x32_bf16 v[76:79], a[56:59], a[164:167], v[76:79]
  ds_read_b64_tr_b16 a[2:3], v12 offset:3584
  ds_read_b64_tr_b16 a[4:5], v12 offset:32
  v_mfma_f32_16x16x32_bf16 v[132:135], a[56:59], a[168:171], v[132:135]
  ds_read_b64_tr_b16 a[6:7], v12 offset:3616
  ds_read_b64_tr_b16 a[8:9], v12 offset:64
  v_mfma_f32_16x16x32_bf16 v[188:191], a[56:59], a[172:175], v[188:191]
  ds_read_b64_tr_b16 a[10:11], v12 offset:3648
  ds_read_b64_tr_b16 a[12:13], v12 offset:96
  v_mfma_f32_16x16x32_bf16 v[192:195], a[60:63], a[172:175], v[192:195]
  ds_read_b64_tr_b16 a[14:15], v12 offset:3680
  ds_read_b64_tr_b16 a[16:17], v12 offset:128
  v_mfma_f32_16x16x32_bf16 v[136:139], a[60:63], a[168:171], v[136:139]
  ds_read_b64_tr_b16 a[18:19], v12 offset:3712
  ds_read_b64_tr_b16 a[20:21], v12 offset:160
  v_mfma_f32_16x16x32_bf16 v[80:83], a[60:63], a[164:167], v[80:83]
  ds_read_b64_tr_b16 a[22:23], v12 offset:3744
  ds_read_b64_tr_b16 a[24:25], v12 offset:192
  v_mfma_f32_16x16x32_bf16 v[24:27], a[60:63], a[160:163], v[24:27]
  ds_read_b64_tr_b16 a[26:27], v12 offset:3776
  ds_read_b64_tr_b16 a[28:29], v12 offset:14336
  v_mfma_f32_16x16x32_bf16 v[28:31], a[64:67], a[160:163], v[28:31]
  ds_read_b64_tr_b16 a[30:31], v12 offset:17920
  ds_read_b64_tr_b16 a[32:33], v12 offset:14368
  v_mfma_f32_16x16x32_bf16 v[84:87], a[64:67], a[164:167], v[84:87]
  ds_read_b64_tr_b16 a[34:35], v12 offset:17952
  ds_read_b64_tr_b16 a[36:37], v12 offset:14400
  v_mfma_f32_16x16x32_bf16 v[140:143], a[64:67], a[168:171], v[140:143]
  ds_read_b64_tr_b16 a[38:39], v12 offset:17984
  ds_read_b64_tr_b16 a[40:41], v12 offset:14432
  v_mfma_f32_16x16x32_bf16 v[196:199], a[64:67], a[172:175], v[196:199]
  ds_read_b64_tr_b16 a[42:43], v12 offset:18016
  ds_read_b64_tr_b16 a[44:45], v12 offset:14464
  v_mfma_f32_16x16x32_bf16 v[200:203], a[68:71], a[172:175], v[200:203]
  buffer_load_dwordx4 a[148:151], v9, s[8:11], s33 offen offset:2048 sc1
  ds_read_b64_tr_b16 a[46:47], v12 offset:18048
  v_mfma_f32_16x16x32_bf16 v[144:147], a[68:71], a[168:171], v[144:147]
  ds_read_b64_tr_b16 a[48:49], v12 offset:14496
  ds_read_b64_tr_b16 a[50:51], v12 offset:18080
  v_mfma_f32_16x16x32_bf16 v[88:91], a[68:71], a[164:167], v[88:91]
  ds_read_b64_tr_b16 a[52:53], v12 offset:14528
  ds_read_b64_tr_b16 a[54:55], v12 offset:18112
  v_mfma_f32_16x16x32_bf16 v[32:35], a[68:71], a[160:163], v[32:35]
  buffer_load_dwordx4 a[152:155], v10, s[8:11], s33 offen offset:2048 sc1
  buffer_load_dwordx4 a[156:159], v11, s[8:11], s33 offen offset:2048 sc1
  s_waitcnt vmcnt(17)
  v_mfma_f32_16x16x32_bf16 v[36:39], a[72:75], a[160:163], v[36:39]
  v_accvgpr_read_b32 v14, a192
  v_mfma_f32_16x16x32_bf16 v[92:95], a[72:75], a[164:167], v[92:95]
  v_accvgpr_read_b32 v15, a193
  v_mfma_f32_16x16x32_bf16 v[148:151], a[72:75], a[168:171], v[148:151]
  v_accvgpr_read_b32 v16, a194
  v_mfma_f32_16x16x32_bf16 v[204:207], a[72:75], a[172:175], v[204:207]
  v_accvgpr_read_b32 v17, a195
  v_mfma_f32_16x16x32_bf16 v[208:211], a[76:79], a[172:175], v[208:211]
  v_accvgpr_read_b32 v254, a196
  v_mfma_f32_16x16x32_bf16 v[152:155], a[76:79], a[168:171], v[152:155]
  v_add_f32 v14, v14, v254
  v_mfma_f32_16x16x32_bf16 v[96:99], a[76:79], a[164:167], v[96:99]
  v_accvgpr_read_b32 v252, a197
  v_mfma_f32_16x16x32_bf16 v[40:43], a[76:79], a[160:163], v[40:43]
  v_add_f32 v15, v15, v252
  v_mfma_f32_16x16x32_bf16 v[44:47], a[80:83], a[160:163], v[44:47]
  v_accvgpr_read_b32 v254, a198
  v_mfma_f32_16x16x32_bf16 v[100:103], a[80:83], a[164:167], v[100:103]
  v_add_f32 v16, v16, v254
  v_mfma_f32_16x16x32_bf16 v[156:159], a[80:83], a[168:171], v[156:159]
  v_accvgpr_read_b32 v252, a199
  v_mfma_f32_16x16x32_bf16 v[212:215], a[80:83], a[172:175], v[212:215]
  v_add_f32 v17, v17, v252
  v_mfma_f32_16x16x32_bf16 v[216:219], a[84:87], a[172:175], v[216:219]
  v_accvgpr_read_b32 v254, a200
  v_mfma_f32_16x16x32_bf16 v[160:163], a[84:87], a[168:171], v[160:163]
  v_add_f32 v14, v14, v254
  v_mfma_f32_16x16x32_bf16 v[104:107], a[84:87], a[164:167], v[104:107]
  v_accvgpr_read_b32 v252, a201
  v_mfma_f32_16x16x32_bf16 v[48:51], a[84:87], a[160:163], v[48:51]
  v_add_f32 v15, v15, v252
  v_mfma_f32_16x16x32_bf16 v[52:55], a[88:91], a[160:163], v[52:55]
  v_accvgpr_read_b32 v254, a202
  v_mfma_f32_16x16x32_bf16 v[108:111], a[88:91], a[164:167], v[108:111]
  v_add_f32 v16, v16, v254
  v_mfma_f32_16x16x32_bf16 v[164:167], a[88:91], a[168:171], v[164:167]
  v_accvgpr_read_b32 v252, a203
  v_mfma_f32_16x16x32_bf16 v[220:223], a[88:91], a[172:175], v[220:223]
  v_add_f32 v17, v17, v252
  v_mfma_f32_16x16x32_bf16 v[224:227], a[92:95], a[172:175], v[224:227]
  v_accvgpr_read_b32 v254, a204
  v_mfma_f32_16x16x32_bf16 v[168:171], a[92:95], a[168:171], v[168:171]
  v_add_f32 v14, v14, v254
  v_mfma_f32_16x16x32_bf16 v[112:115], a[92:95], a[164:167], v[112:115]
  v_accvgpr_read_b32 v252, a205
  v_mfma_f32_16x16x32_bf16 v[56:59], a[92:95], a[160:163], v[56:59]
  v_add_f32 v15, v15, v252
  v_mfma_f32_16x16x32_bf16 v[60:63], a[96:99], a[160:163], v[60:63]
  v_accvgpr_read_b32 v254, a206
  v_mfma_f32_16x16x32_bf16 v[116:119], a[96:99], a[164:167], v[116:119]
  v_add_f32 v16, v16, v254
  v_mfma_f32_16x16x32_bf16 v[172:175], a[96:99], a[168:171], v[172:175]
  v_accvgpr_read_b32 v252, a207
  v_mfma_f32_16x16x32_bf16 v[228:231], a[96:99], a[172:175], v[228:231]
  v_add_f32 v17, v17, v252
  v_mfma_f32_16x16x32_bf16 v[232:235], a[100:103], a[172:175], v[232:235]
  v_add_f32_dpp v14, v14, v14 quad_perm:[1,0,3,2] row_mask:0xf bank_mask:0xf
  v_mfma_f32_16x16x32_bf16 v[176:179], a[100:103], a[168:171], v[176:179]
  v_add_f32_dpp v15, v15, v15 quad_perm:[1,0,3,2] row_mask:0xf bank_mask:0xf
  v_mfma_f32_16x16x32_bf16 v[120:123], a[100:103], a[164:167], v[120:123]
  v_add_f32_dpp v16, v16, v16 quad_perm:[1,0,3,2] row_mask:0xf bank_mask:0xf
  v_mfma_f32_16x16x32_bf16 v[64:67], a[100:103], a[160:163], v[64:67]
  v_add_f32_dpp v17, v17, v17 quad_perm:[1,0,3,2] row_mask:0xf bank_mask:0xf
  v_mfma_f32_16x16x32_bf16 v[68:71], a[104:107], a[160:163], v[68:71]
  v_add_f32_dpp v14, v14, v14 quad_perm:[2,3,0,1] row_mask:0xf bank_mask:0xf
  v_mfma_f32_16x16x32_bf16 v[124:127], a[104:107], a[164:167], v[124:127]
  v_add_f32_dpp v15, v15, v15 quad_perm:[2,3,0,1] row_mask:0xf bank_mask:0xf
  v_mfma_f32_16x16x32_bf16 v[180:183], a[104:107], a[168:171], v[180:183]
  v_add_f32_dpp v16, v16, v16 quad_perm:[2,3,0,1] row_mask:0xf bank_mask:0xf
  v_mfma_f32_16x16x32_bf16 v[236:239], a[104:107], a[172:175], v[236:239]
  v_add_f32_dpp v17, v17, v17 quad_perm:[2,3,0,1] row_mask:0xf bank_mask:0xf
  ds_write_b128 v255, v[14:17]
  v_mfma_f32_16x16x32_bf16 v[240:243], a[108:111], a[172:175], v[240:243]
  v_mfma_f32_16x16x32_bf16 v[184:187], a[108:111], a[168:171], v[184:187]
  v_mfma_f32_16x16x32_bf16 v[128:131], a[108:111], a[164:167], v[128:131]
  v_mfma_f32_16x16x32_bf16 v[72:75], a[108:111], a[160:163], v[72:75]
  s_waitcnt vmcnt(21) lgkmcnt(0)
  v_mfma_f32_16x16x32_bf16 v[20:23], a[0:3], a[112:115], v[20:23]
  buffer_load_dwordx4 a[160:163], v8, s[8:11], s33 offen offset:3072 sc1
  ds_read_b64_tr_b16 a[56:57], v12 offset:7168
  v_mfma_f32_16x16x32_bf16 v[76:79], a[0:3], a[116:119], v[76:79]
  ds_read_b64_tr_b16 a[58:59], v12 offset:10752
  ds_read_b64_tr_b16 a[60:61], v12 offset:7200
  v_mfma_f32_16x16x32_bf16 v[132:135], a[0:3], a[120:123], v[132:135]
  ds_read_b64_tr_b16 a[62:63], v12 offset:10784
  ds_read_b64_tr_b16 a[64:65], v12 offset:7232
  v_mfma_f32_16x16x32_bf16 v[188:191], a[0:3], a[124:127], v[188:191]
  ds_read_b64_tr_b16 a[66:67], v12 offset:10816
  ds_read_b64_tr_b16 a[68:69], v12 offset:7264
  v_mfma_f32_16x16x32_bf16 v[192:195], a[4:7], a[124:127], v[192:195]
  ds_read_b64_tr_b16 a[70:71], v12 offset:10848
  ds_read_b64_tr_b16 a[72:73], v12 offset:7296
  v_mfma_f32_16x16x32_bf16 v[136:139], a[4:7], a[120:123], v[136:139]
  ds_read_b64_tr_b16 a[74:75], v12 offset:10880
  ds_read_b64_tr_b16 a[76:77], v12 offset:7328
  v_mfma_f32_16x16x32_bf16 v[80:83], a[4:7], a[116:119], v[80:83]
  ds_read_b64_tr_b16 a[78:79], v12 offset:10912
  ds_read_b64_tr_b16 a[80:81], v12 offset:7360
  v_mfma_f32_16x16x32_bf16 v[24:27], a[4:7], a[112:115], v[24:27]
  buffer_load_dwordx4 a[164:167], v9, s[8:11], s33 offen offset:3072 sc1
  ds_read_b64_tr_b16 a[82:83], v12 offset:10944
  v_mfma_f32_16x16x32_bf16 v[28:31], a[8:11], a[112:115], v[28:31]
  ds_read_b64_tr_b16 a[84:85], v12 offset:21504
  ds_read_b64_tr_b16 a[86:87], v12 offset:25088
  v_mfma_f32_16x16x32_bf16 v[84:87], a[8:11], a[116:119], v[84:87]
  ds_read_b64_tr_b16 a[88:89], v12 offset:21536
  ds_read_b64_tr_b16 a[90:91], v12 offset:25120
  v_mfma_f32_16x16x32_bf16 v[140:143], a[8:11], a[120:123], v[140:143]
  ds_read_b64_tr_b16 a[92:93], v12 offset:21568
  ds_read_b64_tr_b16 a[94:95], v12 offset:25152
  v_mfma_f32_16x16x32_bf16 v[196:199], a[8:11], a[124:127], v[196:199]
  ds_read_b64_tr_b16 a[96:97], v12 offset:21600
  ds_read_b64_tr_b16 a[98:99], v12 offset:25184
  v_mfma_f32_16x16x32_bf16 v[200:203], a[12:15], a[124:127], v[200:203]
  ds_read_b64_tr_b16 a[100:101], v12 offset:21632
  ds_read_b64_tr_b16 a[102:103], v12 offset:25216
  v_mfma_f32_16x16x32_bf16 v[144:147], a[12:15], a[120:123], v[144:147]
  buffer_load_dwordx4 a[168:171], v10, s[8:11], s33 offen offset:3072 sc1
  ds_read_b64_tr_b16 a[104:105], v12 offset:21664
  v_mfma_f32_16x16x32_bf16 v[88:91], a[12:15], a[116:119], v[88:91]
  ds_read_b64_tr_b16 a[106:107], v12 offset:25248
  ds_read_b64_tr_b16 a[108:109], v12 offset:21696
  v_mfma_f32_16x16x32_bf16 v[32:35], a[12:15], a[112:115], v[32:35]
  ds_read_b64_tr_b16 a[110:111], v12 offset:25280
  buffer_load_dwordx4 a[172:175], v11, s[8:11], s33 offen offset:3072 sc1
  s_and_b32 s28, s3, 2
  v_mfma_f32_16x16x32_bf16 v[36:39], a[16:19], a[112:115], v[36:39]
  s_lshr_b32 s28, s28, 1
  v_mfma_f32_16x16x32_bf16 v[92:95], a[16:19], a[116:119], v[92:95]
  s_lshl_b32 s29, s52, 1
  v_mfma_f32_16x16x32_bf16 v[148:151], a[16:19], a[120:123], v[148:151]
  s_add_u32 s54, s28, s29
  v_mfma_f32_16x16x32_bf16 v[204:207], a[16:19], a[124:127], v[204:207]
  s_lshr_b32 s28, s3, 2
  v_mfma_f32_16x16x32_bf16 v[208:211], a[20:23], a[124:127], v[208:211]
  s_lshl_b32 s28, s28, 2
  v_mfma_f32_16x16x32_bf16 v[152:155], a[20:23], a[120:123], v[152:155]
  s_lshr_b32 s29, s4, 3
  v_mfma_f32_16x16x32_bf16 v[96:99], a[20:23], a[116:119], v[96:99]
  s_add_u32 s55, s28, s29
  v_mfma_f32_16x16x32_bf16 v[40:43], a[20:23], a[112:115], v[40:43]
  s_lshl_b32 s28, s5, 4
  v_mfma_f32_16x16x32_bf16 v[44:47], a[24:27], a[112:115], v[44:47]
  v_add_u32 v252, s28, v4
  v_mfma_f32_16x16x32_bf16 v[100:103], a[24:27], a[116:119], v[100:103]
  v_lshlrev_b32 v252, 11, v252
  v_mfma_f32_16x16x32_bf16 v[156:159], a[24:27], a[120:123], v[156:159]
  s_lshl_b32 s28, s55, 8
  v_mfma_f32_16x16x32_bf16 v[212:215], a[24:27], a[124:127], v[212:215]
  v_add_u32 v252, s28, v252
  v_mfma_f32_16x16x32_bf16 v[216:219], a[28:31], a[124:127], v[216:219]
  v_lshlrev_b32 v253, 1, v4
  v_mfma_f32_16x16x32_bf16 v[160:163], a[28:31], a[120:123], v[160:163]
  v_xor_b32 v253, v253, v3
  v_mfma_f32_16x16x32_bf16 v[104:107], a[28:31], a[116:119], v[104:107]
  v_xor_b32 v254, 8, v253
  v_mfma_f32_16x16x32_bf16 v[48:51], a[28:31], a[112:115], v[48:51]
  v_lshl_add_u32 v14, v253, 4, v252
  v_mfma_f32_16x16x32_bf16 v[52:55], a[32:35], a[112:115], v[52:55]
  v_lshl_add_u32 v254, v254, 4, v252
  v_mfma_f32_16x16x32_bf16 v[108:111], a[32:35], a[116:119], v[108:111]
  v_add_u32 v15, 7168, v254
  v_mfma_f32_16x16x32_bf16 v[164:167], a[32:35], a[120:123], v[164:167]
  v_add_u32 v16, 14336, v14
  v_mfma_f32_16x16x32_bf16 v[220:223], a[32:35], a[124:127], v[220:223]
  v_add_u32 v17, 21504, v254
  v_mfma_f32_16x16x32_bf16 v[224:227], a[36:39], a[124:127], v[224:227]
  s_mov_b32 s16, s76
  v_mfma_f32_16x16x32_bf16 v[168:171], a[36:39], a[120:123], v[168:171]
  s_mov_b32 s17, s77
  v_mfma_f32_16x16x32_bf16 v[112:115], a[36:39], a[116:119], v[112:115]
  s_mov_b32 s18, 7340032
  v_mfma_f32_16x16x32_bf16 v[56:59], a[36:39], a[112:115], v[56:59]
  s_mov_b32 s19, 0x20000
  v_mfma_f32_16x16x32_bf16 v[60:63], a[40:43], a[112:115], v[60:63]
  s_and_b32 s28, s3, 1
  v_mfma_f32_16x16x32_bf16 v[116:119], a[40:43], a[116:119], v[116:119]
  s_mul_i32 s40, s28, 3145728
  v_mfma_f32_16x16x32_bf16 v[172:175], a[40:43], a[120:123], v[172:175]
  s_sub_u32 s40, s40, 131072
  v_mfma_f32_16x16x32_bf16 v[228:231], a[40:43], a[124:127], v[228:231]
  s_lshl_b32 s41, s5, 12
  v_mfma_f32_16x16x32_bf16 v[232:235], a[44:47], a[124:127], v[232:235]
  s_add_u32 s41, s41, 32768
  v_mfma_f32_16x16x32_bf16 v[176:179], a[44:47], a[120:123], v[176:179]
  s_add_u32 m0, s41, 81920
  v_mfma_f32_16x16x32_bf16 v[120:123], a[44:47], a[116:119], v[120:123]
  s_add_u32 s40, s40, 131072
  buffer_load_dwordx4 v14, s[16:19], s40 offen offset:0 lds
  buffer_load_dwordx4 v15, s[16:19], s40 offen offset:1024 lds
  v_mfma_f32_16x16x32_bf16 v[64:67], a[44:47], a[112:115], v[64:67]
  buffer_load_dwordx4 v16, s[16:19], s40 offen offset:2048 lds
  buffer_load_dwordx4 v17, s[16:19], s40 offen offset:3072 lds
  v_mfma_f32_16x16x32_bf16 v[68:71], a[48:51], a[112:115], v[68:71]
  v_mfma_f32_16x16x32_bf16 v[124:127], a[48:51], a[116:119], v[124:127]
  v_mfma_f32_16x16x32_bf16 v[180:183], a[48:51], a[120:123], v[180:183]
  s_add_u32 s44, s39, 28672
  v_mfma_f32_16x16x32_bf16 v[236:239], a[48:51], a[124:127], v[236:239]
  s_cmp_ge_u32 s44, 114688
  s_cselect_b32 s44, 0, s44
  v_mfma_f32_16x16x32_bf16 v[240:243], a[52:55], a[124:127], v[240:243]
  s_sub_u32 s45, s44, s39
  v_mfma_f32_16x16x32_bf16 v[184:187], a[52:55], a[120:123], v[184:187]
  s_mov_b32 s39, s44
  v_mfma_f32_16x16x32_bf16 v[128:131], a[52:55], a[116:119], v[128:131]
  v_add_u32 v12, s45, v12
  v_mfma_f32_16x16x32_bf16 v[72:75], a[52:55], a[112:115], v[72:75]
  s_waitcnt vmcnt(21) lgkmcnt(0)
  s_barrier
  v_mfma_f32_16x16x32_bf16 v[20:23], a[56:59], a[128:131], v[20:23]
  s_add_u32 m0, s41, 98304
  s_add_u32 s40, s40, 131072
  buffer_load_dwordx4 v14, s[16:19], s40 offen offset:0 lds
  ds_read_b64_tr_b16 a[0:1], v12 offset:0
  v_mfma_f32_16x16x32_bf16 v[76:79], a[56:59], a[132:135], v[76:79]
  ds_read_b64_tr_b16 a[2:3], v12 offset:3584
  ds_read_b64_tr_b16 a[4:5], v12 offset:32
  v_mfma_f32_16x16x32_bf16 v[132:135], a[56:59], a[136:139], v[132:135]
  ds_read_b64_tr_b16 a[6:7], v12 offset:3616
  ds_read_b64_tr_b16 a[8:9], v12 offset:64
  v_mfma_f32_16x16x32_bf16 v[188:191], a[56:59], a[140:143], v[188:191]
  ds_read_b64_tr_b16 a[10:11], v12 offset:3648
  ds_read_b64_tr_b16 a[12:13], v12 offset:96
  v_mfma_f32_16x16x32_bf16 v[192:195], a[60:63], a[140:143], v[192:195]
  ds_read_b64_tr_b16 a[14:15], v12 offset:3680
  ds_read_b64_tr_b16 a[16:17], v12 offset:128
  v_mfma_f32_16x16x32_bf16 v[136:139], a[60:63], a[136:139], v[136:139]
  ds_read_b64_tr_b16 a[18:19], v12 offset:3712
  ds_read_b64_tr_b16 a[20:21], v12 offset:160
  v_mfma_f32_16x16x32_bf16 v[80:83], a[60:63], a[132:135], v[80:83]
  ds_read_b64_tr_b16 a[22:23], v12 offset:3744
  ds_read_b64_tr_b16 a[24:25], v12 offset:192
  v_mfma_f32_16x16x32_bf16 v[24:27], a[60:63], a[128:131], v[24:27]
  ds_read_b64_tr_b16 a[26:27], v12 offset:3776
  ds_read_b64_tr_b16 a[28:29], v12 offset:14336
  v_mfma_f32_16x16x32_bf16 v[28:31], a[64:67], a[128:131], v[28:31]
  ds_read_b64_tr_b16 a[30:31], v12 offset:17920
  ds_read_b64_tr_b16 a[32:33], v12 offset:14368
  v_mfma_f32_16x16x32_bf16 v[84:87], a[64:67], a[132:135], v[84:87]
  ds_read_b64_tr_b16 a[34:35], v12 offset:17952
  ds_read_b64_tr_b16 a[36:37], v12 offset:14400
  v_mfma_f32_16x16x32_bf16 v[140:143], a[64:67], a[136:139], v[140:143]
  ds_read_b64_tr_b16 a[38:39], v12 offset:17984
  ds_read_b64_tr_b16 a[40:41], v12 offset:14432
  v_mfma_f32_16x16x32_bf16 v[196:199], a[64:67], a[140:143], v[196:199]
  ds_read_b64_tr_b16 a[42:43], v12 offset:18016
  ds_read_b64_tr_b16 a[44:45], v12 offset:14464
  v_mfma_f32_16x16x32_bf16 v[200:203], a[68:71], a[140:143], v[200:203]
  ds_read_b64_tr_b16 a[46:47], v12 offset:18048
  ds_read_b64_tr_b16 a[48:49], v12 offset:14496
  v_mfma_f32_16x16x32_bf16 v[144:147], a[68:71], a[136:139], v[144:147]
  ds_read_b64_tr_b16 a[50:51], v12 offset:18080
  ds_read_b64_tr_b16 a[52:53], v12 offset:14528
  v_mfma_f32_16x16x32_bf16 v[88:91], a[68:71], a[132:135], v[88:91]
  buffer_load_dwordx4 v15, s[16:19], s40 offen offset:1024 lds
  ds_read_b64_tr_b16 a[54:55], v12 offset:18112
  v_mfma_f32_16x16x32_bf16 v[32:35], a[68:71], a[128:131], v[32:35]
  buffer_load_dwordx4 v16, s[16:19], s40 offen offset:2048 lds
  buffer_load_dwordx4 v17, s[16:19], s40 offen offset:3072 lds
  s_waitcnt vmcnt(17)
  v_accvgpr_read_b32 v8, a176
  v_mfma_f32_16x16x32_bf16 v[36:39], a[72:75], a[128:131], v[36:39]
  v_accvgpr_read_b32 v252, a177
  v_accvgpr_read_b32 v253, a178
  v_mfma_f32_16x16x32_bf16 v[92:95], a[72:75], a[132:135], v[92:95]
  v_accvgpr_read_b32 v254, a179
  v_add_f32 v8, v8, v252
  v_mfma_f32_16x16x32_bf16 v[148:151], a[72:75], a[136:139], v[148:151]
  v_add_f32 v253, v253, v254
  v_add_f32 v8, v8, v253
  v_mfma_f32_16x16x32_bf16 v[204:207], a[72:75], a[140:143], v[204:207]
  v_accvgpr_read_b32 v9, a180
  v_accvgpr_read_b32 v252, a181
  v_mfma_f32_16x16x32_bf16 v[208:211], a[76:79], a[140:143], v[208:211]
  v_accvgpr_read_b32 v253, a182
  v_accvgpr_read_b32 v254, a183
  v_mfma_f32_16x16x32_bf16 v[152:155], a[76:79], a[136:139], v[152:155]
  v_add_f32 v9, v9, v252
  v_add_f32 v253, v253, v254
  v_mfma_f32_16x16x32_bf16 v[96:99], a[76:79], a[132:135], v[96:99]
  v_add_f32 v9, v9, v253
  v_accvgpr_read_b32 v10, a184
  v_mfma_f32_16x16x32_bf16 v[40:43], a[76:79], a[128:131], v[40:43]
  v_accvgpr_read_b32 v252, a185
  v_accvgpr_read_b32 v253, a186
  v_mfma_f32_16x16x32_bf16 v[44:47], a[80:83], a[128:131], v[44:47]
  v_accvgpr_read_b32 v254, a187
  v_add_f32 v10, v10, v252
  v_mfma_f32_16x16x32_bf16 v[100:103], a[80:83], a[132:135], v[100:103]
  v_add_f32 v253, v253, v254
  v_add_f32 v10, v10, v253
  v_mfma_f32_16x16x32_bf16 v[156:159], a[80:83], a[136:139], v[156:159]
  v_accvgpr_read_b32 v11, a188
  v_accvgpr_read_b32 v252, a189
  v_mfma_f32_16x16x32_bf16 v[212:215], a[80:83], a[140:143], v[212:215]
  v_accvgpr_read_b32 v253, a190
  v_accvgpr_read_b32 v254, a191
  v_mfma_f32_16x16x32_bf16 v[216:219], a[84:87], a[140:143], v[216:219]
  v_add_f32 v11, v11, v252
  v_add_f32 v253, v253, v254
  v_mfma_f32_16x16x32_bf16 v[160:163], a[84:87], a[136:139], v[160:163]
  v_add_f32 v11, v11, v253
  v_mov_b32 v252, v8
  v_mfma_f32_16x16x32_bf16 v[104:107], a[84:87], a[132:135], v[104:107]
  v_mov_b32 v253, v9
  v_mov_b32 v254, v10
  v_mfma_f32_16x16x32_bf16 v[48:51], a[84:87], a[128:131], v[48:51]
  v_mov_b32 v255, v11
  s_nop 0
  v_mfma_f32_16x16x32_bf16 v[52:55], a[88:91], a[128:131], v[52:55]
  v_permlane16_swap_b32 v8, v252
  v_permlane16_swap_b32 v9, v253
  v_mfma_f32_16x16x32_bf16 v[108:111], a[88:91], a[132:135], v[108:111]
  v_permlane16_swap_b32 v10, v254
  v_permlane16_swap_b32 v11, v255
  v_mfma_f32_16x16x32_bf16 v[164:167], a[88:91], a[136:139], v[164:167]
  v_add_f32 v8, v8, v252
  v_add_f32 v9, v9, v253
  v_mfma_f32_16x16x32_bf16 v[220:223], a[88:91], a[140:143], v[220:223]
  v_add_f32 v10, v10, v254
  v_add_f32 v11, v11, v255
  v_mfma_f32_16x16x32_bf16 v[224:227], a[92:95], a[140:143], v[224:227]
  v_mov_b32 v252, v8
  v_mov_b32 v253, v9
  v_mfma_f32_16x16x32_bf16 v[168:171], a[92:95], a[136:139], v[168:171]
  v_mov_b32 v254, v10
  v_mov_b32 v255, v11
  v_mfma_f32_16x16x32_bf16 v[112:115], a[92:95], a[132:135], v[112:115]
  s_nop 0
  v_permlane32_swap_b32 v8, v252
  v_mfma_f32_16x16x32_bf16 v[56:59], a[92:95], a[128:131], v[56:59]
  v_permlane32_swap_b32 v9, v253
  v_permlane32_swap_b32 v10, v254
  v_mfma_f32_16x16x32_bf16 v[60:63], a[96:99], a[128:131], v[60:63]
  v_permlane32_swap_b32 v11, v255
  v_add_f32 v8, v8, v252
  v_mfma_f32_16x16x32_bf16 v[116:119], a[96:99], a[132:135], v[116:119]
  v_add_f32 v9, v9, v253
  v_add_f32 v10, v10, v254
  v_mfma_f32_16x16x32_bf16 v[172:175], a[96:99], a[136:139], v[172:175]
  v_add_f32 v11, v11, v255
  v_mul_f32 v8, 0xba800000, v8
  v_mfma_f32_16x16x32_bf16 v[228:231], a[96:99], a[140:143], v[228:231]
  v_mul_f32 v9, 0xba800000, v9
  v_mul_f32 v10, 0xba800000, v10
  v_mfma_f32_16x16x32_bf16 v[232:235], a[100:103], a[140:143], v[232:235]
  v_mul_f32 v11, 0xba800000, v11
  v_mfma_f32_16x16x32_bf16 v[176:179], a[100:103], a[136:139], v[176:179]
  v_mfma_f32_16x16x32_bf16 v[120:123], a[100:103], a[132:135], v[120:123]
  v_mfma_f32_16x16x32_bf16 v[64:67], a[100:103], a[128:131], v[64:67]
  v_mfma_f32_16x16x32_bf16 v[68:71], a[104:107], a[128:131], v[68:71]
  v_mfma_f32_16x16x32_bf16 v[124:127], a[104:107], a[132:135], v[124:127]
  v_mfma_f32_16x16x32_bf16 v[180:183], a[104:107], a[136:139], v[180:183]
  v_mfma_f32_16x16x32_bf16 v[236:239], a[104:107], a[140:143], v[236:239]
  v_mfma_f32_16x16x32_bf16 v[240:243], a[108:111], a[140:143], v[240:243]
  v_mfma_f32_16x16x32_bf16 v[184:187], a[108:111], a[136:139], v[184:187]
  v_mfma_f32_16x16x32_bf16 v[128:131], a[108:111], a[132:135], v[128:131]
  v_mfma_f32_16x16x32_bf16 v[72:75], a[108:111], a[128:131], v[72:75]
  s_waitcnt vmcnt(12) lgkmcnt(0)
  v_mfma_f32_16x16x32_bf16 v[20:23], a[0:3], a[144:147], v[20:23]
  s_add_u32 m0, s41, 114688
  ds_read_b64_tr_b16 a[56:57], v12 offset:7168
  ds_read_b64_tr_b16 a[58:59], v12 offset:10752
  v_mfma_f32_16x16x32_bf16 v[76:79], a[0:3], a[148:151], v[76:79]
  s_add_u32 s40, s40, 131072
  buffer_load_dwordx4 v14, s[16:19], s40 offen offset:0 lds
  ds_read_b64_tr_b16 a[60:61], v12 offset:7200
  v_mfma_f32_16x16x32_bf16 v[80:83], a[4:7], a[148:151], v[80:83]
  ds_read_b64_tr_b16 a[62:63], v12 offset:10784
  ds_read_b64_tr_b16 a[64:65], v12 offset:7232
  v_mfma_f32_16x16x32_bf16 v[24:27], a[4:7], a[144:147], v[24:27]
  ds_read_b64_tr_b16 a[66:67], v12 offset:10816
  ds_read_b64_tr_b16 a[68:69], v12 offset:7264
  v_mfma_f32_16x16x32_bf16 v[28:31], a[8:11], a[144:147], v[28:31]
  ds_read_b64_tr_b16 a[70:71], v12 offset:10848
  ds_read_b64_tr_b16 a[72:73], v12 offset:7296
  v_mfma_f32_16x16x32_bf16 v[84:87], a[8:11], a[148:151], v[84:87]
  ds_read_b64_tr_b16 a[74:75], v12 offset:10880
  ds_read_b64_tr_b16 a[76:77], v12 offset:7328
  v_mfma_f32_16x16x32_bf16 v[88:91], a[12:15], a[148:151], v[88:91]
  ds_read_b64_tr_b16 a[78:79], v12 offset:10912
  ds_read_b64_tr_b16 a[80:81], v12 offset:7360
  v_mfma_f32_16x16x32_bf16 v[32:35], a[12:15], a[144:147], v[32:35]
  buffer_load_dwordx4 v15, s[16:19], s40 offen offset:1024 lds
  ds_read_b64_tr_b16 a[82:83], v12 offset:10944
  v_mfma_f32_16x16x32_bf16 v[36:39], a[16:19], a[144:147], v[36:39]
  ds_read_b64_tr_b16 a[84:85], v12 offset:21504
  ds_read_b64_tr_b16 a[86:87], v12 offset:25088
  v_mfma_f32_16x16x32_bf16 v[92:95], a[16:19], a[148:151], v[92:95]
  ds_read_b64_tr_b16 a[88:89], v12 offset:21536
  ds_read_b64_tr_b16 a[90:91], v12 offset:25120
  v_mfma_f32_16x16x32_bf16 v[96:99], a[20:23], a[148:151], v[96:99]
  ds_read_b64_tr_b16 a[92:93], v12 offset:21568
  ds_read_b64_tr_b16 a[94:95], v12 offset:25152
  v_mfma_f32_16x16x32_bf16 v[40:43], a[20:23], a[144:147], v[40:43]
  ds_read_b64_tr_b16 a[96:97], v12 offset:21600
  ds_read_b64_tr_b16 a[98:99], v12 offset:25184
  v_mfma_f32_16x16x32_bf16 v[44:47], a[24:27], a[144:147], v[44:47]
  ds_read_b64_tr_b16 a[100:101], v12 offset:21632
  ds_read_b64_tr_b16 a[102:103], v12 offset:25216
  v_mfma_f32_16x16x32_bf16 v[100:103], a[24:27], a[148:151], v[100:103]
  ds_read_b64_tr_b16 a[104:105], v12 offset:21664
  ds_read_b64_tr_b16 a[106:107], v12 offset:25248
  v_mfma_f32_16x16x32_bf16 v[104:107], a[28:31], a[148:151], v[104:107]
  buffer_load_dwordx4 v16, s[16:19], s40 offen offset:2048 lds
  ds_read_b64_tr_b16 a[108:109], v12 offset:21696
  v_mfma_f32_16x16x32_bf16 v[48:51], a[28:31], a[144:147], v[48:51]
  ds_read_b64_tr_b16 a[110:111], v12 offset:25280
  buffer_load_dwordx4 v17, s[16:19], s40 offen offset:3072 lds
  v_mfma_f32_16x16x32_bf16 v[52:55], a[32:35], a[144:147], v[52:55]
  v_mfma_f32_16x16x32_bf16 v[108:111], a[32:35], a[148:151], v[108:111]
  v_mfma_f32_16x16x32_bf16 v[112:115], a[36:39], a[148:151], v[112:115]
  v_mfma_f32_16x16x32_bf16 v[56:59], a[36:39], a[144:147], v[56:59]
  v_mfma_f32_16x16x32_bf16 v[60:63], a[40:43], a[144:147], v[60:63]
  v_mfma_f32_16x16x32_bf16 v[116:119], a[40:43], a[148:151], v[116:119]
  v_mfma_f32_16x16x32_bf16 v[120:123], a[44:47], a[148:151], v[120:123]
  v_mfma_f32_16x16x32_bf16 v[64:67], a[44:47], a[144:147], v[64:67]
  v_mfma_f32_16x16x32_bf16 v[68:71], a[48:51], a[144:147], v[68:71]
  v_mfma_f32_16x16x32_bf16 v[124:127], a[48:51], a[148:151], v[124:127]
  v_mfma_f32_16x16x32_bf16 v[128:131], a[52:55], a[148:151], v[128:131]
  v_mfma_f32_16x16x32_bf16 v[72:75], a[52:55], a[144:147], v[72:75]
  s_waitcnt vmcnt(12) lgkmcnt(15)
  v_mfma_f32_16x16x32_bf16 v[20:23], a[56:59], a[160:163], v[20:23]
  v_lshlrev_b32 v13, 4, v4
  v_mfma_f32_16x16x32_bf16 v[76:79], a[56:59], a[164:167], v[76:79]
  v_add_u32 v13, 28672, v13
  v_mfma_f32_16x16x32_bf16 v[80:83], a[60:63], a[164:167], v[80:83]
  v_mul_u32_u24 v248, 114688, v6
  v_mfma_f32_16x16x32_bf16 v[24:27], a[60:63], a[160:163], v[24:27]
  v_lshl_add_u32 v248, v5, 4, v248
  v_mfma_f32_16x16x32_bf16 v[28:31], a[64:67], a[160:163], v[28:31]
  s_mul_i32 s28, s32, 114688
  v_mfma_f32_16x16x32_bf16 v[84:87], a[64:67], a[164:167], v[84:87]
  s_mul_i32 s29, s53, 3584
  v_mfma_f32_16x16x32_bf16 v[88:91], a[68:71], a[164:167], v[88:91]
  s_add_u32 s28, s28, s29
  v_mfma_f32_16x16x32_bf16 v[32:35], a[68:71], a[160:163], v[32:35]
  s_add_u32 s28, s28, 16777216
  s_waitcnt lgkmcnt(10)
  v_mfma_f32_16x16x32_bf16 v[36:39], a[72:75], a[160:163], v[36:39]
  s_add_u32 s29, s28, 229376
  v_mfma_f32_16x16x32_bf16 v[92:95], a[72:75], a[164:167], v[92:95]
  v_mfma_f32_16x16x32_bf16 v[96:99], a[76:79], a[164:167], v[96:99]
  v_mfma_f32_16x16x32_bf16 v[40:43], a[76:79], a[160:163], v[40:43]
  v_mfma_f32_16x16x32_bf16 v[44:47], a[80:83], a[160:163], v[44:47]
  v_mfma_f32_16x16x32_bf16 v[100:103], a[80:83], a[164:167], v[100:103]
  v_mfma_f32_16x16x32_bf16 v[104:107], a[84:87], a[164:167], v[104:107]
  v_mfma_f32_16x16x32_bf16 v[48:51], a[84:87], a[160:163], v[48:51]
  v_mfma_f32_16x16x32_bf16 v[52:55], a[88:91], a[160:163], v[52:55]
  v_mfma_f32_16x16x32_bf16 v[108:111], a[88:91], a[164:167], v[108:111]
  s_waitcnt lgkmcnt(0)
  v_mfma_f32_16x16x32_bf16 v[112:115], a[92:95], a[164:167], v[112:115]
  v_mfma_f32_16x16x32_bf16 v[56:59], a[92:95], a[160:163], v[56:59]
  v_mfma_f32_16x16x32_bf16 v[60:63], a[96:99], a[160:163], v[60:63]
  v_mfma_f32_16x16x32_bf16 v[116:119], a[96:99], a[164:167], v[116:119]
  v_mfma_f32_16x16x32_bf16 v[120:123], a[100:103], a[164:167], v[120:123]
  v_mfma_f32_16x16x32_bf16 v[64:67], a[100:103], a[160:163], v[64:67]
  v_mfma_f32_16x16x32_bf16 v[68:71], a[104:107], a[160:163], v[68:71]
  v_mfma_f32_16x16x32_bf16 v[124:127], a[104:107], a[164:167], v[124:127]
  v_mfma_f32_16x16x32_bf16 v[128:131], a[108:111], a[164:167], v[128:131]
  v_mfma_f32_16x16x32_bf16 v[72:75], a[108:111], a[160:163], v[72:75]
  v_mfma_f32_16x16x32_bf16 v[132:135], a[0:3], a[152:155], v[132:135]
  ds_read_b128 v[252:255], v13 offset:0
  v_mfma_f32_16x16x32_bf16 v[188:191], a[0:3], a[156:159], v[188:191]
  ds_read_b128 v[244:247], v13 offset:448
  s_waitcnt lgkmcnt(1)
  v_fmac_f32 v20, v252, v8
  v_fmac_f32 v21, v253, v8
  v_fmac_f32 v22, v254, v8
  v_fmac_f32 v23, v255, v8
  v_fmac_f32 v76, v252, v9
  v_mfma_f32_16x16x32_bf16 v[192:195], a[4:7], a[156:159], v[192:195]
  v_fmac_f32 v77, v253, v9
  v_fmac_f32 v78, v254, v9
  v_fmac_f32 v79, v255, v9
  ds_read_b128 v[252:255], v13 offset:64
  s_waitcnt lgkmcnt(1)
  v_fmac_f32 v48, v244, v8
  v_fmac_f32 v49, v245, v8
  v_mfma_f32_16x16x32_bf16 v[136:139], a[4:7], a[152:155], v[136:139]
  v_fmac_f32 v50, v246, v8
  v_fmac_f32 v51, v247, v8
  v_fmac_f32 v104, v244, v9
  v_fmac_f32 v105, v245, v9
  v_fmac_f32 v106, v246, v9
  v_fmac_f32 v107, v247, v9
  ds_read_b128 v[244:247], v13 offset:512
  v_mfma_f32_16x16x32_bf16 v[140:143], a[8:11], a[152:155], v[140:143]
  v_max_f32 v20, 0, v20
  v_max_f32 v21, 0, v21
  v_max_f32 v22, 0, v22
  v_max_f32 v23, 0, v23
  v_max_f32 v76, 0, v76
  v_max_f32 v77, 0, v77
  v_mfma_f32_16x16x32_bf16 v[196:199], a[8:11], a[156:159], v[196:199]
  v_max_f32 v78, 0, v78
  v_max_f32 v79, 0, v79
  v_mul_f32 v20, v20, v48
  v_mul_f32 v21, v21, v49
  v_mul_f32 v22, v22, v50
  v_mul_f32 v23, v23, v51
  v_mfma_f32_16x16x32_bf16 v[200:203], a[12:15], a[156:159], v[200:203]
  v_mul_f32 v76, v76, v104
  v_mul_f32 v77, v77, v105
  v_mul_f32 v78, v78, v106
  v_mul_f32 v79, v79, v107
  v_cvt_pk_bf16_f32 v48, v20, v21
  v_cvt_pk_bf16_f32 v50, v76, v77
  v_mfma_f32_16x16x32_bf16 v[144:147], a[12:15], a[152:155], v[144:147]
  v_cvt_pk_bf16_f32 v49, v22, v23
  v_cvt_pk_bf16_f32 v51, v78, v79
  s_nop 0
  v_permlane32_swap_b32 v48, v50
  v_permlane32_swap_b32 v49, v51
  buffer_store_dwordx4 v[48:51], v248, s[8:11], s28 offen offset:0 sc1
  s_waitcnt lgkmcnt(1)
  v_mfma_f32_16x16x32_bf16 v[148:151], a[16:19], a[152:155], v[148:151]
  v_fmac_f32 v24, v252, v8
  v_fmac_f32 v25, v253, v8
  v_fmac_f32 v26, v254, v8
  v_fmac_f32 v27, v255, v8
  v_fmac_f32 v80, v252, v9
  v_fmac_f32 v81, v253, v9
  v_mfma_f32_16x16x32_bf16 v[204:207], a[16:19], a[156:159], v[204:207]
  v_fmac_f32 v82, v254, v9
  v_fmac_f32 v83, v255, v9
  ds_read_b128 v[252:255], v13 offset:128
  s_waitcnt lgkmcnt(1)
  v_fmac_f32 v52, v244, v8
  v_fmac_f32 v53, v245, v8
  v_fmac_f32 v54, v246, v8
  v_mfma_f32_16x16x32_bf16 v[208:211], a[20:23], a[156:159], v[208:211]
  v_fmac_f32 v55, v247, v8
  v_fmac_f32 v108, v244, v9
  v_fmac_f32 v109, v245, v9
  v_fmac_f32 v110, v246, v9
  v_fmac_f32 v111, v247, v9
  ds_read_b128 v[244:247], v13 offset:576
  v_max_f32 v24, 0, v24
  v_mfma_f32_16x16x32_bf16 v[152:155], a[20:23], a[152:155], v[152:155]
  v_max_f32 v25, 0, v25
  v_max_f32 v26, 0, v26
  v_max_f32 v27, 0, v27
  v_max_f32 v80, 0, v80
  v_max_f32 v81, 0, v81
  v_max_f32 v82, 0, v82
  v_mfma_f32_16x16x32_bf16 v[156:159], a[24:27], a[152:155], v[156:159]
  v_max_f32 v83, 0, v83
  v_mul_f32 v24, v24, v52
  v_mul_f32 v25, v25, v53
  v_mul_f32 v26, v26, v54
  v_mul_f32 v27, v27, v55
  v_mul_f32 v80, v80, v108
  v_mfma_f32_16x16x32_bf16 v[212:215], a[24:27], a[156:159], v[212:215]
  v_mul_f32 v81, v81, v109
  v_mul_f32 v82, v82, v110
  v_mul_f32 v83, v83, v111
  v_cvt_pk_bf16_f32 v52, v24, v25
  v_cvt_pk_bf16_f32 v54, v80, v81
  v_cvt_pk_bf16_f32 v53, v26, v27
  v_mfma_f32_16x16x32_bf16 v[216:219], a[28:31], a[156:159], v[216:219]
  v_cvt_pk_bf16_f32 v55, v82, v83
  s_nop 0
  v_permlane32_swap_b32 v52, v54
  v_permlane32_swap_b32 v53, v55
  buffer_store_dwordx4 v[52:55], v248, s[8:11], s28 offen offset:512 sc1
  s_waitcnt lgkmcnt(1)
  v_fmac_f32 v28, v252, v8
  v_mfma_f32_16x16x32_bf16 v[160:163], a[28:31], a[152:155], v[160:163]
  v_fmac_f32 v29, v253, v8
  v_fmac_f32 v30, v254, v8
  v_fmac_f32 v31, v255, v8
  v_fmac_f32 v84, v252, v9
  v_fmac_f32 v85, v253, v9
  v_fmac_f32 v86, v254, v9
  v_mfma_f32_16x16x32_bf16 v[164:167], a[32:35], a[152:155], v[164:167]
  v_fmac_f32 v87, v255, v9
  ds_read_b128 v[252:255], v13 offset:192
  s_waitcnt lgkmcnt(1)
  v_fmac_f32 v56, v244, v8
  v_fmac_f32 v57, v245, v8
  v_fmac_f32 v58, v246, v8
  v_fmac_f32 v59, v247, v8
  v_mfma_f32_16x16x32_bf16 v[220:223], a[32:35], a[156:159], v[220:223]
  v_fmac_f32 v112, v244, v9
  v_fmac_f32 v113, v245, v9
  v_fmac_f32 v114, v246, v9
  v_fmac_f32 v115, v247, v9
  ds_read_b128 v[244:247], v13 offset:640
  v_max_f32 v28, 0, v28
  v_max_f32 v29, 0, v29
  v_mfma_f32_16x16x32_bf16 v[224:227], a[36:39], a[156:159], v[224:227]
  v_max_f32 v30, 0, v30
  v_max_f32 v31, 0, v31
  v_max_f32 v84, 0, v84
  v_max_f32 v85, 0, v85
  v_max_f32 v86, 0, v86
  v_max_f32 v87, 0, v87
  v_mfma_f32_16x16x32_bf16 v[168:171], a[36:39], a[152:155], v[168:171]
  v_mul_f32 v28, v28, v56
  v_mul_f32 v29, v29, v57
  v_mul_f32 v30, v30, v58
  v_mul_f32 v31, v31, v59
  v_mul_f32 v84, v84, v112
  v_mul_f32 v85, v85, v113
  v_mfma_f32_16x16x32_bf16 v[172:175], a[40:43], a[152:155], v[172:175]
  v_mul_f32 v86, v86, v114
  v_mul_f32 v87, v87, v115
  v_cvt_pk_bf16_f32 v56, v28, v29
  v_cvt_pk_bf16_f32 v58, v84, v85
  v_cvt_pk_bf16_f32 v57, v30, v31
  v_cvt_pk_bf16_f32 v59, v86, v87
  v_mfma_f32_16x16x32_bf16 v[228:231], a[40:43], a[156:159], v[228:231]
  s_nop 0
  v_permlane32_swap_b32 v56, v58
  v_permlane32_swap_b32 v57, v59
  buffer_store_dwordx4 v[56:59], v248, s[8:11], s28 offen offset:1024 sc1
  s_waitcnt lgkmcnt(1)
  v_fmac_f32 v32, v252, v8
  v_fmac_f32 v33, v253, v8
  v_mfma_f32_16x16x32_bf16 v[232:235], a[44:47], a[156:159], v[232:235]
  v_fmac_f32 v34, v254, v8
  v_fmac_f32 v35, v255, v8
  v_fmac_f32 v88, v252, v9
  v_fmac_f32 v89, v253, v9
  v_fmac_f32 v90, v254, v9
  v_fmac_f32 v91, v255, v9
  ds_read_b128 v[252:255], v13 offset:256
  v_mfma_f32_16x16x32_bf16 v[176:179], a[44:47], a[152:155], v[176:179]
  s_waitcnt lgkmcnt(1)
  v_fmac_f32 v60, v244, v8
  v_fmac_f32 v61, v245, v8
  v_fmac_f32 v62, v246, v8
  v_fmac_f32 v63, v247, v8
  v_fmac_f32 v116, v244, v9
  v_mfma_f32_16x16x32_bf16 v[180:183], a[48:51], a[152:155], v[180:183]
  v_fmac_f32 v117, v245, v9
  v_fmac_f32 v118, v246, v9
  v_fmac_f32 v119, v247, v9
  ds_read_b128 v[244:247], v13 offset:704
  v_mfma_f32_16x16x32_bf16 v[236:239], a[48:51], a[156:159], v[236:239]
  v_mfma_f32_16x16x32_bf16 v[240:243], a[52:55], a[156:159], v[240:243]
  v_mfma_f32_16x16x32_bf16 v[184:187], a[52:55], a[152:155], v[184:187]
  v_mfma_f32_16x16x32_bf16 v[132:135], a[56:59], a[168:171], v[132:135]
  v_max_f32 v32, 0, v32
  v_max_f32 v33, 0, v33
  v_max_f32 v34, 0, v34
  v_max_f32 v35, 0, v35
  v_max_f32 v88, 0, v88
  v_max_f32 v89, 0, v89
  v_mfma_f32_16x16x32_bf16 v[188:191], a[56:59], a[172:175], v[188:191]
  v_max_f32 v90, 0, v90
  v_max_f32 v91, 0, v91
  v_mul_f32 v32, v32, v60
  v_mul_f32 v33, v33, v61
  v_mul_f32 v34, v34, v62
  v_mul_f32 v35, v35, v63
  v_mfma_f32_16x16x32_bf16 v[192:195], a[60:63], a[172:175], v[192:195]
  v_mul_f32 v88, v88, v116
  v_mul_f32 v89, v89, v117
  v_mul_f32 v90, v90, v118
  v_mul_f32 v91, v91, v119
  v_cvt_pk_bf16_f32 v60, v32, v33
  v_cvt_pk_bf16_f32 v62, v88, v89
  v_mfma_f32_16x16x32_bf16 v[136:139], a[60:63], a[168:171], v[136:139]
  v_cvt_pk_bf16_f32 v61, v34, v35
  v_cvt_pk_bf16_f32 v63, v90, v91
  s_nop 0
  v_permlane32_swap_b32 v60, v62
  v_permlane32_swap_b32 v61, v63
  buffer_store_dwordx4 v[60:63], v248, s[8:11], s28 offen offset:1536 sc1
  s_waitcnt lgkmcnt(1)
  v_mfma_f32_16x16x32_bf16 v[140:143], a[64:67], a[168:171], v[140:143]
  v_fmac_f32 v36, v252, v8
  v_fmac_f32 v37, v253, v8
  v_fmac_f32 v38, v254, v8
  v_fmac_f32 v39, v255, v8
  v_fmac_f32 v92, v252, v9
  v_fmac_f32 v93, v253, v9
  v_mfma_f32_16x16x32_bf16 v[196:199], a[64:67], a[172:175], v[196:199]
  v_fmac_f32 v94, v254, v9
  v_fmac_f32 v95, v255, v9
  ds_read_b128 v[252:255], v13 offset:320
  s_waitcnt lgkmcnt(1)
  v_fmac_f32 v64, v244, v8
  v_fmac_f32 v65, v245, v8
  v_fmac_f32 v66, v246, v8
  v_mfma_f32_16x16x32_bf16 v[200:203], a[68:71], a[172:175], v[200:203]
  v_fmac_f32 v67, v247, v8
  v_fmac_f32 v120, v244, v9
  v_fmac_f32 v121, v245, v9
  v_fmac_f32 v122, v246, v9
  v_fmac_f32 v123, v247, v9
  ds_read_b128 v[244:247], v13 offset:768
  v_max_f32 v36, 0, v36
  v_mfma_f32_16x16x32_bf16 v[144:147], a[68:71], a[168:171], v[144:147]
  v_max_f32 v37, 0, v37
  v_max_f32 v38, 0, v38
  v_max_f32 v39, 0, v39
  v_max_f32 v92, 0, v92
  v_max_f32 v93, 0, v93
  v_max_f32 v94, 0, v94
  v_mfma_f32_16x16x32_bf16 v[148:151], a[72:75], a[168:171], v[148:151]
  v_max_f32 v95, 0, v95
  v_mul_f32 v36, v36, v64
  v_mul_f32 v37, v37, v65
  v_mul_f32 v38, v38, v66
  v_mul_f32 v39, v39, v67
  v_mul_f32 v92, v92, v120
  v_mfma_f32_16x16x32_bf16 v[204:207], a[72:75], a[172:175], v[204:207]
  v_mul_f32 v93, v93, v121
  v_mul_f32 v94, v94, v122
  v_mul_f32 v95, v95, v123
  v_cvt_pk_bf16_f32 v64, v36, v37
  v_cvt_pk_bf16_f32 v66, v92, v93
  v_cvt_pk_bf16_f32 v65, v38, v39
  v_mfma_f32_16x16x32_bf16 v[208:211], a[76:79], a[172:175], v[208:211]
  v_cvt_pk_bf16_f32 v67, v94, v95
  s_nop 0
  v_permlane32_swap_b32 v64, v66
  v_permlane32_swap_b32 v65, v67
  buffer_store_dwordx4 v[64:67], v248, s[8:11], s28 offen offset:2048 sc1
  s_waitcnt lgkmcnt(1)
  v_fmac_f32 v40, v252, v8
  v_mfma_f32_16x16x32_bf16 v[152:155], a[76:79], a[168:171], v[152:155]
  v_fmac_f32 v41, v253, v8
  v_fmac_f32 v42, v254, v8
  v_fmac_f32 v43, v255, v8
  v_fmac_f32 v96, v252, v9
  v_fmac_f32 v97, v253, v9
  v_fmac_f32 v98, v254, v9
  v_mfma_f32_16x16x32_bf16 v[156:159], a[80:83], a[168:171], v[156:159]
  v_fmac_f32 v99, v255, v9
  ds_read_b128 v[252:255], v13 offset:384
  s_waitcnt lgkmcnt(1)
  v_fmac_f32 v68, v244, v8
  v_fmac_f32 v69, v245, v8
  v_fmac_f32 v70, v246, v8
  v_fmac_f32 v71, v247, v8
  v_mfma_f32_16x16x32_bf16 v[212:215], a[80:83], a[172:175], v[212:215]
  v_fmac_f32 v124, v244, v9
  v_fmac_f32 v125, v245, v9
  v_fmac_f32 v126, v246, v9
  v_fmac_f32 v127, v247, v9
  ds_read_b128 v[244:247], v13 offset:832
  v_max_f32 v40, 0, v40
  v_max_f32 v41, 0, v41
  v_mfma_f32_16x16x32_bf16 v[216:219], a[84:87], a[172:175], v[216:219]
  v_max_f32 v42, 0, v42
  v_max_f32 v43, 0, v43
  v_max_f32 v96, 0, v96
  v_max_f32 v97, 0, v97
  v_max_f32 v98, 0, v98
  v_max_f32 v99, 0, v99
  v_mfma_f32_16x16x32_bf16 v[160:163], a[84:87], a[168:171], v[160:163]
  v_mul_f32 v40, v40, v68
  v_mul_f32 v41, v41, v69
  v_mul_f32 v42, v42, v70
  v_mul_f32 v43, v43, v71
  v_mul_f32 v96, v96, v124
  v_mul_f32 v97, v97, v125
  v_mfma_f32_16x16x32_bf16 v[164:167], a[88:91], a[168:171], v[164:167]
  v_mul_f32 v98, v98, v126
  v_mul_f32 v99, v99, v127
  v_cvt_pk_bf16_f32 v68, v40, v41
  v_cvt_pk_bf16_f32 v70, v96, v97
  v_cvt_pk_bf16_f32 v69, v42, v43
  v_cvt_pk_bf16_f32 v71, v98, v99
  v_mfma_f32_16x16x32_bf16 v[220:223], a[88:91], a[172:175], v[220:223]
  s_nop 0
  v_permlane32_swap_b32 v68, v70
  v_permlane32_swap_b32 v69, v71
  buffer_store_dwordx4 v[68:71], v248, s[8:11], s28 offen offset:2560 sc1
  s_waitcnt lgkmcnt(1)
  v_fmac_f32 v44, v252, v8
  v_fmac_f32 v45, v253, v8
  v_mfma_f32_16x16x32_bf16 v[224:227], a[92:95], a[172:175], v[224:227]
  v_fmac_f32 v46, v254, v8
  v_fmac_f32 v47, v255, v8
  v_fmac_f32 v100, v252, v9
  v_fmac_f32 v101, v253, v9
  v_fmac_f32 v102, v254, v9
  v_fmac_f32 v103, v255, v9
  v_mfma_f32_16x16x32_bf16 v[168:171], a[92:95], a[168:171], v[168:171]
  s_waitcnt lgkmcnt(0)
  v_fmac_f32 v72, v244, v8
  v_fmac_f32 v73, v245, v8
  v_fmac_f32 v74, v246, v8
  v_fmac_f32 v75, v247, v8
  v_fmac_f32 v128, v244, v9
  v_mfma_f32_16x16x32_bf16 v[172:175], a[96:99], a[168:171], v[172:175]
  v_fmac_f32 v129, v245, v9
  v_fmac_f32 v130, v246, v9
  v_fmac_f32 v131, v247, v9
  v_max_f32 v44, 0, v44
  v_max_f32 v45, 0, v45
  v_max_f32 v46, 0, v46
  v_mfma_f32_16x16x32_bf16 v[228:231], a[96:99], a[172:175], v[228:231]
  v_max_f32 v47, 0, v47
  v_max_f32 v100, 0, v100
  v_max_f32 v101, 0, v101
  v_max_f32 v102, 0, v102
  v_max_f32 v103, 0, v103
  v_mul_f32 v44, v44, v72
  v_mfma_f32_16x16x32_bf16 v[232:235], a[100:103], a[172:175], v[232:235]
  v_mul_f32 v45, v45, v73
  v_mul_f32 v46, v46, v74
  v_mul_f32 v47, v47, v75
  v_mul_f32 v100, v100, v128
  v_mul_f32 v101, v101, v129
  v_mul_f32 v102, v102, v130
  v_mfma_f32_16x16x32_bf16 v[176:179], a[100:103], a[168:171], v[176:179]
  v_mul_f32 v103, v103, v131
  v_cvt_pk_bf16_f32 v72, v44, v45
  v_cvt_pk_bf16_f32 v74, v100, v101
  v_cvt_pk_bf16_f32 v73, v46, v47
  v_cvt_pk_bf16_f32 v75, v102, v103
  s_nop 0
  v_mfma_f32_16x16x32_bf16 v[180:183], a[104:107], a[168:171], v[180:183]
  v_permlane32_swap_b32 v72, v74
  v_permlane32_swap_b32 v73, v75
  buffer_store_dwordx4 v[72:75], v248, s[8:11], s28 offen offset:3072 sc1
  v_mfma_f32_16x16x32_bf16 v[236:239], a[104:107], a[172:175], v[236:239]
  v_mfma_f32_16x16x32_bf16 v[240:243], a[108:111], a[172:175], v[240:243]
  v_mfma_f32_16x16x32_bf16 v[184:187], a[108:111], a[168:171], v[184:187]
  ds_read_b128 v[252:255], v13 offset:0
  ds_read_b128 v[244:247], v13 offset:448
  s_waitcnt lgkmcnt(1)
  v_pk_fma_f32 v[132:133], v[252:253], v[10:11], v[132:133] op_sel:[0,0,0] op_sel_hi:[1,0,1]
  v_pk_fma_f32 v[134:135], v[254:255], v[10:11], v[134:135] op_sel:[0,0,0] op_sel_hi:[1,0,1]
  v_pk_fma_f32 v[188:189], v[252:253], v[10:11], v[188:189] op_sel:[0,1,0] op_sel_hi:[1,1,1]
  v_pk_fma_f32 v[190:191], v[254:255], v[10:11], v[190:191] op_sel:[0,1,0] op_sel_hi:[1,1,1]
  ds_read_b128 v[252:255], v13 offset:64
  s_waitcnt lgkmcnt(1)
  v_pk_fma_f32 v[160:161], v[244:245], v[10:11], v[160:161] op_sel:[0,0,0] op_sel_hi:[1,0,1]
  v_pk_fma_f32 v[162:163], v[246:247], v[10:11], v[162:163] op_sel:[0,0,0] op_sel_hi:[1,0,1]
  v_pk_fma_f32 v[216:217], v[244:245], v[10:11], v[216:217] op_sel:[0,1,0] op_sel_hi:[1,1,1]
  v_pk_fma_f32 v[218:219], v[246:247], v[10:11], v[218:219] op_sel:[0,1,0] op_sel_hi:[1,1,1]
  ds_read_b128 v[244:247], v13 offset:512
  v_max_f32 v132, 0, v132
  v_max_f32 v133, 0, v133
  v_max_f32 v134, 0, v134
  v_max_f32 v135, 0, v135
  v_max_f32 v188, 0, v188
  v_max_f32 v189, 0, v189
  v_max_f32 v190, 0, v190
  v_max_f32 v191, 0, v191
  v_pk_mul_f32 v[132:133], v[132:133], v[160:161]
  v_pk_mul_f32 v[134:135], v[134:135], v[162:163]
  v_pk_mul_f32 v[188:189], v[188:189], v[216:217]
  v_pk_mul_f32 v[190:191], v[190:191], v[218:219]
  v_cvt_pk_bf16_f32 v160, v132, v133
  v_cvt_pk_bf16_f32 v162, v188, v189
  v_cvt_pk_bf16_f32 v161, v134, v135
  v_cvt_pk_bf16_f32 v163, v190, v191
  s_nop 1
  v_permlane32_swap_b32 v160, v162
  v_permlane32_swap_b32 v161, v163
  buffer_store_dwordx4 v[160:163], v248, s[8:11], s29 offen offset:0 sc1
  s_waitcnt lgkmcnt(1)
  v_pk_fma_f32 v[136:137], v[252:253], v[10:11], v[136:137] op_sel:[0,0,0] op_sel_hi:[1,0,1]
  v_pk_fma_f32 v[138:139], v[254:255], v[10:11], v[138:139] op_sel:[0,0,0] op_sel_hi:[1,0,1]
  v_pk_fma_f32 v[192:193], v[252:253], v[10:11], v[192:193] op_sel:[0,1,0] op_sel_hi:[1,1,1]
  v_pk_fma_f32 v[194:195], v[254:255], v[10:11], v[194:195] op_sel:[0,1,0] op_sel_hi:[1,1,1]
  ds_read_b128 v[252:255], v13 offset:128
  s_waitcnt lgkmcnt(1)
  v_pk_fma_f32 v[164:165], v[244:245], v[10:11], v[164:165] op_sel:[0,0,0] op_sel_hi:[1,0,1]
  v_pk_fma_f32 v[166:167], v[246:247], v[10:11], v[166:167] op_sel:[0,0,0] op_sel_hi:[1,0,1]
  v_pk_fma_f32 v[220:221], v[244:245], v[10:11], v[220:221] op_sel:[0,1,0] op_sel_hi:[1,1,1]
  v_pk_fma_f32 v[222:223], v[246:247], v[10:11], v[222:223] op_sel:[0,1,0] op_sel_hi:[1,1,1]
  ds_read_b128 v[244:247], v13 offset:576
  v_max_f32 v136, 0, v136
  v_max_f32 v137, 0, v137
  v_max_f32 v138, 0, v138
  v_max_f32 v139, 0, v139
  v_max_f32 v192, 0, v192
  v_max_f32 v193, 0, v193
  v_max_f32 v194, 0, v194
  v_max_f32 v195, 0, v195
  v_pk_mul_f32 v[136:137], v[136:137], v[164:165]
  v_pk_mul_f32 v[138:139], v[138:139], v[166:167]
  v_pk_mul_f32 v[192:193], v[192:193], v[220:221]
  v_pk_mul_f32 v[194:195], v[194:195], v[222:223]
  v_cvt_pk_bf16_f32 v164, v136, v137
  v_cvt_pk_bf16_f32 v166, v192, v193
  v_cvt_pk_bf16_f32 v165, v138, v139
  v_cvt_pk_bf16_f32 v167, v194, v195
  s_nop 1
  v_permlane32_swap_b32 v164, v166
  v_permlane32_swap_b32 v165, v167
  buffer_store_dwordx4 v[164:167], v248, s[8:11], s29 offen offset:512 sc1
  s_waitcnt lgkmcnt(1)
  v_pk_fma_f32 v[140:141], v[252:253], v[10:11], v[140:141] op_sel:[0,0,0] op_sel_hi:[1,0,1]
  v_pk_fma_f32 v[142:143], v[254:255], v[10:11], v[142:143] op_sel:[0,0,0] op_sel_hi:[1,0,1]
  v_pk_fma_f32 v[196:197], v[252:253], v[10:11], v[196:197] op_sel:[0,1,0] op_sel_hi:[1,1,1]
  v_pk_fma_f32 v[198:199], v[254:255], v[10:11], v[198:199] op_sel:[0,1,0] op_sel_hi:[1,1,1]
  ds_read_b128 v[252:255], v13 offset:192
  s_waitcnt lgkmcnt(1)
  v_pk_fma_f32 v[168:169], v[244:245], v[10:11], v[168:169] op_sel:[0,0,0] op_sel_hi:[1,0,1]
  v_pk_fma_f32 v[170:171], v[246:247], v[10:11], v[170:171] op_sel:[0,0,0] op_sel_hi:[1,0,1]
  v_pk_fma_f32 v[224:225], v[244:245], v[10:11], v[224:225] op_sel:[0,1,0] op_sel_hi:[1,1,1]
  v_pk_fma_f32 v[226:227], v[246:247], v[10:11], v[226:227] op_sel:[0,1,0] op_sel_hi:[1,1,1]
  ds_read_b128 v[244:247], v13 offset:640
  v_max_f32 v140, 0, v140
  v_max_f32 v141, 0, v141
  v_max_f32 v142, 0, v142
  v_max_f32 v143, 0, v143
  v_max_f32 v196, 0, v196
  v_max_f32 v197, 0, v197
  v_max_f32 v198, 0, v198
  v_max_f32 v199, 0, v199
  v_pk_mul_f32 v[140:141], v[140:141], v[168:169]
  v_pk_mul_f32 v[142:143], v[142:143], v[170:171]
  v_pk_mul_f32 v[196:197], v[196:197], v[224:225]
  v_pk_mul_f32 v[198:199], v[198:199], v[226:227]
  v_cvt_pk_bf16_f32 v168, v140, v141
  v_cvt_pk_bf16_f32 v170, v196, v197
  v_cvt_pk_bf16_f32 v169, v142, v143
  v_cvt_pk_bf16_f32 v171, v198, v199
  s_nop 1
  v_permlane32_swap_b32 v168, v170
  v_permlane32_swap_b32 v169, v171
  buffer_store_dwordx4 v[168:171], v248, s[8:11], s29 offen offset:1024 sc1
  s_waitcnt lgkmcnt(1)
  v_pk_fma_f32 v[144:145], v[252:253], v[10:11], v[144:145] op_sel:[0,0,0] op_sel_hi:[1,0,1]
  v_pk_fma_f32 v[146:147], v[254:255], v[10:11], v[146:147] op_sel:[0,0,0] op_sel_hi:[1,0,1]
  v_pk_fma_f32 v[200:201], v[252:253], v[10:11], v[200:201] op_sel:[0,1,0] op_sel_hi:[1,1,1]
  v_pk_fma_f32 v[202:203], v[254:255], v[10:11], v[202:203] op_sel:[0,1,0] op_sel_hi:[1,1,1]
  ds_read_b128 v[252:255], v13 offset:256
  s_waitcnt lgkmcnt(1)
  v_pk_fma_f32 v[172:173], v[244:245], v[10:11], v[172:173] op_sel:[0,0,0] op_sel_hi:[1,0,1]
  v_pk_fma_f32 v[174:175], v[246:247], v[10:11], v[174:175] op_sel:[0,0,0] op_sel_hi:[1,0,1]
  v_pk_fma_f32 v[228:229], v[244:245], v[10:11], v[228:229] op_sel:[0,1,0] op_sel_hi:[1,1,1]
  v_pk_fma_f32 v[230:231], v[246:247], v[10:11], v[230:231] op_sel:[0,1,0] op_sel_hi:[1,1,1]
  ds_read_b128 v[244:247], v13 offset:704
  v_max_f32 v144, 0, v144
  v_max_f32 v145, 0, v145
  v_max_f32 v146, 0, v146
  v_max_f32 v147, 0, v147
  v_max_f32 v200, 0, v200
  v_max_f32 v201, 0, v201
  v_max_f32 v202, 0, v202
  v_max_f32 v203, 0, v203
  v_pk_mul_f32 v[144:145], v[144:145], v[172:173]
  v_pk_mul_f32 v[146:147], v[146:147], v[174:175]
  v_pk_mul_f32 v[200:201], v[200:201], v[228:229]
  v_pk_mul_f32 v[202:203], v[202:203], v[230:231]
  v_cvt_pk_bf16_f32 v172, v144, v145
  v_cvt_pk_bf16_f32 v174, v200, v201
  v_cvt_pk_bf16_f32 v173, v146, v147
  v_cvt_pk_bf16_f32 v175, v202, v203
  s_nop 1
  v_permlane32_swap_b32 v172, v174
  v_permlane32_swap_b32 v173, v175
  buffer_store_dwordx4 v[172:175], v248, s[8:11], s29 offen offset:1536 sc1
  s_waitcnt lgkmcnt(1)
  v_pk_fma_f32 v[148:149], v[252:253], v[10:11], v[148:149] op_sel:[0,0,0] op_sel_hi:[1,0,1]
  v_pk_fma_f32 v[150:151], v[254:255], v[10:11], v[150:151] op_sel:[0,0,0] op_sel_hi:[1,0,1]
  v_pk_fma_f32 v[204:205], v[252:253], v[10:11], v[204:205] op_sel:[0,1,0] op_sel_hi:[1,1,1]
  v_pk_fma_f32 v[206:207], v[254:255], v[10:11], v[206:207] op_sel:[0,1,0] op_sel_hi:[1,1,1]
  ds_read_b128 v[252:255], v13 offset:320
  s_waitcnt lgkmcnt(1)
  v_pk_fma_f32 v[176:177], v[244:245], v[10:11], v[176:177] op_sel:[0,0,0] op_sel_hi:[1,0,1]
  v_pk_fma_f32 v[178:179], v[246:247], v[10:11], v[178:179] op_sel:[0,0,0] op_sel_hi:[1,0,1]
  v_pk_fma_f32 v[232:233], v[244:245], v[10:11], v[232:233] op_sel:[0,1,0] op_sel_hi:[1,1,1]
  v_pk_fma_f32 v[234:235], v[246:247], v[10:11], v[234:235] op_sel:[0,1,0] op_sel_hi:[1,1,1]
  ds_read_b128 v[244:247], v13 offset:768
  v_max_f32 v148, 0, v148
  v_max_f32 v149, 0, v149
  v_max_f32 v150, 0, v150
  v_max_f32 v151, 0, v151
  v_max_f32 v204, 0, v204
  v_max_f32 v205, 0, v205
  v_max_f32 v206, 0, v206
  v_max_f32 v207, 0, v207
  v_pk_mul_f32 v[148:149], v[148:149], v[176:177]
  v_pk_mul_f32 v[150:151], v[150:151], v[178:179]
  v_pk_mul_f32 v[204:205], v[204:205], v[232:233]
  v_pk_mul_f32 v[206:207], v[206:207], v[234:235]
  v_cvt_pk_bf16_f32 v176, v148, v149
  v_cvt_pk_bf16_f32 v178, v204, v205
  v_cvt_pk_bf16_f32 v177, v150, v151
  v_cvt_pk_bf16_f32 v179, v206, v207
  s_nop 1
  v_permlane32_swap_b32 v176, v178
  v_permlane32_swap_b32 v177, v179
  buffer_store_dwordx4 v[176:179], v248, s[8:11], s29 offen offset:2048 sc1
  s_waitcnt lgkmcnt(1)
  v_pk_fma_f32 v[152:153], v[252:253], v[10:11], v[152:153] op_sel:[0,0,0] op_sel_hi:[1,0,1]
  v_pk_fma_f32 v[154:155], v[254:255], v[10:11], v[154:155] op_sel:[0,0,0] op_sel_hi:[1,0,1]
  v_pk_fma_f32 v[208:209], v[252:253], v[10:11], v[208:209] op_sel:[0,1,0] op_sel_hi:[1,1,1]
  v_pk_fma_f32 v[210:211], v[254:255], v[10:11], v[210:211] op_sel:[0,1,0] op_sel_hi:[1,1,1]
  ds_read_b128 v[252:255], v13 offset:384
  s_waitcnt lgkmcnt(1)
  v_pk_fma_f32 v[180:181], v[244:245], v[10:11], v[180:181] op_sel:[0,0,0] op_sel_hi:[1,0,1]
  v_pk_fma_f32 v[182:183], v[246:247], v[10:11], v[182:183] op_sel:[0,0,0] op_sel_hi:[1,0,1]
  v_pk_fma_f32 v[236:237], v[244:245], v[10:11], v[236:237] op_sel:[0,1,0] op_sel_hi:[1,1,1]
  v_pk_fma_f32 v[238:239], v[246:247], v[10:11], v[238:239] op_sel:[0,1,0] op_sel_hi:[1,1,1]
  ds_read_b128 v[244:247], v13 offset:832
  v_max_f32 v152, 0, v152
  v_max_f32 v153, 0, v153
  v_max_f32 v154, 0, v154
  v_max_f32 v155, 0, v155
  v_max_f32 v208, 0, v208
  v_max_f32 v209, 0, v209
  v_max_f32 v210, 0, v210
  v_max_f32 v211, 0, v211
  v_pk_mul_f32 v[152:153], v[152:153], v[180:181]
  v_pk_mul_f32 v[154:155], v[154:155], v[182:183]
  v_pk_mul_f32 v[208:209], v[208:209], v[236:237]
  v_pk_mul_f32 v[210:211], v[210:211], v[238:239]
  v_cvt_pk_bf16_f32 v180, v152, v153
  v_cvt_pk_bf16_f32 v182, v208, v209
  v_cvt_pk_bf16_f32 v181, v154, v155
  v_cvt_pk_bf16_f32 v183, v210, v211
  s_nop 1
  v_permlane32_swap_b32 v180, v182
  v_permlane32_swap_b32 v181, v183
  buffer_store_dwordx4 v[180:183], v248, s[8:11], s29 offen offset:2560 sc1
  s_waitcnt lgkmcnt(1)
  v_pk_fma_f32 v[156:157], v[252:253], v[10:11], v[156:157] op_sel:[0,0,0] op_sel_hi:[1,0,1]
  v_pk_fma_f32 v[158:159], v[254:255], v[10:11], v[158:159] op_sel:[0,0,0] op_sel_hi:[1,0,1]
  v_pk_fma_f32 v[212:213], v[252:253], v[10:11], v[212:213] op_sel:[0,1,0] op_sel_hi:[1,1,1]
  v_pk_fma_f32 v[214:215], v[254:255], v[10:11], v[214:215] op_sel:[0,1,0] op_sel_hi:[1,1,1]
  s_waitcnt lgkmcnt(0)
  v_pk_fma_f32 v[184:185], v[244:245], v[10:11], v[184:185] op_sel:[0,0,0] op_sel_hi:[1,0,1]
  v_pk_fma_f32 v[186:187], v[246:247], v[10:11], v[186:187] op_sel:[0,0,0] op_sel_hi:[1,0,1]
  v_pk_fma_f32 v[240:241], v[244:245], v[10:11], v[240:241] op_sel:[0,1,0] op_sel_hi:[1,1,1]
  v_pk_fma_f32 v[242:243], v[246:247], v[10:11], v[242:243] op_sel:[0,1,0] op_sel_hi:[1,1,1]
  v_max_f32 v156, 0, v156
  v_max_f32 v157, 0, v157
  v_max_f32 v158, 0, v158
  v_max_f32 v159, 0, v159
  v_max_f32 v212, 0, v212
  v_max_f32 v213, 0, v213
  v_max_f32 v214, 0, v214
  v_max_f32 v215, 0, v215
  v_pk_mul_f32 v[156:157], v[156:157], v[184:185]
  v_pk_mul_f32 v[158:159], v[158:159], v[186:187]
  v_pk_mul_f32 v[212:213], v[212:213], v[240:241]
  v_pk_mul_f32 v[214:215], v[214:215], v[242:243]
  v_cvt_pk_bf16_f32 v184, v156, v157
  v_cvt_pk_bf16_f32 v186, v212, v213
  v_cvt_pk_bf16_f32 v185, v158, v159
  v_cvt_pk_bf16_f32 v187, v214, v215
  s_nop 1
  v_permlane32_swap_b32 v184, v186
  v_permlane32_swap_b32 v185, v187
  buffer_store_dwordx4 v[184:187], v248, s[8:11], s29 offen offset:3072 sc1
  s_lshl_b32 s47, s52, 7
  s_lshl_b32 s29, s53, 2
  s_add_u32 s47, s47, s29
  s_add_u32 s47, s47, 39856128
L_P5:
  s_lshr_b32 s28, s54, 1
  s_lshl_b32 s28, s28, 7
  s_add_u32 s28, s28, 39856128
  v_lshlrev_b32 v232, 2, v5
  v_add_u32 v232, s28, v232
  v_mov_b32 v228, 1
  v_mov_b32 v229, 0
  s_cmp_eq_u32 s5, 0
  s_cselect_b32 s47, s47, 2146435072
  s_waitcnt vmcnt(0)
  s_barrier
  buffer_store_dword v228, v229, s[8:11], s47 offen sc1
  s_add_u32 m0, s41, 0
  s_add_u32 s40, s40, 131072
  buffer_load_dwordx4 v14, s[16:19], s40 offen offset:0 lds
  buffer_load_dwordx4 v15, s[16:19], s40 offen offset:1024 lds
  buffer_load_dwordx4 v16, s[16:19], s40 offen offset:2048 lds
  buffer_load_dwordx4 v17, s[16:19], s40 offen offset:3072 lds
  s_and_b32 s34, s3, 1
  s_lshl_b32 s35, s55, 1
  s_add_u32 s35, s35, s34
  s_lshl_b32 s32, s54, 3
  s_lshl_b32 s28, s5, 1
  s_add_u32 s32, s32, s28
  v_lshrrev_b32 v37, 2, v1
  v_and_b32 v37, 3, v37
  v_and_b32 v38, 1, v4
  v_lshl_add_u32 v37, v38, 2, v37
  v_lshl_add_u32 v38, v6, 4, v37
  v_lshlrev_b32 v38, 8, v38
  s_lshl_b32 s28, s34, 2
  v_xor_b32 v37, s28, v37
  v_lshl_add_u32 v38, v37, 5, v38
  v_and_b32 v37, 3, v1
  v_lshl_add_u32 v38, v37, 3, v38
  v_add_u32 v20, 98304, v38
  v_xor_b32 v21, 32, v20
  v_xor_b32 v22, 64, v20
  v_xor_b32 v23, 96, v20
  v_xor_b32 v24, 128, v20
  v_xor_b32 v25, 160, v20
  v_xor_b32 v26, 192, v20
  v_xor_b32 v27, 224, v20
  v_lshrrev_b32 v37, 2, v1
  v_and_b32 v37, 3, v37
  v_and_b32 v38, 1, v4
  v_lshl_add_u32 v29, v38, 2, v37
  v_lshl_add_u32 v29, v6, 4, v29
  v_lshlrev_b32 v29, 7, v29
  v_lshrrev_b32 v37, 1, v37
  v_lshl_add_u32 v37, v38, 1, v37
  v_lshl_add_u32 v29, v37, 5, v29
  v_and_b32 v37, 3, v1
  v_lshl_add_u32 v28, v37, 3, v29
  v_add_u32 v28, 114688, v28
  v_xor_b32 v29, 32, v28
  v_xor_b32 v30, 64, v28
  v_xor_b32 v31, 96, v28
  v_lshrrev_b32 v37, 3, v1
  v_and_b32 v38, 6, v37
  s_lshl_b32 s29, s5, 4
  v_add_u32 v37, s29, v37
  v_lshlrev_b32 v37, 11, v37
  v_and_b32 v32, 7, v1
  v_xor_b32 v38, v38, v32
  v_lshl_add_u32 v37, v38, 4, v37
  s_lshl_b32 s29, s35, 7
  v_add_u32 v32, s29, v37
  v_add_u32 v33, 15360, v32
  s_add_u32 s36, s41, 65536
  s_mul_i32 s33, s32, 114688
  s_mul_i32 s28, s34, 49152
  s_add_u32 s33, s33, s28
  s_add_u32 s33, s33, 16777216
  v_mov_b32 v18, v2
  v_add_u32 v19, 114688, v2
  s_lshl_b32 s28, s4, 3
  s_lshl_b32 s29, s5, 1
  s_add_u32 s28, s28, s29
  v_and_b32 v34, 1, v1
  v_add_u32 v34, s28, v34
  v_lshlrev_b32 v34, 11, v34
  s_lshr_b32 s28, s3, 2
  s_lshl_b32 s28, s28, 10
  s_add_u32 s28, s28, 384
  s_mul_i32 s37, s34, 3145728
  s_add_u32 s37, s37, s28
  s_add_u32 s37, s37, 524288
  s_mov_b32 s12, s78
  s_mov_b32 s13, s79
  s_mov_b32 s14, 4194304
  s_mov_b32 s15, 0x20000
  ds_read_b64_tr_b16 v[108:109], v20 offset:16384
  ds_read_b64_tr_b16 v[110:111], v20 offset:18432
  ds_read_b64_tr_b16 v[112:113], v21 offset:16384
  ds_read_b64_tr_b16 v[114:115], v21 offset:18432
  ds_read_b64_tr_b16 v[116:117], v22 offset:16384
  ds_read_b64_tr_b16 v[118:119], v22 offset:18432
  ds_read_b64_tr_b16 v[120:121], v23 offset:16384
  ds_read_b64_tr_b16 v[122:123], v23 offset:18432
  ds_read_b64_tr_b16 v[124:125], v24 offset:16384
  ds_read_b64_tr_b16 v[126:127], v24 offset:18432
  ds_read_b64_tr_b16 v[128:129], v25 offset:16384
  ds_read_b64_tr_b16 v[130:131], v25 offset:18432
  ds_read_b64_tr_b16 v[132:133], v26 offset:16384
  ds_read_b64_tr_b16 v[134:135], v26 offset:18432
  ds_read_b64_tr_b16 v[136:137], v27 offset:16384
  ds_read_b64_tr_b16 v[138:139], v27 offset:18432
  s_cmp_lg_u32 s5, 0
  s_cbranch_scc1 L_p5_ok
  s_mov_b32 s26, 400000
L_p5_poll:
  buffer_load_dword v228, v232, s[8:11], 0 offen sc1
  s_waitcnt vmcnt(0)
  v_cmp_eq_u32 vcc, 0, v228
  s_sub_u32 s26, s26, 1
  s_cselect_b32 s27, 0, vcc_lo
  s_cselect_b32 s28, 0, vcc_hi
  s_or_b32 s27, s27, s28
  s_cbranch_scc0 L_p5_ok
  s_sleep 1
  s_branch L_p5_poll
L_p5_ok:
  s_barrier
  buffer_load_dwordx4 v[172:175], v18, s[8:11], s33 offen offset:0 sc1
  buffer_load_dwordx4 v[176:179], v19, s[8:11], s33 offen offset:0 sc1
  buffer_load_dwordx4 v[180:183], v18, s[8:11], s33 offen offset:1024 sc1
  buffer_load_dwordx4 v[184:187], v19, s[8:11], s33 offen offset:1024 sc1
  buffer_load_dwordx4 v[188:191], v18, s[8:11], s33 offen offset:2048 sc1
  buffer_load_dwordx4 v[192:195], v19, s[8:11], s33 offen offset:2048 sc1
  buffer_load_dwordx4 v[196:199], v18, s[8:11], s33 offen offset:3072 sc1
  buffer_load_dwordx4 v[200:203], v19, s[8:11], s33 offen offset:3072 sc1
  s_add_u32 s33, s33, 4096
  buffer_load_dwordx4 v[204:207], v18, s[8:11], s33 offen offset:0 sc1
  buffer_load_dwordx4 v[208:211], v19, s[8:11], s33 offen offset:0 sc1
  buffer_load_dwordx4 v[212:215], v18, s[8:11], s33 offen offset:1024 sc1
  buffer_load_dwordx4 v[216:219], v19, s[8:11], s33 offen offset:1024 sc1
  s_waitcnt vmcnt(10) lgkmcnt(8)
  v_mfma_f32_16x16x32_bf16 v[44:47], v[108:111], v[172:175], 0
  ds_read_b64_tr_b16 v[140:141], v20 offset:24576
  ds_read_b64_tr_b16 v[142:143], v20 offset:26624
  v_mfma_f32_16x16x32_bf16 v[76:79], v[108:111], v[176:179], 0
  ds_read_b64_tr_b16 v[144:145], v21 offset:24576
  v_mfma_f32_16x16x32_bf16 v[80:83], v[112:115], v[176:179], 0
  buffer_load_dwordx4 v[220:223], v18, s[8:11], s33 offen offset:2048 sc1
  v_mfma_f32_16x16x32_bf16 v[48:51], v[112:115], v[172:175], 0
  ds_read_b64_tr_b16 v[146:147], v21 offset:26624
  v_mfma_f32_16x16x32_bf16 v[52:55], v[116:119], v[172:175], 0
  ds_read_b64_tr_b16 v[148:149], v22 offset:24576
  ds_read_b64_tr_b16 v[150:151], v22 offset:26624
  v_mfma_f32_16x16x32_bf16 v[84:87], v[116:119], v[176:179], 0
  ds_read_b64_tr_b16 v[152:153], v23 offset:24576
  v_mfma_f32_16x16x32_bf16 v[88:91], v[120:123], v[176:179], 0
  buffer_load_dwordx4 v[224:227], v19, s[8:11], s33 offen offset:2048 sc1
  v_mfma_f32_16x16x32_bf16 v[56:59], v[120:123], v[172:175], 0
  ds_read_b64_tr_b16 v[154:155], v23 offset:26624
  s_add_u32 m0, s41, 16384
  s_waitcnt lgkmcnt(8)
  v_mfma_f32_16x16x32_bf16 v[60:63], v[124:127], v[172:175], 0
  ds_read_b64_tr_b16 v[156:157], v24 offset:24576
  ds_read_b64_tr_b16 v[158:159], v24 offset:26624
  s_add_u32 s40, s40, 131072
  v_mfma_f32_16x16x32_bf16 v[92:95], v[124:127], v[176:179], 0
  ds_read_b64_tr_b16 v[160:161], v25 offset:24576
  v_mfma_f32_16x16x32_bf16 v[96:99], v[128:131], v[176:179], 0
  buffer_load_dwordx4 v14, s[16:19], s40 offen offset:0 lds
  v_mfma_f32_16x16x32_bf16 v[64:67], v[128:131], v[172:175], 0
  ds_read_b64_tr_b16 v[162:163], v25 offset:26624
  v_mfma_f32_16x16x32_bf16 v[68:71], v[132:135], v[172:175], 0
  ds_read_b64_tr_b16 v[164:165], v26 offset:24576
  ds_read_b64_tr_b16 v[166:167], v26 offset:26624
  v_mfma_f32_16x16x32_bf16 v[100:103], v[132:135], v[176:179], 0
  ds_read_b64_tr_b16 v[168:169], v27 offset:24576
  v_mfma_f32_16x16x32_bf16 v[104:107], v[136:139], v[176:179], 0
  buffer_load_dwordx4 v15, s[16:19], s40 offen offset:1024 lds
  v_mfma_f32_16x16x32_bf16 v[72:75], v[136:139], v[172:175], 0
  ds_read_b64_tr_b16 v[170:171], v27 offset:26624
  s_waitcnt vmcnt(12) lgkmcnt(8)
  s_barrier
  v_mfma_f32_16x16x32_bf16 v[44:47], v[140:143], v[180:183], v[44:47]
  ds_read_b64_tr_b16 v[108:109], v20 offset:32768
  ds_read_b64_tr_b16 v[110:111], v20 offset:34816
  v_mfma_f32_16x16x32_bf16 v[76:79], v[140:143], v[184:187], v[76:79]
  ds_read_b64_tr_b16 v[112:113], v21 offset:32768
  v_mfma_f32_16x16x32_bf16 v[80:83], v[144:147], v[184:187], v[80:83]
  buffer_load_dwordx4 v[228:231], v18, s[8:11], s33 offen offset:3072 sc1
  v_mfma_f32_16x16x32_bf16 v[48:51], v[144:147], v[180:183], v[48:51]
  ds_read_b64_tr_b16 v[114:115], v21 offset:34816
  v_mfma_f32_16x16x32_bf16 v[52:55], v[148:151], v[180:183], v[52:55]
  ds_read_b64_tr_b16 v[116:117], v22 offset:32768
  ds_read_b64_tr_b16 v[118:119], v22 offset:34816
  v_mfma_f32_16x16x32_bf16 v[84:87], v[148:151], v[184:187], v[84:87]
  ds_read_b64_tr_b16 v[120:121], v23 offset:32768
  v_mfma_f32_16x16x32_bf16 v[88:91], v[152:155], v[184:187], v[88:91]
  buffer_load_dwordx4 v[232:235], v19, s[8:11], s33 offen offset:3072 sc1
  v_mfma_f32_16x16x32_bf16 v[56:59], v[152:155], v[180:183], v[56:59]
  ds_read_b64_tr_b16 v[122:123], v23 offset:34816
  s_waitcnt lgkmcnt(8)
  v_mfma_f32_16x16x32_bf16 v[60:63], v[156:159], v[180:183], v[60:63]
  ds_read_b64_tr_b16 v[124:125], v24 offset:32768
  ds_read_b64_tr_b16 v[126:127], v24 offset:34816
  v_mfma_f32_16x16x32_bf16 v[92:95], v[156:159], v[184:187], v[92:95]
  ds_read_b64_tr_b16 v[128:129], v25 offset:32768
  v_mfma_f32_16x16x32_bf16 v[96:99], v[160:163], v[184:187], v[96:99]
  buffer_load_dwordx4 v16, s[16:19], s40 offen offset:2048 lds
  v_mfma_f32_16x16x32_bf16 v[64:67], v[160:163], v[180:183], v[64:67]
  ds_read_b64_tr_b16 v[130:131], v25 offset:34816
  v_mfma_f32_16x16x32_bf16 v[68:71], v[164:167], v[180:183], v[68:71]
  ds_read_b64_tr_b16 v[132:133], v26 offset:32768
  ds_read_b64_tr_b16 v[134:135], v26 offset:34816
  v_mfma_f32_16x16x32_bf16 v[100:103], v[164:167], v[184:187], v[100:103]
  ds_read_b64_tr_b16 v[136:137], v27 offset:32768
  v_mfma_f32_16x16x32_bf16 v[104:107], v[168:171], v[184:187], v[104:107]
  buffer_load_dwordx4 v17, s[16:19], s40 offen offset:3072 lds
  v_mfma_f32_16x16x32_bf16 v[72:75], v[168:171], v[180:183], v[72:75]
  ds_read_b64_tr_b16 v[138:139], v27 offset:34816
  s_waitcnt vmcnt(14) lgkmcnt(8)
  v_mfma_f32_16x16x32_bf16 v[44:47], v[108:111], v[188:191], v[44:47]
  ds_read_b64_tr_b16 v[140:141], v20 offset:40960
  ds_read_b64_tr_b16 v[142:143], v20 offset:43008
  s_add_u32 s33, s33, 4096
  v_mfma_f32_16x16x32_bf16 v[76:79], v[108:111], v[192:195], v[76:79]
  buffer_load_dwordx4 v[172:175], v18, s[8:11], s33 offen offset:0 sc1
  v_mfma_f32_16x16x32_bf16 v[80:83], v[112:115], v[192:195], v[80:83]
  ds_read_b64_tr_b16 v[144:145], v21 offset:40960
  ds_read_b64_tr_b16 v[146:147], v21 offset:43008
  v_mfma_f32_16x16x32_bf16 v[48:51], v[112:115], v[188:191], v[48:51]
  buffer_load_dwordx4 v[176:179], v19, s[8:11], s33 offen offset:0 sc1
  v_mfma_f32_16x16x32_bf16 v[52:55], v[116:119], v[188:191], v[52:55]
  ds_read_b64_tr_b16 v[148:149], v22 offset:40960
  ds_read_b64_tr_b16 v[150:151], v22 offset:43008
  s_add_u32 m0, s41, 32768
  v_mfma_f32_16x16x32_bf16 v[84:87], v[116:119], v[192:195], v[84:87]
  s_add_u32 s40, s40, 131072
  buffer_load_dwordx4 v14, s[16:19], s40 offen offset:0 lds
  v_mfma_f32_16x16x32_bf16 v[88:91], v[120:123], v[192:195], v[88:91]
  ds_read_b64_tr_b16 v[152:153], v23 offset:40960
  ds_read_b64_tr_b16 v[154:155], v23 offset:43008
  v_mfma_f32_16x16x32_bf16 v[56:59], v[120:123], v[188:191], v[56:59]
  buffer_load_dwordx4 v15, s[16:19], s40 offen offset:1024 lds
  s_waitcnt lgkmcnt(8)
  v_mfma_f32_16x16x32_bf16 v[60:63], v[124:127], v[188:191], v[60:63]
  ds_read_b64_tr_b16 v[156:157], v24 offset:40960
  ds_read_b64_tr_b16 v[158:159], v24 offset:43008
  s_lshl_b32 s28, s32, 15
  v_mfma_f32_16x16x32_bf16 v[92:95], v[124:127], v[192:195], v[92:95]
  s_lshl_b32 s29, s35, 11
  s_add_u32 s28, s28, s29
  s_add_u32 s28, s28, 33554432
  v_add_u32 v37, 32768, v2
  buffer_load_dwordx4 a[0:3], v2, s[8:11], s28 offen offset:0 sc1
  v_mfma_f32_16x16x32_bf16 v[96:99], v[128:131], v[192:195], v[96:99]
  ds_read_b64_tr_b16 v[160:161], v25 offset:40960
  ds_read_b64_tr_b16 v[162:163], v25 offset:43008
  v_mfma_f32_16x16x32_bf16 v[64:67], v[128:131], v[188:191], v[64:67]
  buffer_load_dwordx4 a[4:7], v2, s[8:11], s28 offen offset:1024 sc1
  v_mfma_f32_16x16x32_bf16 v[68:71], v[132:135], v[188:191], v[68:71]
  ds_read_b64_tr_b16 v[164:165], v26 offset:40960
  ds_read_b64_tr_b16 v[166:167], v26 offset:43008
  v_mfma_f32_16x16x32_bf16 v[100:103], v[132:135], v[192:195], v[100:103]
  buffer_load_dwordx4 a[8:11], v37, s[8:11], s28 offen offset:0 sc1
  v_mfma_f32_16x16x32_bf16 v[104:107], v[136:139], v[192:195], v[104:107]
  ds_read_b64_tr_b16 v[168:169], v27 offset:40960
  ds_read_b64_tr_b16 v[170:171], v27 offset:43008
  v_mfma_f32_16x16x32_bf16 v[72:75], v[136:139], v[188:191], v[72:75]
  buffer_load_dwordx4 a[12:15], v37, s[8:11], s28 offen offset:1024 sc1
  s_waitcnt vmcnt(20) lgkmcnt(8)
  s_barrier
  v_mfma_f32_16x16x32_bf16 v[44:47], v[140:143], v[196:199], v[44:47]
  ds_read_b64_tr_b16 v[108:109], v20 offset:49152
  ds_read_b64_tr_b16 v[110:111], v20 offset:51200
  v_mfma_f32_16x16x32_bf16 v[76:79], v[140:143], v[200:203], v[76:79]
  buffer_load_dwordx4 v[180:183], v18, s[8:11], s33 offen offset:1024 sc1
  v_mfma_f32_16x16x32_bf16 v[80:83], v[144:147], v[200:203], v[80:83]
  ds_read_b64_tr_b16 v[112:113], v21 offset:49152
  ds_read_b64_tr_b16 v[114:115], v21 offset:51200
  v_mfma_f32_16x16x32_bf16 v[48:51], v[144:147], v[196:199], v[48:51]
  buffer_load_dwordx4 v[184:187], v19, s[8:11], s33 offen offset:1024 sc1
  v_mfma_f32_16x16x32_bf16 v[52:55], v[148:151], v[196:199], v[52:55]
  ds_read_b64_tr_b16 v[116:117], v22 offset:49152
  ds_read_b64_tr_b16 v[118:119], v22 offset:51200
  v_mfma_f32_16x16x32_bf16 v[84:87], v[148:151], v[200:203], v[84:87]
  buffer_load_dwordx4 v16, s[16:19], s40 offen offset:2048 lds
  v_mfma_f32_16x16x32_bf16 v[88:91], v[152:155], v[200:203], v[88:91]
  ds_read_b64_tr_b16 v[120:121], v23 offset:49152
  ds_read_b64_tr_b16 v[122:123], v23 offset:51200
  v_mfma_f32_16x16x32_bf16 v[56:59], v[152:155], v[196:199], v[56:59]
  buffer_load_dwordx4 v17, s[16:19], s40 offen offset:3072 lds
  s_waitcnt lgkmcnt(8)
  v_mfma_f32_16x16x32_bf16 v[60:63], v[156:159], v[196:199], v[60:63]
  ds_read_b64_tr_b16 v[124:125], v24 offset:49152
  ds_read_b64_tr_b16 v[126:127], v24 offset:51200
  v_lshlrev_b32 v38, 3, v3
  v_mfma_f32_16x16x32_bf16 v[92:95], v[156:159], v[200:203], v[92:95]
  v_lshl_add_u32 v38, v4, 16, v38
  s_lshl_b32 s28, s32, 7
  s_add_u32 s28, s28, 37748736
  buffer_load_dwordx2 a[16:17], v38, s[8:11], s28 offen offset:0 sc1
  v_mfma_f32_16x16x32_bf16 v[96:99], v[160:163], v[200:203], v[96:99]
  ds_read_b64_tr_b16 v[128:129], v25 offset:49152
  ds_read_b64_tr_b16 v[130:131], v25 offset:51200
  v_mfma_f32_16x16x32_bf16 v[64:67], v[160:163], v[196:199], v[64:67]
  buffer_load_dwordx2 a[24:25], v38, s[8:11], s28 offen offset:128 sc1
  v_mfma_f32_16x16x32_bf16 v[68:71], v[164:167], v[196:199], v[68:71]
  ds_read_b64_tr_b16 v[132:133], v26 offset:49152
  ds_read_b64_tr_b16 v[134:135], v26 offset:51200
  s_add_u32 s28, s28, 16384
  v_mfma_f32_16x16x32_bf16 v[100:103], v[164:167], v[200:203], v[100:103]
  buffer_load_dwordx2 a[18:19], v38, s[8:11], s28 offen offset:0 sc1
  v_mfma_f32_16x16x32_bf16 v[104:107], v[168:171], v[200:203], v[104:107]
  ds_read_b64_tr_b16 v[136:137], v27 offset:49152
  ds_read_b64_tr_b16 v[138:139], v27 offset:51200
  v_mfma_f32_16x16x32_bf16 v[72:75], v[168:171], v[196:199], v[72:75]
  buffer_load_dwordx2 a[26:27], v38, s[8:11], s28 offen offset:128 sc1
  s_add_u32 s28, s28, 16384
  s_waitcnt vmcnt(26) lgkmcnt(8)
  v_mfma_f32_16x16x32_bf16 v[44:47], v[108:111], v[204:207], v[44:47]
  ds_read_b64_tr_b16 v[140:141], v20 offset:57344
  ds_read_b64_tr_b16 v[142:143], v20 offset:59392
  v_xor_b32 v20, 65536, v20
  v_mfma_f32_16x16x32_bf16 v[76:79], v[108:111], v[208:211], v[76:79]
  buffer_load_dwordx4 v[188:191], v18, s[8:11], s33 offen offset:2048 sc1
  v_mfma_f32_16x16x32_bf16 v[80:83], v[112:115], v[208:211], v[80:83]
  ds_read_b64_tr_b16 v[144:145], v21 offset:57344
  ds_read_b64_tr_b16 v[146:147], v21 offset:59392
  v_xor_b32 v21, 65536, v21
  v_mfma_f32_16x16x32_bf16 v[48:51], v[112:115], v[204:207], v[48:51]
  buffer_load_dwordx4 v[192:195], v19, s[8:11], s33 offen offset:2048 sc1
  v_mfma_f32_16x16x32_bf16 v[52:55], v[116:119], v[204:207], v[52:55]
  ds_read_b64_tr_b16 v[148:149], v22 offset:57344
  ds_read_b64_tr_b16 v[150:151], v22 offset:59392
  v_xor_b32 v22, 65536, v22
  s_add_u32 m0, s41, 49152
  v_mfma_f32_16x16x32_bf16 v[84:87], v[116:119], v[208:211], v[84:87]
  s_add_u32 s40, s40, 131072
  buffer_load_dwordx4 v14, s[16:19], s40 offen offset:0 lds
  v_mfma_f32_16x16x32_bf16 v[88:91], v[120:123], v[208:211], v[88:91]
  ds_read_b64_tr_b16 v[152:153], v23 offset:57344
  ds_read_b64_tr_b16 v[154:155], v23 offset:59392
  v_xor_b32 v23, 65536, v23
  v_mfma_f32_16x16x32_bf16 v[56:59], v[120:123], v[204:207], v[56:59]
  buffer_load_dwordx4 v15, s[16:19], s40 offen offset:1024 lds
  s_waitcnt lgkmcnt(8)
  v_mfma_f32_16x16x32_bf16 v[60:63], v[124:127], v[204:207], v[60:63]
  ds_read_b64_tr_b16 v[156:157], v24 offset:57344
  ds_read_b64_tr_b16 v[158:159], v24 offset:59392
  v_xor_b32 v24, 65536, v24
  v_mfma_f32_16x16x32_bf16 v[92:95], v[124:127], v[208:211], v[92:95]
  buffer_load_dwordx2 a[20:21], v38, s[8:11], s28 offen offset:0 sc1
  v_mfma_f32_16x16x32_bf16 v[96:99], v[128:131], v[208:211], v[96:99]
  ds_read_b64_tr_b16 v[160:161], v25 offset:57344
  ds_read_b64_tr_b16 v[162:163], v25 offset:59392
  v_xor_b32 v25, 65536, v25
  v_mfma_f32_16x16x32_bf16 v[64:67], v[128:131], v[204:207], v[64:67]
  buffer_load_dwordx2 a[28:29], v38, s[8:11], s28 offen offset:128 sc1
  v_mfma_f32_16x16x32_bf16 v[68:71], v[132:135], v[204:207], v[68:71]
  ds_read_b64_tr_b16 v[164:165], v26 offset:57344
  ds_read_b64_tr_b16 v[166:167], v26 offset:59392
  v_xor_b32 v26, 65536, v26
  s_add_u32 s28, s28, 16384
  v_mfma_f32_16x16x32_bf16 v[100:103], v[132:135], v[208:211], v[100:103]
  buffer_load_dwordx2 a[22:23], v38, s[8:11], s28 offen offset:0 sc1
  v_mfma_f32_16x16x32_bf16 v[104:107], v[136:139], v[208:211], v[104:107]
  ds_read_b64_tr_b16 v[168:169], v27 offset:57344
  ds_read_b64_tr_b16 v[170:171], v27 offset:59392
  v_xor_b32 v27, 65536, v27
  v_mfma_f32_16x16x32_bf16 v[72:75], v[136:139], v[204:207], v[72:75]
  buffer_load_dwordx2 a[30:31], v38, s[8:11], s28 offen offset:128 sc1
  s_add_u32 s28, s28, 16384
  s_waitcnt vmcnt(32) lgkmcnt(8)
  s_barrier
  v_mfma_f32_16x16x32_bf16 v[44:47], v[140:143], v[212:215], v[44:47]
  ds_read_b64_tr_b16 v[108:109], v20 offset:0
  ds_read_b64_tr_b16 v[110:111], v20 offset:2048
  v_mfma_f32_16x16x32_bf16 v[76:79], v[140:143], v[216:219], v[76:79]
  ds_read_b64_tr_b16 v[112:113], v21 offset:0
  v_mfma_f32_16x16x32_bf16 v[80:83], v[144:147], v[216:219], v[80:83]
  buffer_load_dwordx4 v[196:199], v18, s[8:11], s33 offen offset:3072 sc1
  v_mfma_f32_16x16x32_bf16 v[48:51], v[144:147], v[212:215], v[48:51]
  ds_read_b64_tr_b16 v[114:115], v21 offset:2048
  v_mfma_f32_16x16x32_bf16 v[52:55], v[148:151], v[212:215], v[52:55]
  ds_read_b64_tr_b16 v[116:117], v22 offset:0
  ds_read_b64_tr_b16 v[118:119], v22 offset:2048
  v_mfma_f32_16x16x32_bf16 v[84:87], v[148:151], v[216:219], v[84:87]
  ds_read_b64_tr_b16 v[120:121], v23 offset:0
  v_mfma_f32_16x16x32_bf16 v[88:91], v[152:155], v[216:219], v[88:91]
  buffer_load_dwordx4 v[200:203], v19, s[8:11], s33 offen offset:3072 sc1
  v_mfma_f32_16x16x32_bf16 v[56:59], v[152:155], v[212:215], v[56:59]
  ds_read_b64_tr_b16 v[122:123], v23 offset:2048
  s_waitcnt lgkmcnt(8)
  v_mfma_f32_16x16x32_bf16 v[60:63], v[156:159], v[212:215], v[60:63]
  ds_read_b64_tr_b16 v[124:125], v24 offset:0
  ds_read_b64_tr_b16 v[126:127], v24 offset:2048
  v_mfma_f32_16x16x32_bf16 v[92:95], v[156:159], v[216:219], v[92:95]
  ds_read_b64_tr_b16 v[128:129], v25 offset:0
  v_mfma_f32_16x16x32_bf16 v[96:99], v[160:163], v[216:219], v[96:99]
  buffer_load_dwordx4 v16, s[16:19], s40 offen offset:2048 lds
  v_mfma_f32_16x16x32_bf16 v[64:67], v[160:163], v[212:215], v[64:67]
  ds_read_b64_tr_b16 v[130:131], v25 offset:2048
  v_mfma_f32_16x16x32_bf16 v[68:71], v[164:167], v[212:215], v[68:71]
  ds_read_b64_tr_b16 v[132:133], v26 offset:0
  ds_read_b64_tr_b16 v[134:135], v26 offset:2048
  v_mfma_f32_16x16x32_bf16 v[100:103], v[164:167], v[216:219], v[100:103]
  ds_read_b64_tr_b16 v[136:137], v27 offset:0
  v_mfma_f32_16x16x32_bf16 v[104:107], v[168:171], v[216:219], v[104:107]
  buffer_load_dwordx4 v17, s[16:19], s40 offen offset:3072 lds
  v_mfma_f32_16x16x32_bf16 v[72:75], v[168:171], v[212:215], v[72:75]
  ds_read_b64_tr_b16 v[138:139], v27 offset:2048
  s_mov_b32 s24, 4
.p2align 4
L_p5_4:
  s_waitcnt vmcnt(22) lgkmcnt(8)
  v_mfma_f32_16x16x32_bf16 v[44:47], v[108:111], v[220:223], v[44:47]
  ds_read_b64_tr_b16 v[140:141], v20 offset:8192
  ds_read_b64_tr_b16 v[142:143], v20 offset:10240
  s_add_u32 s33, s33, 4096
  v_mfma_f32_16x16x32_bf16 v[76:79], v[108:111], v[224:227], v[76:79]
  ds_read_b64_tr_b16 v[144:145], v21 offset:8192
  v_mfma_f32_16x16x32_bf16 v[80:83], v[112:115], v[224:227], v[80:83]
  buffer_load_dwordx4 v[204:207], v18, s[8:11], s33 offen offset:0 sc1
  v_mfma_f32_16x16x32_bf16 v[48:51], v[112:115], v[220:223], v[48:51]
  ds_read_b64_tr_b16 v[146:147], v21 offset:10240
  v_mfma_f32_16x16x32_bf16 v[52:55], v[116:119], v[220:223], v[52:55]
  ds_read_b64_tr_b16 v[148:149], v22 offset:8192
  ds_read_b64_tr_b16 v[150:151], v22 offset:10240
  v_mfma_f32_16x16x32_bf16 v[84:87], v[116:119], v[224:227], v[84:87]
  ds_read_b64_tr_b16 v[152:153], v23 offset:8192
  v_mfma_f32_16x16x32_bf16 v[88:91], v[120:123], v[224:227], v[88:91]
  buffer_load_dwordx4 v[208:211], v19, s[8:11], s33 offen offset:0 sc1
  v_mfma_f32_16x16x32_bf16 v[56:59], v[120:123], v[220:223], v[56:59]
  ds_read_b64_tr_b16 v[154:155], v23 offset:10240
  s_add_u32 m0, s36, 0
  s_waitcnt lgkmcnt(8)
  v_mfma_f32_16x16x32_bf16 v[60:63], v[124:127], v[220:223], v[60:63]
  ds_read_b64_tr_b16 v[156:157], v24 offset:8192
  ds_read_b64_tr_b16 v[158:159], v24 offset:10240
  s_add_u32 s40, s40, 131072
  v_mfma_f32_16x16x32_bf16 v[92:95], v[124:127], v[224:227], v[92:95]
  ds_read_b64_tr_b16 v[160:161], v25 offset:8192
  v_mfma_f32_16x16x32_bf16 v[96:99], v[128:131], v[224:227], v[96:99]
  buffer_load_dwordx4 v14, s[16:19], s40 offen offset:0 lds
  v_mfma_f32_16x16x32_bf16 v[64:67], v[128:131], v[220:223], v[64:67]
  ds_read_b64_tr_b16 v[162:163], v25 offset:10240
  v_mfma_f32_16x16x32_bf16 v[68:71], v[132:135], v[220:223], v[68:71]
  ds_read_b64_tr_b16 v[164:165], v26 offset:8192
  ds_read_b64_tr_b16 v[166:167], v26 offset:10240
  v_mfma_f32_16x16x32_bf16 v[100:103], v[132:135], v[224:227], v[100:103]
  ds_read_b64_tr_b16 v[168:169], v27 offset:8192
  v_mfma_f32_16x16x32_bf16 v[104:107], v[136:139], v[224:227], v[104:107]
  buffer_load_dwordx4 v15, s[16:19], s40 offen offset:1024 lds
  v_mfma_f32_16x16x32_bf16 v[72:75], v[136:139], v[220:223], v[72:75]
  ds_read_b64_tr_b16 v[170:171], v27 offset:10240
  s_waitcnt vmcnt(20) lgkmcnt(8)
  s_barrier
  v_mfma_f32_16x16x32_bf16 v[44:47], v[140:143], v[228:231], v[44:47]
  ds_read_b64_tr_b16 v[108:109], v20 offset:16384
  ds_read_b64_tr_b16 v[110:111], v20 offset:18432
  v_mfma_f32_16x16x32_bf16 v[76:79], v[140:143], v[232:235], v[76:79]
  ds_read_b64_tr_b16 v[112:113], v21 offset:16384
  v_mfma_f32_16x16x32_bf16 v[80:83], v[144:147], v[232:235], v[80:83]
  buffer_load_dwordx4 v[212:215], v18, s[8:11], s33 offen offset:1024 sc1
  v_mfma_f32_16x16x32_bf16 v[48:51], v[144:147], v[228:231], v[48:51]
  ds_read_b64_tr_b16 v[114:115], v21 offset:18432
  v_mfma_f32_16x16x32_bf16 v[52:55], v[148:151], v[228:231], v[52:55]
  ds_read_b64_tr_b16 v[116:117], v22 offset:16384
  ds_read_b64_tr_b16 v[118:119], v22 offset:18432
  v_mfma_f32_16x16x32_bf16 v[84:87], v[148:151], v[232:235], v[84:87]
  ds_read_b64_tr_b16 v[120:121], v23 offset:16384
  v_mfma_f32_16x16x32_bf16 v[88:91], v[152:155], v[232:235], v[88:91]
  buffer_load_dwordx4 v[216:219], v19, s[8:11], s33 offen offset:1024 sc1
  v_mfma_f32_16x16x32_bf16 v[56:59], v[152:155], v[228:231], v[56:59]
  ds_read_b64_tr_b16 v[122:123], v23 offset:18432
  s_waitcnt lgkmcnt(8)
  v_mfma_f32_16x16x32_bf16 v[60:63], v[156:159], v[228:231], v[60:63]
  ds_read_b64_tr_b16 v[124:125], v24 offset:16384
  ds_read_b64_tr_b16 v[126:127], v24 offset:18432
  v_mfma_f32_16x16x32_bf16 v[92:95], v[156:159], v[232:235], v[92:95]
  ds_read_b64_tr_b16 v[128:129], v25 offset:16384
  v_mfma_f32_16x16x32_bf16 v[96:99], v[160:163], v[232:235], v[96:99]
  buffer_load_dwordx4 v16, s[16:19], s40 offen offset:2048 lds
  v_mfma_f32_16x16x32_bf16 v[64:67], v[160:163], v[228:231], v[64:67]
  ds_read_b64_tr_b16 v[130:131], v25 offset:18432
  v_mfma_f32_16x16x32_bf16 v[68:71], v[164:167], v[228:231], v[68:71]
  ds_read_b64_tr_b16 v[132:133], v26 offset:16384
  ds_read_b64_tr_b16 v[134:135], v26 offset:18432
  v_mfma_f32_16x16x32_bf16 v[100:103], v[164:167], v[232:235], v[100:103]
  ds_read_b64_tr_b16 v[136:137], v27 offset:16384
  v_mfma_f32_16x16x32_bf16 v[104:107], v[168:171], v[232:235], v[104:107]
  buffer_load_dwordx4 v17, s[16:19], s40 offen offset:3072 lds
  v_mfma_f32_16x16x32_bf16 v[72:75], v[168:171], v[228:231], v[72:75]
  ds_read_b64_tr_b16 v[138:139], v27 offset:18432
  s_waitcnt vmcnt(22) lgkmcnt(8)
  v_mfma_f32_16x16x32_bf16 v[44:47], v[108:111], v[172:175], v[44:47]
  ds_read_b64_tr_b16 v[140:141], v20 offset:24576
  ds_read_b64_tr_b16 v[142:143], v20 offset:26624
  v_mfma_f32_16x16x32_bf16 v[76:79], v[108:111], v[176:179], v[76:79]
  ds_read_b64_tr_b16 v[144:145], v21 offset:24576
  v_mfma_f32_16x16x32_bf16 v[80:83], v[112:115], v[176:179], v[80:83]
  buffer_load_dwordx4 v[220:223], v18, s[8:11], s33 offen offset:2048 sc1
  v_mfma_f32_16x16x32_bf16 v[48:51], v[112:115], v[172:175], v[48:51]
  ds_read_b64_tr_b16 v[146:147], v21 offset:26624
  v_mfma_f32_16x16x32_bf16 v[52:55], v[116:119], v[172:175], v[52:55]
  ds_read_b64_tr_b16 v[148:149], v22 offset:24576
  ds_read_b64_tr_b16 v[150:151], v22 offset:26624
  v_mfma_f32_16x16x32_bf16 v[84:87], v[116:119], v[176:179], v[84:87]
  ds_read_b64_tr_b16 v[152:153], v23 offset:24576
  v_mfma_f32_16x16x32_bf16 v[88:91], v[120:123], v[176:179], v[88:91]
  buffer_load_dwordx4 v[224:227], v19, s[8:11], s33 offen offset:2048 sc1
  v_mfma_f32_16x16x32_bf16 v[56:59], v[120:123], v[172:175], v[56:59]
  ds_read_b64_tr_b16 v[154:155], v23 offset:26624
  s_add_u32 m0, s36, 16384
  s_waitcnt lgkmcnt(8)
  v_mfma_f32_16x16x32_bf16 v[60:63], v[124:127], v[172:175], v[60:63]
  ds_read_b64_tr_b16 v[156:157], v24 offset:24576
  ds_read_b64_tr_b16 v[158:159], v24 offset:26624
  s_add_u32 s40, s40, 131072
  v_mfma_f32_16x16x32_bf16 v[92:95], v[124:127], v[176:179], v[92:95]
  ds_read_b64_tr_b16 v[160:161], v25 offset:24576
  v_mfma_f32_16x16x32_bf16 v[96:99], v[128:131], v[176:179], v[96:99]
  buffer_load_dwordx4 v14, s[16:19], s40 offen offset:0 lds
  v_mfma_f32_16x16x32_bf16 v[64:67], v[128:131], v[172:175], v[64:67]
  ds_read_b64_tr_b16 v[162:163], v25 offset:26624
  v_mfma_f32_16x16x32_bf16 v[68:71], v[132:135], v[172:175], v[68:71]
  ds_read_b64_tr_b16 v[164:165], v26 offset:24576
  ds_read_b64_tr_b16 v[166:167], v26 offset:26624
  v_mfma_f32_16x16x32_bf16 v[100:103], v[132:135], v[176:179], v[100:103]
  ds_read_b64_tr_b16 v[168:169], v27 offset:24576
  v_mfma_f32_16x16x32_bf16 v[104:107], v[136:139], v[176:179], v[104:107]
  buffer_load_dwordx4 v15, s[16:19], s40 offen offset:1024 lds
  v_mfma_f32_16x16x32_bf16 v[72:75], v[136:139], v[172:175], v[72:75]
  ds_read_b64_tr_b16 v[170:171], v27 offset:26624
  s_waitcnt vmcnt(20) lgkmcnt(8)
  s_barrier
  v_mfma_f32_16x16x32_bf16 v[44:47], v[140:143], v[180:183], v[44:47]
  ds_read_b64_tr_b16 v[108:109], v20 offset:32768
  ds_read_b64_tr_b16 v[110:111], v20 offset:34816
  v_mfma_f32_16x16x32_bf16 v[76:79], v[140:143], v[184:187], v[76:79]
  ds_read_b64_tr_b16 v[112:113], v21 offset:32768
  v_mfma_f32_16x16x32_bf16 v[80:83], v[144:147], v[184:187], v[80:83]
  buffer_load_dwordx4 v[228:231], v18, s[8:11], s33 offen offset:3072 sc1
  v_mfma_f32_16x16x32_bf16 v[48:51], v[144:147], v[180:183], v[48:51]
  ds_read_b64_tr_b16 v[114:115], v21 offset:34816
  v_mfma_f32_16x16x32_bf16 v[52:55], v[148:151], v[180:183], v[52:55]
  ds_read_b64_tr_b16 v[116:117], v22 offset:32768
  ds_read_b64_tr_b16 v[118:119], v22 offset:34816
  v_mfma_f32_16x16x32_bf16 v[84:87], v[148:151], v[184:187], v[84:87]
  ds_read_b64_tr_b16 v[120:121], v23 offset:32768
  v_mfma_f32_16x16x32_bf16 v[88:91], v[152:155], v[184:187], v[88:91]
  buffer_load_dwordx4 v[232:235], v19, s[8:11], s33 offen offset:3072 sc1
  v_mfma_f32_16x16x32_bf16 v[56:59], v[152:155], v[180:183], v[56:59]
  ds_read_b64_tr_b16 v[122:123], v23 offset:34816
  s_waitcnt lgkmcnt(8)
  v_mfma_f32_16x16x32_bf16 v[60:63], v[156:159], v[180:183], v[60:63]
  ds_read_b64_tr_b16 v[124:125], v24 offset:32768
  ds_read_b64_tr_b16 v[126:127], v24 offset:34816
  v_mfma_f32_16x16x32_bf16 v[92:95], v[156:159], v[184:187], v[92:95]
  ds_read_b64_tr_b16 v[128:129], v25 offset:32768
  v_mfma_f32_16x16x32_bf16 v[96:99], v[160:163], v[184:187], v[96:99]
  buffer_load_dwordx4 v16, s[16:19], s40 offen offset:2048 lds
  v_mfma_f32_16x16x32_bf16 v[64:67], v[160:163], v[180:183], v[64:67]
  ds_read_b64_tr_b16 v[130:131], v25 offset:34816
  v_mfma_f32_16x16x32_bf16 v[68:71], v[164:167], v[180:183], v[68:71]
  ds_read_b64_tr_b16 v[132:133], v26 offset:32768
  ds_read_b64_tr_b16 v[134:135], v26 offset:34816
  v_mfma_f32_16x16x32_bf16 v[100:103], v[164:167], v[184:187], v[100:103]
  ds_read_b64_tr_b16 v[136:137], v27 offset:32768
  v_mfma_f32_16x16x32_bf16 v[104:107], v[168:171], v[184:187], v[104:107]
  buffer_load_dwordx4 v17, s[16:19], s40 offen offset:3072 lds
  v_mfma_f32_16x16x32_bf16 v[72:75], v[168:171], v[180:183], v[72:75]
  ds_read_b64_tr_b16 v[138:139], v27 offset:34816
  s_waitcnt vmcnt(22) lgkmcnt(8)
  v_mfma_f32_16x16x32_bf16 v[44:47], v[108:111], v[188:191], v[44:47]
  ds_read_b64_tr_b16 v[140:141], v20 offset:40960
  ds_read_b64_tr_b16 v[142:143], v20 offset:43008
  s_add_u32 s33, s33, 4096
  v_mfma_f32_16x16x32_bf16 v[76:79], v[108:111], v[192:195], v[76:79]
  ds_read_b64_tr_b16 v[144:145], v21 offset:40960
  v_mfma_f32_16x16x32_bf16 v[80:83], v[112:115], v[192:195], v[80:83]
  buffer_load_dwordx4 v[172:175], v18, s[8:11], s33 offen offset:0 sc1
  v_mfma_f32_16x16x32_bf16 v[48:51], v[112:115], v[188:191], v[48:51]
  ds_read_b64_tr_b16 v[146:147], v21 offset:43008
  v_mfma_f32_16x16x32_bf16 v[52:55], v[116:119], v[188:191], v[52:55]
  ds_read_b64_tr_b16 v[148:149], v22 offset:40960
  ds_read_b64_tr_b16 v[150:151], v22 offset:43008
  v_mfma_f32_16x16x32_bf16 v[84:87], v[116:119], v[192:195], v[84:87]
  ds_read_b64_tr_b16 v[152:153], v23 offset:40960
  v_mfma_f32_16x16x32_bf16 v[88:91], v[120:123], v[192:195], v[88:91]
  buffer_load_dwordx4 v[176:179], v19, s[8:11], s33 offen offset:0 sc1
  v_mfma_f32_16x16x32_bf16 v[56:59], v[120:123], v[188:191], v[56:59]
  ds_read_b64_tr_b16 v[154:155], v23 offset:43008
  s_add_u32 m0, s36, 32768
  s_waitcnt lgkmcnt(8)
  v_mfma_f32_16x16x32_bf16 v[60:63], v[124:127], v[188:191], v[60:63]
  ds_read_b64_tr_b16 v[156:157], v24 offset:40960
  ds_read_b64_tr_b16 v[158:159], v24 offset:43008
  s_add_u32 s40, s40, 131072
  v_mfma_f32_16x16x32_bf16 v[92:95], v[124:127], v[192:195], v[92:95]
  ds_read_b64_tr_b16 v[160:161], v25 offset:40960
  v_mfma_f32_16x16x32_bf16 v[96:99], v[128:131], v[192:195], v[96:99]
  buffer_load_dwordx4 v14, s[16:19], s40 offen offset:0 lds
  v_mfma_f32_16x16x32_bf16 v[64:67], v[128:131], v[188:191], v[64:67]
  ds_read_b64_tr_b16 v[162:163], v25 offset:43008
  v_mfma_f32_16x16x32_bf16 v[68:71], v[132:135], v[188:191], v[68:71]
  ds_read_b64_tr_b16 v[164:165], v26 offset:40960
  ds_read_b64_tr_b16 v[166:167], v26 offset:43008
  v_mfma_f32_16x16x32_bf16 v[100:103], v[132:135], v[192:195], v[100:103]
  ds_read_b64_tr_b16 v[168:169], v27 offset:40960
  v_mfma_f32_16x16x32_bf16 v[104:107], v[136:139], v[192:195], v[104:107]
  buffer_load_dwordx4 v15, s[16:19], s40 offen offset:1024 lds
  v_mfma_f32_16x16x32_bf16 v[72:75], v[136:139], v[188:191], v[72:75]
  ds_read_b64_tr_b16 v[170:171], v27 offset:43008
  s_waitcnt vmcnt(20) lgkmcnt(8)
  s_barrier
  v_mfma_f32_16x16x32_bf16 v[44:47], v[140:143], v[196:199], v[44:47]
  ds_read_b64_tr_b16 v[108:109], v20 offset:49152
  ds_read_b64_tr_b16 v[110:111], v20 offset:51200
  v_mfma_f32_16x16x32_bf16 v[76:79], v[140:143], v[200:203], v[76:79]
  ds_read_b64_tr_b16 v[112:113], v21 offset:49152
  v_mfma_f32_16x16x32_bf16 v[80:83], v[144:147], v[200:203], v[80:83]
  buffer_load_dwordx4 v[180:183], v18, s[8:11], s33 offen offset:1024 sc1
  v_mfma_f32_16x16x32_bf16 v[48:51], v[144:147], v[196:199], v[48:51]
  ds_read_b64_tr_b16 v[114:115], v21 offset:51200
  v_mfma_f32_16x16x32_bf16 v[52:55], v[148:151], v[196:199], v[52:55]
  ds_read_b64_tr_b16 v[116:117], v22 offset:49152
  ds_read_b64_tr_b16 v[118:119], v22 offset:51200
  v_mfma_f32_16x16x32_bf16 v[84:87], v[148:151], v[200:203], v[84:87]
  ds_read_b64_tr_b16 v[120:121], v23 offset:49152
  v_mfma_f32_16x16x32_bf16 v[88:91], v[152:155], v[200:203], v[88:91]
  buffer_load_dwordx4 v[184:187], v19, s[8:11], s33 offen offset:1024 sc1
  v_mfma_f32_16x16x32_bf16 v[56:59], v[152:155], v[196:199], v[56:59]
  ds_read_b64_tr_b16 v[122:123], v23 offset:51200
  s_waitcnt lgkmcnt(8)
  v_mfma_f32_16x16x32_bf16 v[60:63], v[156:159], v[196:199], v[60:63]
  ds_read_b64_tr_b16 v[124:125], v24 offset:49152
  ds_read_b64_tr_b16 v[126:127], v24 offset:51200
  v_mfma_f32_16x16x32_bf16 v[92:95], v[156:159], v[200:203], v[92:95]
  ds_read_b64_tr_b16 v[128:129], v25 offset:49152
  v_mfma_f32_16x16x32_bf16 v[96:99], v[160:163], v[200:203], v[96:99]
  buffer_load_dwordx4 v16, s[16:19], s40 offen offset:2048 lds
  v_mfma_f32_16x16x32_bf16 v[64:67], v[160:163], v[196:199], v[64:67]
  ds_read_b64_tr_b16 v[130:131], v25 offset:51200
  v_mfma_f32_16x16x32_bf16 v[68:71], v[164:167], v[196:199], v[68:71]
  ds_read_b64_tr_b16 v[132:133], v26 offset:49152
  ds_read_b64_tr_b16 v[134:135], v26 offset:51200
  v_mfma_f32_16x16x32_bf16 v[100:103], v[164:167], v[200:203], v[100:103]
  ds_read_b64_tr_b16 v[136:137], v27 offset:49152
  v_mfma_f32_16x16x32_bf16 v[104:107], v[168:171], v[200:203], v[104:107]
  buffer_load_dwordx4 v17, s[16:19], s40 offen offset:3072 lds
  v_mfma_f32_16x16x32_bf16 v[72:75], v[168:171], v[196:199], v[72:75]
  ds_read_b64_tr_b16 v[138:139], v27 offset:51200
  s_waitcnt vmcnt(22) lgkmcnt(8)
  v_mfma_f32_16x16x32_bf16 v[44:47], v[108:111], v[204:207], v[44:47]
  ds_read_b64_tr_b16 v[140:141], v20 offset:57344
  ds_read_b64_tr_b16 v[142:143], v20 offset:59392
  v_xor_b32 v20, 65536, v20
  v_mfma_f32_16x16x32_bf16 v[76:79], v[108:111], v[208:211], v[76:79]
  ds_read_b64_tr_b16 v[144:145], v21 offset:57344
  v_mfma_f32_16x16x32_bf16 v[80:83], v[112:115], v[208:211], v[80:83]
  buffer_load_dwordx4 v[188:191], v18, s[8:11], s33 offen offset:2048 sc1
  v_mfma_f32_16x16x32_bf16 v[48:51], v[112:115], v[204:207], v[48:51]
  ds_read_b64_tr_b16 v[146:147], v21 offset:59392
  v_xor_b32 v21, 65536, v21
  v_mfma_f32_16x16x32_bf16 v[52:55], v[116:119], v[204:207], v[52:55]
  ds_read_b64_tr_b16 v[148:149], v22 offset:57344
  ds_read_b64_tr_b16 v[150:151], v22 offset:59392
  v_xor_b32 v22, 65536, v22
  v_mfma_f32_16x16x32_bf16 v[84:87], v[116:119], v[208:211], v[84:87]
  ds_read_b64_tr_b16 v[152:153], v23 offset:57344
  v_mfma_f32_16x16x32_bf16 v[88:91], v[120:123], v[208:211], v[88:91]
  buffer_load_dwordx4 v[192:195], v19, s[8:11], s33 offen offset:2048 sc1
  v_mfma_f32_16x16x32_bf16 v[56:59], v[120:123], v[204:207], v[56:59]
  ds_read_b64_tr_b16 v[154:155], v23 offset:59392
  v_xor_b32 v23, 65536, v23
  s_add_u32 m0, s36, 49152
  s_waitcnt lgkmcnt(8)
  v_mfma_f32_16x16x32_bf16 v[60:63], v[124:127], v[204:207], v[60:63]
  ds_read_b64_tr_b16 v[156:157], v24 offset:57344
  ds_read_b64_tr_b16 v[158:159], v24 offset:59392
  v_xor_b32 v24, 65536, v24
  s_add_u32 s40, s40, 131072
  v_mfma_f32_16x16x32_bf16 v[92:95], v[124:127], v[208:211], v[92:95]
  ds_read_b64_tr_b16 v[160:161], v25 offset:57344
  v_mfma_f32_16x16x32_bf16 v[96:99], v[128:131], v[208:211], v[96:99]
  buffer_load_dwordx4 v14, s[16:19], s40 offen offset:0 lds
  v_mfma_f32_16x16x32_bf16 v[64:67], v[128:131], v[204:207], v[64:67]
  ds_read_b64_tr_b16 v[162:163], v25 offset:59392
  v_xor_b32 v25, 65536, v25
  v_mfma_f32_16x16x32_bf16 v[68:71], v[132:135], v[204:207], v[68:71]
  ds_read_b64_tr_b16 v[164:165], v26 offset:57344
  ds_read_b64_tr_b16 v[166:167], v26 offset:59392
  v_xor_b32 v26, 65536, v26
  v_mfma_f32_16x16x32_bf16 v[100:103], v[132:135], v[208:211], v[100:103]
  ds_read_b64_tr_b16 v[168:169], v27 offset:57344
  v_mfma_f32_16x16x32_bf16 v[104:107], v[136:139], v[208:211], v[104:107]
  buffer_load_dwordx4 v15, s[16:19], s40 offen offset:1024 lds
  v_mfma_f32_16x16x32_bf16 v[72:75], v[136:139], v[204:207], v[72:75]
  ds_read_b64_tr_b16 v[170:171], v27 offset:59392
  v_xor_b32 v27, 65536, v27
  s_waitcnt vmcnt(20) lgkmcnt(8)
  s_barrier
  v_mfma_f32_16x16x32_bf16 v[44:47], v[140:143], v[212:215], v[44:47]
  ds_read_b64_tr_b16 v[108:109], v20 offset:0
  ds_read_b64_tr_b16 v[110:111], v20 offset:2048
  v_mfma_f32_16x16x32_bf16 v[76:79], v[140:143], v[216:219], v[76:79]
  ds_read_b64_tr_b16 v[112:113], v21 offset:0
  v_mfma_f32_16x16x32_bf16 v[80:83], v[144:147], v[216:219], v[80:83]
  buffer_load_dwordx4 v[196:199], v18, s[8:11], s33 offen offset:3072 sc1
  v_mfma_f32_16x16x32_bf16 v[48:51], v[144:147], v[212:215], v[48:51]
  ds_read_b64_tr_b16 v[114:115], v21 offset:2048
  v_mfma_f32_16x16x32_bf16 v[52:55], v[148:151], v[212:215], v[52:55]
  ds_read_b64_tr_b16 v[116:117], v22 offset:0
  ds_read_b64_tr_b16 v[118:119], v22 offset:2048
  v_mfma_f32_16x16x32_bf16 v[84:87], v[148:151], v[216:219], v[84:87]
  ds_read_b64_tr_b16 v[120:121], v23 offset:0
  v_mfma_f32_16x16x32_bf16 v[88:91], v[152:155], v[216:219], v[88:91]
  buffer_load_dwordx4 v[200:203], v19, s[8:11], s33 offen offset:3072 sc1
  v_mfma_f32_16x16x32_bf16 v[56:59], v[152:155], v[212:215], v[56:59]
  ds_read_b64_tr_b16 v[122:123], v23 offset:2048
  s_waitcnt lgkmcnt(8)
  v_mfma_f32_16x16x32_bf16 v[60:63], v[156:159], v[212:215], v[60:63]
  ds_read_b64_tr_b16 v[124:125], v24 offset:0
  ds_read_b64_tr_b16 v[126:127], v24 offset:2048
  v_mfma_f32_16x16x32_bf16 v[92:95], v[156:159], v[216:219], v[92:95]
  ds_read_b64_tr_b16 v[128:129], v25 offset:0
  v_mfma_f32_16x16x32_bf16 v[96:99], v[160:163], v[216:219], v[96:99]
  buffer_load_dwordx4 v16, s[16:19], s40 offen offset:2048 lds
  v_mfma_f32_16x16x32_bf16 v[64:67], v[160:163], v[212:215], v[64:67]
  ds_read_b64_tr_b16 v[130:131], v25 offset:2048
  v_mfma_f32_16x16x32_bf16 v[68:71], v[164:167], v[212:215], v[68:71]
  ds_read_b64_tr_b16 v[132:133], v26 offset:0
  ds_read_b64_tr_b16 v[134:135], v26 offset:2048
  v_mfma_f32_16x16x32_bf16 v[100:103], v[164:167], v[216:219], v[100:103]
  ds_read_b64_tr_b16 v[136:137], v27 offset:0
  v_mfma_f32_16x16x32_bf16 v[104:107], v[168:171], v[216:219], v[104:107]
  buffer_load_dwordx4 v17, s[16:19], s40 offen offset:3072 lds
  v_mfma_f32_16x16x32_bf16 v[72:75], v[168:171], v[212:215], v[72:75]
  ds_read_b64_tr_b16 v[138:139], v27 offset:2048
  s_xor_b32 s36, s36, 65536
  s_sub_u32 s24, s24, 1
  s_cmp_lg_u32 s24, 0
  s_cbranch_scc1 L_p5_4
  s_waitcnt vmcnt(22) lgkmcnt(8)
  v_mfma_f32_16x16x32_bf16 v[44:47], v[108:111], v[220:223], v[44:47]
  ds_read_b64_tr_b16 v[140:141], v20 offset:8192
  ds_read_b64_tr_b16 v[142:143], v20 offset:10240
  s_add_u32 s33, s33, 4096
  v_mfma_f32_16x16x32_bf16 v[76:79], v[108:111], v[224:227], v[76:79]
  ds_read_b64_tr_b16 v[144:145], v21 offset:8192
  v_mfma_f32_16x16x32_bf16 v[80:83], v[112:115], v[224:227], v[80:83]
  buffer_load_dwordx4 v[204:207], v18, s[8:11], s33 offen offset:0 sc1
  v_mfma_f32_16x16x32_bf16 v[48:51], v[112:115], v[220:223], v[48:51]
  ds_read_b64_tr_b16 v[146:147], v21 offset:10240
  v_mfma_f32_16x16x32_bf16 v[52:55], v[116:119], v[220:223], v[52:55]
  ds_read_b64_tr_b16 v[148:149], v22 offset:8192
  ds_read_b64_tr_b16 v[150:151], v22 offset:10240
  v_mfma_f32_16x16x32_bf16 v[84:87], v[116:119], v[224:227], v[84:87]
  ds_read_b64_tr_b16 v[152:153], v23 offset:8192
  v_mfma_f32_16x16x32_bf16 v[88:91], v[120:123], v[224:227], v[88:91]
  buffer_load_dwordx4 v[208:211], v19, s[8:11], s33 offen offset:0 sc1
  v_mfma_f32_16x16x32_bf16 v[56:59], v[120:123], v[220:223], v[56:59]
  ds_read_b64_tr_b16 v[154:155], v23 offset:10240
  s_add_u32 m0, s36, 0
  s_waitcnt lgkmcnt(8)
  v_mfma_f32_16x16x32_bf16 v[60:63], v[124:127], v[220:223], v[60:63]
  ds_read_b64_tr_b16 v[156:157], v24 offset:8192
  ds_read_b64_tr_b16 v[158:159], v24 offset:10240
  s_add_u32 s40, s40, 131072
  v_mfma_f32_16x16x32_bf16 v[92:95], v[124:127], v[224:227], v[92:95]
  ds_read_b64_tr_b16 v[160:161], v25 offset:8192
  v_mfma_f32_16x16x32_bf16 v[96:99], v[128:131], v[224:227], v[96:99]
  buffer_load_dwordx4 v14, s[16:19], s40 offen offset:0 lds
  v_mfma_f32_16x16x32_bf16 v[64:67], v[128:131], v[220:223], v[64:67]
  ds_read_b64_tr_b16 v[162:163], v25 offset:10240
  v_mfma_f32_16x16x32_bf16 v[68:71], v[132:135], v[220:223], v[68:71]
  ds_read_b64_tr_b16 v[164:165], v26 offset:8192
  ds_read_b64_tr_b16 v[166:167], v26 offset:10240
  v_mfma_f32_16x16x32_bf16 v[100:103], v[132:135], v[224:227], v[100:103]
  ds_read_b64_tr_b16 v[168:169], v27 offset:8192
  v_mfma_f32_16x16x32_bf16 v[104:107], v[136:139], v[224:227], v[104:107]
  buffer_load_dwordx4 v15, s[16:19], s40 offen offset:1024 lds
  v_mfma_f32_16x16x32_bf16 v[72:75], v[136:139], v[220:223], v[72:75]
  ds_read_b64_tr_b16 v[170:171], v27 offset:10240
  s_waitcnt vmcnt(20) lgkmcnt(8)
  s_barrier
  v_mfma_f32_16x16x32_bf16 v[44:47], v[140:143], v[228:231], v[44:47]
  ds_read_b64_tr_b16 v[108:109], v20 offset:16384
  ds_read_b64_tr_b16 v[110:111], v20 offset:18432
  v_mfma_f32_16x16x32_bf16 v[76:79], v[140:143], v[232:235], v[76:79]
  ds_read_b64_tr_b16 v[112:113], v21 offset:16384
  v_mfma_f32_16x16x32_bf16 v[80:83], v[144:147], v[232:235], v[80:83]
  buffer_load_dwordx4 v[212:215], v18, s[8:11], s33 offen offset:1024 sc1
  v_mfma_f32_16x16x32_bf16 v[48:51], v[144:147], v[228:231], v[48:51]
  ds_read_b64_tr_b16 v[114:115], v21 offset:18432
  v_mfma_f32_16x16x32_bf16 v[52:55], v[148:151], v[228:231], v[52:55]
  ds_read_b64_tr_b16 v[116:117], v22 offset:16384
  ds_read_b64_tr_b16 v[118:119], v22 offset:18432
  v_mfma_f32_16x16x32_bf16 v[84:87], v[148:151], v[232:235], v[84:87]
  ds_read_b64_tr_b16 v[120:121], v23 offset:16384
  v_mfma_f32_16x16x32_bf16 v[88:91], v[152:155], v[232:235], v[88:91]
  buffer_load_dwordx4 v[216:219], v19, s[8:11], s33 offen offset:1024 sc1
  v_mfma_f32_16x16x32_bf16 v[56:59], v[152:155], v[228:231], v[56:59]
  ds_read_b64_tr_b16 v[122:123], v23 offset:18432
  s_waitcnt lgkmcnt(8)
  v_mfma_f32_16x16x32_bf16 v[60:63], v[156:159], v[228:231], v[60:63]
  ds_read_b64_tr_b16 v[124:125], v24 offset:16384
  ds_read_b64_tr_b16 v[126:127], v24 offset:18432
  v_mfma_f32_16x16x32_bf16 v[92:95], v[156:159], v[232:235], v[92:95]
  ds_read_b64_tr_b16 v[128:129], v25 offset:16384
  v_mfma_f32_16x16x32_bf16 v[96:99], v[160:163], v[232:235], v[96:99]
  buffer_load_dwordx4 v16, s[16:19], s40 offen offset:2048 lds
  v_mfma_f32_16x16x32_bf16 v[64:67], v[160:163], v[228:231], v[64:67]
  ds_read_b64_tr_b16 v[130:131], v25 offset:18432
  v_mfma_f32_16x16x32_bf16 v[68:71], v[164:167], v[228:231], v[68:71]
  ds_read_b64_tr_b16 v[132:133], v26 offset:16384
  ds_read_b64_tr_b16 v[134:135], v26 offset:18432
  v_mfma_f32_16x16x32_bf16 v[100:103], v[164:167], v[232:235], v[100:103]
  ds_read_b64_tr_b16 v[136:137], v27 offset:16384
  v_mfma_f32_16x16x32_bf16 v[104:107], v[168:171], v[232:235], v[104:107]
  buffer_load_dwordx4 v17, s[16:19], s40 offen offset:3072 lds
  v_mfma_f32_16x16x32_bf16 v[72:75], v[168:171], v[228:231], v[72:75]
  ds_read_b64_tr_b16 v[138:139], v27 offset:18432
  s_waitcnt vmcnt(22) lgkmcnt(8)
  v_mfma_f32_16x16x32_bf16 v[44:47], v[108:111], v[172:175], v[44:47]
  ds_read_b64_tr_b16 v[140:141], v20 offset:24576
  ds_read_b64_tr_b16 v[142:143], v20 offset:26624
  v_mfma_f32_16x16x32_bf16 v[76:79], v[108:111], v[176:179], v[76:79]
  ds_read_b64_tr_b16 v[144:145], v21 offset:24576
  v_mfma_f32_16x16x32_bf16 v[80:83], v[112:115], v[176:179], v[80:83]
  buffer_load_dwordx4 v[220:223], v18, s[8:11], s33 offen offset:2048 sc1
  v_mfma_f32_16x16x32_bf16 v[48:51], v[112:115], v[172:175], v[48:51]
  ds_read_b64_tr_b16 v[146:147], v21 offset:26624
  v_mfma_f32_16x16x32_bf16 v[52:55], v[116:119], v[172:175], v[52:55]
  ds_read_b64_tr_b16 v[148:149], v22 offset:24576
  ds_read_b64_tr_b16 v[150:151], v22 offset:26624
  v_mfma_f32_16x16x32_bf16 v[84:87], v[116:119], v[176:179], v[84:87]
  ds_read_b64_tr_b16 v[152:153], v23 offset:24576
  v_mfma_f32_16x16x32_bf16 v[88:91], v[120:123], v[176:179], v[88:91]
  buffer_load_dwordx4 v[224:227], v19, s[8:11], s33 offen offset:2048 sc1
  v_mfma_f32_16x16x32_bf16 v[56:59], v[120:123], v[172:175], v[56:59]
  ds_read_b64_tr_b16 v[154:155], v23 offset:26624
  s_mov_b32 s40, 6160384
  s_waitcnt lgkmcnt(8)
  v_mfma_f32_16x16x32_bf16 v[60:63], v[124:127], v[172:175], v[60:63]
  ds_read_b64_tr_b16 v[156:157], v24 offset:24576
  ds_read_b64_tr_b16 v[158:159], v24 offset:26624
  s_lshl_b32 s28, s5, 11
  v_mfma_f32_16x16x32_bf16 v[92:95], v[124:127], v[176:179], v[92:95]
  ds_read_b64_tr_b16 v[160:161], v25 offset:24576
  s_sub_u32 s41, s41, s28
  v_mfma_f32_16x16x32_bf16 v[96:99], v[128:131], v[176:179], v[96:99]
  s_add_u32 m0, s41, 81920
  s_add_u32 s40, s40, 131072
  buffer_load_dwordx4 v32, s[16:19], s40 offen offset:0 lds
  v_mfma_f32_16x16x32_bf16 v[64:67], v[128:131], v[172:175], v[64:67]
  ds_read_b64_tr_b16 v[162:163], v25 offset:26624
  v_mfma_f32_16x16x32_bf16 v[68:71], v[132:135], v[172:175], v[68:71]
  ds_read_b64_tr_b16 v[164:165], v26 offset:24576
  ds_read_b64_tr_b16 v[166:167], v26 offset:26624
  v_mfma_f32_16x16x32_bf16 v[100:103], v[132:135], v[176:179], v[100:103]
  ds_read_b64_tr_b16 v[168:169], v27 offset:24576
  v_mfma_f32_16x16x32_bf16 v[104:107], v[136:139], v[176:179], v[104:107]
  buffer_load_dwordx4 v33, s[16:19], s40 offen offset:1024 lds
  v_mfma_f32_16x16x32_bf16 v[72:75], v[136:139], v[172:175], v[72:75]
  ds_read_b64_tr_b16 v[170:171], v27 offset:26624
  s_waitcnt vmcnt(20) lgkmcnt(8)
  s_barrier
  v_mfma_f32_16x16x32_bf16 v[44:47], v[140:143], v[180:183], v[44:47]
  ds_read_b64_tr_b16 v[108:109], v20 offset:32768
  ds_read_b64_tr_b16 v[110:111], v20 offset:34816
  v_mfma_f32_16x16x32_bf16 v[76:79], v[140:143], v[184:187], v[76:79]
  ds_read_b64_tr_b16 v[112:113], v21 offset:32768
  v_mfma_f32_16x16x32_bf16 v[80:83], v[144:147], v[184:187], v[80:83]
  ds_read_b64_tr_b16 v[114:115], v21 offset:34816
  v_mfma_f32_16x16x32_bf16 v[48:51], v[144:147], v[180:183], v[48:51]
  ds_read_b64_tr_b16 v[116:117], v22 offset:32768
  v_mfma_f32_16x16x32_bf16 v[52:55], v[148:151], v[180:183], v[52:55]
  buffer_load_dwordx4 v[228:231], v18, s[8:11], s33 offen offset:3072 sc1
  v_mfma_f32_16x16x32_bf16 v[84:87], v[148:151], v[184:187], v[84:87]
  ds_read_b64_tr_b16 v[118:119], v22 offset:34816
  v_mfma_f32_16x16x32_bf16 v[88:91], v[152:155], v[184:187], v[88:91]
  ds_read_b64_tr_b16 v[120:121], v23 offset:32768
  v_mfma_f32_16x16x32_bf16 v[56:59], v[152:155], v[180:183], v[56:59]
  ds_read_b64_tr_b16 v[122:123], v23 offset:34816
  s_waitcnt lgkmcnt(8)
  v_mfma_f32_16x16x32_bf16 v[60:63], v[156:159], v[180:183], v[60:63]
  ds_read_b64_tr_b16 v[124:125], v24 offset:32768
  ds_read_b64_tr_b16 v[126:127], v24 offset:34816
  v_mfma_f32_16x16x32_bf16 v[92:95], v[156:159], v[184:187], v[92:95]
  ds_read_b64_tr_b16 v[128:129], v25 offset:32768
  v_mfma_f32_16x16x32_bf16 v[96:99], v[160:163], v[184:187], v[96:99]
  ds_read_b64_tr_b16 v[130:131], v25 offset:34816
  v_mfma_f32_16x16x32_bf16 v[64:67], v[160:163], v[180:183], v[64:67]
  ds_read_b64_tr_b16 v[132:133], v26 offset:32768
  v_mfma_f32_16x16x32_bf16 v[68:71], v[164:167], v[180:183], v[68:71]
  buffer_load_dwordx4 v[232:235], v19, s[8:11], s33 offen offset:3072 sc1
  v_mfma_f32_16x16x32_bf16 v[100:103], v[164:167], v[184:187], v[100:103]
  ds_read_b64_tr_b16 v[134:135], v26 offset:34816
  v_mfma_f32_16x16x32_bf16 v[104:107], v[168:171], v[184:187], v[104:107]
  ds_read_b64_tr_b16 v[136:137], v27 offset:32768
  v_mfma_f32_16x16x32_bf16 v[72:75], v[168:171], v[180:183], v[72:75]
  ds_read_b64_tr_b16 v[138:139], v27 offset:34816
  s_waitcnt vmcnt(20) lgkmcnt(8)
  v_mfma_f32_16x16x32_bf16 v[44:47], v[108:111], v[188:191], v[44:47]
  ds_read_b64_tr_b16 v[140:141], v20 offset:40960
  ds_read_b64_tr_b16 v[142:143], v20 offset:43008
  s_mul_i32 s33, s32, 114688
  v_mfma_f32_16x16x32_bf16 v[76:79], v[108:111], v[192:195], v[76:79]
  ds_read_b64_tr_b16 v[144:145], v21 offset:40960
  s_add_u32 s33, s33, 16875520
  v_mfma_f32_16x16x32_bf16 v[80:83], v[112:115], v[192:195], v[80:83]
  buffer_load_dwordx4 v[172:175], v18, s[8:11], s33 offen offset:0 sc1
  v_mfma_f32_16x16x32_bf16 v[48:51], v[112:115], v[188:191], v[48:51]
  ds_read_b64_tr_b16 v[146:147], v21 offset:43008
  v_mfma_f32_16x16x32_bf16 v[52:55], v[116:119], v[188:191], v[52:55]
  ds_read_b64_tr_b16 v[148:149], v22 offset:40960
  ds_read_b64_tr_b16 v[150:151], v22 offset:43008
  v_mfma_f32_16x16x32_bf16 v[84:87], v[116:119], v[192:195], v[84:87]
  ds_read_b64_tr_b16 v[152:153], v23 offset:40960
  v_mfma_f32_16x16x32_bf16 v[88:91], v[120:123], v[192:195], v[88:91]
  buffer_load_dwordx4 v[176:179], v19, s[8:11], s33 offen offset:0 sc1
  v_mfma_f32_16x16x32_bf16 v[56:59], v[120:123], v[188:191], v[56:59]
  ds_read_b64_tr_b16 v[154:155], v23 offset:43008
  s_add_u32 m0, s41, 98304
  s_waitcnt lgkmcnt(8)
  v_mfma_f32_16x16x32_bf16 v[60:63], v[124:127], v[188:191], v[60:63]
  ds_read_b64_tr_b16 v[156:157], v24 offset:40960
  ds_read_b64_tr_b16 v[158:159], v24 offset:43008
  s_add_u32 s40, s40, 131072
  v_mfma_f32_16x16x32_bf16 v[92:95], v[124:127], v[192:195], v[92:95]
  ds_read_b64_tr_b16 v[160:161], v25 offset:40960
  v_mfma_f32_16x16x32_bf16 v[96:99], v[128:131], v[192:195], v[96:99]
  buffer_load_dwordx4 v32, s[16:19], s40 offen offset:0 lds
  v_mfma_f32_16x16x32_bf16 v[64:67], v[128:131], v[188:191], v[64:67]
  ds_read_b64_tr_b16 v[162:163], v25 offset:43008
  v_mfma_f32_16x16x32_bf16 v[68:71], v[132:135], v[188:191], v[68:71]
  ds_read_b64_tr_b16 v[164:165], v26 offset:40960
  ds_read_b64_tr_b16 v[166:167], v26 offset:43008
  v_mfma_f32_16x16x32_bf16 v[100:103], v[132:135], v[192:195], v[100:103]
  ds_read_b64_tr_b16 v[168:169], v27 offset:40960
  v_mfma_f32_16x16x32_bf16 v[104:107], v[136:139], v[192:195], v[104:107]
  buffer_load_dwordx4 v33, s[16:19], s40 offen offset:1024 lds
  v_mfma_f32_16x16x32_bf16 v[72:75], v[136:139], v[188:191], v[72:75]
  ds_read_b64_tr_b16 v[170:171], v27 offset:43008
  s_waitcnt vmcnt(18) lgkmcnt(8)
  s_barrier
  v_mfma_f32_16x16x32_bf16 v[44:47], v[140:143], v[196:199], v[44:47]
  ds_read_b64_tr_b16 v[108:109], v20 offset:49152
  ds_read_b64_tr_b16 v[110:111], v20 offset:51200
  v_mfma_f32_16x16x32_bf16 v[76:79], v[140:143], v[200:203], v[76:79]
  ds_read_b64_tr_b16 v[112:113], v21 offset:49152
  v_mfma_f32_16x16x32_bf16 v[80:83], v[144:147], v[200:203], v[80:83]
  ds_read_b64_tr_b16 v[114:115], v21 offset:51200
  v_mfma_f32_16x16x32_bf16 v[48:51], v[144:147], v[196:199], v[48:51]
  ds_read_b64_tr_b16 v[116:117], v22 offset:49152
  v_mfma_f32_16x16x32_bf16 v[52:55], v[148:151], v[196:199], v[52:55]
  buffer_load_dwordx4 v[180:183], v18, s[8:11], s33 offen offset:1024 sc1
  v_mfma_f32_16x16x32_bf16 v[84:87], v[148:151], v[200:203], v[84:87]
  ds_read_b64_tr_b16 v[118:119], v22 offset:51200
  v_mfma_f32_16x16x32_bf16 v[88:91], v[152:155], v[200:203], v[88:91]
  ds_read_b64_tr_b16 v[120:121], v23 offset:49152
  v_mfma_f32_16x16x32_bf16 v[56:59], v[152:155], v[196:199], v[56:59]
  ds_read_b64_tr_b16 v[122:123], v23 offset:51200
  s_waitcnt lgkmcnt(8)
  v_mfma_f32_16x16x32_bf16 v[60:63], v[156:159], v[196:199], v[60:63]
  ds_read_b64_tr_b16 v[124:125], v24 offset:49152
  ds_read_b64_tr_b16 v[126:127], v24 offset:51200
  v_mfma_f32_16x16x32_bf16 v[92:95], v[156:159], v[200:203], v[92:95]
  ds_read_b64_tr_b16 v[128:129], v25 offset:49152
  v_mfma_f32_16x16x32_bf16 v[96:99], v[160:163], v[200:203], v[96:99]
  ds_read_b64_tr_b16 v[130:131], v25 offset:51200
  v_mfma_f32_16x16x32_bf16 v[64:67], v[160:163], v[196:199], v[64:67]
  ds_read_b64_tr_b16 v[132:133], v26 offset:49152
  v_mfma_f32_16x16x32_bf16 v[68:71], v[164:167], v[196:199], v[68:71]
  buffer_load_dwordx4 v[184:187], v19, s[8:11], s33 offen offset:1024 sc1
  v_mfma_f32_16x16x32_bf16 v[100:103], v[164:167], v[200:203], v[100:103]
  ds_read_b64_tr_b16 v[134:135], v26 offset:51200
  v_mfma_f32_16x16x32_bf16 v[104:107], v[168:171], v[200:203], v[104:107]
  ds_read_b64_tr_b16 v[136:137], v27 offset:49152
  v_mfma_f32_16x16x32_bf16 v[72:75], v[168:171], v[196:199], v[72:75]
  ds_read_b64_tr_b16 v[138:139], v27 offset:51200
  s_waitcnt vmcnt(18) lgkmcnt(8)
  v_mfma_f32_16x16x32_bf16 v[44:47], v[108:111], v[204:207], v[44:47]
  ds_read_b64_tr_b16 v[140:141], v20 offset:57344
  ds_read_b64_tr_b16 v[142:143], v20 offset:59392
  v_xor_b32 v20, 65536, v20
  v_mfma_f32_16x16x32_bf16 v[76:79], v[108:111], v[208:211], v[76:79]
  ds_read_b64_tr_b16 v[144:145], v21 offset:57344
  v_mfma_f32_16x16x32_bf16 v[80:83], v[112:115], v[208:211], v[80:83]
  buffer_load_dwordx4 v[188:191], v18, s[8:11], s33 offen offset:2048 sc1
  v_mfma_f32_16x16x32_bf16 v[48:51], v[112:115], v[204:207], v[48:51]
  ds_read_b64_tr_b16 v[146:147], v21 offset:59392
  v_xor_b32 v21, 65536, v21
  v_mfma_f32_16x16x32_bf16 v[52:55], v[116:119], v[204:207], v[52:55]
  ds_read_b64_tr_b16 v[148:149], v22 offset:57344
  ds_read_b64_tr_b16 v[150:151], v22 offset:59392
  v_xor_b32 v22, 65536, v22
  v_mfma_f32_16x16x32_bf16 v[84:87], v[116:119], v[208:211], v[84:87]
  ds_read_b64_tr_b16 v[152:153], v23 offset:57344
  v_mfma_f32_16x16x32_bf16 v[88:91], v[120:123], v[208:211], v[88:91]
  buffer_load_dwordx4 v[192:195], v19, s[8:11], s33 offen offset:2048 sc1
  v_mfma_f32_16x16x32_bf16 v[56:59], v[120:123], v[204:207], v[56:59]
  ds_read_b64_tr_b16 v[154:155], v23 offset:59392
  v_xor_b32 v23, 65536, v23
  s_add_u32 m0, s41, 114688
  s_waitcnt lgkmcnt(8)
  v_mfma_f32_16x16x32_bf16 v[60:63], v[124:127], v[204:207], v[60:63]
  ds_read_b64_tr_b16 v[156:157], v24 offset:57344
  ds_read_b64_tr_b16 v[158:159], v24 offset:59392
  v_xor_b32 v24, 65536, v24
  s_add_u32 s40, s40, 131072
  v_mfma_f32_16x16x32_bf16 v[92:95], v[124:127], v[208:211], v[92:95]
  ds_read_b64_tr_b16 v[160:161], v25 offset:57344
  v_mfma_f32_16x16x32_bf16 v[96:99], v[128:131], v[208:211], v[96:99]
  buffer_load_dwordx4 v32, s[16:19], s40 offen offset:0 lds
  v_mfma_f32_16x16x32_bf16 v[64:67], v[128:131], v[204:207], v[64:67]
  ds_read_b64_tr_b16 v[162:163], v25 offset:59392
  v_xor_b32 v25, 65536, v25
  v_mfma_f32_16x16x32_bf16 v[68:71], v[132:135], v[204:207], v[68:71]
  ds_read_b64_tr_b16 v[164:165], v26 offset:57344
  ds_read_b64_tr_b16 v[166:167], v26 offset:59392
  v_xor_b32 v26, 65536, v26
  v_mfma_f32_16x16x32_bf16 v[100:103], v[132:135], v[208:211], v[100:103]
  ds_read_b64_tr_b16 v[168:169], v27 offset:57344
  v_mfma_f32_16x16x32_bf16 v[104:107], v[136:139], v[208:211], v[104:107]
  buffer_load_dwordx4 v33, s[16:19], s40 offen offset:1024 lds
  v_mfma_f32_16x16x32_bf16 v[72:75], v[136:139], v[204:207], v[72:75]
  ds_read_b64_tr_b16 v[170:171], v27 offset:59392
  v_xor_b32 v27, 65536, v27
  s_waitcnt vmcnt(16) lgkmcnt(8)
  s_barrier
  v_mfma_f32_16x16x32_bf16 v[44:47], v[140:143], v[212:215], v[44:47]
  ds_read_b64_tr_b16 v[108:109], v20 offset:0
  ds_read_b64_tr_b16 v[110:111], v20 offset:2048
  v_mfma_f32_16x16x32_bf16 v[76:79], v[140:143], v[216:219], v[76:79]
  ds_read_b64_tr_b16 v[112:113], v21 offset:0
  v_mfma_f32_16x16x32_bf16 v[80:83], v[144:147], v[216:219], v[80:83]
  ds_read_b64_tr_b16 v[114:115], v21 offset:2048
  v_mfma_f32_16x16x32_bf16 v[48:51], v[144:147], v[212:215], v[48:51]
  ds_read_b64_tr_b16 v[116:117], v22 offset:0
  v_mfma_f32_16x16x32_bf16 v[52:55], v[148:151], v[212:215], v[52:55]
  buffer_load_dwordx4 v[196:199], v18, s[8:11], s33 offen offset:3072 sc1
  v_mfma_f32_16x16x32_bf16 v[84:87], v[148:151], v[216:219], v[84:87]
  ds_read_b64_tr_b16 v[118:119], v22 offset:2048
  v_mfma_f32_16x16x32_bf16 v[88:91], v[152:155], v[216:219], v[88:91]
  ds_read_b64_tr_b16 v[120:121], v23 offset:0
  v_mfma_f32_16x16x32_bf16 v[56:59], v[152:155], v[212:215], v[56:59]
  ds_read_b64_tr_b16 v[122:123], v23 offset:2048
  s_waitcnt lgkmcnt(8)
  v_mfma_f32_16x16x32_bf16 v[60:63], v[156:159], v[212:215], v[60:63]
  ds_read_b64_tr_b16 v[124:125], v24 offset:0
  ds_read_b64_tr_b16 v[126:127], v24 offset:2048
  v_mfma_f32_16x16x32_bf16 v[92:95], v[156:159], v[216:219], v[92:95]
  ds_read_b64_tr_b16 v[128:129], v25 offset:0
  v_mfma_f32_16x16x32_bf16 v[96:99], v[160:163], v[216:219], v[96:99]
  ds_read_b64_tr_b16 v[130:131], v25 offset:2048
  v_mfma_f32_16x16x32_bf16 v[64:67], v[160:163], v[212:215], v[64:67]
  ds_read_b64_tr_b16 v[132:133], v26 offset:0
  v_mfma_f32_16x16x32_bf16 v[68:71], v[164:167], v[212:215], v[68:71]
  buffer_load_dwordx4 v[200:203], v19, s[8:11], s33 offen offset:3072 sc1
  v_mfma_f32_16x16x32_bf16 v[100:103], v[164:167], v[216:219], v[100:103]
  ds_read_b64_tr_b16 v[134:135], v26 offset:2048
  s_xor_b32 s36, s36, 65536
  v_mfma_f32_16x16x32_bf16 v[104:107], v[168:171], v[216:219], v[104:107]
  ds_read_b64_tr_b16 v[136:137], v27 offset:0
  v_mfma_f32_16x16x32_bf16 v[72:75], v[168:171], v[212:215], v[72:75]
  ds_read_b64_tr_b16 v[138:139], v27 offset:2048
  s_waitcnt vmcnt(16) lgkmcnt(8)
  v_mfma_f32_16x16x32_bf16 v[44:47], v[108:111], v[220:223], v[44:47]
  ds_read_b64_tr_b16 v[140:141], v20 offset:8192
  ds_read_b64_tr_b16 v[142:143], v20 offset:10240
  s_add_u32 s33, s33, 4096
  v_mfma_f32_16x16x32_bf16 v[76:79], v[108:111], v[224:227], v[76:79]
  ds_read_b64_tr_b16 v[144:145], v21 offset:8192
  v_mfma_f32_16x16x32_bf16 v[80:83], v[112:115], v[224:227], v[80:83]
  buffer_load_dwordx4 v[204:207], v18, s[8:11], s33 offen offset:0 sc1
  v_mfma_f32_16x16x32_bf16 v[48:51], v[112:115], v[220:223], v[48:51]
  ds_read_b64_tr_b16 v[146:147], v21 offset:10240
  v_mfma_f32_16x16x32_bf16 v[52:55], v[116:119], v[220:223], v[52:55]
  ds_read_b64_tr_b16 v[148:149], v22 offset:8192
  ds_read_b64_tr_b16 v[150:151], v22 offset:10240
  v_mfma_f32_16x16x32_bf16 v[84:87], v[116:119], v[224:227], v[84:87]
  ds_read_b64_tr_b16 v[152:153], v23 offset:8192
  v_mfma_f32_16x16x32_bf16 v[88:91], v[120:123], v[224:227], v[88:91]
  buffer_load_dwordx4 v[208:211], v19, s[8:11], s33 offen offset:0 sc1
  v_mfma_f32_16x16x32_bf16 v[56:59], v[120:123], v[220:223], v[56:59]
  ds_read_b64_tr_b16 v[154:155], v23 offset:10240
  s_add_u32 m0, s41, 0
  s_waitcnt lgkmcnt(8)
  v_mfma_f32_16x16x32_bf16 v[60:63], v[124:127], v[220:223], v[60:63]
  ds_read_b64_tr_b16 v[156:157], v24 offset:8192
  ds_read_b64_tr_b16 v[158:159], v24 offset:10240
  s_add_u32 s40, s40, 131072
  v_mfma_f32_16x16x32_bf16 v[92:95], v[124:127], v[224:227], v[92:95]
  ds_read_b64_tr_b16 v[160:161], v25 offset:8192
  v_mfma_f32_16x16x32_bf16 v[96:99], v[128:131], v[224:227], v[96:99]
  buffer_load_dwordx4 v32, s[16:19], s40 offen offset:0 lds
  v_mfma_f32_16x16x32_bf16 v[64:67], v[128:131], v[220:223], v[64:67]
  ds_read_b64_tr_b16 v[162:163], v25 offset:10240
  v_mfma_f32_16x16x32_bf16 v[68:71], v[132:135], v[220:223], v[68:71]
  ds_read_b64_tr_b16 v[164:165], v26 offset:8192
  ds_read_b64_tr_b16 v[166:167], v26 offset:10240
  v_mfma_f32_16x16x32_bf16 v[100:103], v[132:135], v[224:227], v[100:103]
  ds_read_b64_tr_b16 v[168:169], v27 offset:8192
  v_mfma_f32_16x16x32_bf16 v[104:107], v[136:139], v[224:227], v[104:107]
  buffer_load_dwordx4 v33, s[16:19], s40 offen offset:1024 lds
  v_mfma_f32_16x16x32_bf16 v[72:75], v[136:139], v[220:223], v[72:75]
  ds_read_b64_tr_b16 v[170:171], v27 offset:10240
  s_waitcnt vmcnt(16) lgkmcnt(8)
  s_barrier
  v_mfma_f32_16x16x32_bf16 v[44:47], v[140:143], v[228:231], v[44:47]
  ds_read_b64_tr_b16 v[108:109], v28 offset:0
  v_mfma_f32_16x16x32_bf16 v[76:79], v[140:143], v[232:235], v[76:79]
  ds_read_b64_tr_b16 v[110:111], v28 offset:1024
  v_mfma_f32_16x16x32_bf16 v[80:83], v[144:147], v[232:235], v[80:83]
  v_mfma_f32_16x16x32_bf16 v[48:51], v[144:147], v[228:231], v[48:51]
  ds_read_b64_tr_b16 v[112:113], v29 offset:0
  v_mfma_f32_16x16x32_bf16 v[52:55], v[148:151], v[228:231], v[52:55]
  buffer_load_dwordx4 v[212:215], v18, s[8:11], s33 offen offset:1024 sc1
  v_mfma_f32_16x16x32_bf16 v[84:87], v[148:151], v[232:235], v[84:87]
  v_mfma_f32_16x16x32_bf16 v[88:91], v[152:155], v[232:235], v[88:91]
  ds_read_b64_tr_b16 v[114:115], v29 offset:1024
  v_mfma_f32_16x16x32_bf16 v[56:59], v[152:155], v[228:231], v[56:59]
  s_waitcnt lgkmcnt(4)
  v_mfma_f32_16x16x32_bf16 v[60:63], v[156:159], v[228:231], v[60:63]
  ds_read_b64_tr_b16 v[116:117], v30 offset:0
  v_mfma_f32_16x16x32_bf16 v[92:95], v[156:159], v[232:235], v[92:95]
  ds_read_b64_tr_b16 v[118:119], v30 offset:1024
  v_mfma_f32_16x16x32_bf16 v[96:99], v[160:163], v[232:235], v[96:99]
  v_mfma_f32_16x16x32_bf16 v[64:67], v[160:163], v[228:231], v[64:67]
  ds_read_b64_tr_b16 v[120:121], v31 offset:0
  v_mfma_f32_16x16x32_bf16 v[68:71], v[164:167], v[228:231], v[68:71]
  buffer_load_dwordx4 v[216:219], v19, s[8:11], s33 offen offset:1024 sc1
  v_mfma_f32_16x16x32_bf16 v[100:103], v[164:167], v[232:235], v[100:103]
  s_xor_b32 s28, s2, 1
  s_lshl_b32 s28, s28, 14
  v_mfma_f32_16x16x32_bf16 v[104:107], v[168:171], v[232:235], v[104:107]
  ds_read_b64_tr_b16 v[122:123], v31 offset:1024
  s_lshl_b32 s29, s5, 12
  s_add_u32 s28, s28, s29
  v_mfma_f32_16x16x32_bf16 v[72:75], v[168:171], v[228:231], v[72:75]
  s_add_u32 s30, s28, 41943040
  s_waitcnt vmcnt(16) lgkmcnt(4)
  v_mfma_f32_16x16x32_bf16 v[44:47], v[108:111], v[172:175], v[44:47]
  ds_read_b64_tr_b16 v[140:141], v28 offset:4096
  buffer_load_dwordx4 v[220:223], v18, s[8:11], s33 offen offset:2048 sc1
  buffer_load_dwordx4 v[224:227], v19, s[8:11], s33 offen offset:2048 sc1
  v_mfma_f32_16x16x32_bf16 v[76:79], v[108:111], v[176:179], v[76:79]
  ds_read_b64_tr_b16 v[142:143], v28 offset:5120
  s_add_u32 m0, s41, 16384
  s_add_u32 s40, s40, 131072
  v_mfma_f32_16x16x32_bf16 v[80:83], v[112:115], v[176:179], v[80:83]
  ds_read_b64_tr_b16 v[144:145], v29 offset:4096
  buffer_load_dwordx4 v32, s[16:19], s40 offen offset:0 lds
  buffer_load_dwordx4 v33, s[16:19], s40 offen offset:1024 lds
  v_mfma_f32_16x16x32_bf16 v[48:51], v[112:115], v[172:175], v[48:51]
  ds_read_b64_tr_b16 v[146:147], v29 offset:5120
  v_cvt_pk_bf16_f32 v60, v60, v61
  v_cvt_pk_bf16_f32 v61, v62, v63
  s_waitcnt lgkmcnt(4)
  v_mfma_f32_16x16x32_bf16 v[52:55], v[116:119], v[172:175], v[52:55]
  ds_read_b64_tr_b16 v[148:149], v30 offset:4096
  v_cvt_pk_bf16_f32 v62, v64, v65
  v_cvt_pk_bf16_f32 v63, v66, v67
  v_mfma_f32_16x16x32_bf16 v[84:87], v[116:119], v[176:179], v[84:87]
  ds_read_b64_tr_b16 v[150:151], v30 offset:5120
  buffer_store_dwordx4 v[60:63], v2, s[8:11], s30 offen offset:0 sc1
  v_cvt_pk_bf16_f32 v68, v68, v69
  v_mfma_f32_16x16x32_bf16 v[88:91], v[120:123], v[176:179], v[88:91]
  ds_read_b64_tr_b16 v[152:153], v31 offset:4096
  v_cvt_pk_bf16_f32 v69, v70, v71
  v_cvt_pk_bf16_f32 v70, v72, v73
  v_mfma_f32_16x16x32_bf16 v[56:59], v[120:123], v[172:175], v[56:59]
  ds_read_b64_tr_b16 v[154:155], v31 offset:5120
  v_cvt_pk_bf16_f32 v71, v74, v75
  buffer_store_dwordx4 v[68:71], v2, s[8:11], s30 offen offset:1024 sc1
  s_waitcnt vmcnt(18) lgkmcnt(4)
  s_barrier
  v_mfma_f32_16x16x32_bf16 v[44:47], v[140:143], v[180:183], v[44:47]
  ds_read_b64_tr_b16 v[108:109], v28 offset:16384
  ds_read_b64_tr_b16 v[110:111], v28 offset:17408
  v_mfma_f32_16x16x32_bf16 v[76:79], v[140:143], v[184:187], v[76:79]
  buffer_load_dwordx4 v[228:231], v18, s[8:11], s33 offen offset:3072 sc1
  v_mfma_f32_16x16x32_bf16 v[80:83], v[144:147], v[184:187], v[80:83]
  ds_read_b64_tr_b16 v[112:113], v29 offset:16384
  ds_read_b64_tr_b16 v[114:115], v29 offset:17408
  v_mfma_f32_16x16x32_bf16 v[48:51], v[144:147], v[180:183], v[48:51]
  buffer_load_dwordx4 v[232:235], v19, s[8:11], s33 offen offset:3072 sc1
  s_waitcnt lgkmcnt(4)
  v_mfma_f32_16x16x32_bf16 v[52:55], v[148:151], v[180:183], v[52:55]
  ds_read_b64_tr_b16 v[116:117], v30 offset:16384
  ds_read_b64_tr_b16 v[118:119], v30 offset:17408
  v_cvt_pk_bf16_f32 v92, v92, v93
  v_cvt_pk_bf16_f32 v93, v94, v95
  v_mfma_f32_16x16x32_bf16 v[84:87], v[148:151], v[184:187], v[84:87]
  v_cvt_pk_bf16_f32 v94, v96, v97
  v_cvt_pk_bf16_f32 v95, v98, v99
  buffer_store_dwordx4 v[92:95], v2, s[8:11], s30 offen offset:2048 sc1
  v_mfma_f32_16x16x32_bf16 v[88:91], v[152:155], v[184:187], v[88:91]
  ds_read_b64_tr_b16 v[120:121], v31 offset:16384
  ds_read_b64_tr_b16 v[122:123], v31 offset:17408
  v_cvt_pk_bf16_f32 v100, v100, v101
  v_cvt_pk_bf16_f32 v101, v102, v103
  v_mfma_f32_16x16x32_bf16 v[56:59], v[152:155], v[180:183], v[56:59]
  v_cvt_pk_bf16_f32 v102, v104, v105
  v_cvt_pk_bf16_f32 v103, v106, v107
  buffer_store_dwordx4 v[100:103], v2, s[8:11], s30 offen offset:3072 sc1
  s_waitcnt vmcnt(20) lgkmcnt(4)
  v_mfma_f32_16x16x32_bf16 v[44:47], v[108:111], v[188:191], v[44:47]
  ds_read_b64_tr_b16 v[140:141], v28 offset:20480
  ds_read_b64_tr_b16 v[142:143], v28 offset:21504
  s_add_u32 s33, s33, 4096
  v_mfma_f32_16x16x32_bf16 v[76:79], v[108:111], v[192:195], v[76:79]
  buffer_load_dwordx4 v[172:175], v18, s[8:11], s33 offen offset:0 sc1
  v_mfma_f32_16x16x32_bf16 v[80:83], v[112:115], v[192:195], v[80:83]
  ds_read_b64_tr_b16 v[144:145], v29 offset:20480
  ds_read_b64_tr_b16 v[146:147], v29 offset:21504
  v_mfma_f32_16x16x32_bf16 v[48:51], v[112:115], v[188:191], v[48:51]
  buffer_load_dwordx4 v[176:179], v19, s[8:11], s33 offen offset:0 sc1
  s_waitcnt lgkmcnt(4)
  v_mfma_f32_16x16x32_bf16 v[52:55], v[116:119], v[188:191], v[52:55]
  ds_read_b64_tr_b16 v[148:149], v30 offset:20480
  ds_read_b64_tr_b16 v[150:151], v30 offset:21504
  s_add_u32 m0, s41, 32768
  v_mfma_f32_16x16x32_bf16 v[84:87], v[116:119], v[192:195], v[84:87]
  s_add_u32 s40, s40, 131072
  buffer_load_dwordx4 v32, s[16:19], s40 offen offset:0 lds
  v_mfma_f32_16x16x32_bf16 v[88:91], v[120:123], v[192:195], v[88:91]
  ds_read_b64_tr_b16 v[152:153], v31 offset:20480
  ds_read_b64_tr_b16 v[154:155], v31 offset:21504
  v_mfma_f32_16x16x32_bf16 v[56:59], v[120:123], v[188:191], v[56:59]
  buffer_load_dwordx4 v33, s[16:19], s40 offen offset:1024 lds
  s_waitcnt vmcnt(20) lgkmcnt(4)
  s_barrier
  v_mfma_f32_16x16x32_bf16 v[44:47], v[140:143], v[196:199], v[44:47]
  ds_read_b64_tr_b16 v[108:109], v28 offset:32768
  ds_read_b64_tr_b16 v[110:111], v28 offset:33792
  v_mfma_f32_16x16x32_bf16 v[76:79], v[140:143], v[200:203], v[76:79]
  ds_read_b64_tr_b16 v[112:113], v29 offset:32768
  v_mfma_f32_16x16x32_bf16 v[80:83], v[144:147], v[200:203], v[80:83]
  buffer_load_dwordx4 v[180:183], v18, s[8:11], s33 offen offset:1024 sc1
  v_mfma_f32_16x16x32_bf16 v[48:51], v[144:147], v[196:199], v[48:51]
  ds_read_b64_tr_b16 v[114:115], v29 offset:33792
  s_waitcnt lgkmcnt(4)
  v_mfma_f32_16x16x32_bf16 v[52:55], v[148:151], v[196:199], v[52:55]
  ds_read_b64_tr_b16 v[116:117], v30 offset:32768
  ds_read_b64_tr_b16 v[118:119], v30 offset:33792
  v_mfma_f32_16x16x32_bf16 v[84:87], v[148:151], v[200:203], v[84:87]
  ds_read_b64_tr_b16 v[120:121], v31 offset:32768
  v_mfma_f32_16x16x32_bf16 v[88:91], v[152:155], v[200:203], v[88:91]
  buffer_load_dwordx4 v[184:187], v19, s[8:11], s33 offen offset:1024 sc1
  v_mfma_f32_16x16x32_bf16 v[56:59], v[152:155], v[196:199], v[56:59]
  ds_read_b64_tr_b16 v[122:123], v31 offset:33792
  s_waitcnt vmcnt(20) lgkmcnt(4)
  v_mfma_f32_16x16x32_bf16 v[44:47], v[108:111], v[204:207], v[44:47]
  ds_read_b64_tr_b16 v[140:141], v28 offset:36864
  ds_read_b64_tr_b16 v[142:143], v28 offset:37888
  v_subrev_u32 v28, 81920, v28
  v_mfma_f32_16x16x32_bf16 v[76:79], v[108:111], v[208:211], v[76:79]
  buffer_load_dwordx4 v[188:191], v18, s[8:11], s33 offen offset:2048 sc1
  v_mfma_f32_16x16x32_bf16 v[80:83], v[112:115], v[208:211], v[80:83]
  ds_read_b64_tr_b16 v[144:145], v29 offset:36864
  ds_read_b64_tr_b16 v[146:147], v29 offset:37888
  v_subrev_u32 v29, 81920, v29
  v_mfma_f32_16x16x32_bf16 v[48:51], v[112:115], v[204:207], v[48:51]
  buffer_load_dwordx4 v[192:195], v19, s[8:11], s33 offen offset:2048 sc1
  s_waitcnt lgkmcnt(4)
  v_mfma_f32_16x16x32_bf16 v[52:55], v[116:119], v[204:207], v[52:55]
  ds_read_b64_tr_b16 v[148:149], v30 offset:36864
  ds_read_b64_tr_b16 v[150:151], v30 offset:37888
  v_subrev_u32 v30, 81920, v30
  s_add_u32 m0, s41, 49152
  s_add_u32 s40, s40, 131072
  v_mfma_f32_16x16x32_bf16 v[84:87], v[116:119], v[208:211], v[84:87]
  buffer_load_dwordx4 v32, s[16:19], s40 offen offset:0 lds
  v_mfma_f32_16x16x32_bf16 v[88:91], v[120:123], v[208:211], v[88:91]
  ds_read_b64_tr_b16 v[152:153], v31 offset:36864
  ds_read_b64_tr_b16 v[154:155], v31 offset:37888
  v_subrev_u32 v31, 81920, v31
  v_mfma_f32_16x16x32_bf16 v[56:59], v[120:123], v[204:207], v[56:59]
  buffer_load_dwordx4 v33, s[16:19], s40 offen offset:1024 lds
  v_accvgpr_read_b32 v124, a0
  v_accvgpr_read_b32 v156, a16
  v_accvgpr_read_b32 v125, a1
  v_accvgpr_read_b32 v157, a17
  v_accvgpr_read_b32 v126, a2
  v_accvgpr_read_b32 v158, a18
  v_accvgpr_read_b32 v127, a3
  v_accvgpr_read_b32 v159, a19
  s_waitcnt vmcnt(20) lgkmcnt(4)
  s_barrier
  v_mfma_f32_16x16x32_bf16 v[44:47], v[140:143], v[212:215], v[44:47]
  ds_read_b64_tr_b16 v[108:109], v28 offset:0
  ds_read_b64_tr_b16 v[110:111], v28 offset:1024
  v_mfma_f32_16x16x32_bf16 v[76:79], v[140:143], v[216:219], v[76:79]
  ds_read_b64_tr_b16 v[112:113], v29 offset:0
  v_mfma_f32_16x16x32_bf16 v[80:83], v[144:147], v[216:219], v[80:83]
  buffer_load_dwordx4 v[196:199], v18, s[8:11], s33 offen offset:3072 sc1
  v_mfma_f32_16x16x32_bf16 v[48:51], v[144:147], v[212:215], v[48:51]
  ds_read_b64_tr_b16 v[114:115], v29 offset:1024
  s_waitcnt lgkmcnt(4)
  v_mfma_f32_16x16x32_bf16 v[52:55], v[148:151], v[212:215], v[52:55]
  ds_read_b64_tr_b16 v[116:117], v30 offset:0
  ds_read_b64_tr_b16 v[118:119], v30 offset:1024
  v_mfma_f32_16x16x32_bf16 v[84:87], v[148:151], v[216:219], v[84:87]
  ds_read_b64_tr_b16 v[120:121], v31 offset:0
  v_mfma_f32_16x16x32_bf16 v[88:91], v[152:155], v[216:219], v[88:91]
  buffer_load_dwordx4 v[200:203], v19, s[8:11], s33 offen offset:3072 sc1
  v_mfma_f32_16x16x32_bf16 v[56:59], v[152:155], v[212:215], v[56:59]
  ds_read_b64_tr_b16 v[122:123], v31 offset:1024
  v_accvgpr_read_b32 v128, a4
  v_accvgpr_read_b32 v160, a20
  v_accvgpr_read_b32 v129, a5
  v_accvgpr_read_b32 v161, a21
  v_accvgpr_read_b32 v130, a6
  v_accvgpr_read_b32 v162, a22
  v_accvgpr_read_b32 v131, a7
  v_accvgpr_read_b32 v163, a23
  s_waitcnt vmcnt(20) lgkmcnt(4)
  v_mfma_f32_16x16x32_bf16 v[44:47], v[108:111], v[220:223], v[44:47]
  ds_read_b64_tr_b16 v[140:141], v28 offset:4096
  ds_read_b64_tr_b16 v[142:143], v28 offset:5120
  s_add_u32 s33, s33, 4096
  v_mfma_f32_16x16x32_bf16 v[76:79], v[108:111], v[224:227], v[76:79]
  buffer_load_dwordx4 v[204:207], v18, s[8:11], s33 offen offset:0 sc1
  v_mfma_f32_16x16x32_bf16 v[80:83], v[112:115], v[224:227], v[80:83]
  ds_read_b64_tr_b16 v[144:145], v29 offset:4096
  ds_read_b64_tr_b16 v[146:147], v29 offset:5120
  v_mfma_f32_16x16x32_bf16 v[48:51], v[112:115], v[220:223], v[48:51]
  buffer_load_dwordx4 v[208:211], v19, s[8:11], s33 offen offset:0 sc1
  s_waitcnt lgkmcnt(4)
  v_mfma_f32_16x16x32_bf16 v[52:55], v[116:119], v[220:223], v[52:55]
  ds_read_b64_tr_b16 v[148:149], v30 offset:4096
  ds_read_b64_tr_b16 v[150:151], v30 offset:5120
  s_add_u32 m0, s41, 65536
  s_add_u32 s40, s40, 131072
  v_mfma_f32_16x16x32_bf16 v[84:87], v[116:119], v[224:227], v[84:87]
  buffer_load_dwordx4 v32, s[16:19], s40 offen offset:0 lds
  v_mfma_f32_16x16x32_bf16 v[88:91], v[120:123], v[224:227], v[88:91]
  ds_read_b64_tr_b16 v[152:153], v31 offset:4096
  ds_read_b64_tr_b16 v[154:155], v31 offset:5120
  v_mfma_f32_16x16x32_bf16 v[56:59], v[120:123], v[220:223], v[56:59]
  buffer_load_dwordx4 v33, s[16:19], s40 offen offset:1024 lds
  v_accvgpr_read_b32 v132, a8
  v_accvgpr_read_b32 v164, a24
  v_accvgpr_read_b32 v133, a9
  v_accvgpr_read_b32 v165, a25
  v_accvgpr_read_b32 v134, a10
  v_accvgpr_read_b32 v166, a26
  v_accvgpr_read_b32 v135, a11
  v_accvgpr_read_b32 v167, a27
  s_waitcnt vmcnt(18) lgkmcnt(4)
  s_barrier
  v_mfma_f32_16x16x32_bf16 v[44:47], v[140:143], v[228:231], v[44:47]
  ds_read_b64_tr_b16 v[108:109], v28 offset:16384
  ds_read_b64_tr_b16 v[110:111], v28 offset:17408
  v_mfma_f32_16x16x32_bf16 v[76:79], v[140:143], v[232:235], v[76:79]
  ds_read_b64_tr_b16 v[112:113], v29 offset:16384
  v_mfma_f32_16x16x32_bf16 v[80:83], v[144:147], v[232:235], v[80:83]
  buffer_load_dwordx4 v[212:215], v18, s[8:11], s33 offen offset:1024 sc1
  v_mfma_f32_16x16x32_bf16 v[48:51], v[144:147], v[228:231], v[48:51]
  ds_read_b64_tr_b16 v[114:115], v29 offset:17408
  s_waitcnt lgkmcnt(4)
  v_mfma_f32_16x16x32_bf16 v[52:55], v[148:151], v[228:231], v[52:55]
  ds_read_b64_tr_b16 v[116:117], v30 offset:16384
  ds_read_b64_tr_b16 v[118:119], v30 offset:17408
  v_mfma_f32_16x16x32_bf16 v[84:87], v[148:151], v[232:235], v[84:87]
  ds_read_b64_tr_b16 v[120:121], v31 offset:16384
  v_mfma_f32_16x16x32_bf16 v[88:91], v[152:155], v[232:235], v[88:91]
  buffer_load_dwordx4 v[216:219], v19, s[8:11], s33 offen offset:1024 sc1
  v_mfma_f32_16x16x32_bf16 v[56:59], v[152:155], v[228:231], v[56:59]
  ds_read_b64_tr_b16 v[122:123], v31 offset:17408
  v_accvgpr_read_b32 v136, a12
  v_accvgpr_read_b32 v168, a28
  v_accvgpr_read_b32 v137, a13
  v_accvgpr_read_b32 v169, a29
  v_accvgpr_read_b32 v138, a14
  v_accvgpr_read_b32 v170, a30
  v_accvgpr_read_b32 v139, a15
  v_accvgpr_read_b32 v171, a31
  s_waitcnt vmcnt(16) lgkmcnt(4)
  v_mfma_f32_16x16x32_bf16 v[44:47], v[108:111], v[172:175], v[44:47]
  ds_read_b64_tr_b16 v[140:141], v28 offset:20480
  ds_read_b64_tr_b16 v[142:143], v28 offset:21504
  v_mfma_f32_16x16x32_bf16 v[76:79], v[108:111], v[176:179], v[76:79]
  ds_read_b64_tr_b16 v[144:145], v29 offset:20480
  v_mfma_f32_16x16x32_bf16 v[80:83], v[112:115], v[176:179], v[80:83]
  buffer_load_dwordx4 v[220:223], v18, s[8:11], s33 offen offset:2048 sc1
  v_mfma_f32_16x16x32_bf16 v[48:51], v[112:115], v[172:175], v[48:51]
  ds_read_b64_tr_b16 v[146:147], v29 offset:21504
  s_waitcnt lgkmcnt(4)
  v_mfma_f32_16x16x32_bf16 v[52:55], v[116:119], v[172:175], v[52:55]
  ds_read_b64_tr_b16 v[148:149], v30 offset:20480
  ds_read_b64_tr_b16 v[150:151], v30 offset:21504
  v_mfma_f32_16x16x32_bf16 v[84:87], v[116:119], v[176:179], v[84:87]
  ds_read_b64_tr_b16 v[152:153], v31 offset:20480
  v_mfma_f32_16x16x32_bf16 v[88:91], v[120:123], v[176:179], v[88:91]
  buffer_load_dwordx4 v[224:227], v19, s[8:11], s33 offen offset:2048 sc1
  v_mfma_f32_16x16x32_bf16 v[56:59], v[120:123], v[172:175], v[56:59]
  ds_read_b64_tr_b16 v[154:155], v31 offset:21504
  s_waitcnt vmcnt(14) lgkmcnt(4)
  s_barrier
  v_mfma_f32_16x16x32_bf16 v[44:47], v[140:143], v[180:183], v[44:47]
  ds_read_b64_tr_b16 v[108:109], v28 offset:32768
  ds_read_b64_tr_b16 v[110:111], v28 offset:33792
  v_mfma_f32_16x16x32_bf16 v[76:79], v[140:143], v[184:187], v[76:79]
  ds_read_b64_tr_b16 v[112:113], v29 offset:32768
  v_mfma_f32_16x16x32_bf16 v[80:83], v[144:147], v[184:187], v[80:83]
  buffer_load_dwordx4 v[228:231], v18, s[8:11], s33 offen offset:3072 sc1
  v_mfma_f32_16x16x32_bf16 v[48:51], v[144:147], v[180:183], v[48:51]
  ds_read_b64_tr_b16 v[114:115], v29 offset:33792
  s_waitcnt lgkmcnt(4)
  v_mfma_f32_16x16x32_bf16 v[52:55], v[148:151], v[180:183], v[52:55]
  ds_read_b64_tr_b16 v[116:117], v30 offset:32768
  ds_read_b64_tr_b16 v[118:119], v30 offset:33792
  v_mfma_f32_16x16x32_bf16 v[84:87], v[148:151], v[184:187], v[84:87]
  ds_read_b64_tr_b16 v[120:121], v31 offset:32768
  v_mfma_f32_16x16x32_bf16 v[88:91], v[152:155], v[184:187], v[88:91]
  buffer_load_dwordx4 v[232:235], v19, s[8:11], s33 offen offset:3072 sc1
  v_mfma_f32_16x16x32_bf16 v[56:59], v[152:155], v[180:183], v[56:59]
  ds_read_b64_tr_b16 v[122:123], v31 offset:33792
  s_waitcnt vmcnt(14) lgkmcnt(4)
  v_mfma_f32_16x16x32_bf16 v[44:47], v[108:111], v[188:191], v[44:47]
  ds_read_b64_tr_b16 v[140:141], v28 offset:36864
  v_mfma_f32_16x16x32_bf16 v[76:79], v[108:111], v[192:195], v[76:79]
  ds_read_b64_tr_b16 v[142:143], v28 offset:37888
  v_mfma_f32_16x16x32_bf16 v[80:83], v[112:115], v[192:195], v[80:83]
  ds_read_b64_tr_b16 v[144:145], v29 offset:36864
  v_mfma_f32_16x16x32_bf16 v[48:51], v[112:115], v[188:191], v[48:51]
  ds_read_b64_tr_b16 v[146:147], v29 offset:37888
  s_waitcnt lgkmcnt(4)
  v_mfma_f32_16x16x32_bf16 v[52:55], v[116:119], v[188:191], v[52:55]
  ds_read_b64_tr_b16 v[148:149], v30 offset:36864
  v_mfma_f32_16x16x32_bf16 v[84:87], v[116:119], v[192:195], v[84:87]
  ds_read_b64_tr_b16 v[150:151], v30 offset:37888
  v_mfma_f32_16x16x32_bf16 v[88:91], v[120:123], v[192:195], v[88:91]
  ds_read_b64_tr_b16 v[152:153], v31 offset:36864
  v_mfma_f32_16x16x32_bf16 v[56:59], v[120:123], v[188:191], v[56:59]
  ds_read_b64_tr_b16 v[154:155], v31 offset:37888
  s_waitcnt vmcnt(10) lgkmcnt(4)
  s_barrier
  v_mfma_f32_16x16x32_bf16 v[44:47], v[140:143], v[196:199], v[44:47]
  ds_read_b64_tr_b16 v[108:109], v28 offset:49152
  v_mfma_f32_16x16x32_bf16 v[76:79], v[140:143], v[200:203], v[76:79]
  ds_read_b64_tr_b16 v[110:111], v28 offset:50176
  v_mfma_f32_16x16x32_bf16 v[80:83], v[144:147], v[200:203], v[80:83]
  ds_read_b64_tr_b16 v[112:113], v29 offset:49152
  v_mfma_f32_16x16x32_bf16 v[48:51], v[144:147], v[196:199], v[48:51]
  ds_read_b64_tr_b16 v[114:115], v29 offset:50176
  s_waitcnt lgkmcnt(4)
  v_mfma_f32_16x16x32_bf16 v[52:55], v[148:151], v[196:199], v[52:55]
  ds_read_b64_tr_b16 v[116:117], v30 offset:49152
  v_mfma_f32_16x16x32_bf16 v[84:87], v[148:151], v[200:203], v[84:87]
  ds_read_b64_tr_b16 v[118:119], v30 offset:50176
  v_mfma_f32_16x16x32_bf16 v[88:91], v[152:155], v[200:203], v[88:91]
  ds_read_b64_tr_b16 v[120:121], v31 offset:49152
  v_mfma_f32_16x16x32_bf16 v[56:59], v[152:155], v[196:199], v[56:59]
  ds_read_b64_tr_b16 v[122:123], v31 offset:50176
  s_waitcnt vmcnt(8) lgkmcnt(4)
  v_mfma_f32_16x16x32_bf16 v[44:47], v[108:111], v[204:207], v[44:47]
  ds_read_b64_tr_b16 v[140:141], v28 offset:53248
  s_waitcnt vmcnt(63)
  v_add_f32 v156, v156, v158
  v_add_f32 v157, v157, v159
  v_mfma_f32_16x16x32_bf16 v[76:79], v[108:111], v[208:211], v[76:79]
  ds_read_b64_tr_b16 v[142:143], v28 offset:54272
  v_add_u32 v28, 65536, v28
  v_add_f32 v160, v160, v162
  v_add_f32 v161, v161, v163
  v_mfma_f32_16x16x32_bf16 v[80:83], v[112:115], v[208:211], v[80:83]
  ds_read_b64_tr_b16 v[144:145], v29 offset:53248
  v_add_f32 v164, v164, v166
  v_add_f32 v165, v165, v167
  v_mfma_f32_16x16x32_bf16 v[48:51], v[112:115], v[204:207], v[48:51]
  ds_read_b64_tr_b16 v[146:147], v29 offset:54272
  v_add_u32 v29, 65536, v29
  v_add_f32 v168, v168, v170
  v_add_f32 v169, v169, v171
  s_waitcnt lgkmcnt(4)
  v_mfma_f32_16x16x32_bf16 v[52:55], v[116:119], v[204:207], v[52:55]
  ds_read_b64_tr_b16 v[148:149], v30 offset:53248
  v_add_f32 v156, v156, v160
  v_add_f32 v157, v157, v161
  v_mfma_f32_16x16x32_bf16 v[84:87], v[116:119], v[208:211], v[84:87]
  ds_read_b64_tr_b16 v[150:151], v30 offset:54272
  v_add_u32 v30, 65536, v30
  v_add_f32 v164, v164, v168
  v_add_f32 v165, v165, v169
  v_mfma_f32_16x16x32_bf16 v[88:91], v[120:123], v[208:211], v[88:91]
  ds_read_b64_tr_b16 v[152:153], v31 offset:53248
  v_mov_b32 v158, v156
  v_mov_b32 v159, v157
  v_mfma_f32_16x16x32_bf16 v[56:59], v[120:123], v[204:207], v[56:59]
  ds_read_b64_tr_b16 v[154:155], v31 offset:54272
  v_add_u32 v31, 65536, v31
  v_mov_b32 v166, v164
  v_mov_b32 v167, v165
  s_waitcnt vmcnt(4) lgkmcnt(4)
  s_barrier
  v_mfma_f32_16x16x32_bf16 v[44:47], v[140:143], v[212:215], v[44:47]
  ds_read_b64_tr_b16 v[108:109], v28 offset:0
  ds_read_b64_tr_b16 v[110:111], v28 offset:1024
  s_xor_b32 s30, s30, 16384
  v_mfma_f32_16x16x32_bf16 v[76:79], v[140:143], v[216:219], v[76:79]
  buffer_load_dwordx4 v[60:63], v2, s[8:11], s30 offen offset:0 sc1
  v_mfma_f32_16x16x32_bf16 v[80:83], v[144:147], v[216:219], v[80:83]
  ds_read_b64_tr_b16 v[112:113], v29 offset:0
  ds_read_b64_tr_b16 v[114:115], v29 offset:1024
  v_mfma_f32_16x16x32_bf16 v[48:51], v[144:147], v[212:215], v[48:51]
  buffer_load_dwordx4 v[68:71], v2, s[8:11], s30 offen offset:1024 sc1
  s_waitcnt lgkmcnt(4)
  v_mfma_f32_16x16x32_bf16 v[52:55], v[148:151], v[212:215], v[52:55]
  ds_read_b64_tr_b16 v[116:117], v30 offset:0
  ds_read_b64_tr_b16 v[118:119], v30 offset:1024
  v_mfma_f32_16x16x32_bf16 v[84:87], v[148:151], v[216:219], v[84:87]
  buffer_load_dwordx4 v[92:95], v2, s[8:11], s30 offen offset:2048 sc1
  v_mfma_f32_16x16x32_bf16 v[88:91], v[152:155], v[216:219], v[88:91]
  ds_read_b64_tr_b16 v[120:121], v31 offset:0
  ds_read_b64_tr_b16 v[122:123], v31 offset:1024
  v_mfma_f32_16x16x32_bf16 v[56:59], v[152:155], v[212:215], v[56:59]
  buffer_load_dwordx4 v[100:103], v2, s[8:11], s30 offen offset:3072 sc1
  s_nop 0
  v_permlane16_swap_b32 v156, v158
  v_permlane16_swap_b32 v157, v159
  v_permlane16_swap_b32 v164, v166
  v_permlane16_swap_b32 v165, v167
  v_add_f32 v156, v156, v158
  v_add_f32 v157, v157, v159
  v_add_f32 v164, v164, v166
  v_add_f32 v165, v165, v167
  v_mov_b32 v158, v156
  v_mov_b32 v159, v157
  v_mov_b32 v166, v164
  v_mov_b32 v167, v165
  s_nop 0
  v_permlane32_swap_b32 v156, v158
  v_permlane32_swap_b32 v157, v159
  v_permlane32_swap_b32 v164, v166
  s_waitcnt vmcnt(6) lgkmcnt(4)
  v_mfma_f32_16x16x32_bf16 v[44:47], v[108:111], v[220:223], v[44:47]
  ds_read_b64_tr_b16 v[140:141], v28 offset:4096
  v_permlane32_swap_b32 v165, v167
  v_add_f32 v156, v156, v158
  v_add_f32 v157, v157, v159
  v_mfma_f32_16x16x32_bf16 v[76:79], v[108:111], v[224:227], v[76:79]
  ds_read_b64_tr_b16 v[142:143], v28 offset:5120
  v_add_f32 v164, v164, v166
  v_add_f32 v165, v165, v167
  v_mfma_f32_16x16x32_bf16 v[80:83], v[112:115], v[224:227], v[80:83]
  ds_read_b64_tr_b16 v[144:145], v29 offset:4096
  v_mul_f32 v156, 0x3a800000, v156
  v_mul_f32 v157, 0x3a800000, v157
  v_mfma_f32_16x16x32_bf16 v[48:51], v[112:115], v[220:223], v[48:51]
  ds_read_b64_tr_b16 v[146:147], v29 offset:5120
  v_fma_f32 v157, -v156, v156, v157
  v_max_f32 v157, 0, v157
  s_waitcnt lgkmcnt(4)
  v_mfma_f32_16x16x32_bf16 v[52:55], v[116:119], v[220:223], v[52:55]
  ds_read_b64_tr_b16 v[148:149], v30 offset:4096
  v_add_f32 v157, 0x3727c5ac, v157
  v_rcp_f32 v20, v157
  v_mfma_f32_16x16x32_bf16 v[84:87], v[116:119], v[224:227], v[84:87]
  ds_read_b64_tr_b16 v[150:151], v30 offset:5120
  v_mul_f32 v164, 0x3a800000, v164
  v_mul_f32 v165, 0x3a800000, v165
  v_mfma_f32_16x16x32_bf16 v[88:91], v[120:123], v[224:227], v[88:91]
  ds_read_b64_tr_b16 v[152:153], v31 offset:4096
  v_fma_f32 v165, -v164, v164, v165
  v_max_f32 v165, 0, v165
  v_mfma_f32_16x16x32_bf16 v[56:59], v[120:123], v[220:223], v[56:59]
  ds_read_b64_tr_b16 v[154:155], v31 offset:5120
  v_add_f32 v165, 0x3727c5ac, v165
  v_rcp_f32 v21, v165
  s_waitcnt vmcnt(4) lgkmcnt(4)
  v_mfma_f32_16x16x32_bf16 v[44:47], v[140:143], v[228:231], v[44:47]
  v_mfma_f32_16x16x32_bf16 v[76:79], v[140:143], v[232:235], v[76:79]
  v_mfma_f32_16x16x32_bf16 v[80:83], v[144:147], v[232:235], v[80:83]
  v_mfma_f32_16x16x32_bf16 v[48:51], v[144:147], v[228:231], v[48:51]
  s_waitcnt lgkmcnt(0)
  v_mfma_f32_16x16x32_bf16 v[52:55], v[148:151], v[228:231], v[52:55]
  v_mfma_f32_16x16x32_bf16 v[84:87], v[148:151], v[232:235], v[84:87]
  v_mfma_f32_16x16x32_bf16 v[88:91], v[152:155], v[232:235], v[88:91]
  v_mfma_f32_16x16x32_bf16 v[56:59], v[152:155], v[228:231], v[56:59]
  s_lshl_b32 s30, s5, 12
  v_lshrrev_b32 v37, 1, v3
  v_xor_b32 v37, v37, v6
  v_lshlrev_b32 v37, 4, v37
  v_and_b32 v38, 1, v4
  v_lshlrev_b32 v38, 3, v38
  v_lshl_add_u32 v38, v3, 7, v38
  v_add_u32 v38, s30, v38
  v_lshlrev_b32 v172, 16, v124
  v_and_b32 v173, 0xffff0000, v124
  v_lshlrev_b32 v174, 16, v125
  v_and_b32 v175, 0xffff0000, v125
  v_lshlrev_b32 v176, 16, v126
  v_and_b32 v177, 0xffff0000, v126
  v_lshlrev_b32 v178, 16, v127
  v_and_b32 v179, 0xffff0000, v127
  v_lshlrev_b32 v180, 16, v128
  v_and_b32 v181, 0xffff0000, v128
  v_lshlrev_b32 v182, 16, v129
  v_and_b32 v183, 0xffff0000, v129
  v_lshlrev_b32 v184, 16, v130
  v_and_b32 v185, 0xffff0000, v130
  v_lshlrev_b32 v186, 16, v131
  v_and_b32 v187, 0xffff0000, v131
  v_lshlrev_b32 v188, 16, v132
  v_and_b32 v189, 0xffff0000, v132
  v_lshlrev_b32 v190, 16, v133
  v_and_b32 v191, 0xffff0000, v133
  v_lshlrev_b32 v192, 16, v134
  v_and_b32 v193, 0xffff0000, v134
  v_lshlrev_b32 v194, 16, v135
  v_and_b32 v195, 0xffff0000, v135
  v_lshlrev_b32 v196, 16, v136
  v_and_b32 v197, 0xffff0000, v136
  v_lshlrev_b32 v198, 16, v137
  v_and_b32 v199, 0xffff0000, v137
  v_lshlrev_b32 v200, 16, v138
  v_and_b32 v201, 0xffff0000, v138
  v_lshlrev_b32 v202, 16, v139
  v_and_b32 v203, 0xffff0000, v139
  v_pk_fma_f32 v[172:173], v[44:45], v[20:21], v[172:173] op_sel:[0,0,0] op_sel_hi:[1,0,1]
  v_pk_fma_f32 v[174:175], v[46:47], v[20:21], v[174:175] op_sel:[0,0,0] op_sel_hi:[1,0,1]
  v_pk_fma_f32 v[176:177], v[48:49], v[20:21], v[176:177] op_sel:[0,0,0] op_sel_hi:[1,0,1]
  v_pk_fma_f32 v[178:179], v[50:51], v[20:21], v[178:179] op_sel:[0,0,0] op_sel_hi:[1,0,1]
  v_pk_fma_f32 v[180:181], v[52:53], v[20:21], v[180:181] op_sel:[0,0,0] op_sel_hi:[1,0,1]
  v_pk_fma_f32 v[182:183], v[54:55], v[20:21], v[182:183] op_sel:[0,0,0] op_sel_hi:[1,0,1]
  v_pk_fma_f32 v[184:185], v[56:57], v[20:21], v[184:185] op_sel:[0,0,0] op_sel_hi:[1,0,1]
  v_pk_fma_f32 v[186:187], v[58:59], v[20:21], v[186:187] op_sel:[0,0,0] op_sel_hi:[1,0,1]
  v_pk_fma_f32 v[188:189], v[76:77], v[20:21], v[188:189] op_sel:[0,1,0] op_sel_hi:[1,1,1]
  v_pk_fma_f32 v[190:191], v[78:79], v[20:21], v[190:191] op_sel:[0,1,0] op_sel_hi:[1,1,1]
  v_pk_fma_f32 v[192:193], v[80:81], v[20:21], v[192:193] op_sel:[0,1,0] op_sel_hi:[1,1,1]
  v_pk_fma_f32 v[194:195], v[82:83], v[20:21], v[194:195] op_sel:[0,1,0] op_sel_hi:[1,1,1]
  v_pk_fma_f32 v[196:197], v[84:85], v[20:21], v[196:197] op_sel:[0,1,0] op_sel_hi:[1,1,1]
  v_pk_fma_f32 v[198:199], v[86:87], v[20:21], v[198:199] op_sel:[0,1,0] op_sel_hi:[1,1,1]
  v_pk_fma_f32 v[200:201], v[88:89], v[20:21], v[200:201] op_sel:[0,1,0] op_sel_hi:[1,1,1]
  v_pk_fma_f32 v[202:203], v[90:91], v[20:21], v[202:203] op_sel:[0,1,0] op_sel_hi:[1,1,1]
  s_waitcnt vmcnt(0)
  v_max3_u32 v35, v60, v61, v62
  v_max3_u32 v36, v92, v93, v94
  v_max3_u32 v35, v35, v63, v68
  v_max3_u32 v36, v36, v95, v100
  v_max3_u32 v35, v35, v69, v70
  v_max3_u32 v36, v36, v101, v102
  v_max3_u32 v35, v35, v71, v103
  v_max_u32 v35, v35, v36
  v_cmp_eq_u32 vcc, -1, v35
  s_nop 1
  s_cmp_lg_u64 vcc, 0
  s_cbranch_scc1 L_p5x_spin
L_p5x_back:
  v_lshlrev_b32 v64, 16, v62
  v_and_b32 v65, 0xffff0000, v62
  v_lshlrev_b32 v66, 16, v63
  v_and_b32 v67, 0xffff0000, v63
  v_lshlrev_b32 v62, 16, v61
  v_and_b32 v63, 0xffff0000, v61
  v_and_b32 v61, 0xffff0000, v60
  v_lshlrev_b32 v60, 16, v60
  v_lshlrev_b32 v72, 16, v70
  v_and_b32 v73, 0xffff0000, v70
  v_lshlrev_b32 v74, 16, v71
  v_and_b32 v75, 0xffff0000, v71
  v_lshlrev_b32 v70, 16, v69
  v_and_b32 v71, 0xffff0000, v69
  v_and_b32 v69, 0xffff0000, v68
  v_lshlrev_b32 v68, 16, v68
  v_pk_fma_f32 v[172:173], v[60:61], v[20:21], v[172:173] op_sel:[0,0,0] op_sel_hi:[1,0,1]
  v_pk_fma_f32 v[174:175], v[62:63], v[20:21], v[174:175] op_sel:[0,0,0] op_sel_hi:[1,0,1]
  v_pk_fma_f32 v[176:177], v[64:65], v[20:21], v[176:177] op_sel:[0,0,0] op_sel_hi:[1,0,1]
  v_pk_fma_f32 v[178:179], v[66:67], v[20:21], v[178:179] op_sel:[0,0,0] op_sel_hi:[1,0,1]
  v_pk_fma_f32 v[180:181], v[68:69], v[20:21], v[180:181] op_sel:[0,0,0] op_sel_hi:[1,0,1]
  v_pk_fma_f32 v[182:183], v[70:71], v[20:21], v[182:183] op_sel:[0,0,0] op_sel_hi:[1,0,1]
  v_pk_fma_f32 v[184:185], v[72:73], v[20:21], v[184:185] op_sel:[0,0,0] op_sel_hi:[1,0,1]
  v_pk_fma_f32 v[186:187], v[74:75], v[20:21], v[186:187] op_sel:[0,0,0] op_sel_hi:[1,0,1]
  v_cvt_pk_bf16_f32 v204, v172, v173
  v_cvt_pk_bf16_f32 v205, v174, v175
  v_cvt_pk_bf16_f32 v206, v176, v177
  v_cvt_pk_bf16_f32 v207, v178, v179
  v_cvt_pk_bf16_f32 v208, v180, v181
  v_cvt_pk_bf16_f32 v209, v182, v183
  v_cvt_pk_bf16_f32 v210, v184, v185
  v_cvt_pk_bf16_f32 v211, v186, v187
  v_lshlrev_b32 v96, 16, v94
  v_and_b32 v97, 0xffff0000, v94
  v_lshlrev_b32 v98, 16, v95
  v_and_b32 v99, 0xffff0000, v95
  v_lshlrev_b32 v94, 16, v93
  v_and_b32 v95, 0xffff0000, v93
  v_and_b32 v93, 0xffff0000, v92
  v_lshlrev_b32 v92, 16, v92
  v_lshlrev_b32 v104, 16, v102
  v_and_b32 v105, 0xffff0000, v102
  v_lshlrev_b32 v106, 16, v103
  v_and_b32 v107, 0xffff0000, v103
  v_lshlrev_b32 v102, 16, v101
  v_and_b32 v103, 0xffff0000, v101
  v_and_b32 v101, 0xffff0000, v100
  v_lshlrev_b32 v100, 16, v100
  v_pk_fma_f32 v[188:189], v[92:93], v[20:21], v[188:189] op_sel:[0,1,0] op_sel_hi:[1,1,1]
  v_pk_fma_f32 v[190:191], v[94:95], v[20:21], v[190:191] op_sel:[0,1,0] op_sel_hi:[1,1,1]
  v_pk_fma_f32 v[192:193], v[96:97], v[20:21], v[192:193] op_sel:[0,1,0] op_sel_hi:[1,1,1]
  v_pk_fma_f32 v[194:195], v[98:99], v[20:21], v[194:195] op_sel:[0,1,0] op_sel_hi:[1,1,1]
  v_pk_fma_f32 v[196:197], v[100:101], v[20:21], v[196:197] op_sel:[0,1,0] op_sel_hi:[1,1,1]
  v_pk_fma_f32 v[198:199], v[102:103], v[20:21], v[198:199] op_sel:[0,1,0] op_sel_hi:[1,1,1]
  v_pk_fma_f32 v[200:201], v[104:105], v[20:21], v[200:201] op_sel:[0,1,0] op_sel_hi:[1,1,1]
  v_pk_fma_f32 v[202:203], v[106:107], v[20:21], v[202:203] op_sel:[0,1,0] op_sel_hi:[1,1,1]
  v_cvt_pk_bf16_f32 v212, v188, v189
  v_cvt_pk_bf16_f32 v213, v190, v191
  v_cvt_pk_bf16_f32 v214, v192, v193
  v_cvt_pk_bf16_f32 v215, v194, v195
  v_cvt_pk_bf16_f32 v216, v196, v197
  v_cvt_pk_bf16_f32 v217, v198, v199
  v_cvt_pk_bf16_f32 v218, v200, v201
  v_cvt_pk_bf16_f32 v219, v202, v203
  v_xor_b32 v39, 0, v37
  v_add_u32 v39, v39, v38
  ds_write_b64 v39, v[204:205] offset:0
  ds_write_b64 v39, v[212:213] offset:2048
  v_xor_b32 v39, 32, v37
  v_add_u32 v39, v39, v38
  ds_write_b64 v39, v[206:207] offset:0
  ds_write_b64 v39, v[214:215] offset:2048
  v_xor_b32 v39, 64, v37
  v_add_u32 v39, v39, v38
  ds_write_b64 v39, v[208:209] offset:0
  ds_write_b64 v39, v[216:217] offset:2048
  v_xor_b32 v39, 96, v37
  v_add_u32 v39, v39, v38
  ds_write_b64 v39, v[210:211] offset:0
  ds_write_b64 v39, v[218:219] offset:2048
  v_add_u32 v39, s30, v2
  s_waitcnt lgkmcnt(0)
  ds_read_b128 v[172:175], v39 offset:0
  ds_read_b128 v[176:179], v39 offset:1024
  ds_read_b128 v[180:183], v39 offset:2048
  ds_read_b128 v[184:187], v39 offset:3072
  s_lshl_b32 s30, s32, 4
  v_lshrrev_b32 v37, 3, v1
  v_add_u32 v38, s30, v37
  v_lshlrev_b32 v38, 11, v38
  s_lshl_b32 s29, s35, 7
  v_add_u32 v38, s29, v38
  v_and_b32 v39, 7, v1
  v_xor_b32 v39, v39, v4
  v_xor_b32 v40, 4, v39
  v_lshl_add_u32 v39, v39, 4, v38
  v_lshl_add_u32 v40, v40, 4, v38
  s_mov_b32 s29, 0
  s_waitcnt lgkmcnt(3)
  buffer_store_dwordx4 v[172:175], v39, s[12:15], s29 offen sc1
  s_mov_b32 s29, 16384
  s_waitcnt lgkmcnt(2)
  buffer_store_dwordx4 v[176:179], v40, s[12:15], s29 offen sc1
  s_mov_b32 s29, 32768
  s_waitcnt lgkmcnt(1)
  buffer_store_dwordx4 v[180:183], v39, s[12:15], s29 offen sc1
  s_mov_b32 s29, 49152
  s_waitcnt lgkmcnt(0)
  buffer_store_dwordx4 v[184:187], v40, s[12:15], s29 offen sc1
L_end:
  s_endpgm
L_p1d_spin:
  s_mov_b32 s26, 400000
L_p1d_spin2:
  s_sleep 2
  buffer_load_dword v182, v25, s[20:23], 0 offen sc1
  s_waitcnt vmcnt(0)
  v_cmp_eq_u32 vcc, 0, v182
  s_sub_u32 s26, s26, 1
  s_cbranch_scc1 L_p1d_back
  s_cmp_lg_u64 vcc, 0
  s_cbranch_scc1 L_p1d_spin2
  s_branch L_p1d_back
L_p1f_spin:
  s_mov_b32 s26, 400000
L_p1f_spin2:
  s_sleep 2
  buffer_load_dword v182, v25, s[8:11], 0 offen sc1
  s_waitcnt vmcnt(0)
  v_cmp_eq_u32 vcc, 0, v182
  s_sub_u32 s26, s26, 1
  s_cbranch_scc1 L_p1f_back
  s_cmp_lg_u64 vcc, 0
  s_cbranch_scc1 L_p1f_spin2
  s_branch L_p1f_back
L_p2f_spin:
  s_mov_b32 s26, 400000
L_p2f_spin2:
  s_sleep 2
  buffer_load_dword v157, v156, s[8:11], 0 offen sc1
  s_waitcnt vmcnt(0)
  v_cmp_eq_u32 vcc, 0, v157
  s_sub_u32 s26, s26, 1
  s_cbranch_scc1 L_p2f_back
  s_cmp_lg_u64 vcc, 0
  s_cbranch_scc1 L_p2f_spin2
  s_branch L_p2f_back
L_p2_slow:
  v_mov_b32 v10, 0xff800000
  v_mov_b32 v92, 0
  v_mov_b32 v52, 0
  v_mov_b32 v53, 0
  v_mov_b32 v54, 0
  v_mov_b32 v55, 0
  v_mov_b32 v56, 0
  v_mov_b32 v57, 0
  v_mov_b32 v58, 0
  v_mov_b32 v59, 0
  v_mov_b32 v60, 0
  v_mov_b32 v61, 0
  v_mov_b32 v62, 0
  v_mov_b32 v63, 0
  v_mov_b32 v64, 0
  v_mov_b32 v65, 0
  v_mov_b32 v66, 0
  v_mov_b32 v67, 0
  s_mov_b32 s37, 0
  s_mov_b32 s24, 64
L_p2_slow2:
  buffer_load_dwordx4 a[48:51], v2, s[92:95], s37 offen offset:0 sc1
  buffer_load_dwordx4 a[116:119], v2, s[84:87], s37 offen offset:0 sc1
  buffer_load_dwordx4 a[52:55], v2, s[92:95], s37 offen offset:1024 sc1
  buffer_load_dwordx4 a[120:123], v2, s[84:87], s37 offen offset:1024 sc1
  s_add_u32 s37, s37, 2048
  s_waitcnt vmcnt(0)
  v_mfma_f32_32x32x16_bf16 v[100:115], a[48:51], a[16:19], 0
  v_mfma_f32_32x32x16_bf16 v[100:115], a[52:55], a[20:23], v[100:115]
  s_nop 7
  s_nop 7
  v_max_f32 v11, v100, v101
  v_max3_f32 v11, v11, v102, v103
  v_max3_f32 v11, v11, v104, v105
  v_max3_f32 v11, v11, v106, v107
  v_max3_f32 v11, v11, v108, v109
  v_max3_f32 v11, v11, v110, v111
  v_max3_f32 v11, v11, v112, v113
  v_max3_f32 v11, v11, v114, v115
  v_mov_b32 v13, v11
  s_nop 1
  v_permlane32_swap_b32 v11, v13
  v_max3_f32 v11, v11, v13, v10
  v_sub_f32 v12, v10, v11
  v_exp_f32 v12, v12
  v_mov_b32 v10, v11
  v_sub_f32 v100, v100, v11
  v_sub_f32 v101, v101, v11
  v_sub_f32 v102, v102, v11
  v_sub_f32 v103, v103, v11
  v_sub_f32 v104, v104, v11
  v_sub_f32 v105, v105, v11
  v_sub_f32 v106, v106, v11
  v_sub_f32 v107, v107, v11
  v_sub_f32 v108, v108, v11
  v_sub_f32 v109, v109, v11
  v_sub_f32 v110, v110, v11
  v_sub_f32 v111, v111, v11
  v_sub_f32 v112, v112, v11
  v_sub_f32 v113, v113, v11
  v_sub_f32 v114, v114, v11
  v_sub_f32 v115, v115, v11
  v_exp_f32 v100, v100
  v_exp_f32 v101, v101
  v_exp_f32 v102, v102
  v_exp_f32 v103, v103
  v_exp_f32 v104, v104
  v_exp_f32 v105, v105
  v_exp_f32 v106, v106
  v_exp_f32 v107, v107
  v_exp_f32 v108, v108
  v_exp_f32 v109, v109
  v_exp_f32 v110, v110
  v_exp_f32 v111, v111
  v_exp_f32 v112, v112
  v_exp_f32 v113, v113
  v_exp_f32 v114, v114
  v_exp_f32 v115, v115
  v_mul_f32 v92, v92, v12
  v_mul_f32 v52, v52, v12
  v_mul_f32 v53, v53, v12
  v_mul_f32 v54, v54, v12
  v_mul_f32 v55, v55, v12
  v_mul_f32 v56, v56, v12
  v_mul_f32 v57, v57, v12
  v_mul_f32 v58, v58, v12
  v_mul_f32 v59, v59, v12
  v_mul_f32 v60, v60, v12
  v_mul_f32 v61, v61, v12
  v_mul_f32 v62, v62, v12
  v_mul_f32 v63, v63, v12
  v_mul_f32 v64, v64, v12
  v_mul_f32 v65, v65, v12
  v_mul_f32 v66, v66, v12
  v_mul_f32 v67, v67, v12
  v_cvt_pk_bf16_f32 v132, v100, v101
  v_cvt_pk_bf16_f32 v133, v102, v103
  v_cvt_pk_bf16_f32 v134, v104, v105
  v_cvt_pk_bf16_f32 v135, v106, v107
  v_cvt_pk_bf16_f32 v136, v108, v109
  v_cvt_pk_bf16_f32 v137, v110, v111
  v_cvt_pk_bf16_f32 v138, v112, v113
  v_cvt_pk_bf16_f32 v139, v114, v115
  v_lshlrev_b32 v13, 16, v132
  v_add_f32 v92, v92, v13
  v_and_b32 v13, 0xffff0000, v132
  v_add_f32 v92, v92, v13
  v_lshlrev_b32 v13, 16, v133
  v_add_f32 v92, v92, v13
  v_and_b32 v13, 0xffff0000, v133
  v_add_f32 v92, v92, v13
  v_lshlrev_b32 v13, 16, v134
  v_add_f32 v92, v92, v13
  v_and_b32 v13, 0xffff0000, v134
  v_add_f32 v92, v92, v13
  v_lshlrev_b32 v13, 16, v135
  v_add_f32 v92, v92, v13
  v_and_b32 v13, 0xffff0000, v135
  v_add_f32 v92, v92, v13
  v_lshlrev_b32 v13, 16, v136
  v_add_f32 v92, v92, v13
  v_and_b32 v13, 0xffff0000, v136
  v_add_f32 v92, v92, v13
  v_lshlrev_b32 v13, 16, v137
  v_add_f32 v92, v92, v13
  v_and_b32 v13, 0xffff0000, v137
  v_add_f32 v92, v92, v13
  v_lshlrev_b32 v13, 16, v138
  v_add_f32 v92, v92, v13
  v_and_b32 v13, 0xffff0000, v138
  v_add_f32 v92, v92, v13
  v_lshlrev_b32 v13, 16, v139
  v_add_f32 v92, v92, v13
  v_and_b32 v13, 0xffff0000, v139
  v_add_f32 v92, v92, v13
  v_mfma_f32_32x32x16_bf16 v[52:67], a[116:119], v[132:135], v[52:67]
  v_mfma_f32_32x32x16_bf16 v[52:67], a[120:123], v[136:139], v[52:67]
  s_nop 7
  s_nop 7
  s_sub_u32 s24, s24, 1
  s_cmp_lg_u32 s24, 0
  s_cbranch_scc1 L_p2_slow2
  v_mov_b32 v13, v92
  s_nop 1
  v_permlane32_swap_b32 v92, v13
  v_add_f32 v92, v92, v13
  v_mov_b32 v10, 0xff800000
  v_mov_b32 v96, 0
  v_mov_b32 v68, 0
  v_mov_b32 v69, 0
  v_mov_b32 v70, 0
  v_mov_b32 v71, 0
  v_mov_b32 v72, 0
  v_mov_b32 v73, 0
  v_mov_b32 v74, 0
  v_mov_b32 v75, 0
  v_mov_b32 v76, 0
  v_mov_b32 v77, 0
  v_mov_b32 v78, 0
  v_mov_b32 v79, 0
  v_mov_b32 v80, 0
  v_mov_b32 v81, 0
  v_mov_b32 v82, 0
  v_mov_b32 v83, 0
  s_mov_b32 s37, 0
  s_mov_b32 s24, 64
L_p2_slow3:
  buffer_load_dwordx4 a[48:51], v2, s[92:95], s37 offen offset:0 sc1
  buffer_load_dwordx4 a[116:119], v2, s[84:87], s37 offen offset:0 sc1
  buffer_load_dwordx4 a[52:55], v2, s[92:95], s37 offen offset:1024 sc1
  buffer_load_dwordx4 a[120:123], v2, s[84:87], s37 offen offset:1024 sc1
  s_add_u32 s37, s37, 2048
  s_waitcnt vmcnt(0)
  v_mfma_f32_32x32x16_bf16 v[100:115], a[48:51], a[24:27], 0
  v_mfma_f32_32x32x16_bf16 v[100:115], a[52:55], a[28:31], v[100:115]
  s_nop 7
  s_nop 7
  v_max_f32 v11, v100, v101
  v_max3_f32 v11, v11, v102, v103
  v_max3_f32 v11, v11, v104, v105
  v_max3_f32 v11, v11, v106, v107
  v_max3_f32 v11, v11, v108, v109
  v_max3_f32 v11, v11, v110, v111
  v_max3_f32 v11, v11, v112, v113
  v_max3_f32 v11, v11, v114, v115
  v_mov_b32 v13, v11
  s_nop 1
  v_permlane32_swap_b32 v11, v13
  v_max3_f32 v11, v11, v13, v10
  v_sub_f32 v12, v10, v11
  v_exp_f32 v12, v12
  v_mov_b32 v10, v11
  v_sub_f32 v100, v100, v11
  v_sub_f32 v101, v101, v11
  v_sub_f32 v102, v102, v11
  v_sub_f32 v103, v103, v11
  v_sub_f32 v104, v104, v11
  v_sub_f32 v105, v105, v11
  v_sub_f32 v106, v106, v11
  v_sub_f32 v107, v107, v11
  v_sub_f32 v108, v108, v11
  v_sub_f32 v109, v109, v11
  v_sub_f32 v110, v110, v11
  v_sub_f32 v111, v111, v11
  v_sub_f32 v112, v112, v11
  v_sub_f32 v113, v113, v11
  v_sub_f32 v114, v114, v11
  v_sub_f32 v115, v115, v11
  v_exp_f32 v100, v100
  v_exp_f32 v101, v101
  v_exp_f32 v102, v102
  v_exp_f32 v103, v103
  v_exp_f32 v104, v104
  v_exp_f32 v105, v105
  v_exp_f32 v106, v106
  v_exp_f32 v107, v107
  v_exp_f32 v108, v108
  v_exp_f32 v109, v109
  v_exp_f32 v110, v110
  v_exp_f32 v111, v111
  v_exp_f32 v112, v112
  v_exp_f32 v113, v113
  v_exp_f32 v114, v114
  v_exp_f32 v115, v115
  v_mul_f32 v96, v96, v12
  v_mul_f32 v68, v68, v12
  v_mul_f32 v69, v69, v12
  v_mul_f32 v70, v70, v12
  v_mul_f32 v71, v71, v12
  v_mul_f32 v72, v72, v12
  v_mul_f32 v73, v73, v12
  v_mul_f32 v74, v74, v12
  v_mul_f32 v75, v75, v12
  v_mul_f32 v76, v76, v12
  v_mul_f32 v77, v77, v12
  v_mul_f32 v78, v78, v12
  v_mul_f32 v79, v79, v12
  v_mul_f32 v80, v80, v12
  v_mul_f32 v81, v81, v12
  v_mul_f32 v82, v82, v12
  v_mul_f32 v83, v83, v12
  v_cvt_pk_bf16_f32 v132, v100, v101
  v_cvt_pk_bf16_f32 v133, v102, v103
  v_cvt_pk_bf16_f32 v134, v104, v105
  v_cvt_pk_bf16_f32 v135, v106, v107
  v_cvt_pk_bf16_f32 v136, v108, v109
  v_cvt_pk_bf16_f32 v137, v110, v111
  v_cvt_pk_bf16_f32 v138, v112, v113
  v_cvt_pk_bf16_f32 v139, v114, v115
  v_lshlrev_b32 v13, 16, v132
  v_add_f32 v96, v96, v13
  v_and_b32 v13, 0xffff0000, v132
  v_add_f32 v96, v96, v13
  v_lshlrev_b32 v13, 16, v133
  v_add_f32 v96, v96, v13
  v_and_b32 v13, 0xffff0000, v133
  v_add_f32 v96, v96, v13
  v_lshlrev_b32 v13, 16, v134
  v_add_f32 v96, v96, v13
  v_and_b32 v13, 0xffff0000, v134
  v_add_f32 v96, v96, v13
  v_lshlrev_b32 v13, 16, v135
  v_add_f32 v96, v96, v13
  v_and_b32 v13, 0xffff0000, v135
  v_add_f32 v96, v96, v13
  v_lshlrev_b32 v13, 16, v136
  v_add_f32 v96, v96, v13
  v_and_b32 v13, 0xffff0000, v136
  v_add_f32 v96, v96, v13
  v_lshlrev_b32 v13, 16, v137
  v_add_f32 v96, v96, v13
  v_and_b32 v13, 0xffff0000, v137
  v_add_f32 v96, v96, v13
  v_lshlrev_b32 v13, 16, v138
  v_add_f32 v96, v96, v13
  v_and_b32 v13, 0xffff0000, v138
  v_add_f32 v96, v96, v13
  v_lshlrev_b32 v13, 16, v139
  v_add_f32 v96, v96, v13
  v_and_b32 v13, 0xffff0000, v139
  v_add_f32 v96, v96, v13
  v_mfma_f32_32x32x16_bf16 v[68:83], a[116:119], v[132:135], v[68:83]
  v_mfma_f32_32x32x16_bf16 v[68:83], a[120:123], v[136:139], v[68:83]
  s_nop 7
  s_nop 7
  s_sub_u32 s24, s24, 1
  s_cmp_lg_u32 s24, 0
  s_cbranch_scc1 L_p2_slow3
  v_mov_b32 v13, v96
  s_nop 1
  v_permlane32_swap_b32 v96, v13
  v_add_f32 v96, v96, v13
  s_branch L_p2_fin
L_p5x_spin:
  s_mov_b32 s26, 400000
  v_lshlrev_b32 v34, 4, v1
L_p5x_spin2:
  s_sleep 2
  s_xor_b32 s27, s2, 0
  s_lshl_b32 s27, s27, 14
  s_lshl_b32 s28, s5, 12
  s_add_u32 s27, s27, s28
  s_add_u32 s27, s27, 41943040
  buffer_load_dwordx4 v[60:63], v2, s[8:11], s27 offen offset:0 sc1
  buffer_load_dwordx4 v[68:71], v2, s[8:11], s27 offen offset:1024 sc1
  buffer_load_dwordx4 v[92:95], v2, s[8:11], s27 offen offset:2048 sc1
  buffer_load_dwordx4 v[100:103], v2, s[8:11], s27 offen offset:3072 sc1
  s_waitcnt vmcnt(0)
  v_max3_u32 v35, v60, v61, v62
  v_max3_u32 v36, v92, v93, v94
  v_max3_u32 v35, v35, v63, v68
  v_max3_u32 v36, v36, v95, v100
  v_max3_u32 v35, v35, v69, v70
  v_max3_u32 v36, v36, v101, v102
  v_max3_u32 v35, v35, v71, v103
  v_max_u32 v35, v35, v36
  v_cmp_eq_u32 vcc, -1, v35
  s_nop 1
  s_cmp_lg_u64 vcc, 0
  s_cbranch_scc0 L_p5x_back
  s_sub_u32 s26, s26, 1
  s_cbranch_scc0 L_p5x_spin2
  s_branch L_p5x_back

.section .rodata,"a"
.p2align 6
.amdhsa_kernel sequential_preLN__mha_block__glu_gated_reglu__prompt_kernel
  .amdhsa_next_free_vgpr 512
  .amdhsa_next_free_sgpr 102
  .amdhsa_accum_offset 256
  .amdhsa_group_segment_fixed_size 0
  .amdhsa_kernarg_size 80
  .amdhsa_user_sgpr_count 2
  .amdhsa_user_sgpr_kernarg_segment_ptr 1
  .amdhsa_system_sgpr_workgroup_id_x 1
.end_amdhsa_kernel
```
